```python
import torch

def _softmax(x, axis=-1):
    return torch.softmax(x, dim=axis)
def _gelu(x):
    return torch.nn.functional.gelu(x, approximate="tanh")
def _silu(x):
    return torch.nn.functional.silu(x)
def _sigmoid(x):
    return torch.sigmoid(x)
def _layernorm(x, axis=-1, eps=1e-5):
    m = x.mean(dim=axis, keepdim=True)
    v = x.var(dim=axis, keepdim=True, unbiased=False)
    return (x - m) / torch.sqrt(v + eps)
def _scatter_add(tgt, idx, src, axis=0):
    return tgt.clone().index_add_(axis, idx, src)
def _segment_sum(src, seg, n):
    out = torch.zeros((n,) + src.shape[1:], dtype=src.dtype)
    return out.index_add_(0, seg, src)
def _pad(x, pw):
    flat = tuple(v for pair in reversed(pw) for v in pair)
    return torch.nn.functional.pad(x, flat)

kernel_name = 'recurrent_scan__mha_block_cached__glu_gated_glu__prompt'

def setup_inputs():

    _w = (lambda a: (lambda t: t.to(torch.bfloat16) if t.is_floating_point() else t)(torch.as_tensor(a)))
    def _A_setup():
        B, Sq, D = 1, 2048, 576
        H, Sk, Dh = 32, 2048, 128
        return {
            "x": _w((lambda *s: torch.randn(*s, dtype=torch.bfloat16) * 0.05)(B, Sq, D)),
            "k_cache": _w((lambda *s: torch.randn(*s, dtype=torch.bfloat16) * 0.8)(B, H, Sk, Dh)),
            "v_cache": _w((lambda *s: torch.randn(*s, dtype=torch.bfloat16) * 0.2)(B, H, Sk, Dh)),
            "wq": _w((lambda *s: torch.randn(*s, dtype=torch.bfloat16) * 0.8)(D, H * Dh) * (D ** -0.5)),
            "wo": _w((lambda *s: torch.randn(*s, dtype=torch.bfloat16) * 0.2)(H * Dh, D) * ((H * Dh) ** -0.5)),
        }
    _A_in = _A_setup()

    def _B_setup():
        B, S, D, F = 1, 2048, 576, 4608
        return {
            "x": _w((lambda *s: torch.randn(*s, dtype=torch.bfloat16) * 0.05)(B, S, D)),
            "w_gate": _w((lambda *s: torch.randn(*s, dtype=torch.bfloat16) * 0.2)(D, F)),
            "w_up": _w((lambda *s: torch.randn(*s, dtype=torch.bfloat16) * 0.1)(D, F)),
            "w_down": _w((lambda *s: torch.randn(*s, dtype=torch.bfloat16) * 0.1)(F, D)),
        }
    _B_in = _B_setup()

    return {
        "A_x": _A_in["x"],
        "A_k_cache": _A_in["k_cache"],
        "A_v_cache": _A_in["v_cache"],
        "A_wq": _A_in["wq"],
        "A_wo": _A_in["wo"],
        "B_x": _B_in["x"],
        "B_w_gate": _B_in["w_gate"],
        "B_w_up": _B_in["w_up"],
        "B_w_down": _B_in["w_down"],
    }

def reference(A_x, A_k_cache, A_v_cache, A_wq, A_wo, B_x, B_w_gate, B_w_up, B_w_down):
    def _A_ref(x, k_cache, v_cache, wq, wo):
        B, Sq, D = x.shape
        H, Dh = 32, 128
        q = (lambda x, *d: x.permute(*d))((x @ wq).reshape(B, Sq, H, Dh), 0, 2, 1, 3)
        scores = torch.einsum("bhqd,bhkd->bhqk", q, k_cache) * (Dh ** -0.5)
        p = _softmax(scores, axis=-1)
        o = torch.einsum("bhqk,bhkd->bhqd", p, v_cache)
        return (lambda x, *d: x.permute(*d))(o, 0, 2, 1, 3).reshape(B, Sq, H * Dh) @ wo

    def _B_ref(x, w_gate, w_up, w_down):
        g = torch.einsum("bsd,df->bsf", x, w_gate)
        u = torch.einsum("bsd,df->bsf", x, w_up)
        h = _sigmoid(g) * u
        return torch.einsum("bsf,fd->bsd", h, w_down)

    x = A_x
    xn = _layernorm(x, axis=-1)
    s = _A_ref(xn, A_k_cache, A_v_cache, A_wq, A_wo)
    g = _silu(_B_ref(xn, B_w_gate, B_w_up, B_w_down))
    return x + s * g
```

```asm
; @launch kernel=ln_kernel grid=(512,1,1) block=(576,1,1) lds=768
; @launch kernel=attn_kernel grid=(256,1,1) block=(256,1,1) lds=163840
.amdgcn_target "amdgcn-amd-amdhsa--gfx950"
.text
.globl ln_kernel
.p2align 8
.type ln_kernel,@function
ln_kernel:
    s_cmp_ge_u32 s2, 256
    s_cbranch_scc1 L_ln_hop
    s_load_dwordx2 s[4:5], s[0:1], 0
    s_load_dwordx2 s[6:7], s[0:1], 88
    s_load_dwordx4 s[20:23], s[0:1], 48
    s_getpc_b64 s[26:27]
L_ln_pc:
    s_lshr_b32 s16, s2, 3
    v_lshl_add_u32 v30, v0, 5, s16
    v_lshlrev_b32 v30, 7, v30
    v_min_u32 v30, L_k2_last-L_ln_pc, v30
    v_mov_b32 v31, s27
    v_add_co_u32 v30, vcc, s26, v30
    v_and_b32 v3, 7, v0
    v_lshrrev_b32 v4, 3, v0
    v_addc_co_u32 v31, vcc, 0, v31, vcc
    global_load_dword v32, v[30:31], off
    v_mul_u32_u24 v5, 1152, v3
    v_lshl_add_u32 v5, v4, 4, v5
    s_mul_i32 s3, s2, 9216
    v_lshrrev_b32 v2, 6, v0
    v_and_b32 v1, 63, v0
    v_readfirstlane_b32 s16, v2
    s_waitcnt lgkmcnt(0)
    s_mov_b32 s8, s4
    s_and_b32 s9, s5, 0xffff
    s_mov_b32 s10, 0x240000
    s_mov_b32 s11, 0x20000
    buffer_load_dwordx4 v[8:11], v5, s[8:11], s3 offen
    s_mov_b32 s12, s6
    s_and_b32 s13, s7, 0xffff
    s_mov_b32 s14, 0x10000000
    s_mov_b32 s15, 0x20000
    s_mul_i32 s17, s2, 9
    s_add_u32 s33, s16, s17
    s_lshl_b32 s17, s2, 2
    s_add_u32 s17, s17, s16
    s_lshl_b32 s18, s16, 8
    s_add_u32 s18, s18, s2
    s_cmp_lt_u32 s16, 4
    s_cselect_b32 s16, s17, s18
    s_and_b32 s17, s16, 31
    s_lshr_b32 s16, s16, 5
    s_mul_i32 s19, s17, 36
    s_add_u32 s19, s19, s16
    s_lshl_b32 s19, s19, 10
    s_add_u32 s19, s19, 0x280000
    s_cmp_lt_u32 s16, 36
    s_cselect_b32 s19, s19, 0x40000000
    s_cmp_lt_u32 s16, 18
    s_cselect_b32 s24, s20, s22
    s_cselect_b32 s25, s21, s23
    s_cselect_b32 s18, 0, 18
    s_sub_u32 s16, s16, s18
    s_mov_b32 s28, s24
    s_and_b32 s29, s25, 0xffff
    s_mov_b32 s30, 0x510000
    s_mov_b32 s31, 0x20000
    s_mul_i32 s16, s16, 294912
    s_lshl_b32 s17, s17, 5
    s_add_u32 s16, s16, s17
    s_add_u32 s16, s16, 8192
    v_bfe_u32 v16, v1, 3, 2
    v_lshlrev_b32 v16, 3, v16
    v_lshrrev_b32 v17, 5, v1
    v_lshl_add_u32 v16, v17, 2, v16
    v_bfe_u32 v17, v1, 1, 2
    v_add_u32 v16, v16, v17
    v_mul_u32_u24 v16, 9216, v16
    v_and_b32 v17, 1, v1
    v_lshl_add_u32 v16, v17, 4, v16
    s_barrier
    buffer_load_dwordx4 v[36:39], v16, s[28:31], s16 offen
    s_lshr_b32 s16, s2, 3
    s_mul_i32 s16, s16, 9
    v_add_u32 v16, s16, v2
    v_mul_u32_u24 v16, 9216, v16
    v_and_b32 v17, 3, v1
    v_lshl_add_u32 v16, v17, 8, v16
    s_and_b32 s16, s2, 7
    s_lshl_b32 s16, s16, 10
    s_mov_b32 s28, s20
    s_and_b32 s29, s21, 0xffff
    s_mov_b32 s30, 0x510000
    s_mov_b32 s31, 0x20000
    buffer_load_dword v33, v16, s[28:31], s16 offen
    s_mov_b32 s28, s22
    s_and_b32 s29, s23, 0xffff
    s_mov_b32 s30, 0x510000
    s_mov_b32 s31, 0x20000
    buffer_load_dword v34, v16, s[28:31], s16 offen
    s_mov_b32 s28, s20
    s_and_b32 s29, s21, 0xffff
    s_mov_b32 s30, 0x510000
    s_mov_b32 s31, 0x20000
    s_add_u32 s16, s16, 2654208
    buffer_load_dword v35, v16, s[28:31], s16 offen
    s_mov_b32 s28, s22
    s_and_b32 s29, s23, 0xffff
    s_mov_b32 s30, 0x510000
    s_mov_b32 s31, 0x20000
    buffer_load_dword v33, v16, s[28:31], s16 offen
    v_mov_b32 v6, 0
    v_lshrrev_b32 v7, 4, v0
    v_min_u32 v7, 1, v7
    v_lshlrev_b32 v7, 30, v7
    v_lshl_add_u32 v7, v0, 2, v7
    s_lshl_b32 s16, s2, 6
    s_add_u32 s16, s16, 0x3400000
    buffer_store_dword v6, v7, s[12:15], s16 offen sc1
    v_mul_u32_u24 v6, 48, v3
    v_lshl_add_u32 v7, v2, 2, v6
    v_lshrrev_b32 v5, 2, v4
    v_lshlrev_b32 v5, 12, v5
    v_and_b32 v4, 3, v4
    v_lshl_add_u32 v5, v4, 8, v5
    v_lshl_add_u32 v5, v3, 4, v5
    s_lshr_b32 s16, s2, 3
    s_mul_i32 s16, s16, 73728
    s_bfe_u32 s17, s2, 0x20001
    s_lshl_b32 s17, s17, 10
    s_add_u32 s16, s16, s17
    s_and_b32 s17, s2, 1
    s_lshl_b32 s17, s17, 7
    s_add_u32 s16, s16, s17
    v_lshlrev_b32 v1, 4, v1
    s_waitcnt vmcnt(6)
    v_lshlrev_b32 v16, 16, v8
    v_and_b32 v17, 0xffff0000, v8
    v_lshlrev_b32 v18, 16, v9
    v_and_b32 v19, 0xffff0000, v9
    v_lshlrev_b32 v20, 16, v10
    v_and_b32 v21, 0xffff0000, v10
    v_lshlrev_b32 v22, 16, v11
    v_and_b32 v23, 0xffff0000, v11
    v_add_f32 v40, v16, v20
    v_add_f32 v41, v17, v21
    v_add_f32 v42, v18, v22
    v_add_f32 v43, v19, v23
    v_add_f32 v40, v40, v42
    v_add_f32 v41, v41, v43
    v_add_f32 v40, v40, v41
    s_nop 1
    v_add_f32_dpp v40, v40, v40 row_ror:8 row_mask:0xf bank_mask:0xf
    v_mov_b32 v41, v40
    s_nop 1
    v_permlane16_swap_b32 v40, v41
    v_add_f32 v40, v40, v41
    v_mov_b32 v41, v40
    s_nop 1
    v_permlane32_swap_b32 v40, v41
    v_add_f32 v40, v40, v41
    ds_write_b32 v7, v40 offset:0
    s_waitcnt lgkmcnt(0)
    s_barrier
    ds_read_b128 v[40:43], v6 offset:0
    ds_read_b128 v[44:47], v6 offset:16
    ds_read_b32 v48, v6 offset:32
    s_waitcnt lgkmcnt(1)
    v_add_f32 v40, v40, v44
    v_add_f32 v41, v41, v45
    v_add_f32 v42, v42, v46
    v_add_f32 v43, v43, v47
    v_add_f32 v40, v40, v42
    v_add_f32 v41, v41, v43
    s_waitcnt lgkmcnt(0)
    v_add_f32 v40, v40, v48
    v_add_f32 v40, v40, v41
    v_mul_f32 v24, 0x3ae38e39, v40
    v_sub_f32 v48, v16, v24
    v_sub_f32 v49, v17, v24
    v_sub_f32 v50, v18, v24
    v_sub_f32 v51, v19, v24
    v_sub_f32 v52, v20, v24
    v_sub_f32 v53, v21, v24
    v_sub_f32 v54, v22, v24
    v_sub_f32 v55, v23, v24
    v_mul_f32 v40, v48, v48
    v_mul_f32 v41, v49, v49
    v_fmac_f32 v40, v50, v50
    v_fmac_f32 v41, v51, v51
    v_fmac_f32 v40, v52, v52
    v_fmac_f32 v41, v53, v53
    v_fmac_f32 v40, v54, v54
    v_fmac_f32 v41, v55, v55
    v_add_f32 v40, v40, v41
    v_cvt_pk_bf16_f32 v24, v24, v24
    v_lshlrev_b32 v24, 16, v24
    v_sub_f32 v16, v16, v24
    v_sub_f32 v17, v17, v24
    v_sub_f32 v18, v18, v24
    v_sub_f32 v19, v19, v24
    v_sub_f32 v20, v20, v24
    v_sub_f32 v21, v21, v24
    v_sub_f32 v22, v22, v24
    v_sub_f32 v23, v23, v24
    v_cvt_pk_bf16_f32 v8, v16, v17
    v_cvt_pk_bf16_f32 v9, v18, v19
    v_cvt_pk_bf16_f32 v10, v20, v21
    v_cvt_pk_bf16_f32 v11, v22, v23
    s_nop 1
    v_add_f32_dpp v40, v40, v40 row_ror:8 row_mask:0xf bank_mask:0xf
    v_mov_b32 v41, v40
    s_nop 1
    v_permlane16_swap_b32 v40, v41
    v_add_f32 v40, v40, v41
    v_mov_b32 v41, v40
    s_nop 1
    v_permlane32_swap_b32 v40, v41
    v_add_f32 v40, v40, v41
    ds_write_b32 v7, v40 offset:384
    s_waitcnt lgkmcnt(0)
    s_barrier
    ds_read_b128 v[40:43], v6 offset:384
    ds_read_b128 v[44:47], v6 offset:400
    ds_read_b32 v48, v6 offset:416
    s_waitcnt lgkmcnt(1)
    v_add_f32 v40, v40, v44
    v_add_f32 v41, v41, v45
    v_add_f32 v42, v42, v46
    v_add_f32 v43, v43, v47
    v_add_f32 v40, v40, v42
    v_add_f32 v41, v41, v43
    s_waitcnt lgkmcnt(0)
    v_add_f32 v40, v40, v48
    v_add_f32 v40, v40, v41
    v_mul_f32 v25, 0x3ae38e39, v40
    v_cvt_pk_bf16_f32 v25, v25, v25
    v_lshlrev_b32 v25, 16, v25
    v_add_f32 v25, 0x3727c5ac, v25
    v_cvt_pk_bf16_f32 v25, v25, v25
    v_lshlrev_b32 v25, 16, v25
    v_sqrt_f32 v25, v25
    v_lshlrev_b32 v16, 16, v8
    v_and_b32 v17, 0xffff0000, v8
    v_lshlrev_b32 v18, 16, v9
    v_and_b32 v19, 0xffff0000, v9
    v_lshlrev_b32 v20, 16, v10
    v_and_b32 v21, 0xffff0000, v10
    v_lshlrev_b32 v22, 16, v11
    v_and_b32 v23, 0xffff0000, v11
    v_cvt_pk_bf16_f32 v25, v25, v25
    v_lshlrev_b32 v25, 16, v25
    v_rcp_f32 v25, v25
    s_nop 0
    v_mul_f32 v25, 0x3d800000, v25
    v_mul_f32 v16, v16, v25
    v_mul_f32 v17, v17, v25
    v_mul_f32 v18, v18, v25
    v_mul_f32 v19, v19, v25
    v_mul_f32 v20, v20, v25
    v_mul_f32 v21, v21, v25
    v_mul_f32 v22, v22, v25
    v_mul_f32 v23, v23, v25
    v_cvt_pk_bf16_f32 v8, v16, v17
    v_cvt_pk_bf16_f32 v9, v18, v19
    v_cvt_pk_bf16_f32 v10, v20, v21
    v_cvt_pk_bf16_f32 v11, v22, v23
    buffer_store_dwordx4 v[8:11], v5, s[12:15], s16 offen sc1
    s_waitcnt vmcnt(6)
    buffer_store_dwordx4 v[36:39], v1, s[12:15], s19 offen sc1
L_ln_end:
    s_endpgm
L_ln_hop:
    s_cmp_ge_u32 s2, 512
    s_cbranch_scc1 L_hop0_ret
    v_readfirstlane_b32 s3, v0
    s_mov_b64 exec, 0
    s_cmp_eq_u32 s3, 64
    s_cbranch_scc1 L_hop0_1
    s_cmp_eq_u32 s3, 128
    s_cbranch_scc1 L_hop0_2
    s_cmp_eq_u32 s3, 192
    s_cbranch_scc1 L_hop0_3
    s_cmp_eq_u32 s3, 256
    s_cbranch_scc1 L_hop0_4
    s_cmp_eq_u32 s3, 320
    s_cbranch_scc1 L_hop0_5
    s_cmp_eq_u32 s3, 384
    s_cbranch_scc1 L_hop0_6
    s_cmp_eq_u32 s3, 448
    s_cbranch_scc1 L_hop0_7
    s_cmp_eq_u32 s3, 512
    s_cbranch_scc1 L_hop0_8
    s_branch L_hop0_0
L_hop0_ret:
    s_endpgm
.globl attn_kernel
.p2align 8
.type attn_kernel,@function
attn_kernel:
    s_cmp_ge_u32 s2, 256
    s_cbranch_scc1 L_k2_end
L_k2_entry:
    s_load_dwordx2 s[60:61], s[0:1], 88
    s_load_dwordx4 s[64:67], s[0:1], 48
    s_load_dwordx2 s[68:69], s[0:1], 8
    s_load_dwordx4 s[72:75], s[0:1], 16
    s_load_dwordx2 s[70:71], s[0:1], 32
    s_load_dwordx4 s[76:79], s[0:1], 64
    s_load_dwordx2 s[80:81], s[0:1], 0
    s_branch L_k2_body
.p2align 12
L_k2_body:
L_hop0_0:
    s_cbranch_execz L_hop0_9
    v_lshrrev_b32 v15, 6, v0
    v_and_b32 v0, 63, v0
    v_readfirstlane_b32 s32, v15
    v_lshlrev_b32 v1, 4, v0
    s_and_b32 s54, s2, 7
    s_lshl_b32 s54, s54, 2
    s_bfe_u32 s55, s2, 0x20003
    s_add_u32 s33, s54, s55
    s_lshr_b32 s54, s2, 5
    s_lshl_b32 s54, s54, 2
    s_add_u32 s34, s54, s32
    s_lshl_b32 s35, s32, 10
    s_mul_i32 s40, s34, 73728
    s_lshl_b32 s37, s33, 8
    s_add_u32 s56, s33, 1
    s_and_b32 s56, s56, 3
    s_and_b32 s57, s33, 28
    s_add_u32 s56, s56, s57
    s_lshl_b32 s56, s56, 1
    s_add_u32 s56, s56, 0
    s_lshl_b32 s36, s56, 7
    s_add_u32 s56, s33, 2
    s_and_b32 s56, s56, 3
    s_and_b32 s57, s33, 28
    s_add_u32 s56, s56, s57
    s_lshl_b32 s56, s56, 1
    s_add_u32 s56, s56, 1
    s_lshl_b32 s83, s56, 7
    s_lshr_b32 s54, s2, 5
    s_lshl_b32 s54, s54, 12
    s_and_b32 s55, s2, 3
    s_bcnt1_i32_b32 s55, s55
    s_and_b32 s3, s55, 1
    s_mul_i32 s54, s54, 1
    s_add_u32 s28, s54, s35
    s_add_u32 s54, s28, 4096
    s_sub_u32 s55, s54, 36864
    s_min_u32 s29, s54, s55
    s_add_u32 s54, s28, 8192
    s_sub_u32 s55, s54, 36864
    s_min_u32 s30, s54, s55
    s_add_u32 s54, s28, 12288
    s_sub_u32 s55, s54, 36864
    s_min_u32 s31, s54, s55
    s_add_u32 s54, s28, 16384
    s_sub_u32 s55, s54, 36864
    s_min_u32 s46, s54, s55
    s_add_u32 s54, s28, 20480
    s_sub_u32 s55, s54, 36864
    s_min_u32 s47, s54, s55
    s_add_u32 s54, s28, 24576
    s_sub_u32 s55, s54, 36864
    s_min_u32 s48, s54, s55
    s_add_u32 s54, s28, 28672
    s_sub_u32 s55, s54, 36864
    s_min_u32 s82, s54, s55
    s_add_u32 s54, s28, 32768
    s_sub_u32 s55, s54, 36864
    s_min_u32 s84, s54, s55
    v_lshrrev_b32 v15, 3, v0
    v_bfe_u32 v248, v0, 4, 1
    s_and_b32 s54, s32, 1
    s_lshl_b32 s54, s54, 1
    v_or_b32 v248, s54, v248
    v_lshlrev_b32 v248, 1, v248
    v_and_b32 v249, 7, v0
    v_xor_b32 v248, v248, v249
    v_lshlrev_b32 v248, 4, v248
    v_mul_u32_u24 v9, 9216, v15
    v_add_u32 v9, v9, v248
    v_lshl_add_u32 v10, v15, 13, v248
    s_waitcnt lgkmcnt(0)
    s_mov_b32 s4, s60
    s_and_b32 s5, s61, 0xffff
    s_mov_b32 s6, 0x10000000
    s_mov_b32 s7, 0x20000
    s_mov_b32 s8, s64
    s_and_b32 s9, s65, 0xffff
    s_mov_b32 s10, 0x510000
    s_mov_b32 s11, 0x20000
    s_mov_b32 s12, s66
    s_and_b32 s13, s67, 0xffff
    s_mov_b32 s14, 0x510000
    s_mov_b32 s15, 0x20000
    s_add_u32 m0, s28, 0x9000
    s_mul_i32 s41, s28, 72
    s_add_u32 s41, s41, s36
    buffer_load_dwordx4 v9, s[8:11], s41 offen nt lds
    s_add_u32 m0, s29, 0x9000
    s_mul_i32 s41, s29, 72
    s_add_u32 s41, s41, s36
    buffer_load_dwordx4 v9, s[8:11], s41 offen nt lds
    s_add_u32 m0, s30, 0x9000
    s_mul_i32 s41, s30, 72
    s_add_u32 s41, s41, s36
    buffer_load_dwordx4 v9, s[8:11], s41 offen nt lds
    s_add_u32 m0, s31, 0x9000
    s_mul_i32 s41, s31, 72
    s_add_u32 s41, s41, s36
    buffer_load_dwordx4 v9, s[8:11], s41 offen nt lds
    s_add_u32 m0, s46, 0x9000
    s_mul_i32 s41, s46, 72
    s_add_u32 s41, s41, s36
    buffer_load_dwordx4 v9, s[8:11], s41 offen nt lds
    s_add_u32 m0, s47, 0x9000
    s_mul_i32 s41, s47, 72
    s_add_u32 s41, s41, s36
    buffer_load_dwordx4 v9, s[8:11], s41 offen nt lds
    s_add_u32 m0, s48, 0x9000
    s_mul_i32 s41, s48, 72
    s_add_u32 s41, s41, s36
    buffer_load_dwordx4 v9, s[8:11], s41 offen nt lds
    s_add_u32 m0, s82, 0x9000
    s_mul_i32 s41, s82, 72
    s_add_u32 s41, s41, s36
    buffer_load_dwordx4 v9, s[8:11], s41 offen nt lds
    s_add_u32 m0, s84, 0x9000
    s_mul_i32 s41, s84, 72
    s_add_u32 s41, s41, s36
    buffer_load_dwordx4 v9, s[8:11], s41 offen nt lds
    s_getpc_b64 s[54:55]
L_k2_pc:
    s_lshr_b32 s56, s2, 3
    s_lshl_b32 s56, s56, 2
    s_add_u32 s56, s56, s32
    s_mul_i32 s56, s56, 768
    v_min_u32 v2, 5, v0
    v_lshlrev_b32 v2, 7, v2
    v_add_u32 v2, s56, v2
    v_min_u32 v2, L_k2_last-L_k2_pc, v2
    v_mov_b32 v3, s55
    v_add_co_u32 v2, vcc, s54, v2
    s_nop 1
    v_addc_co_u32 v3, vcc, 0, v3, vcc
    global_load_dword v72, v[2:3], off
    s_lshr_b32 s56, s56, 1
    s_add_u32 s56, s56, L_k2_exit-L_k2_pc
    v_min_u32 v252, 2, v0
    v_lshlrev_b32 v252, 7, v252
    v_add_u32 v252, s56, v252
    v_min_u32 v252, L_k2_last-L_k2_pc, v252
    v_mov_b32 v253, s55
    v_add_co_u32 v252, vcc, s54, v252
    s_nop 1
    v_addc_co_u32 v253, vcc, 0, v253, vcc
    s_mov_b32 s16, s74
    s_and_b32 s17, s75, 0xffff
    s_mov_b32 s18, 0x480000
    s_mov_b32 s19, 0x20000
    s_mov_b32 s20, s68
    s_and_b32 s21, s69, 0xffff
    s_mov_b32 s22, 0x1000000
    s_mov_b32 s23, 0x20000
    s_mov_b32 s24, s72
    s_and_b32 s25, s73, 0xffff
    s_mov_b32 s26, 0x1000000
    s_add_u32 s42, s40, 0x0
    buffer_load_dwordx4 a[0:3], v1, s[4:7], s42 offen offset:0
    s_mov_b32 s27, 0x20000
    v_lshrrev_b32 v248, 4, v0
    v_bfe_u32 v249, v0, 2, 2
    v_lshl_add_u32 v15, v248, 3, v249
    v_lshlrev_b32 v15, 7, v15
    v_add_u32 v15, 36864, v15
    v_bfe_u32 v250, v0, 3, 2
    v_and_b32 v251, 3, v0
    v_xor_b32 v2, 0, v250
    v_lshl_add_u32 v2, v2, 5, v15
    v_lshl_add_u32 v2, v251, 3, v2
    v_xor_b32 v3, 1, v250
    buffer_load_dwordx4 a[4:7], v1, s[4:7], s42 offen offset:1024
    v_lshl_add_u32 v3, v3, 5, v15
    v_lshl_add_u32 v3, v251, 3, v3
    v_xor_b32 v4, 2, v250
    v_lshl_add_u32 v4, v4, 5, v15
    v_lshl_add_u32 v4, v251, 3, v4
    v_xor_b32 v5, 3, v250
    v_lshl_add_u32 v5, v5, 5, v15
    v_lshl_add_u32 v5, v251, 3, v5
    v_add_u32 v15, 4294930432, v15
    v_lshlrev_b32 v250, 1, v250
    v_or_b32 v6, 0, v251
    v_xor_b32 v6, v6, v250
    buffer_load_dwordx4 a[8:11], v1, s[4:7], s42 offen offset:2048
    v_lshl_add_u32 v6, v6, 4, v15
    v_or_b32 v7, 4, v251
    v_xor_b32 v7, v7, v250
    v_lshl_add_u32 v7, v7, 4, v15
    v_lshlrev_b32 v8, 3, v0
    v_add_u32 v8, 110592, v8
    s_mul_i32 s39, s32, 9216
    s_mul_i32 s54, s33, 36864
    s_add_u32 s54, s54, s39
    s_add_u32 s38, s54, 0x280000
    s_lshl_b32 s54, s34, 19
    s_add_u32 s43, s54, 0x400000
    buffer_load_dwordx4 a[12:15], v1, s[4:7], s42 offen offset:3072
    s_lshl_b32 s55, s33, 14
    s_add_u32 s54, s54, s55
    s_add_u32 s45, s54, 0x1800000
    s_lshr_b32 s54, s54, 3
    s_add_u32 s44, s54, 0x13e5000
    s_mov_b32 s49, 0xc1b8aa3b
    s_mov_b32 s50, 0x400293ee
    s_mov_b32 s51, 0
    s_mov_b32 s0, 0x07060302
    s_lshl_b32 s54, s33, 19
    s_add_u32 s52, s54, s35
    s_lshl_b32 s54, s32, 2
    s_add_u32 s53, s40, 0x1000
    buffer_load_dwordx4 a[16:19], v1, s[4:7], s53 offen offset:0
    v_add_u32 v15, s54, v248
    v_and_b32 v250, 15, v0
    v_xor_b32 v12, v250, v15
    v_lshlrev_b32 v12, 4, v12
    v_lshl_add_u32 v12, v248, 8, v12
    v_and_b32 v15, 7, v15
    v_lshlrev_b32 v15, 1, v15
    v_xor_b32 v13, v250, v15
    v_lshlrev_b32 v13, 4, v13
    v_lshl_add_u32 v13, v248, 8, v13
    v_or_b32 v15, 0, v248
    v_xor_b32 v15, v15, v250
    buffer_load_dwordx4 a[20:23], v1, s[4:7], s53 offen offset:1024
    v_lshlrev_b32 v15, 4, v15
    v_lshl_add_u32 v232, v250, 8, v15
    v_or_b32 v15, 4, v248
    v_xor_b32 v15, v15, v250
    v_lshlrev_b32 v15, 4, v15
    v_lshl_add_u32 v233, v250, 8, v15
    v_or_b32 v15, 8, v248
    v_xor_b32 v15, v15, v250
    v_lshlrev_b32 v15, 4, v15
    v_lshl_add_u32 v234, v250, 8, v15
    v_or_b32 v15, 12, v248
    v_xor_b32 v15, v15, v250
    buffer_load_dwordx4 a[24:27], v1, s[4:7], s53 offen offset:2048
    v_lshlrev_b32 v15, 4, v15
    v_lshl_add_u32 v235, v250, 8, v15
    v_lshrrev_b32 v249, 2, v0
    v_and_b32 v250, 7, v249
    v_lshlrev_b32 v249, 8, v249
    v_lshl_add_u32 v249, v251, 3, v249
    v_add_u32 v249, 0x10000, v249
    v_xor_b32 v15, 0, v250
    v_lshl_add_u32 v236, v15, 5, v249
    v_xor_b32 v15, 1, v250
    v_lshl_add_u32 v237, v15, 5, v249
    v_xor_b32 v15, 2, v250
    buffer_load_dwordx4 a[28:31], v1, s[4:7], s53 offen offset:3072
    v_lshl_add_u32 v238, v15, 5, v249
    v_xor_b32 v15, 3, v250
    v_lshl_add_u32 v239, v15, 5, v249
    v_xor_b32 v15, 4, v250
    v_lshl_add_u32 v240, v15, 5, v249
    v_xor_b32 v15, 5, v250
    v_lshl_add_u32 v241, v15, 5, v249
    v_xor_b32 v15, 6, v250
    v_lshl_add_u32 v242, v15, 5, v249
    v_xor_b32 v15, 7, v250
    v_lshl_add_u32 v243, v15, 5, v249
    v_mov_b32 v244, 0x3d803d80
    s_add_u32 s42, s40, 0x2000
    buffer_load_dwordx4 a[32:35], v1, s[4:7], s42 offen offset:0
    v_mov_b32 v245, 0x3d803d80
    v_mov_b32 v246, 0x3d803d80
    v_mov_b32 v247, 0x3d803d80
    s_add_u32 s88, s60, 0x2800000
    s_addc_u32 s89, s61, 0
    s_and_b32 s89, s89, 0xffff
    s_mov_b32 s90, 0x990000
    s_mov_b32 s91, 0x20000
    v_lshrrev_b32 v248, 3, v0
    v_mul_u32_u24 v248, 1152, v248
    v_and_b32 v249, 7, v0
    v_lshl_add_u32 v14, v249, 4, v248
    buffer_load_dwordx4 a[36:39], v1, s[4:7], s42 offen offset:1024
    s_lshl_b32 s54, s32, 12
    s_add_u32 s54, s54, 131072
    v_lshrrev_b32 v248, 2, v0
    v_lshlrev_b32 v248, 7, v248
    v_lshl_add_u32 v248, v251, 3, v248
    v_add_u32 v15, s54, v248
    s_lshr_b32 s54, s2, 3
    s_lshl_b32 s54, s54, 1
    s_add_u32 s54, s54, s3
    s_lshl_b32 s54, s54, 2
    s_add_u32 s54, s54, s32
    s_mul_i32 s54, s54, 73728
    buffer_load_dwordx4 a[40:43], v1, s[4:7], s42 offen offset:2048
    s_add_u32 s54, s54, 0x4000000
    s_and_b32 s55, s2, 6
    s_bfe_u32 s56, s2, 0x20001
    s_mul_i32 s56, s56, 18432
    s_add_u32 s54, s54, s56
    s_mov_b32 s56, 8
    s_lshl_b32 s56, s56, 11
    s_add_u32 s62, s54, s56
    s_add_u32 s56, s55, 2
    s_and_b32 s56, s56, 7
    s_lshl_b32 s56, s56, 11
    s_add_u32 s63, s54, s56
    buffer_load_dwordx4 a[44:47], v1, s[4:7], s42 offen offset:3072
    s_add_u32 s56, s55, 3
    s_and_b32 s56, s56, 7
    s_lshl_b32 s56, s56, 11
    s_add_u32 s64, s54, s56
    s_add_u32 s56, s55, 4
    s_and_b32 s56, s56, 7
    s_lshl_b32 s56, s56, 11
    s_add_u32 s65, s54, s56
    s_add_u32 s56, s55, 5
    s_and_b32 s56, s56, 7
    s_lshl_b32 s56, s56, 11
    s_add_u32 s66, s54, s56
    s_add_u32 s53, s40, 0x3000
    buffer_load_dwordx4 a[48:51], v1, s[4:7], s53 offen offset:0
    s_add_u32 s56, s55, 6
    s_and_b32 s56, s56, 7
    s_lshl_b32 s56, s56, 11
    s_add_u32 s67, s54, s56
    s_add_u32 s56, s55, 7
    s_and_b32 s56, s56, 7
    s_lshl_b32 s56, s56, 11
    s_add_u32 s68, s54, s56
    s_add_u32 s56, s33, 1
    s_and_b32 s56, s56, 3
    s_and_b32 s57, s33, 28
    s_add_u32 s56, s56, s57
    buffer_load_dwordx4 a[52:55], v1, s[4:7], s53 offen offset:1024
    s_lshl_b32 s56, s56, 1
    s_add_u32 s56, s56, 0
    s_lshl_b32 s56, s56, 13
    s_add_u32 s56, s56, s43
    s_add_u32 s57, s56, 4096
    s_add_u32 s58, s33, 2
    s_and_b32 s58, s58, 3
    s_and_b32 s59, s33, 28
    s_add_u32 s58, s58, s59
    s_lshl_b32 s58, s58, 1
    s_add_u32 s58, s58, 1
    s_lshl_b32 s58, s58, 13
    buffer_load_dwordx4 a[56:59], v1, s[4:7], s53 offen offset:2048
    s_add_u32 s58, s58, s43
    s_add_u32 s59, s58, 4096
    buffer_load_dwordx4 a[60:63], v1, s[4:7], s53 offen offset:3072
    s_add_u32 s42, s40, 0x4000
    buffer_load_dwordx4 a[64:67], v1, s[4:7], s42 offen offset:0
    buffer_load_dwordx4 a[68:71], v1, s[4:7], s42 offen offset:1024
    buffer_load_dwordx4 a[72:75], v1, s[4:7], s42 offen offset:2048
    buffer_load_dwordx4 a[76:79], v1, s[4:7], s42 offen offset:3072
    s_add_u32 s53, s40, 0x5000
    buffer_load_dwordx4 a[80:83], v1, s[4:7], s53 offen offset:0
    buffer_load_dwordx4 a[84:87], v1, s[4:7], s53 offen offset:1024
    buffer_load_dwordx4 a[88:91], v1, s[4:7], s53 offen offset:2048
    buffer_load_dwordx4 a[92:95], v1, s[4:7], s53 offen offset:3072
    v_mov_b32 v248, 0x3fc00000
    v_mov_b32 v249, 0x3fc00000
    v_mov_b32 v250, 0x3fc00000
    v_mov_b32 v251, 0x3fc00000
    v_mul_f32 v255, s49, v248
    s_waitcnt vmcnt(25) lgkmcnt(0)
    s_barrier
    ds_read_b64_tr_b16 v[16:17], v2 offset:0
    ds_read_b64_tr_b16 v[18:19], v2 offset:512
    ds_read_b64_tr_b16 v[20:21], v2 offset:4096
    ds_read_b64_tr_b16 v[22:23], v2 offset:4608
    ds_read_b64_tr_b16 v[24:25], v2 offset:8192
    ds_read_b64_tr_b16 v[26:27], v2 offset:8704
    s_waitcnt vmcnt(12) lgkmcnt(0)
    v_mfma_f32_16x16x32_bf16 v[72:75], v[16:19], a[0:3], v[248:251]
    ds_read_b64_tr_b16 v[28:29], v3 offset:0
    v_mfma_f32_16x16x32_bf16 v[72:75], v[20:23], a[16:19], v[72:75]
    ds_read_b64_tr_b16 v[30:31], v3 offset:512
    v_mfma_f32_16x16x32_bf16 v[72:75], v[24:27], a[32:35], v[72:75]
    ds_read_b64_tr_b16 v[32:33], v3 offset:4096
    v_mfma_f32_16x16x32_bf16 v[76:79], v[24:27], a[36:39], v[248:251]
    ds_read_b64_tr_b16 v[34:35], v3 offset:4608
    v_mfma_f32_16x16x32_bf16 v[76:79], v[20:23], a[20:23], v[76:79]
    ds_read_b64_tr_b16 v[36:37], v3 offset:8192
    v_mfma_f32_16x16x32_bf16 v[76:79], v[16:19], a[4:7], v[76:79]
    ds_read_b64_tr_b16 v[38:39], v3 offset:8704
    v_mfma_f32_16x16x32_bf16 v[80:83], v[16:19], a[8:11], v[248:251]
    s_add_u32 s42, s40, 0x6000
    buffer_load_dwordx4 a[96:99], v1, s[4:7], s42 offen offset:0
    v_mfma_f32_16x16x32_bf16 v[80:83], v[20:23], a[24:27], v[80:83]
    v_mfma_f32_16x16x32_bf16 v[80:83], v[24:27], a[40:43], v[80:83]
    buffer_load_dwordx4 a[100:103], v1, s[4:7], s42 offen offset:1024
    v_mfma_f32_16x16x32_bf16 v[84:87], v[24:27], a[44:47], v[248:251]
    v_mfma_f32_16x16x32_bf16 v[84:87], v[20:23], a[28:31], v[84:87]
    buffer_load_dwordx4 a[104:107], v1, s[4:7], s42 offen offset:2048
    v_mfma_f32_16x16x32_bf16 v[84:87], v[16:19], a[12:15], v[84:87]
    s_waitcnt lgkmcnt(0)
    v_mfma_f32_16x16x32_bf16 v[100:103], v[28:31], a[12:15], v[248:251]
    ds_read_b64_tr_b16 v[16:17], v4 offset:0
    v_mfma_f32_16x16x32_bf16 v[100:103], v[32:35], a[28:31], v[100:103]
    ds_read_b64_tr_b16 v[18:19], v4 offset:512
    v_mfma_f32_16x16x32_bf16 v[100:103], v[36:39], a[44:47], v[100:103]
    ds_read_b64_tr_b16 v[20:21], v4 offset:4096
    v_mfma_f32_16x16x32_bf16 v[96:99], v[36:39], a[40:43], v[248:251]
    ds_read_b64_tr_b16 v[22:23], v4 offset:4608
    v_mfma_f32_16x16x32_bf16 v[96:99], v[32:35], a[24:27], v[96:99]
    ds_read_b64_tr_b16 v[24:25], v4 offset:8192
    v_mfma_f32_16x16x32_bf16 v[96:99], v[28:31], a[8:11], v[96:99]
    ds_read_b64_tr_b16 v[26:27], v4 offset:8704
    v_mfma_f32_16x16x32_bf16 v[92:95], v[28:31], a[4:7], v[248:251]
    buffer_load_dwordx4 a[108:111], v1, s[4:7], s42 offen offset:3072
    v_mfma_f32_16x16x32_bf16 v[92:95], v[32:35], a[20:23], v[92:95]
    v_mfma_f32_16x16x32_bf16 v[92:95], v[36:39], a[36:39], v[92:95]
    s_add_u32 s53, s40, 0x7000
    buffer_load_dwordx4 a[112:115], v1, s[4:7], s53 offen offset:0
    v_mfma_f32_16x16x32_bf16 v[88:91], v[36:39], a[32:35], v[248:251]
    v_mfma_f32_16x16x32_bf16 v[88:91], v[32:35], a[16:19], v[88:91]
    buffer_load_dwordx4 a[116:119], v1, s[4:7], s53 offen offset:1024
    v_mfma_f32_16x16x32_bf16 v[88:91], v[28:31], a[0:3], v[88:91]
    s_waitcnt lgkmcnt(0)
    v_mfma_f32_16x16x32_bf16 v[104:107], v[16:19], a[0:3], v[248:251]
    ds_read_b64_tr_b16 v[28:29], v5 offset:0
    v_mfma_f32_16x16x32_bf16 v[104:107], v[20:23], a[16:19], v[104:107]
    ds_read_b64_tr_b16 v[30:31], v5 offset:512
    v_mfma_f32_16x16x32_bf16 v[104:107], v[24:27], a[32:35], v[104:107]
    ds_read_b64_tr_b16 v[32:33], v5 offset:4096
    v_mfma_f32_16x16x32_bf16 v[108:111], v[24:27], a[36:39], v[248:251]
    ds_read_b64_tr_b16 v[34:35], v5 offset:4608
    v_mfma_f32_16x16x32_bf16 v[108:111], v[20:23], a[20:23], v[108:111]
    ds_read_b64_tr_b16 v[36:37], v5 offset:8192
    v_mfma_f32_16x16x32_bf16 v[108:111], v[16:19], a[4:7], v[108:111]
    ds_read_b64_tr_b16 v[38:39], v5 offset:8704
    v_mfma_f32_16x16x32_bf16 v[112:115], v[16:19], a[8:11], v[248:251]
    buffer_load_dwordx4 a[120:123], v1, s[4:7], s53 offen offset:2048
    v_mfma_f32_16x16x32_bf16 v[112:115], v[20:23], a[24:27], v[112:115]
    v_mfma_f32_16x16x32_bf16 v[112:115], v[24:27], a[40:43], v[112:115]
    buffer_load_dwordx4 a[124:127], v1, s[4:7], s53 offen offset:3072
    v_mfma_f32_16x16x32_bf16 v[116:119], v[24:27], a[44:47], v[248:251]
    v_mfma_f32_16x16x32_bf16 v[116:119], v[20:23], a[28:31], v[116:119]
    s_add_u32 s42, s40, 0x8000
    buffer_load_dwordx4 a[128:131], v1, s[4:7], s42 offen offset:0
    v_mfma_f32_16x16x32_bf16 v[116:119], v[16:19], a[12:15], v[116:119]
    s_waitcnt lgkmcnt(0)
    v_mfma_f32_16x16x32_bf16 v[132:135], v[28:31], a[12:15], v[248:251]
    ds_read_b64_tr_b16 v[16:17], v5 offset:12288
    v_mfma_f32_16x16x32_bf16 v[132:135], v[32:35], a[28:31], v[132:135]
    ds_read_b64_tr_b16 v[18:19], v5 offset:12800
    v_mfma_f32_16x16x32_bf16 v[132:135], v[36:39], a[44:47], v[132:135]
    ds_read_b64_tr_b16 v[20:21], v5 offset:16384
    v_mfma_f32_16x16x32_bf16 v[128:131], v[36:39], a[40:43], v[248:251]
    ds_read_b64_tr_b16 v[22:23], v5 offset:16896
    v_mfma_f32_16x16x32_bf16 v[128:131], v[32:35], a[24:27], v[128:131]
    ds_read_b64_tr_b16 v[24:25], v5 offset:20480
    v_mfma_f32_16x16x32_bf16 v[128:131], v[28:31], a[8:11], v[128:131]
    ds_read_b64_tr_b16 v[26:27], v5 offset:20992
    v_mfma_f32_16x16x32_bf16 v[124:127], v[28:31], a[4:7], v[248:251]
    buffer_load_dwordx4 a[132:135], v1, s[4:7], s42 offen offset:1024
    v_mfma_f32_16x16x32_bf16 v[124:127], v[32:35], a[20:23], v[124:127]
    v_mfma_f32_16x16x32_bf16 v[124:127], v[36:39], a[36:39], v[124:127]
    buffer_load_dwordx4 a[136:139], v1, s[4:7], s42 offen offset:2048
    v_mfma_f32_16x16x32_bf16 v[120:123], v[36:39], a[32:35], v[248:251]
    v_mfma_f32_16x16x32_bf16 v[120:123], v[32:35], a[16:19], v[120:123]
    buffer_load_dwordx4 a[140:143], v1, s[4:7], s42 offen offset:3072
    v_mfma_f32_16x16x32_bf16 v[120:123], v[28:31], a[0:3], v[120:123]
    s_waitcnt vmcnt(12) lgkmcnt(0)
    v_mfma_f32_16x16x32_bf16 v[120:123], v[16:19], a[48:51], v[120:123]
    ds_read_b64_tr_b16 v[28:29], v4 offset:12288
    v_mfma_f32_16x16x32_bf16 v[120:123], v[20:23], a[64:67], v[120:123]
    ds_read_b64_tr_b16 v[30:31], v4 offset:12800
    v_mfma_f32_16x16x32_bf16 v[120:123], v[24:27], a[80:83], v[120:123]
    ds_read_b64_tr_b16 v[32:33], v4 offset:16384
    v_mfma_f32_16x16x32_bf16 v[124:127], v[24:27], a[84:87], v[124:127]
    ds_read_b64_tr_b16 v[34:35], v4 offset:16896
    v_mfma_f32_16x16x32_bf16 v[124:127], v[20:23], a[68:71], v[124:127]
    ds_read_b64_tr_b16 v[36:37], v4 offset:20480
    v_mfma_f32_16x16x32_bf16 v[124:127], v[16:19], a[52:55], v[124:127]
    ds_read_b64_tr_b16 v[38:39], v4 offset:20992
    v_mfma_f32_16x16x32_bf16 v[128:131], v[16:19], a[56:59], v[128:131]
    s_add_u32 m0, s28, 0x12000
    s_mul_i32 s41, s28, 72
    s_add_u32 s41, s41, s36
    buffer_load_dwordx4 v9, s[12:15], s41 offen nt lds
    v_mfma_f32_16x16x32_bf16 v[128:131], v[20:23], a[72:75], v[128:131]
    v_mfma_f32_16x16x32_bf16 v[128:131], v[24:27], a[88:91], v[128:131]
    s_add_u32 m0, s29, 0x12000
    s_mul_i32 s41, s29, 72
    s_add_u32 s41, s41, s36
    buffer_load_dwordx4 v9, s[12:15], s41 offen nt lds
    v_mfma_f32_16x16x32_bf16 v[132:135], v[24:27], a[92:95], v[132:135]
    v_mfma_f32_16x16x32_bf16 v[132:135], v[20:23], a[76:79], v[132:135]
    s_add_u32 m0, s30, 0x12000
    s_mul_i32 s41, s30, 72
    s_add_u32 s41, s41, s36
    buffer_load_dwordx4 v9, s[12:15], s41 offen nt lds
    v_mfma_f32_16x16x32_bf16 v[132:135], v[16:19], a[60:63], v[132:135]
    s_waitcnt lgkmcnt(0)
    v_mfma_f32_16x16x32_bf16 v[116:119], v[28:31], a[60:63], v[116:119]
    ds_read_b64_tr_b16 v[16:17], v3 offset:12288
    v_mfma_f32_16x16x32_bf16 v[116:119], v[32:35], a[76:79], v[116:119]
    ds_read_b64_tr_b16 v[18:19], v3 offset:12800
    v_mfma_f32_16x16x32_bf16 v[116:119], v[36:39], a[92:95], v[116:119]
    ds_read_b64_tr_b16 v[20:21], v3 offset:16384
    v_mfma_f32_16x16x32_bf16 v[112:115], v[36:39], a[88:91], v[112:115]
    ds_read_b64_tr_b16 v[22:23], v3 offset:16896
    v_mfma_f32_16x16x32_bf16 v[112:115], v[32:35], a[72:75], v[112:115]
    ds_read_b64_tr_b16 v[24:25], v3 offset:20480
    v_mfma_f32_16x16x32_bf16 v[112:115], v[28:31], a[56:59], v[112:115]
    ds_read_b64_tr_b16 v[26:27], v3 offset:20992
    v_mfma_f32_16x16x32_bf16 v[108:111], v[28:31], a[52:55], v[108:111]
    s_add_u32 m0, s31, 0x12000
    s_mul_i32 s41, s31, 72
    s_add_u32 s41, s41, s36
    buffer_load_dwordx4 v9, s[12:15], s41 offen nt lds
    v_mfma_f32_16x16x32_bf16 v[108:111], v[32:35], a[68:71], v[108:111]
    v_mfma_f32_16x16x32_bf16 v[108:111], v[36:39], a[84:87], v[108:111]
    s_add_u32 m0, s46, 0x12000
    s_mul_i32 s41, s46, 72
    s_add_u32 s41, s41, s36
    buffer_load_dwordx4 v9, s[12:15], s41 offen nt lds
    v_mfma_f32_16x16x32_bf16 v[104:107], v[36:39], a[80:83], v[104:107]
    v_mfma_f32_16x16x32_bf16 v[104:107], v[32:35], a[64:67], v[104:107]
    s_add_u32 m0, s47, 0x12000
    s_mul_i32 s41, s47, 72
    s_add_u32 s41, s41, s36
    buffer_load_dwordx4 v9, s[12:15], s41 offen nt lds
    v_mfma_f32_16x16x32_bf16 v[104:107], v[28:31], a[48:51], v[104:107]
    s_waitcnt lgkmcnt(0)
    v_mfma_f32_16x16x32_bf16 v[88:91], v[16:19], a[48:51], v[88:91]
    ds_read_b64_tr_b16 v[28:29], v2 offset:12288
    v_mfma_f32_16x16x32_bf16 v[88:91], v[20:23], a[64:67], v[88:91]
    ds_read_b64_tr_b16 v[30:31], v2 offset:12800
    v_mfma_f32_16x16x32_bf16 v[88:91], v[24:27], a[80:83], v[88:91]
    ds_read_b64_tr_b16 v[32:33], v2 offset:16384
    v_mfma_f32_16x16x32_bf16 v[92:95], v[24:27], a[84:87], v[92:95]
    ds_read_b64_tr_b16 v[34:35], v2 offset:16896
    v_mfma_f32_16x16x32_bf16 v[92:95], v[20:23], a[68:71], v[92:95]
    ds_read_b64_tr_b16 v[36:37], v2 offset:20480
    v_mfma_f32_16x16x32_bf16 v[92:95], v[16:19], a[52:55], v[92:95]
    ds_read_b64_tr_b16 v[38:39], v2 offset:20992
    v_mfma_f32_16x16x32_bf16 v[96:99], v[16:19], a[56:59], v[96:99]
    s_add_u32 m0, s48, 0x12000
    s_mul_i32 s41, s48, 72
    s_add_u32 s41, s41, s36
    buffer_load_dwordx4 v9, s[12:15], s41 offen nt lds
    v_mfma_f32_16x16x32_bf16 v[96:99], v[20:23], a[72:75], v[96:99]
    v_mfma_f32_16x16x32_bf16 v[96:99], v[24:27], a[88:91], v[96:99]
    s_add_u32 m0, s82, 0x12000
    s_mul_i32 s41, s82, 72
    s_add_u32 s41, s41, s36
    buffer_load_dwordx4 v9, s[12:15], s41 offen nt lds
    v_mfma_f32_16x16x32_bf16 v[100:103], v[24:27], a[92:95], v[100:103]
    v_mfma_f32_16x16x32_bf16 v[100:103], v[20:23], a[76:79], v[100:103]
    s_add_u32 m0, s84, 0x12000
    s_mul_i32 s41, s84, 72
    s_add_u32 s41, s41, s36
    buffer_load_dwordx4 v9, s[12:15], s41 offen nt lds
    v_mfma_f32_16x16x32_bf16 v[100:103], v[16:19], a[60:63], v[100:103]
    s_waitcnt lgkmcnt(0)
    v_mfma_f32_16x16x32_bf16 v[84:87], v[28:31], a[60:63], v[84:87]
    ds_read_b64_tr_b16 v[16:17], v2 offset:24576
    v_mfma_f32_16x16x32_bf16 v[84:87], v[32:35], a[76:79], v[84:87]
    ds_read_b64_tr_b16 v[18:19], v2 offset:25088
    v_mfma_f32_16x16x32_bf16 v[84:87], v[36:39], a[92:95], v[84:87]
    ds_read_b64_tr_b16 v[20:21], v2 offset:28672
    v_mfma_f32_16x16x32_bf16 v[80:83], v[36:39], a[88:91], v[80:83]
    ds_read_b64_tr_b16 v[22:23], v2 offset:29184
    v_mfma_f32_16x16x32_bf16 v[80:83], v[32:35], a[72:75], v[80:83]
    ds_read_b64_tr_b16 v[24:25], v2 offset:32768
    v_mfma_f32_16x16x32_bf16 v[80:83], v[28:31], a[56:59], v[80:83]
    ds_read_b64_tr_b16 v[26:27], v2 offset:33280
    v_mfma_f32_16x16x32_bf16 v[76:79], v[28:31], a[52:55], v[76:79]
    v_add_u32 v2, 0x9000, v2
    v_mfma_f32_16x16x32_bf16 v[76:79], v[32:35], a[68:71], v[76:79]
    v_mfma_f32_16x16x32_bf16 v[76:79], v[36:39], a[84:87], v[76:79]
    s_add_u32 s53, s40, 0x9000
    buffer_load_dwordx4 a[144:147], v1, s[4:7], s53 offen offset:0
    v_mfma_f32_16x16x32_bf16 v[72:75], v[36:39], a[80:83], v[72:75]
    v_mfma_f32_16x16x32_bf16 v[72:75], v[32:35], a[64:67], v[72:75]
    buffer_load_dwordx4 a[148:151], v1, s[4:7], s53 offen offset:1024
    v_mfma_f32_16x16x32_bf16 v[72:75], v[28:31], a[48:51], v[72:75]
    s_waitcnt vmcnt(11) lgkmcnt(0)
    v_mfma_f32_16x16x32_bf16 v[72:75], v[16:19], a[96:99], v[72:75]
    ds_read_b64_tr_b16 v[28:29], v3 offset:24576
    v_mfma_f32_16x16x32_bf16 v[72:75], v[20:23], a[112:115], v[72:75]
    ds_read_b64_tr_b16 v[30:31], v3 offset:25088
    v_mfma_f32_16x16x32_bf16 v[72:75], v[24:27], a[128:131], v[72:75]
    ds_read_b64_tr_b16 v[32:33], v3 offset:28672
    v_mfma_f32_16x16x32_bf16 v[76:79], v[24:27], a[132:135], v[76:79]
    ds_read_b64_tr_b16 v[34:35], v3 offset:29184
    v_mfma_f32_16x16x32_bf16 v[76:79], v[20:23], a[116:119], v[76:79]
    ds_read_b64_tr_b16 v[36:37], v3 offset:32768
    v_mfma_f32_16x16x32_bf16 v[76:79], v[16:19], a[100:103], v[76:79]
    ds_read_b64_tr_b16 v[38:39], v3 offset:33280
    v_mfma_f32_16x16x32_bf16 v[80:83], v[16:19], a[104:107], v[80:83]
    v_add_u32 v3, 0x9000, v3
    v_mfma_f32_16x16x32_bf16 v[80:83], v[20:23], a[120:123], v[80:83]
    v_mfma_f32_16x16x32_bf16 v[80:83], v[24:27], a[136:139], v[80:83]
    buffer_load_dwordx4 a[152:155], v1, s[4:7], s53 offen offset:2048
    v_mfma_f32_16x16x32_bf16 v[84:87], v[24:27], a[140:143], v[84:87]
    v_mfma_f32_16x16x32_bf16 v[84:87], v[20:23], a[124:127], v[84:87]
    buffer_load_dwordx4 a[156:159], v1, s[4:7], s53 offen offset:3072
    v_mfma_f32_16x16x32_bf16 v[84:87], v[16:19], a[108:111], v[84:87]
    s_waitcnt lgkmcnt(0)
    v_mfma_f32_16x16x32_bf16 v[100:103], v[28:31], a[108:111], v[100:103]
    ds_read_b64_tr_b16 v[16:17], v4 offset:24576
    v_mfma_f32_16x16x32_bf16 v[100:103], v[32:35], a[124:127], v[100:103]
    ds_read_b64_tr_b16 v[18:19], v4 offset:25088
    v_mfma_f32_16x16x32_bf16 v[100:103], v[36:39], a[140:143], v[100:103]
    ds_read_b64_tr_b16 v[20:21], v4 offset:28672
    v_mfma_f32_16x16x32_bf16 v[96:99], v[36:39], a[136:139], v[96:99]
    ds_read_b64_tr_b16 v[22:23], v4 offset:29184
    v_mfma_f32_16x16x32_bf16 v[96:99], v[32:35], a[120:123], v[96:99]
    ds_read_b64_tr_b16 v[24:25], v4 offset:32768
    v_mfma_f32_16x16x32_bf16 v[96:99], v[28:31], a[104:107], v[96:99]
    ds_read_b64_tr_b16 v[26:27], v4 offset:33280
    v_mfma_f32_16x16x32_bf16 v[92:95], v[28:31], a[100:103], v[92:95]
    v_add_u32 v4, 0x9000, v4
    v_mfma_f32_16x16x32_bf16 v[92:95], v[32:35], a[116:119], v[92:95]
    v_mfma_f32_16x16x32_bf16 v[92:95], v[36:39], a[132:135], v[92:95]
    v_mfma_f32_16x16x32_bf16 v[88:91], v[36:39], a[128:131], v[88:91]
    v_mfma_f32_16x16x32_bf16 v[88:91], v[32:35], a[112:115], v[88:91]
    v_mfma_f32_16x16x32_bf16 v[88:91], v[28:31], a[96:99], v[88:91]
    s_waitcnt lgkmcnt(0)
    v_mfma_f32_16x16x32_bf16 v[104:107], v[16:19], a[96:99], v[104:107]
    ds_read_b64_tr_b16 v[28:29], v5 offset:24576
    v_mfma_f32_16x16x32_bf16 v[104:107], v[20:23], a[112:115], v[104:107]
L_hop0_1:
    s_cbranch_execz L_hop0_10
    ds_read_b64_tr_b16 v[30:31], v5 offset:25088
    v_mfma_f32_16x16x32_bf16 v[104:107], v[24:27], a[128:131], v[104:107]
    ds_read_b64_tr_b16 v[32:33], v5 offset:28672
    v_mfma_f32_16x16x32_bf16 v[108:111], v[24:27], a[132:135], v[108:111]
    ds_read_b64_tr_b16 v[34:35], v5 offset:29184
    v_mfma_f32_16x16x32_bf16 v[108:111], v[20:23], a[116:119], v[108:111]
    ds_read_b64_tr_b16 v[36:37], v5 offset:32768
    v_mfma_f32_16x16x32_bf16 v[108:111], v[16:19], a[100:103], v[108:111]
    ds_read_b64_tr_b16 v[38:39], v5 offset:33280
    v_mfma_f32_16x16x32_bf16 v[112:115], v[16:19], a[104:107], v[112:115]
    v_add_u32 v5, 0x9000, v5
    v_mfma_f32_16x16x32_bf16 v[112:115], v[20:23], a[120:123], v[112:115]
    v_mfma_f32_16x16x32_bf16 v[112:115], v[24:27], a[136:139], v[112:115]
    v_mfma_f32_16x16x32_bf16 v[116:119], v[24:27], a[140:143], v[116:119]
    v_mfma_f32_16x16x32_bf16 v[116:119], v[20:23], a[124:127], v[116:119]
    v_mfma_f32_16x16x32_bf16 v[116:119], v[16:19], a[108:111], v[116:119]
    s_waitcnt vmcnt(4) lgkmcnt(0)
    s_barrier
    v_mfma_f32_16x16x32_bf16 v[132:135], v[28:31], a[108:111], v[132:135]
    ds_read_b64_tr_b16 v[16:17], v2 offset:0
    v_mfma_f32_16x16x32_bf16 v[132:135], v[32:35], a[124:127], v[132:135]
    ds_read_b64_tr_b16 v[18:19], v2 offset:512
    v_mfma_f32_16x16x32_bf16 v[132:135], v[36:39], a[140:143], v[132:135]
    ds_read_b64_tr_b16 v[20:21], v2 offset:4096
    v_mfma_f32_16x16x32_bf16 v[128:131], v[36:39], a[136:139], v[128:131]
    ds_read_b64_tr_b16 v[22:23], v2 offset:4608
    v_mfma_f32_16x16x32_bf16 v[128:131], v[32:35], a[120:123], v[128:131]
    ds_read_b64_tr_b16 v[24:25], v2 offset:8192
    v_mfma_f32_16x16x32_bf16 v[128:131], v[28:31], a[104:107], v[128:131]
    ds_read_b64_tr_b16 v[26:27], v2 offset:8704
    v_mfma_f32_16x16x32_bf16 v[124:127], v[28:31], a[100:103], v[124:127]
    v_mfma_f32_16x16x32_bf16 v[124:127], v[32:35], a[116:119], v[124:127]
    v_mfma_f32_16x16x32_bf16 v[124:127], v[36:39], a[132:135], v[124:127]
    v_mfma_f32_16x16x32_bf16 v[120:123], v[36:39], a[128:131], v[120:123]
    v_mfma_f32_16x16x32_bf16 v[120:123], v[32:35], a[112:115], v[120:123]
    v_mfma_f32_16x16x32_bf16 v[120:123], v[28:31], a[96:99], v[120:123]
    s_waitcnt lgkmcnt(0)
    v_mfma_f32_16x16x32_bf16 v[136:139], v[16:19], a[0:3], 0
    ds_read_b64_tr_b16 v[28:29], v2 offset:12288
    v_mfma_f32_16x16x32_bf16 v[136:139], v[20:23], a[16:19], v[136:139]
    ds_read_b64_tr_b16 v[30:31], v2 offset:12800
    v_mfma_f32_16x16x32_bf16 v[136:139], v[24:27], a[32:35], v[136:139]
    ds_read_b64_tr_b16 v[32:33], v2 offset:16384
    v_mfma_f32_16x16x32_bf16 v[140:143], v[24:27], a[36:39], 0
    ds_read_b64_tr_b16 v[34:35], v2 offset:16896
    v_mfma_f32_16x16x32_bf16 v[140:143], v[20:23], a[20:23], v[140:143]
    ds_read_b64_tr_b16 v[36:37], v2 offset:20480
    v_mfma_f32_16x16x32_bf16 v[140:143], v[16:19], a[4:7], v[140:143]
    ds_read_b64_tr_b16 v[38:39], v2 offset:20992
    v_mfma_f32_16x16x32_bf16 v[144:147], v[16:19], a[8:11], 0
    s_add_u32 m0, s28, 0x0
    s_mul_i32 s41, s28, 72
    s_add_u32 s41, s41, s36
    s_add_u32 s41, s41, 0x288000
    buffer_load_dwordx4 v9, s[8:11], s41 offen nt lds
    v_mfma_f32_16x16x32_bf16 v[144:147], v[20:23], a[24:27], v[144:147]
    v_mfma_f32_16x16x32_bf16 v[144:147], v[24:27], a[40:43], v[144:147]
    s_add_u32 m0, s29, 0x0
    s_mul_i32 s41, s29, 72
    s_add_u32 s41, s41, s36
    s_add_u32 s41, s41, 0x288000
    buffer_load_dwordx4 v9, s[8:11], s41 offen nt lds
    v_mfma_f32_16x16x32_bf16 v[148:151], v[24:27], a[44:47], 0
    v_mfma_f32_16x16x32_bf16 v[148:151], v[20:23], a[28:31], v[148:151]
    s_add_u32 m0, s30, 0x0
    s_mul_i32 s41, s30, 72
    s_add_u32 s41, s41, s36
    s_add_u32 s41, s41, 0x288000
    buffer_load_dwordx4 v9, s[8:11], s41 offen nt lds
    v_mfma_f32_16x16x32_bf16 v[148:151], v[16:19], a[12:15], v[148:151]
    s_waitcnt lgkmcnt(0)
    v_mfma_f32_16x16x32_bf16 v[148:151], v[28:31], a[60:63], v[148:151]
    ds_read_b64_tr_b16 v[16:17], v2 offset:24576
    v_mfma_f32_16x16x32_bf16 v[148:151], v[32:35], a[76:79], v[148:151]
    ds_read_b64_tr_b16 v[18:19], v2 offset:25088
    v_mfma_f32_16x16x32_bf16 v[148:151], v[36:39], a[92:95], v[148:151]
    ds_read_b64_tr_b16 v[20:21], v2 offset:28672
    v_mfma_f32_16x16x32_bf16 v[144:147], v[36:39], a[88:91], v[144:147]
    ds_read_b64_tr_b16 v[22:23], v2 offset:29184
    v_mfma_f32_16x16x32_bf16 v[144:147], v[32:35], a[72:75], v[144:147]
    ds_read_b64_tr_b16 v[24:25], v2 offset:32768
    v_mfma_f32_16x16x32_bf16 v[144:147], v[28:31], a[56:59], v[144:147]
    ds_read_b64_tr_b16 v[26:27], v2 offset:33280
    v_mfma_f32_16x16x32_bf16 v[140:143], v[28:31], a[52:55], v[140:143]
    v_add_u32 v2, 0xfffee000, v2
    v_mfma_f32_16x16x32_bf16 v[140:143], v[32:35], a[68:71], v[140:143]
    v_mfma_f32_16x16x32_bf16 v[140:143], v[36:39], a[84:87], v[140:143]
    s_add_u32 m0, s31, 0x0
    s_mul_i32 s41, s31, 72
    s_add_u32 s41, s41, s36
    s_add_u32 s41, s41, 0x288000
    buffer_load_dwordx4 v9, s[8:11], s41 offen nt lds
    v_mfma_f32_16x16x32_bf16 v[136:139], v[36:39], a[80:83], v[136:139]
    v_mfma_f32_16x16x32_bf16 v[136:139], v[32:35], a[64:67], v[136:139]
    s_add_u32 m0, s46, 0x0
    s_mul_i32 s41, s46, 72
    s_add_u32 s41, s41, s36
    s_add_u32 s41, s41, 0x288000
    buffer_load_dwordx4 v9, s[8:11], s41 offen nt lds
    v_mfma_f32_16x16x32_bf16 v[136:139], v[28:31], a[48:51], v[136:139]
    s_waitcnt lgkmcnt(0)
    v_mfma_f32_16x16x32_bf16 v[136:139], v[16:19], a[96:99], v[136:139]
    ds_read_b64_tr_b16 v[28:29], v3 offset:24576
    v_mfma_f32_16x16x32_bf16 v[136:139], v[20:23], a[112:115], v[136:139]
    ds_read_b64_tr_b16 v[30:31], v3 offset:25088
    v_mfma_f32_16x16x32_bf16 v[136:139], v[24:27], a[128:131], v[136:139]
    ds_read_b64_tr_b16 v[32:33], v3 offset:28672
    v_mfma_f32_16x16x32_bf16 v[140:143], v[24:27], a[132:135], v[140:143]
    ds_read_b64_tr_b16 v[34:35], v3 offset:29184
    v_mfma_f32_16x16x32_bf16 v[140:143], v[20:23], a[116:119], v[140:143]
    ds_read_b64_tr_b16 v[36:37], v3 offset:32768
    v_mfma_f32_16x16x32_bf16 v[140:143], v[16:19], a[100:103], v[140:143]
    ds_read_b64_tr_b16 v[38:39], v3 offset:33280
    v_mfma_f32_16x16x32_bf16 v[144:147], v[16:19], a[104:107], v[144:147]
    s_add_u32 m0, s47, 0x0
    s_mul_i32 s41, s47, 72
    s_add_u32 s41, s41, s36
    s_add_u32 s41, s41, 0x288000
    buffer_load_dwordx4 v9, s[8:11], s41 offen nt lds
    v_mfma_f32_16x16x32_bf16 v[144:147], v[20:23], a[120:123], v[144:147]
    v_mfma_f32_16x16x32_bf16 v[144:147], v[24:27], a[136:139], v[144:147]
    s_add_u32 m0, s48, 0x0
    s_mul_i32 s41, s48, 72
    s_add_u32 s41, s41, s36
    s_add_u32 s41, s41, 0x288000
    buffer_load_dwordx4 v9, s[8:11], s41 offen nt lds
    v_mfma_f32_16x16x32_bf16 v[148:151], v[24:27], a[140:143], v[148:151]
    v_mfma_f32_16x16x32_bf16 v[148:151], v[20:23], a[124:127], v[148:151]
    s_add_u32 m0, s82, 0x0
    s_mul_i32 s41, s82, 72
    s_add_u32 s41, s41, s36
    s_add_u32 s41, s41, 0x288000
    buffer_load_dwordx4 v9, s[8:11], s41 offen nt lds
    v_mfma_f32_16x16x32_bf16 v[148:151], v[16:19], a[108:111], v[148:151]
    s_waitcnt lgkmcnt(0)
    v_mfma_f32_16x16x32_bf16 v[164:167], v[28:31], a[108:111], 0
    ds_read_b64_tr_b16 v[16:17], v3 offset:12288
    v_mfma_f32_16x16x32_bf16 v[164:167], v[32:35], a[124:127], v[164:167]
    ds_read_b64_tr_b16 v[18:19], v3 offset:12800
    v_mfma_f32_16x16x32_bf16 v[164:167], v[36:39], a[140:143], v[164:167]
    ds_read_b64_tr_b16 v[20:21], v3 offset:16384
    v_mfma_f32_16x16x32_bf16 v[160:163], v[36:39], a[136:139], 0
    ds_read_b64_tr_b16 v[22:23], v3 offset:16896
    v_mfma_f32_16x16x32_bf16 v[160:163], v[32:35], a[120:123], v[160:163]
    ds_read_b64_tr_b16 v[24:25], v3 offset:20480
    v_mfma_f32_16x16x32_bf16 v[160:163], v[28:31], a[104:107], v[160:163]
    ds_read_b64_tr_b16 v[26:27], v3 offset:20992
    v_mfma_f32_16x16x32_bf16 v[156:159], v[28:31], a[100:103], 0
    s_add_u32 m0, s84, 0x0
    s_mul_i32 s41, s84, 72
    s_add_u32 s41, s41, s36
    s_add_u32 s41, s41, 0x288000
    buffer_load_dwordx4 v9, s[8:11], s41 offen nt lds
    v_mfma_f32_16x16x32_bf16 v[156:159], v[32:35], a[116:119], v[156:159]
    v_mfma_f32_16x16x32_bf16 v[156:159], v[36:39], a[132:135], v[156:159]
    s_add_u32 s42, s40, 0xa000
    buffer_load_dwordx4 a[160:163], v1, s[4:7], s42 offen offset:0
    v_mfma_f32_16x16x32_bf16 v[152:155], v[36:39], a[128:131], 0
    v_mfma_f32_16x16x32_bf16 v[152:155], v[32:35], a[112:115], v[152:155]
    buffer_load_dwordx4 a[164:167], v1, s[4:7], s42 offen offset:1024
    v_mfma_f32_16x16x32_bf16 v[152:155], v[28:31], a[96:99], v[152:155]
    s_waitcnt lgkmcnt(0)
    v_mfma_f32_16x16x32_bf16 v[152:155], v[16:19], a[48:51], v[152:155]
    ds_read_b64_tr_b16 v[28:29], v3 offset:0
    v_mfma_f32_16x16x32_bf16 v[152:155], v[20:23], a[64:67], v[152:155]
    ds_read_b64_tr_b16 v[30:31], v3 offset:512
    v_mfma_f32_16x16x32_bf16 v[152:155], v[24:27], a[80:83], v[152:155]
    ds_read_b64_tr_b16 v[32:33], v3 offset:4096
    v_mfma_f32_16x16x32_bf16 v[156:159], v[24:27], a[84:87], v[156:159]
    ds_read_b64_tr_b16 v[34:35], v3 offset:4608
    v_mfma_f32_16x16x32_bf16 v[156:159], v[20:23], a[68:71], v[156:159]
    ds_read_b64_tr_b16 v[36:37], v3 offset:8192
    v_mfma_f32_16x16x32_bf16 v[156:159], v[16:19], a[52:55], v[156:159]
    ds_read_b64_tr_b16 v[38:39], v3 offset:8704
    v_mfma_f32_16x16x32_bf16 v[160:163], v[16:19], a[56:59], v[160:163]
    v_add_u32 v3, 0xfffee000, v3
    v_mfma_f32_16x16x32_bf16 v[160:163], v[20:23], a[72:75], v[160:163]
    v_mfma_f32_16x16x32_bf16 v[160:163], v[24:27], a[88:91], v[160:163]
    buffer_load_dwordx4 a[168:171], v1, s[4:7], s42 offen offset:2048
    v_mfma_f32_16x16x32_bf16 v[164:167], v[24:27], a[92:95], v[164:167]
    v_mfma_f32_16x16x32_bf16 v[164:167], v[20:23], a[76:79], v[164:167]
    buffer_load_dwordx4 a[172:175], v1, s[4:7], s42 offen offset:3072
    v_mfma_f32_16x16x32_bf16 v[164:167], v[16:19], a[60:63], v[164:167]
    s_waitcnt lgkmcnt(0)
    v_mfma_f32_16x16x32_bf16 v[164:167], v[28:31], a[12:15], v[164:167]
    ds_read_b64_tr_b16 v[16:17], v4 offset:0
    v_mfma_f32_16x16x32_bf16 v[164:167], v[32:35], a[28:31], v[164:167]
    ds_read_b64_tr_b16 v[18:19], v4 offset:512
    v_mfma_f32_16x16x32_bf16 v[164:167], v[36:39], a[44:47], v[164:167]
    ds_read_b64_tr_b16 v[20:21], v4 offset:4096
    v_mfma_f32_16x16x32_bf16 v[160:163], v[36:39], a[40:43], v[160:163]
    ds_read_b64_tr_b16 v[22:23], v4 offset:4608
    v_mfma_f32_16x16x32_bf16 v[160:163], v[32:35], a[24:27], v[160:163]
    ds_read_b64_tr_b16 v[24:25], v4 offset:8192
    v_mfma_f32_16x16x32_bf16 v[160:163], v[28:31], a[8:11], v[160:163]
    ds_read_b64_tr_b16 v[26:27], v4 offset:8704
    v_mfma_f32_16x16x32_bf16 v[156:159], v[28:31], a[4:7], v[156:159]
    s_add_u32 s53, s40, 0xb000
    buffer_load_dwordx4 a[176:179], v1, s[4:7], s53 offen offset:0
    v_mfma_f32_16x16x32_bf16 v[156:159], v[32:35], a[20:23], v[156:159]
    v_mfma_f32_16x16x32_bf16 v[156:159], v[36:39], a[36:39], v[156:159]
    buffer_load_dwordx4 a[180:183], v1, s[4:7], s53 offen offset:1024
    v_mfma_f32_16x16x32_bf16 v[152:155], v[36:39], a[32:35], v[152:155]
    v_mfma_f32_16x16x32_bf16 v[152:155], v[32:35], a[16:19], v[152:155]
    buffer_load_dwordx4 a[184:187], v1, s[4:7], s53 offen offset:2048
    v_mfma_f32_16x16x32_bf16 v[152:155], v[28:31], a[0:3], v[152:155]
    s_waitcnt lgkmcnt(0)
    v_mfma_f32_16x16x32_bf16 v[168:171], v[16:19], a[0:3], 0
    ds_read_b64_tr_b16 v[28:29], v4 offset:12288
    v_mfma_f32_16x16x32_bf16 v[168:171], v[20:23], a[16:19], v[168:171]
    ds_read_b64_tr_b16 v[30:31], v4 offset:12800
    v_mfma_f32_16x16x32_bf16 v[168:171], v[24:27], a[32:35], v[168:171]
    ds_read_b64_tr_b16 v[32:33], v4 offset:16384
    v_mfma_f32_16x16x32_bf16 v[172:175], v[24:27], a[36:39], 0
    ds_read_b64_tr_b16 v[34:35], v4 offset:16896
    v_mfma_f32_16x16x32_bf16 v[172:175], v[20:23], a[20:23], v[172:175]
    ds_read_b64_tr_b16 v[36:37], v4 offset:20480
    v_mfma_f32_16x16x32_bf16 v[172:175], v[16:19], a[4:7], v[172:175]
    ds_read_b64_tr_b16 v[38:39], v4 offset:20992
    v_mfma_f32_16x16x32_bf16 v[176:179], v[16:19], a[8:11], 0
    buffer_load_dwordx4 a[188:191], v1, s[4:7], s53 offen offset:3072
    v_mfma_f32_16x16x32_bf16 v[176:179], v[20:23], a[24:27], v[176:179]
    v_mfma_f32_16x16x32_bf16 v[176:179], v[24:27], a[40:43], v[176:179]
    s_add_u32 s42, s40, 0xc000
    buffer_load_dwordx4 a[192:195], v1, s[4:7], s42 offen offset:0
    v_mfma_f32_16x16x32_bf16 v[180:183], v[24:27], a[44:47], 0
    v_mfma_f32_16x16x32_bf16 v[180:183], v[20:23], a[28:31], v[180:183]
    buffer_load_dwordx4 a[196:199], v1, s[4:7], s42 offen offset:1024
    v_mfma_f32_16x16x32_bf16 v[180:183], v[16:19], a[12:15], v[180:183]
    s_waitcnt lgkmcnt(0)
    v_mfma_f32_16x16x32_bf16 v[180:183], v[28:31], a[60:63], v[180:183]
    ds_read_b64_tr_b16 v[16:17], v4 offset:24576
    v_mfma_f32_16x16x32_bf16 v[180:183], v[32:35], a[76:79], v[180:183]
    ds_read_b64_tr_b16 v[18:19], v4 offset:25088
    v_mfma_f32_16x16x32_bf16 v[180:183], v[36:39], a[92:95], v[180:183]
    ds_read_b64_tr_b16 v[20:21], v4 offset:28672
    v_mfma_f32_16x16x32_bf16 v[176:179], v[36:39], a[88:91], v[176:179]
    ds_read_b64_tr_b16 v[22:23], v4 offset:29184
    v_mfma_f32_16x16x32_bf16 v[176:179], v[32:35], a[72:75], v[176:179]
    ds_read_b64_tr_b16 v[24:25], v4 offset:32768
    v_mfma_f32_16x16x32_bf16 v[176:179], v[28:31], a[56:59], v[176:179]
    ds_read_b64_tr_b16 v[26:27], v4 offset:33280
    v_mfma_f32_16x16x32_bf16 v[172:175], v[28:31], a[52:55], v[172:175]
    v_add_u32 v4, 0xfffee000, v4
    v_mfma_f32_16x16x32_bf16 v[172:175], v[32:35], a[68:71], v[172:175]
    v_mfma_f32_16x16x32_bf16 v[172:175], v[36:39], a[84:87], v[172:175]
    buffer_load_dwordx4 a[200:203], v1, s[4:7], s42 offen offset:2048
    v_mfma_f32_16x16x32_bf16 v[168:171], v[36:39], a[80:83], v[168:171]
    v_mfma_f32_16x16x32_bf16 v[168:171], v[32:35], a[64:67], v[168:171]
    buffer_load_dwordx4 a[204:207], v1, s[4:7], s42 offen offset:3072
    v_mfma_f32_16x16x32_bf16 v[168:171], v[28:31], a[48:51], v[168:171]
    s_waitcnt lgkmcnt(0)
    v_mfma_f32_16x16x32_bf16 v[168:171], v[16:19], a[96:99], v[168:171]
    ds_read_b64_tr_b16 v[28:29], v5 offset:24576
    v_mfma_f32_16x16x32_bf16 v[168:171], v[20:23], a[112:115], v[168:171]
    ds_read_b64_tr_b16 v[30:31], v5 offset:25088
    v_mfma_f32_16x16x32_bf16 v[168:171], v[24:27], a[128:131], v[168:171]
    ds_read_b64_tr_b16 v[32:33], v5 offset:28672
    v_mfma_f32_16x16x32_bf16 v[172:175], v[24:27], a[132:135], v[172:175]
    ds_read_b64_tr_b16 v[34:35], v5 offset:29184
    v_mfma_f32_16x16x32_bf16 v[172:175], v[20:23], a[116:119], v[172:175]
    ds_read_b64_tr_b16 v[36:37], v5 offset:32768
    v_mfma_f32_16x16x32_bf16 v[172:175], v[16:19], a[100:103], v[172:175]
    ds_read_b64_tr_b16 v[38:39], v5 offset:33280
    v_mfma_f32_16x16x32_bf16 v[176:179], v[16:19], a[104:107], v[176:179]
    s_add_u32 s53, s40, 0xd000
    buffer_load_dwordx4 a[208:211], v1, s[4:7], s53 offen offset:0
    v_mfma_f32_16x16x32_bf16 v[176:179], v[20:23], a[120:123], v[176:179]
    v_mfma_f32_16x16x32_bf16 v[176:179], v[24:27], a[136:139], v[176:179]
    buffer_load_dwordx4 a[212:215], v1, s[4:7], s53 offen offset:1024
    v_mfma_f32_16x16x32_bf16 v[180:183], v[24:27], a[140:143], v[180:183]
    v_mfma_f32_16x16x32_bf16 v[180:183], v[20:23], a[124:127], v[180:183]
    buffer_load_dwordx4 a[216:219], v1, s[4:7], s53 offen offset:2048
    v_mfma_f32_16x16x32_bf16 v[180:183], v[16:19], a[108:111], v[180:183]
    s_waitcnt lgkmcnt(0)
    v_mfma_f32_16x16x32_bf16 v[196:199], v[28:31], a[108:111], 0
    ds_read_b64_tr_b16 v[16:17], v5 offset:12288
    v_mfma_f32_16x16x32_bf16 v[196:199], v[32:35], a[124:127], v[196:199]
    ds_read_b64_tr_b16 v[18:19], v5 offset:12800
    v_mfma_f32_16x16x32_bf16 v[196:199], v[36:39], a[140:143], v[196:199]
    ds_read_b64_tr_b16 v[20:21], v5 offset:16384
    v_mfma_f32_16x16x32_bf16 v[192:195], v[36:39], a[136:139], 0
    ds_read_b64_tr_b16 v[22:23], v5 offset:16896
    v_mfma_f32_16x16x32_bf16 v[192:195], v[32:35], a[120:123], v[192:195]
    ds_read_b64_tr_b16 v[24:25], v5 offset:20480
    v_mfma_f32_16x16x32_bf16 v[192:195], v[28:31], a[104:107], v[192:195]
    ds_read_b64_tr_b16 v[26:27], v5 offset:20992
    v_mfma_f32_16x16x32_bf16 v[188:191], v[28:31], a[100:103], 0
    buffer_load_dwordx4 a[220:223], v1, s[4:7], s53 offen offset:3072
    v_mfma_f32_16x16x32_bf16 v[188:191], v[32:35], a[116:119], v[188:191]
    v_mfma_f32_16x16x32_bf16 v[188:191], v[36:39], a[132:135], v[188:191]
    s_add_u32 s42, s40, 0xe000
    buffer_load_dwordx4 a[224:227], v1, s[4:7], s42 offen offset:0
    v_mfma_f32_16x16x32_bf16 v[184:187], v[36:39], a[128:131], 0
    v_mfma_f32_16x16x32_bf16 v[184:187], v[32:35], a[112:115], v[184:187]
    buffer_load_dwordx4 a[228:231], v1, s[4:7], s42 offen offset:1024
    v_mfma_f32_16x16x32_bf16 v[184:187], v[28:31], a[96:99], v[184:187]
    s_waitcnt lgkmcnt(0)
    v_mfma_f32_16x16x32_bf16 v[184:187], v[16:19], a[48:51], v[184:187]
    ds_read_b64_tr_b16 v[28:29], v5 offset:0
    v_mfma_f32_16x16x32_bf16 v[184:187], v[20:23], a[64:67], v[184:187]
    ds_read_b64_tr_b16 v[30:31], v5 offset:512
    v_mfma_f32_16x16x32_bf16 v[184:187], v[24:27], a[80:83], v[184:187]
    ds_read_b64_tr_b16 v[32:33], v5 offset:4096
    v_mfma_f32_16x16x32_bf16 v[188:191], v[24:27], a[84:87], v[188:191]
    ds_read_b64_tr_b16 v[34:35], v5 offset:4608
    v_mfma_f32_16x16x32_bf16 v[188:191], v[20:23], a[68:71], v[188:191]
    ds_read_b64_tr_b16 v[36:37], v5 offset:8192
    v_mfma_f32_16x16x32_bf16 v[188:191], v[16:19], a[52:55], v[188:191]
    ds_read_b64_tr_b16 v[38:39], v5 offset:8704
    v_mfma_f32_16x16x32_bf16 v[192:195], v[16:19], a[56:59], v[192:195]
    v_add_u32 v5, 0xfffee000, v5
    v_mfma_f32_16x16x32_bf16 v[192:195], v[20:23], a[72:75], v[192:195]
    v_mfma_f32_16x16x32_bf16 v[192:195], v[24:27], a[88:91], v[192:195]
    buffer_load_dwordx4 a[232:235], v1, s[4:7], s42 offen offset:2048
    v_mfma_f32_16x16x32_bf16 v[196:199], v[24:27], a[92:95], v[196:199]
    v_mfma_f32_16x16x32_bf16 v[196:199], v[20:23], a[76:79], v[196:199]
    buffer_load_dwordx4 a[236:239], v1, s[4:7], s42 offen offset:3072
    v_mfma_f32_16x16x32_bf16 v[196:199], v[16:19], a[60:63], v[196:199]
    s_waitcnt vmcnt(20) lgkmcnt(0)
    s_barrier
    v_mfma_f32_16x16x32_bf16 v[196:199], v[28:31], a[12:15], v[196:199]
    ds_read_b64_tr_b16 v[16:17], v2 offset:0
    v_mfma_f32_16x16x32_bf16 v[196:199], v[32:35], a[28:31], v[196:199]
    ds_read_b64_tr_b16 v[18:19], v2 offset:512
    v_mfma_f32_16x16x32_bf16 v[196:199], v[36:39], a[44:47], v[196:199]
    ds_read_b64_tr_b16 v[20:21], v2 offset:4096
    v_mfma_f32_16x16x32_bf16 v[192:195], v[36:39], a[40:43], v[192:195]
    ds_read_b64_tr_b16 v[22:23], v2 offset:4608
    v_mfma_f32_16x16x32_bf16 v[192:195], v[32:35], a[24:27], v[192:195]
    ds_read_b64_tr_b16 v[24:25], v2 offset:8192
    v_mfma_f32_16x16x32_bf16 v[192:195], v[28:31], a[8:11], v[192:195]
    ds_read_b64_tr_b16 v[26:27], v2 offset:8704
    v_mfma_f32_16x16x32_bf16 v[188:191], v[28:31], a[4:7], v[188:191]
    v_mfma_f32_16x16x32_bf16 v[188:191], v[32:35], a[20:23], v[188:191]
    v_mfma_f32_16x16x32_bf16 v[188:191], v[36:39], a[36:39], v[188:191]
    v_mfma_f32_16x16x32_bf16 v[184:187], v[36:39], a[32:35], v[184:187]
    v_mfma_f32_16x16x32_bf16 v[184:187], v[32:35], a[16:19], v[184:187]
    v_mfma_f32_16x16x32_bf16 v[184:187], v[28:31], a[0:3], v[184:187]
    s_waitcnt vmcnt(12) lgkmcnt(0)
    v_mfma_f32_16x16x32_bf16 v[72:75], v[16:19], a[144:147], v[72:75]
    ds_read_b64_tr_b16 v[28:29], v3 offset:0
    v_mfma_f32_16x16x32_bf16 v[72:75], v[20:23], a[160:163], v[72:75]
    ds_read_b64_tr_b16 v[30:31], v3 offset:512
    v_mfma_f32_16x16x32_bf16 v[72:75], v[24:27], a[176:179], v[72:75]
    ds_read_b64_tr_b16 v[32:33], v3 offset:4096
    v_mfma_f32_16x16x32_bf16 v[76:79], v[24:27], a[180:183], v[76:79]
    ds_read_b64_tr_b16 v[34:35], v3 offset:4608
    v_mfma_f32_16x16x32_bf16 v[76:79], v[20:23], a[164:167], v[76:79]
    ds_read_b64_tr_b16 v[36:37], v3 offset:8192
    v_mfma_f32_16x16x32_bf16 v[76:79], v[16:19], a[148:151], v[76:79]
    ds_read_b64_tr_b16 v[38:39], v3 offset:8704
    v_mfma_f32_16x16x32_bf16 v[80:83], v[16:19], a[152:155], v[80:83]
    s_add_u32 s53, s40, 0xf000
    buffer_load_dwordx4 a[240:243], v1, s[4:7], s53 offen offset:0
    v_mfma_f32_16x16x32_bf16 v[80:83], v[20:23], a[168:171], v[80:83]
    v_mfma_f32_16x16x32_bf16 v[80:83], v[24:27], a[184:187], v[80:83]
    buffer_load_dwordx4 a[244:247], v1, s[4:7], s53 offen offset:1024
    v_mfma_f32_16x16x32_bf16 v[84:87], v[24:27], a[188:191], v[84:87]
    v_mfma_f32_16x16x32_bf16 v[84:87], v[20:23], a[172:175], v[84:87]
    buffer_load_dwordx4 a[248:251], v1, s[4:7], s53 offen offset:2048
    v_mfma_f32_16x16x32_bf16 v[84:87], v[16:19], a[156:159], v[84:87]
    s_waitcnt lgkmcnt(0)
    v_mfma_f32_16x16x32_bf16 v[100:103], v[28:31], a[156:159], v[100:103]
    ds_read_b64_tr_b16 v[16:17], v4 offset:0
    v_mfma_f32_16x16x32_bf16 v[100:103], v[32:35], a[172:175], v[100:103]
    ds_read_b64_tr_b16 v[18:19], v4 offset:512
    v_mfma_f32_16x16x32_bf16 v[100:103], v[36:39], a[188:191], v[100:103]
    ds_read_b64_tr_b16 v[20:21], v4 offset:4096
    v_mfma_f32_16x16x32_bf16 v[96:99], v[36:39], a[184:187], v[96:99]
    ds_read_b64_tr_b16 v[22:23], v4 offset:4608
    v_mfma_f32_16x16x32_bf16 v[96:99], v[32:35], a[168:171], v[96:99]
    ds_read_b64_tr_b16 v[24:25], v4 offset:8192
    v_mfma_f32_16x16x32_bf16 v[96:99], v[28:31], a[152:155], v[96:99]
    ds_read_b64_tr_b16 v[26:27], v4 offset:8704
    v_mfma_f32_16x16x32_bf16 v[92:95], v[28:31], a[148:151], v[92:95]
    buffer_load_dwordx4 a[252:255], v1, s[4:7], s53 offen offset:3072
    v_mfma_f32_16x16x32_bf16 v[92:95], v[32:35], a[164:167], v[92:95]
    v_mfma_f32_16x16x32_bf16 v[92:95], v[36:39], a[180:183], v[92:95]
    s_add_u32 s42, s40, 0x10000
    buffer_load_dwordx4 v[40:43], v1, s[4:7], s42 offen offset:0
    v_mfma_f32_16x16x32_bf16 v[88:91], v[36:39], a[176:179], v[88:91]
    v_mfma_f32_16x16x32_bf16 v[88:91], v[32:35], a[160:163], v[88:91]
    buffer_load_dwordx4 v[44:47], v1, s[4:7], s42 offen offset:1024
    v_mfma_f32_16x16x32_bf16 v[88:91], v[28:31], a[144:147], v[88:91]
    s_waitcnt lgkmcnt(0)
    v_mfma_f32_16x16x32_bf16 v[104:107], v[16:19], a[144:147], v[104:107]
    ds_read_b64_tr_b16 v[28:29], v5 offset:0
    v_mfma_f32_16x16x32_bf16 v[104:107], v[20:23], a[160:163], v[104:107]
    ds_read_b64_tr_b16 v[30:31], v5 offset:512
    v_mfma_f32_16x16x32_bf16 v[104:107], v[24:27], a[176:179], v[104:107]
    ds_read_b64_tr_b16 v[32:33], v5 offset:4096
    v_mfma_f32_16x16x32_bf16 v[108:111], v[24:27], a[180:183], v[108:111]
    ds_read_b64_tr_b16 v[34:35], v5 offset:4608
    v_mfma_f32_16x16x32_bf16 v[108:111], v[20:23], a[164:167], v[108:111]
    ds_read_b64_tr_b16 v[36:37], v5 offset:8192
    v_mfma_f32_16x16x32_bf16 v[108:111], v[16:19], a[148:151], v[108:111]
    ds_read_b64_tr_b16 v[38:39], v5 offset:8704
    v_mfma_f32_16x16x32_bf16 v[112:115], v[16:19], a[152:155], v[112:115]
    buffer_load_dwordx4 v[48:51], v1, s[4:7], s42 offen offset:2048
    v_mfma_f32_16x16x32_bf16 v[112:115], v[20:23], a[168:171], v[112:115]
    v_mfma_f32_16x16x32_bf16 v[112:115], v[24:27], a[184:187], v[112:115]
    buffer_load_dwordx4 v[52:55], v1, s[4:7], s42 offen offset:3072
    v_mfma_f32_16x16x32_bf16 v[116:119], v[24:27], a[188:191], v[116:119]
    v_mfma_f32_16x16x32_bf16 v[116:119], v[20:23], a[172:175], v[116:119]
    s_add_u32 s53, s40, 0x11000
    buffer_load_dwordx4 v[56:59], v1, s[4:7], s53 offen offset:0
    v_mfma_f32_16x16x32_bf16 v[116:119], v[16:19], a[156:159], v[116:119]
    s_waitcnt lgkmcnt(0)
    v_mfma_f32_16x16x32_bf16 v[132:135], v[28:31], a[156:159], v[132:135]
    ds_read_b64_tr_b16 v[16:17], v5 offset:12288
    v_mfma_f32_16x16x32_bf16 v[132:135], v[32:35], a[172:175], v[132:135]
    ds_read_b64_tr_b16 v[18:19], v5 offset:12800
    v_mfma_f32_16x16x32_bf16 v[132:135], v[36:39], a[188:191], v[132:135]
    ds_read_b64_tr_b16 v[20:21], v5 offset:16384
    v_mfma_f32_16x16x32_bf16 v[128:131], v[36:39], a[184:187], v[128:131]
    ds_read_b64_tr_b16 v[22:23], v5 offset:16896
    v_mfma_f32_16x16x32_bf16 v[128:131], v[32:35], a[168:171], v[128:131]
    ds_read_b64_tr_b16 v[24:25], v5 offset:20480
    v_mfma_f32_16x16x32_bf16 v[128:131], v[28:31], a[152:155], v[128:131]
    ds_read_b64_tr_b16 v[26:27], v5 offset:20992
    v_mfma_f32_16x16x32_bf16 v[124:127], v[28:31], a[148:151], v[124:127]
    buffer_load_dwordx4 v[60:63], v1, s[4:7], s53 offen offset:1024
    v_mfma_f32_16x16x32_bf16 v[124:127], v[32:35], a[164:167], v[124:127]
    v_mfma_f32_16x16x32_bf16 v[124:127], v[36:39], a[180:183], v[124:127]
    buffer_load_dwordx4 v[64:67], v1, s[4:7], s53 offen offset:2048
    v_mfma_f32_16x16x32_bf16 v[120:123], v[36:39], a[176:179], v[120:123]
    v_mfma_f32_16x16x32_bf16 v[120:123], v[32:35], a[160:163], v[120:123]
    buffer_load_dwordx4 v[68:71], v1, s[4:7], s53 offen offset:3072
    v_mfma_f32_16x16x32_bf16 v[120:123], v[28:31], a[144:147], v[120:123]
    s_waitcnt vmcnt(12) lgkmcnt(0)
    v_mfma_f32_16x16x32_bf16 v[120:123], v[16:19], a[192:195], v[120:123]
    ds_read_b64_tr_b16 v[28:29], v4 offset:12288
    v_mfma_f32_16x16x32_bf16 v[120:123], v[20:23], a[208:211], v[120:123]
    ds_read_b64_tr_b16 v[30:31], v4 offset:12800
    v_mfma_f32_16x16x32_bf16 v[120:123], v[24:27], a[224:227], v[120:123]
    ds_read_b64_tr_b16 v[32:33], v4 offset:16384
    v_mfma_f32_16x16x32_bf16 v[124:127], v[24:27], a[228:231], v[124:127]
    ds_read_b64_tr_b16 v[34:35], v4 offset:16896
    v_mfma_f32_16x16x32_bf16 v[124:127], v[20:23], a[212:215], v[124:127]
    ds_read_b64_tr_b16 v[36:37], v4 offset:20480
    v_mfma_f32_16x16x32_bf16 v[124:127], v[16:19], a[196:199], v[124:127]
    ds_read_b64_tr_b16 v[38:39], v4 offset:20992
    v_mfma_f32_16x16x32_bf16 v[128:131], v[16:19], a[200:203], v[128:131]
    s_add_u32 m0, s28, 0x9000
    s_mul_i32 s41, s28, 72
    s_add_u32 s41, s41, s36
    s_add_u32 s41, s41, 0x288000
    buffer_load_dwordx4 v9, s[12:15], s41 offen nt lds
    v_mfma_f32_16x16x32_bf16 v[128:131], v[20:23], a[216:219], v[128:131]
    v_mfma_f32_16x16x32_bf16 v[128:131], v[24:27], a[232:235], v[128:131]
    s_add_u32 m0, s29, 0x9000
    s_mul_i32 s41, s29, 72
    s_add_u32 s41, s41, s36
    s_add_u32 s41, s41, 0x288000
    buffer_load_dwordx4 v9, s[12:15], s41 offen nt lds
    v_mfma_f32_16x16x32_bf16 v[132:135], v[24:27], a[236:239], v[132:135]
    v_mfma_f32_16x16x32_bf16 v[132:135], v[20:23], a[220:223], v[132:135]
    s_add_u32 m0, s30, 0x9000
    s_mul_i32 s41, s30, 72
    s_add_u32 s41, s41, s36
    s_add_u32 s41, s41, 0x288000
    buffer_load_dwordx4 v9, s[12:15], s41 offen nt lds
    v_mfma_f32_16x16x32_bf16 v[132:135], v[16:19], a[204:207], v[132:135]
    s_waitcnt lgkmcnt(0)
    v_mfma_f32_16x16x32_bf16 v[116:119], v[28:31], a[204:207], v[116:119]
    ds_read_b64_tr_b16 v[16:17], v3 offset:12288
    v_mfma_f32_16x16x32_bf16 v[116:119], v[32:35], a[220:223], v[116:119]
    ds_read_b64_tr_b16 v[18:19], v3 offset:12800
    v_mfma_f32_16x16x32_bf16 v[116:119], v[36:39], a[236:239], v[116:119]
    ds_read_b64_tr_b16 v[20:21], v3 offset:16384
    v_mfma_f32_16x16x32_bf16 v[112:115], v[36:39], a[232:235], v[112:115]
    ds_read_b64_tr_b16 v[22:23], v3 offset:16896
    v_mfma_f32_16x16x32_bf16 v[112:115], v[32:35], a[216:219], v[112:115]
    ds_read_b64_tr_b16 v[24:25], v3 offset:20480
    v_mfma_f32_16x16x32_bf16 v[112:115], v[28:31], a[200:203], v[112:115]
    ds_read_b64_tr_b16 v[26:27], v3 offset:20992
    v_mfma_f32_16x16x32_bf16 v[108:111], v[28:31], a[196:199], v[108:111]
    s_add_u32 m0, s31, 0x9000
    s_mul_i32 s41, s31, 72
    s_add_u32 s41, s41, s36
    s_add_u32 s41, s41, 0x288000
    buffer_load_dwordx4 v9, s[12:15], s41 offen nt lds
    v_mfma_f32_16x16x32_bf16 v[108:111], v[32:35], a[212:215], v[108:111]
    v_mfma_f32_16x16x32_bf16 v[108:111], v[36:39], a[228:231], v[108:111]
    s_add_u32 m0, s46, 0x9000
    s_mul_i32 s41, s46, 72
    s_add_u32 s41, s41, s36
    s_add_u32 s41, s41, 0x288000
    buffer_load_dwordx4 v9, s[12:15], s41 offen nt lds
    v_mfma_f32_16x16x32_bf16 v[104:107], v[36:39], a[224:227], v[104:107]
    v_mfma_f32_16x16x32_bf16 v[104:107], v[32:35], a[208:211], v[104:107]
    s_add_u32 m0, s47, 0x9000
    s_mul_i32 s41, s47, 72
    s_add_u32 s41, s41, s36
    s_add_u32 s41, s41, 0x288000
    buffer_load_dwordx4 v9, s[12:15], s41 offen nt lds
    v_mfma_f32_16x16x32_bf16 v[104:107], v[28:31], a[192:195], v[104:107]
    s_waitcnt lgkmcnt(0)
    v_mfma_f32_16x16x32_bf16 v[88:91], v[16:19], a[192:195], v[88:91]
    ds_read_b64_tr_b16 v[28:29], v2 offset:12288
    v_mfma_f32_16x16x32_bf16 v[88:91], v[20:23], a[208:211], v[88:91]
    ds_read_b64_tr_b16 v[30:31], v2 offset:12800
    v_mfma_f32_16x16x32_bf16 v[88:91], v[24:27], a[224:227], v[88:91]
    ds_read_b64_tr_b16 v[32:33], v2 offset:16384
    v_mfma_f32_16x16x32_bf16 v[92:95], v[24:27], a[228:231], v[92:95]
    ds_read_b64_tr_b16 v[34:35], v2 offset:16896
    v_mfma_f32_16x16x32_bf16 v[92:95], v[20:23], a[212:215], v[92:95]
    ds_read_b64_tr_b16 v[36:37], v2 offset:20480
    v_mfma_f32_16x16x32_bf16 v[92:95], v[16:19], a[196:199], v[92:95]
    ds_read_b64_tr_b16 v[38:39], v2 offset:20992
    v_mfma_f32_16x16x32_bf16 v[96:99], v[16:19], a[200:203], v[96:99]
    s_add_u32 m0, s48, 0x9000
    s_mul_i32 s41, s48, 72
    s_add_u32 s41, s41, s36
    s_add_u32 s41, s41, 0x288000
    buffer_load_dwordx4 v9, s[12:15], s41 offen nt lds
    v_mfma_f32_16x16x32_bf16 v[96:99], v[20:23], a[216:219], v[96:99]
    v_mfma_f32_16x16x32_bf16 v[96:99], v[24:27], a[232:235], v[96:99]
    s_add_u32 m0, s82, 0x9000
    s_mul_i32 s41, s82, 72
    s_add_u32 s41, s41, s36
    s_add_u32 s41, s41, 0x288000
    buffer_load_dwordx4 v9, s[12:15], s41 offen nt lds
    v_mfma_f32_16x16x32_bf16 v[100:103], v[24:27], a[236:239], v[100:103]
    v_mfma_f32_16x16x32_bf16 v[100:103], v[20:23], a[220:223], v[100:103]
    s_add_u32 m0, s84, 0x9000
    s_mul_i32 s41, s84, 72
    s_add_u32 s41, s41, s36
    s_add_u32 s41, s41, 0x288000
    buffer_load_dwordx4 v9, s[12:15], s41 offen nt lds
    v_mfma_f32_16x16x32_bf16 v[100:103], v[16:19], a[204:207], v[100:103]
    s_waitcnt lgkmcnt(0)
    v_mfma_f32_16x16x32_bf16 v[84:87], v[28:31], a[204:207], v[84:87]
    ds_read_b64_tr_b16 v[16:17], v2 offset:24576
    v_mfma_f32_16x16x32_bf16 v[84:87], v[32:35], a[220:223], v[84:87]
    ds_read_b64_tr_b16 v[18:19], v2 offset:25088
    v_mfma_f32_16x16x32_bf16 v[84:87], v[36:39], a[236:239], v[84:87]
L_hop0_2:
    s_cbranch_execz L_hop0_11
    ds_read_b64_tr_b16 v[20:21], v2 offset:28672
    v_mfma_f32_16x16x32_bf16 v[80:83], v[36:39], a[232:235], v[80:83]
    ds_read_b64_tr_b16 v[22:23], v2 offset:29184
    v_mfma_f32_16x16x32_bf16 v[80:83], v[32:35], a[216:219], v[80:83]
    ds_read_b64_tr_b16 v[24:25], v2 offset:32768
    v_mfma_f32_16x16x32_bf16 v[80:83], v[28:31], a[200:203], v[80:83]
    ds_read_b64_tr_b16 v[26:27], v2 offset:33280
    v_mfma_f32_16x16x32_bf16 v[76:79], v[28:31], a[196:199], v[76:79]
    v_add_u32 v2, 0x9000, v2
    v_mfma_f32_16x16x32_bf16 v[76:79], v[32:35], a[212:215], v[76:79]
    v_mfma_f32_16x16x32_bf16 v[76:79], v[36:39], a[228:231], v[76:79]
    s_add_u32 m0, s28, 0x12000
    s_mul_i32 s41, s28, 72
    s_add_u32 s41, s41, s83
    buffer_load_dwordx4 v9, s[8:11], s41 offen nt lds
    v_mfma_f32_16x16x32_bf16 v[72:75], v[36:39], a[224:227], v[72:75]
    v_mfma_f32_16x16x32_bf16 v[72:75], v[32:35], a[208:211], v[72:75]
    s_add_u32 m0, s29, 0x12000
    s_mul_i32 s41, s29, 72
    s_add_u32 s41, s41, s83
    buffer_load_dwordx4 v9, s[8:11], s41 offen nt lds
    v_mfma_f32_16x16x32_bf16 v[72:75], v[28:31], a[192:195], v[72:75]
    s_waitcnt vmcnt(11) lgkmcnt(0)
    v_mfma_f32_16x16x32_bf16 v[72:75], v[16:19], a[240:243], v[72:75]
    ds_read_b64_tr_b16 v[28:29], v3 offset:24576
    v_mfma_f32_16x16x32_bf16 v[72:75], v[20:23], v[40:43], v[72:75]
    ds_read_b64_tr_b16 v[30:31], v3 offset:25088
    v_mfma_f32_16x16x32_bf16 v[72:75], v[24:27], v[56:59], v[72:75]
    ds_read_b64_tr_b16 v[32:33], v3 offset:28672
    v_mfma_f32_16x16x32_bf16 v[76:79], v[24:27], v[60:63], v[76:79]
    ds_read_b64_tr_b16 v[34:35], v3 offset:29184
    v_mfma_f32_16x16x32_bf16 v[76:79], v[20:23], v[44:47], v[76:79]
    ds_read_b64_tr_b16 v[36:37], v3 offset:32768
    v_mfma_f32_16x16x32_bf16 v[76:79], v[16:19], a[244:247], v[76:79]
    ds_read_b64_tr_b16 v[38:39], v3 offset:33280
    v_mfma_f32_16x16x32_bf16 v[80:83], v[16:19], a[248:251], v[80:83]
    v_add_u32 v3, 0x9000, v3
    v_mfma_f32_16x16x32_bf16 v[80:83], v[20:23], v[48:51], v[80:83]
    v_mfma_f32_16x16x32_bf16 v[80:83], v[24:27], v[64:67], v[80:83]
    s_add_u32 m0, s30, 0x12000
    s_mul_i32 s41, s30, 72
    s_add_u32 s41, s41, s83
    buffer_load_dwordx4 v9, s[8:11], s41 offen nt lds
    v_mfma_f32_16x16x32_bf16 v[84:87], v[24:27], v[68:71], v[84:87]
    v_fma_f32 v72, s49, v72, -v255
    v_fma_f32 v73, s49, v73, -v255
    v_mfma_f32_16x16x32_bf16 v[84:87], v[20:23], v[52:55], v[84:87]
    s_add_u32 m0, s31, 0x12000
    s_mul_i32 s41, s31, 72
    s_add_u32 s41, s41, s83
    buffer_load_dwordx4 v9, s[8:11], s41 offen nt lds
    v_mfma_f32_16x16x32_bf16 v[84:87], v[16:19], a[252:255], v[84:87]
    s_waitcnt lgkmcnt(0)
    v_fma_f32 v74, s49, v74, -v255
    v_fma_f32 v75, s49, v75, -v255
    v_mfma_f32_16x16x32_bf16 v[100:103], v[28:31], a[252:255], v[100:103]
    ds_read_b64_tr_b16 v[16:17], v4 offset:24576
    v_fma_f32 v76, s49, v76, -v255
    v_mfma_f32_16x16x32_bf16 v[100:103], v[32:35], v[52:55], v[100:103]
    ds_read_b64_tr_b16 v[18:19], v4 offset:25088
    v_fma_f32 v77, s49, v77, -v255
    v_mfma_f32_16x16x32_bf16 v[100:103], v[36:39], v[68:71], v[100:103]
    ds_read_b64_tr_b16 v[20:21], v4 offset:28672
    v_fma_f32 v78, s49, v78, -v255
    v_mfma_f32_16x16x32_bf16 v[96:99], v[36:39], v[64:67], v[96:99]
    ds_read_b64_tr_b16 v[22:23], v4 offset:29184
    v_fma_f32 v79, s49, v79, -v255
    v_mfma_f32_16x16x32_bf16 v[96:99], v[32:35], v[48:51], v[96:99]
    ds_read_b64_tr_b16 v[24:25], v4 offset:32768
    v_fma_f32 v80, s49, v80, -v255
    v_mfma_f32_16x16x32_bf16 v[96:99], v[28:31], a[248:251], v[96:99]
    ds_read_b64_tr_b16 v[26:27], v4 offset:33280
    v_fma_f32 v81, s49, v81, -v255
    v_mfma_f32_16x16x32_bf16 v[92:95], v[28:31], a[244:247], v[92:95]
    v_add_u32 v4, 0x9000, v4
    v_fma_f32 v82, s49, v82, -v255
    v_mfma_f32_16x16x32_bf16 v[92:95], v[32:35], v[44:47], v[92:95]
    v_exp_f32 v72, v72
    v_mfma_f32_16x16x32_bf16 v[92:95], v[36:39], v[60:63], v[92:95]
    s_add_u32 m0, s46, 0x12000
    s_mul_i32 s41, s46, 72
    s_add_u32 s41, s41, s83
    buffer_load_dwordx4 v9, s[8:11], s41 offen nt lds
    v_mfma_f32_16x16x32_bf16 v[88:91], v[36:39], v[56:59], v[88:91]
    v_exp_f32 v73, v73
    v_mfma_f32_16x16x32_bf16 v[88:91], v[32:35], v[40:43], v[88:91]
    s_add_u32 m0, s47, 0x12000
    s_mul_i32 s41, s47, 72
    s_add_u32 s41, s41, s83
    buffer_load_dwordx4 v9, s[8:11], s41 offen nt lds
    v_mfma_f32_16x16x32_bf16 v[88:91], v[28:31], a[240:243], v[88:91]
    s_waitcnt lgkmcnt(0)
    v_exp_f32 v74, v74
    v_mfma_f32_16x16x32_bf16 v[104:107], v[16:19], a[240:243], v[104:107]
    ds_read_b64_tr_b16 v[28:29], v5 offset:24576
    v_add_f32 v72, 1.0, v72
    v_mfma_f32_16x16x32_bf16 v[104:107], v[20:23], v[40:43], v[104:107]
    ds_read_b64_tr_b16 v[30:31], v5 offset:25088
    v_add_f32 v73, 1.0, v73
    v_mfma_f32_16x16x32_bf16 v[104:107], v[24:27], v[56:59], v[104:107]
    ds_read_b64_tr_b16 v[32:33], v5 offset:28672
    v_add_f32 v74, 1.0, v74
    v_mfma_f32_16x16x32_bf16 v[108:111], v[24:27], v[60:63], v[108:111]
    ds_read_b64_tr_b16 v[34:35], v5 offset:29184
    v_fma_f32 v83, s49, v83, -v255
    v_mfma_f32_16x16x32_bf16 v[108:111], v[20:23], v[44:47], v[108:111]
    ds_read_b64_tr_b16 v[36:37], v5 offset:32768
    v_fma_f32 v84, s49, v84, -v255
    v_mfma_f32_16x16x32_bf16 v[108:111], v[16:19], a[244:247], v[108:111]
    ds_read_b64_tr_b16 v[38:39], v5 offset:33280
    v_fma_f32 v85, s49, v85, -v255
    v_mfma_f32_16x16x32_bf16 v[112:115], v[16:19], a[248:251], v[112:115]
    v_add_u32 v5, 0x9000, v5
    v_fma_f32 v86, s49, v86, -v255
    v_mfma_f32_16x16x32_bf16 v[112:115], v[20:23], v[48:51], v[112:115]
    v_exp_f32 v75, v75
    v_mfma_f32_16x16x32_bf16 v[112:115], v[24:27], v[64:67], v[112:115]
    s_add_u32 m0, s48, 0x12000
    s_mul_i32 s41, s48, 72
    s_add_u32 s41, s41, s83
    buffer_load_dwordx4 v9, s[8:11], s41 offen nt lds
    v_mfma_f32_16x16x32_bf16 v[116:119], v[24:27], v[68:71], v[116:119]
    v_add_f32 v75, 1.0, v75
    v_fma_f32 v87, s49, v87, -v255
    v_mfma_f32_16x16x32_bf16 v[116:119], v[20:23], v[52:55], v[116:119]
    s_add_u32 m0, s82, 0x12000
    s_mul_i32 s41, s82, 72
    s_add_u32 s41, s41, s83
    buffer_load_dwordx4 v9, s[8:11], s41 offen nt lds
    v_mfma_f32_16x16x32_bf16 v[116:119], v[16:19], a[252:255], v[116:119]
    s_waitcnt vmcnt(8) lgkmcnt(0)
    s_barrier
    v_rcp_f32 v72, v72
    v_mfma_f32_16x16x32_bf16 v[132:135], v[28:31], a[252:255], v[132:135]
    ds_read_b64_tr_b16 v[16:17], v2 offset:0
    v_fma_f32 v100, s49, v100, -v255
    v_mfma_f32_16x16x32_bf16 v[132:135], v[32:35], v[52:55], v[132:135]
    ds_read_b64_tr_b16 v[18:19], v2 offset:512
    v_fma_f32 v101, s49, v101, -v255
    v_mfma_f32_16x16x32_bf16 v[132:135], v[36:39], v[68:71], v[132:135]
    ds_read_b64_tr_b16 v[20:21], v2 offset:4096
    v_fma_f32 v102, s49, v102, -v255
    v_mfma_f32_16x16x32_bf16 v[128:131], v[36:39], v[64:67], v[128:131]
    ds_read_b64_tr_b16 v[22:23], v2 offset:4608
    v_fma_f32 v103, s49, v103, -v255
    v_mfma_f32_16x16x32_bf16 v[128:131], v[32:35], v[48:51], v[128:131]
    ds_read_b64_tr_b16 v[24:25], v2 offset:8192
    v_fma_f32 v96, s49, v96, -v255
    v_mfma_f32_16x16x32_bf16 v[128:131], v[28:31], a[248:251], v[128:131]
    ds_read_b64_tr_b16 v[26:27], v2 offset:8704
    v_fma_f32 v97, s49, v97, -v255
    v_mfma_f32_16x16x32_bf16 v[124:127], v[28:31], a[244:247], v[124:127]
    s_add_u32 m0, s84, 0x12000
    s_mul_i32 s41, s84, 72
    s_add_u32 s41, s41, s83
    buffer_load_dwordx4 v9, s[8:11], s41 offen nt lds
    v_mfma_f32_16x16x32_bf16 v[124:127], v[32:35], v[44:47], v[124:127]
    v_rcp_f32 v73, v73
    v_mfma_f32_16x16x32_bf16 v[124:127], v[36:39], v[60:63], v[124:127]
    v_rcp_f32 v74, v74
    v_mfma_f32_16x16x32_bf16 v[120:123], v[36:39], v[56:59], v[120:123]
    v_rcp_f32 v75, v75
    v_mfma_f32_16x16x32_bf16 v[120:123], v[32:35], v[40:43], v[120:123]
    v_exp_f32 v76, v76
    v_mfma_f32_16x16x32_bf16 v[120:123], v[28:31], a[240:243], v[120:123]
    s_waitcnt lgkmcnt(0)
    v_exp_f32 v77, v77
    v_mfma_f32_16x16x32_bf16 v[136:139], v[16:19], a[144:147], v[136:139]
    ds_read_b64_tr_b16 v[28:29], v2 offset:12288
    v_add_f32 v76, 1.0, v76
    v_mfma_f32_16x16x32_bf16 v[136:139], v[20:23], a[160:163], v[136:139]
    s_add_u32 m0, s28, 0x0
    ds_read_b64_tr_b16 v[30:31], v2 offset:12800
    v_add_f32 v77, 1.0, v77
    v_mfma_f32_16x16x32_bf16 v[136:139], v[24:27], a[176:179], v[136:139]
    s_mul_i32 s41, s28, 72
    ds_read_b64_tr_b16 v[32:33], v2 offset:16384
    v_fma_f32 v98, s49, v98, -v255
    v_mfma_f32_16x16x32_bf16 v[140:143], v[24:27], a[180:183], v[140:143]
    s_add_u32 s41, s41, s83
    ds_read_b64_tr_b16 v[34:35], v2 offset:16896
    v_fma_f32 v99, s49, v99, -v255
    v_mfma_f32_16x16x32_bf16 v[140:143], v[20:23], a[164:167], v[140:143]
    s_add_u32 s41, s41, 0x288000
    ds_read_b64_tr_b16 v[36:37], v2 offset:20480
    v_fma_f32 v92, s49, v92, -v255
    v_mfma_f32_16x16x32_bf16 v[140:143], v[16:19], a[148:151], v[140:143]
    ds_read_b64_tr_b16 v[38:39], v2 offset:20992
    v_fma_f32 v93, s49, v93, -v255
    v_mfma_f32_16x16x32_bf16 v[144:147], v[16:19], a[152:155], v[144:147]
    v_exp_f32 v78, v78
    v_mfma_f32_16x16x32_bf16 v[144:147], v[20:23], a[168:171], v[144:147]
    v_exp_f32 v79, v79
    v_mfma_f32_16x16x32_bf16 v[144:147], v[24:27], a[184:187], v[144:147]
    buffer_load_dwordx4 v9, s[8:11], s41 offen nt lds
    v_mfma_f32_16x16x32_bf16 v[148:151], v[24:27], a[188:191], v[148:151]
    v_add_f32 v78, 1.0, v78
    v_add_f32 v79, 1.0, v79
    v_mfma_f32_16x16x32_bf16 v[148:151], v[20:23], a[172:175], v[148:151]
    v_rcp_f32 v76, v76
    v_mfma_f32_16x16x32_bf16 v[148:151], v[16:19], a[156:159], v[148:151]
    s_waitcnt lgkmcnt(0)
    v_rcp_f32 v77, v77
    v_mfma_f32_16x16x32_bf16 v[148:151], v[28:31], a[204:207], v[148:151]
    ds_read_b64_tr_b16 v[16:17], v2 offset:24576
    v_fma_f32 v94, s49, v94, -v255
    v_mfma_f32_16x16x32_bf16 v[148:151], v[32:35], a[220:223], v[148:151]
    s_add_u32 m0, s29, 0x0
    ds_read_b64_tr_b16 v[18:19], v2 offset:25088
    v_fma_f32 v95, s49, v95, -v255
    v_mfma_f32_16x16x32_bf16 v[148:151], v[36:39], a[236:239], v[148:151]
    s_mul_i32 s41, s29, 72
    ds_read_b64_tr_b16 v[20:21], v2 offset:28672
    v_fma_f32 v88, s49, v88, -v255
    v_mfma_f32_16x16x32_bf16 v[144:147], v[36:39], a[232:235], v[144:147]
    s_add_u32 s41, s41, s83
    ds_read_b64_tr_b16 v[22:23], v2 offset:29184
    v_fma_f32 v89, s49, v89, -v255
    v_mfma_f32_16x16x32_bf16 v[144:147], v[32:35], a[216:219], v[144:147]
    s_add_u32 s41, s41, 0x288000
    ds_read_b64_tr_b16 v[24:25], v2 offset:32768
    v_fma_f32 v90, s49, v90, -v255
    v_mfma_f32_16x16x32_bf16 v[144:147], v[28:31], a[200:203], v[144:147]
    ds_read_b64_tr_b16 v[26:27], v2 offset:33280
    v_fma_f32 v91, s49, v91, -v255
    v_mfma_f32_16x16x32_bf16 v[140:143], v[28:31], a[196:199], v[140:143]
    v_add_u32 v2, 0x9000, v2
    v_mfma_f32_16x16x32_bf16 v[140:143], v[32:35], a[212:215], v[140:143]
    v_rcp_f32 v78, v78
    v_mfma_f32_16x16x32_bf16 v[140:143], v[36:39], a[228:231], v[140:143]
    buffer_load_dwordx4 v9, s[8:11], s41 offen nt lds
    v_mfma_f32_16x16x32_bf16 v[136:139], v[36:39], a[224:227], v[136:139]
    v_rcp_f32 v79, v79
    v_mfma_f32_16x16x32_bf16 v[136:139], v[32:35], a[208:211], v[136:139]
    v_exp_f32 v80, v80
    v_mfma_f32_16x16x32_bf16 v[136:139], v[28:31], a[192:195], v[136:139]
    s_waitcnt lgkmcnt(0)
    v_exp_f32 v81, v81
    v_mfma_f32_16x16x32_bf16 v[136:139], v[16:19], a[240:243], v[136:139]
    ds_read_b64_tr_b16 v[28:29], v3 offset:24576
    v_add_f32 v80, 1.0, v80
    v_mfma_f32_16x16x32_bf16 v[136:139], v[20:23], v[40:43], v[136:139]
    s_add_u32 m0, s30, 0x0
    ds_read_b64_tr_b16 v[30:31], v3 offset:25088
    v_add_f32 v81, 1.0, v81
    v_mfma_f32_16x16x32_bf16 v[136:139], v[24:27], v[56:59], v[136:139]
    s_mul_i32 s41, s30, 72
    ds_read_b64_tr_b16 v[32:33], v3 offset:28672
    v_mfma_f32_16x16x32_bf16 v[140:143], v[24:27], v[60:63], v[140:143]
    s_add_u32 s41, s41, s83
    ds_read_b64_tr_b16 v[34:35], v3 offset:29184
    v_mfma_f32_16x16x32_bf16 v[140:143], v[20:23], v[44:47], v[140:143]
    s_add_u32 s41, s41, 0x288000
    ds_read_b64_tr_b16 v[36:37], v3 offset:32768
    v_mfma_f32_16x16x32_bf16 v[140:143], v[16:19], a[244:247], v[140:143]
    ds_read_b64_tr_b16 v[38:39], v3 offset:33280
    v_mfma_f32_16x16x32_bf16 v[144:147], v[16:19], a[248:251], v[144:147]
    v_exp_f32 v82, v82
    v_mfma_f32_16x16x32_bf16 v[144:147], v[20:23], v[48:51], v[144:147]
    v_exp_f32 v83, v83
    v_mfma_f32_16x16x32_bf16 v[144:147], v[24:27], v[64:67], v[144:147]
    buffer_load_dwordx4 v9, s[8:11], s41 offen nt lds
    v_mfma_f32_16x16x32_bf16 v[148:151], v[24:27], v[68:71], v[148:151]
    v_mul_f32 v136, v136, v72
    v_mul_f32 v137, v137, v73
    v_mfma_f32_16x16x32_bf16 v[148:151], v[20:23], v[52:55], v[148:151]
    v_mul_f32 v138, v138, v74
    v_mul_f32 v139, v139, v75
    v_mfma_f32_16x16x32_bf16 v[148:151], v[16:19], a[252:255], v[148:151]
    s_waitcnt lgkmcnt(0)
    v_mul_f32 v140, v140, v76
    v_mul_f32 v141, v141, v77
    v_mfma_f32_16x16x32_bf16 v[164:167], v[28:31], a[252:255], v[164:167]
    ds_read_b64_tr_b16 v[16:17], v3 offset:12288
    v_mul_f32 v142, v142, v78
    v_mfma_f32_16x16x32_bf16 v[164:167], v[32:35], v[52:55], v[164:167]
    s_add_u32 m0, s31, 0x0
    ds_read_b64_tr_b16 v[18:19], v3 offset:12800
    v_mul_f32 v143, v143, v79
    v_mfma_f32_16x16x32_bf16 v[164:167], v[36:39], v[68:71], v[164:167]
    s_mul_i32 s41, s31, 72
    ds_read_b64_tr_b16 v[20:21], v3 offset:16384
    v_add_f32 v82, 1.0, v82
    v_mfma_f32_16x16x32_bf16 v[160:163], v[36:39], v[64:67], v[160:163]
    s_add_u32 s41, s41, s83
    ds_read_b64_tr_b16 v[22:23], v3 offset:16896
    v_add_f32 v83, 1.0, v83
    v_mfma_f32_16x16x32_bf16 v[160:163], v[32:35], v[48:51], v[160:163]
    s_add_u32 s41, s41, 0x288000
    ds_read_b64_tr_b16 v[24:25], v3 offset:20480
    v_mfma_f32_16x16x32_bf16 v[160:163], v[28:31], a[248:251], v[160:163]
    ds_read_b64_tr_b16 v[26:27], v3 offset:20992
    v_mfma_f32_16x16x32_bf16 v[156:159], v[28:31], a[244:247], v[156:159]
    v_rcp_f32 v80, v80
    v_mfma_f32_16x16x32_bf16 v[156:159], v[32:35], v[44:47], v[156:159]
    v_rcp_f32 v81, v81
    v_mfma_f32_16x16x32_bf16 v[156:159], v[36:39], v[60:63], v[156:159]
    buffer_load_dwordx4 v9, s[8:11], s41 offen nt lds
    v_mfma_f32_16x16x32_bf16 v[152:155], v[36:39], v[56:59], v[152:155]
    v_rcp_f32 v82, v82
    v_mfma_f32_16x16x32_bf16 v[152:155], v[32:35], v[40:43], v[152:155]
    v_rcp_f32 v83, v83
    v_mfma_f32_16x16x32_bf16 v[152:155], v[28:31], a[240:243], v[152:155]
    s_waitcnt lgkmcnt(0)
    v_mul_f32 v144, v144, v80
    v_mul_f32 v145, v145, v81
    v_mfma_f32_16x16x32_bf16 v[152:155], v[16:19], a[192:195], v[152:155]
    ds_read_b64_tr_b16 v[28:29], v3 offset:0
    v_mul_f32 v146, v146, v82
    v_mfma_f32_16x16x32_bf16 v[152:155], v[20:23], a[208:211], v[152:155]
    s_add_u32 m0, s46, 0x0
    ds_read_b64_tr_b16 v[30:31], v3 offset:512
    v_mul_f32 v147, v147, v83
    v_mfma_f32_16x16x32_bf16 v[152:155], v[24:27], a[224:227], v[152:155]
    s_mul_i32 s41, s46, 72
    ds_read_b64_tr_b16 v[32:33], v3 offset:4096
    v_mfma_f32_16x16x32_bf16 v[156:159], v[24:27], a[228:231], v[156:159]
    s_add_u32 s41, s41, s83
    ds_read_b64_tr_b16 v[34:35], v3 offset:4608
    v_mfma_f32_16x16x32_bf16 v[156:159], v[20:23], a[212:215], v[156:159]
    s_add_u32 s41, s41, 0x288000
    ds_read_b64_tr_b16 v[36:37], v3 offset:8192
    v_mfma_f32_16x16x32_bf16 v[156:159], v[16:19], a[196:199], v[156:159]
    ds_read_b64_tr_b16 v[38:39], v3 offset:8704
    v_mfma_f32_16x16x32_bf16 v[160:163], v[16:19], a[200:203], v[160:163]
    v_add_u32 v3, 0x9000, v3
    v_mfma_f32_16x16x32_bf16 v[160:163], v[20:23], a[216:219], v[160:163]
    v_exp_f32 v84, v84
    v_mfma_f32_16x16x32_bf16 v[160:163], v[24:27], a[232:235], v[160:163]
    buffer_load_dwordx4 v9, s[8:11], s41 offen nt lds
    v_mfma_f32_16x16x32_bf16 v[164:167], v[24:27], a[236:239], v[164:167]
    v_exp_f32 v85, v85
    v_mfma_f32_16x16x32_bf16 v[164:167], v[20:23], a[220:223], v[164:167]
    v_exp_f32 v86, v86
    v_mfma_f32_16x16x32_bf16 v[164:167], v[16:19], a[204:207], v[164:167]
    s_waitcnt lgkmcnt(0)
    v_exp_f32 v87, v87
    v_mfma_f32_16x16x32_bf16 v[164:167], v[28:31], a[156:159], v[164:167]
    ds_read_b64_tr_b16 v[16:17], v4 offset:0
    v_add_f32 v84, 1.0, v84
    v_mfma_f32_16x16x32_bf16 v[164:167], v[32:35], a[172:175], v[164:167]
    s_add_u32 m0, s47, 0x0
    ds_read_b64_tr_b16 v[18:19], v4 offset:512
    v_add_f32 v85, 1.0, v85
    v_mfma_f32_16x16x32_bf16 v[164:167], v[36:39], a[188:191], v[164:167]
    s_mul_i32 s41, s47, 72
    ds_read_b64_tr_b16 v[20:21], v4 offset:4096
    v_add_f32 v86, 1.0, v86
    v_mfma_f32_16x16x32_bf16 v[160:163], v[36:39], a[184:187], v[160:163]
    s_add_u32 s41, s41, s83
    ds_read_b64_tr_b16 v[22:23], v4 offset:4608
    v_add_f32 v87, 1.0, v87
    v_mfma_f32_16x16x32_bf16 v[160:163], v[32:35], a[168:171], v[160:163]
    s_add_u32 s41, s41, 0x288000
    ds_read_b64_tr_b16 v[24:25], v4 offset:8192
    v_cvt_pk_bf16_f32 v136, v136, v137
    v_mfma_f32_16x16x32_bf16 v[160:163], v[28:31], a[152:155], v[160:163]
    ds_read_b64_tr_b16 v[26:27], v4 offset:8704
    v_cvt_pk_bf16_f32 v137, v138, v139
    v_mfma_f32_16x16x32_bf16 v[156:159], v[28:31], a[148:151], v[156:159]
    v_rcp_f32 v84, v84
    v_mfma_f32_16x16x32_bf16 v[156:159], v[32:35], a[164:167], v[156:159]
    v_rcp_f32 v85, v85
    v_mfma_f32_16x16x32_bf16 v[156:159], v[36:39], a[180:183], v[156:159]
    buffer_load_dwordx4 v9, s[8:11], s41 offen nt lds
    v_mfma_f32_16x16x32_bf16 v[152:155], v[36:39], a[176:179], v[152:155]
    v_rcp_f32 v86, v86
    v_mfma_f32_16x16x32_bf16 v[152:155], v[32:35], a[160:163], v[152:155]
    v_rcp_f32 v87, v87
    v_mfma_f32_16x16x32_bf16 v[152:155], v[28:31], a[144:147], v[152:155]
    s_waitcnt lgkmcnt(0)
    v_mul_f32 v148, v148, v84
    v_mul_f32 v149, v149, v85
    v_mfma_f32_16x16x32_bf16 v[168:171], v[16:19], a[144:147], v[168:171]
    ds_read_b64_tr_b16 v[28:29], v4 offset:12288
    v_mul_f32 v150, v150, v86
    v_mfma_f32_16x16x32_bf16 v[168:171], v[20:23], a[160:163], v[168:171]
    s_add_u32 m0, s48, 0x0
    ds_read_b64_tr_b16 v[30:31], v4 offset:12800
    v_mul_f32 v151, v151, v87
    v_mfma_f32_16x16x32_bf16 v[168:171], v[24:27], a[176:179], v[168:171]
    s_mul_i32 s41, s48, 72
    ds_read_b64_tr_b16 v[32:33], v4 offset:16384
    v_cvt_pk_bf16_f32 v140, v140, v141
    v_mfma_f32_16x16x32_bf16 v[172:175], v[24:27], a[180:183], v[172:175]
    s_add_u32 s41, s41, s83
    ds_read_b64_tr_b16 v[34:35], v4 offset:16896
    v_cvt_pk_bf16_f32 v141, v142, v143
    v_mfma_f32_16x16x32_bf16 v[172:175], v[20:23], a[164:167], v[172:175]
    s_add_u32 s41, s41, 0x288000
    ds_read_b64_tr_b16 v[36:37], v4 offset:20480
    v_cvt_pk_bf16_f32 v144, v144, v145
    v_mfma_f32_16x16x32_bf16 v[172:175], v[16:19], a[148:151], v[172:175]
    ds_read_b64_tr_b16 v[38:39], v4 offset:20992
    v_mfma_f32_16x16x32_bf16 v[176:179], v[16:19], a[152:155], v[176:179]
    v_exp_f32 v100, v100
    v_mfma_f32_16x16x32_bf16 v[176:179], v[20:23], a[168:171], v[176:179]
    v_exp_f32 v101, v101
    v_mfma_f32_16x16x32_bf16 v[176:179], v[24:27], a[184:187], v[176:179]
    buffer_load_dwordx4 v9, s[8:11], s41 offen nt lds
    v_mfma_f32_16x16x32_bf16 v[180:183], v[24:27], a[188:191], v[180:183]
    v_exp_f32 v102, v102
    v_mfma_f32_16x16x32_bf16 v[180:183], v[20:23], a[172:175], v[180:183]
    v_exp_f32 v103, v103
    v_mfma_f32_16x16x32_bf16 v[180:183], v[16:19], a[156:159], v[180:183]
    s_waitcnt lgkmcnt(0)
    v_add_f32 v100, 1.0, v100
    v_add_f32 v101, 1.0, v101
    v_mfma_f32_16x16x32_bf16 v[180:183], v[28:31], a[204:207], v[180:183]
    ds_read_b64_tr_b16 v[16:17], v4 offset:24576
    v_add_f32 v102, 1.0, v102
    v_mfma_f32_16x16x32_bf16 v[180:183], v[32:35], a[220:223], v[180:183]
    s_add_u32 m0, s82, 0x0
    ds_read_b64_tr_b16 v[18:19], v4 offset:25088
    v_add_f32 v103, 1.0, v103
    v_mfma_f32_16x16x32_bf16 v[180:183], v[36:39], a[236:239], v[180:183]
    s_mul_i32 s41, s82, 72
    ds_read_b64_tr_b16 v[20:21], v4 offset:28672
    v_cvt_pk_bf16_f32 v145, v146, v147
    v_mfma_f32_16x16x32_bf16 v[176:179], v[36:39], a[232:235], v[176:179]
    s_add_u32 s41, s41, s83
    ds_read_b64_tr_b16 v[22:23], v4 offset:29184
    v_cvt_pk_bf16_f32 v148, v148, v149
    v_mfma_f32_16x16x32_bf16 v[176:179], v[32:35], a[216:219], v[176:179]
    s_add_u32 s41, s41, 0x288000
    ds_read_b64_tr_b16 v[24:25], v4 offset:32768
    v_cvt_pk_bf16_f32 v149, v150, v151
    v_mfma_f32_16x16x32_bf16 v[176:179], v[28:31], a[200:203], v[176:179]
    ds_read_b64_tr_b16 v[26:27], v4 offset:33280
    v_mfma_f32_16x16x32_bf16 v[172:175], v[28:31], a[196:199], v[172:175]
    v_add_u32 v4, 0x9000, v4
    v_mfma_f32_16x16x32_bf16 v[172:175], v[32:35], a[212:215], v[172:175]
    v_rcp_f32 v100, v100
    v_mfma_f32_16x16x32_bf16 v[172:175], v[36:39], a[228:231], v[172:175]
    buffer_load_dwordx4 v9, s[8:11], s41 offen nt lds
    v_mfma_f32_16x16x32_bf16 v[168:171], v[36:39], a[224:227], v[168:171]
    v_rcp_f32 v101, v101
    v_mfma_f32_16x16x32_bf16 v[168:171], v[32:35], a[208:211], v[168:171]
    v_rcp_f32 v102, v102
    v_mfma_f32_16x16x32_bf16 v[168:171], v[28:31], a[192:195], v[168:171]
    s_waitcnt lgkmcnt(0)
    v_rcp_f32 v103, v103
    v_mfma_f32_16x16x32_bf16 v[168:171], v[16:19], a[240:243], v[168:171]
    ds_read_b64_tr_b16 v[28:29], v5 offset:24576
    v_mul_f32 v164, v164, v100
    v_mfma_f32_16x16x32_bf16 v[168:171], v[20:23], v[40:43], v[168:171]
    s_add_u32 m0, s84, 0x0
    ds_read_b64_tr_b16 v[30:31], v5 offset:25088
    v_mul_f32 v165, v165, v101
    v_mfma_f32_16x16x32_bf16 v[168:171], v[24:27], v[56:59], v[168:171]
    s_mul_i32 s41, s84, 72
    ds_read_b64_tr_b16 v[32:33], v5 offset:28672
    v_mul_f32 v166, v166, v102
    v_mfma_f32_16x16x32_bf16 v[172:175], v[24:27], v[60:63], v[172:175]
    s_add_u32 s41, s41, s83
    ds_read_b64_tr_b16 v[34:35], v5 offset:29184
    v_mul_f32 v167, v167, v103
    v_mfma_f32_16x16x32_bf16 v[172:175], v[20:23], v[44:47], v[172:175]
    s_add_u32 s41, s41, 0x288000
    ds_read_b64_tr_b16 v[36:37], v5 offset:32768
    v_cvt_pk_bf16_f32 v150, v164, v165
    v_mfma_f32_16x16x32_bf16 v[172:175], v[16:19], a[244:247], v[172:175]
    ds_read_b64_tr_b16 v[38:39], v5 offset:33280
    v_cvt_pk_bf16_f32 v151, v166, v167
    v_mfma_f32_16x16x32_bf16 v[176:179], v[16:19], a[248:251], v[176:179]
    v_exp_f32 v96, v96
    v_mfma_f32_16x16x32_bf16 v[176:179], v[20:23], v[48:51], v[176:179]
    v_exp_f32 v97, v97
    v_mfma_f32_16x16x32_bf16 v[176:179], v[24:27], v[64:67], v[176:179]
    buffer_load_dwordx4 v9, s[8:11], s41 offen nt lds
    v_mfma_f32_16x16x32_bf16 v[180:183], v[24:27], v[68:71], v[180:183]
    v_exp_f32 v98, v98
    v_mfma_f32_16x16x32_bf16 v[180:183], v[20:23], v[52:55], v[180:183]
    v_exp_f32 v99, v99
    v_mfma_f32_16x16x32_bf16 v[180:183], v[16:19], a[252:255], v[180:183]
    s_waitcnt lgkmcnt(0)
    v_add_f32 v96, 1.0, v96
    v_add_f32 v97, 1.0, v97
    v_mfma_f32_16x16x32_bf16 v[196:199], v[28:31], a[252:255], v[196:199]
    ds_read_b64_tr_b16 v[16:17], v5 offset:12288
    v_add_f32 v98, 1.0, v98
    v_mfma_f32_16x16x32_bf16 v[196:199], v[32:35], v[52:55], v[196:199]
    ds_read_b64_tr_b16 v[18:19], v5 offset:12800
    v_add_f32 v99, 1.0, v99
    v_mfma_f32_16x16x32_bf16 v[196:199], v[36:39], v[68:71], v[196:199]
    ds_read_b64_tr_b16 v[20:21], v5 offset:16384
    v_fma_f32 v104, s49, v104, -v255
    v_mfma_f32_16x16x32_bf16 v[192:195], v[36:39], v[64:67], v[192:195]
    ds_read_b64_tr_b16 v[22:23], v5 offset:16896
    v_fma_f32 v105, s49, v105, -v255
    v_mfma_f32_16x16x32_bf16 v[192:195], v[32:35], v[48:51], v[192:195]
    ds_read_b64_tr_b16 v[24:25], v5 offset:20480
    v_fma_f32 v106, s49, v106, -v255
    v_mfma_f32_16x16x32_bf16 v[192:195], v[28:31], a[248:251], v[192:195]
    ds_read_b64_tr_b16 v[26:27], v5 offset:20992
    v_fma_f32 v107, s49, v107, -v255
    v_mfma_f32_16x16x32_bf16 v[188:191], v[28:31], a[244:247], v[188:191]
    v_rcp_f32 v96, v96
    v_mfma_f32_16x16x32_bf16 v[188:191], v[32:35], v[44:47], v[188:191]
    v_rcp_f32 v97, v97
    v_mfma_f32_16x16x32_bf16 v[188:191], v[36:39], v[60:63], v[188:191]
    v_rcp_f32 v98, v98
    v_mfma_f32_16x16x32_bf16 v[184:187], v[36:39], v[56:59], v[184:187]
    v_rcp_f32 v99, v99
    v_mfma_f32_16x16x32_bf16 v[184:187], v[32:35], v[40:43], v[184:187]
    v_mul_f32 v160, v160, v96
    v_mul_f32 v161, v161, v97
    v_mfma_f32_16x16x32_bf16 v[184:187], v[28:31], a[240:243], v[184:187]
    s_waitcnt lgkmcnt(0)
    v_mul_f32 v162, v162, v98
    v_mul_f32 v163, v163, v99
    v_mfma_f32_16x16x32_bf16 v[184:187], v[16:19], a[192:195], v[184:187]
    ds_read_b64_tr_b16 v[28:29], v5 offset:0
    v_cvt_pk_bf16_f32 v146, v160, v161
    v_mfma_f32_16x16x32_bf16 v[184:187], v[20:23], a[208:211], v[184:187]
    ds_read_b64_tr_b16 v[30:31], v5 offset:512
    v_cvt_pk_bf16_f32 v147, v162, v163
    v_mfma_f32_16x16x32_bf16 v[184:187], v[24:27], a[224:227], v[184:187]
    ds_read_b64_tr_b16 v[32:33], v5 offset:4096
    v_fma_f32 v108, s49, v108, -v255
    v_mfma_f32_16x16x32_bf16 v[188:191], v[24:27], a[228:231], v[188:191]
    ds_read_b64_tr_b16 v[34:35], v5 offset:4608
    v_fma_f32 v109, s49, v109, -v255
    v_mfma_f32_16x16x32_bf16 v[188:191], v[20:23], a[212:215], v[188:191]
    ds_read_b64_tr_b16 v[36:37], v5 offset:8192
    v_fma_f32 v110, s49, v110, -v255
    v_mfma_f32_16x16x32_bf16 v[188:191], v[16:19], a[196:199], v[188:191]
    ds_read_b64_tr_b16 v[38:39], v5 offset:8704
    v_fma_f32 v111, s49, v111, -v255
    v_mfma_f32_16x16x32_bf16 v[192:195], v[16:19], a[200:203], v[192:195]
    v_add_u32 v5, 0x9000, v5
    v_mfma_f32_16x16x32_bf16 v[192:195], v[20:23], a[216:219], v[192:195]
    v_exp_f32 v92, v92
    v_mfma_f32_16x16x32_bf16 v[192:195], v[24:27], a[232:235], v[192:195]
    v_exp_f32 v93, v93
    v_mfma_f32_16x16x32_bf16 v[196:199], v[24:27], a[236:239], v[196:199]
    v_exp_f32 v94, v94
    v_mfma_f32_16x16x32_bf16 v[196:199], v[20:23], a[220:223], v[196:199]
    v_exp_f32 v95, v95
    v_mfma_f32_16x16x32_bf16 v[196:199], v[16:19], a[204:207], v[196:199]
    s_waitcnt vmcnt(9) lgkmcnt(0)
    s_barrier
    v_add_f32 v92, 1.0, v92
    v_add_f32 v93, 1.0, v93
    v_mfma_f32_16x16x32_bf16 v[196:199], v[28:31], a[156:159], v[196:199]
    ds_read_b64_tr_b16 v[16:17], v2 offset:0
    v_add_f32 v94, 1.0, v94
    v_mfma_f32_16x16x32_bf16 v[196:199], v[32:35], a[172:175], v[196:199]
    ds_read_b64_tr_b16 v[18:19], v2 offset:512
    v_add_f32 v95, 1.0, v95
    v_mfma_f32_16x16x32_bf16 v[196:199], v[36:39], a[188:191], v[196:199]
    ds_read_b64_tr_b16 v[20:21], v2 offset:4096
    v_mfma_f32_16x16x32_bf16 v[192:195], v[36:39], a[184:187], v[192:195]
    ds_read_b64_tr_b16 v[22:23], v2 offset:4608
    v_mfma_f32_16x16x32_bf16 v[192:195], v[32:35], a[168:171], v[192:195]
    ds_read_b64_tr_b16 v[24:25], v2 offset:8192
    v_mfma_f32_16x16x32_bf16 v[192:195], v[28:31], a[152:155], v[192:195]
    ds_read_b64_tr_b16 v[26:27], v2 offset:8704
    v_mfma_f32_16x16x32_bf16 v[188:191], v[28:31], a[148:151], v[188:191]
    v_rcp_f32 v92, v92
    v_mfma_f32_16x16x32_bf16 v[188:191], v[32:35], a[164:167], v[188:191]
    v_rcp_f32 v93, v93
    v_mfma_f32_16x16x32_bf16 v[188:191], v[36:39], a[180:183], v[188:191]
    v_rcp_f32 v94, v94
    v_mfma_f32_16x16x32_bf16 v[184:187], v[36:39], a[176:179], v[184:187]
    v_rcp_f32 v95, v95
    v_mfma_f32_16x16x32_bf16 v[184:187], v[32:35], a[160:163], v[184:187]
    v_mul_f32 v156, v156, v92
    v_mul_f32 v157, v157, v93
    v_mfma_f32_16x16x32_bf16 v[184:187], v[28:31], a[144:147], v[184:187]
    s_waitcnt lgkmcnt(0)
    v_mul_f32 v158, v158, v94
    v_mul_f32 v159, v159, v95
    v_mfma_f32_16x16x32_bf16 v[200:203], v[16:19], a[0:3], v[248:251]
    ds_read_b64_tr_b16 v[28:29], v2 offset:12288
    v_cvt_pk_bf16_f32 v142, v156, v157
    v_mfma_f32_16x16x32_bf16 v[200:203], v[20:23], a[16:19], v[200:203]
    s_add_u32 m0, s28, 0x9000
    ds_read_b64_tr_b16 v[30:31], v2 offset:12800
    v_cvt_pk_bf16_f32 v143, v158, v159
    v_mfma_f32_16x16x32_bf16 v[200:203], v[24:27], a[32:35], v[200:203]
    s_mul_i32 s41, s28, 72
    ds_read_b64_tr_b16 v[32:33], v2 offset:16384
    v_fma_f32 v112, s49, v112, -v255
    v_mfma_f32_16x16x32_bf16 v[204:207], v[24:27], a[36:39], v[248:251]
    s_add_u32 s41, s41, s83
    ds_read_b64_tr_b16 v[34:35], v2 offset:16896
    v_fma_f32 v113, s49, v113, -v255
    v_mfma_f32_16x16x32_bf16 v[204:207], v[20:23], a[20:23], v[204:207]
    ds_read_b64_tr_b16 v[36:37], v2 offset:20480
    v_fma_f32 v114, s49, v114, -v255
    v_mfma_f32_16x16x32_bf16 v[204:207], v[16:19], a[4:7], v[204:207]
L_hop0_3:
    s_cbranch_execz L_hop0_12
    ds_read_b64_tr_b16 v[38:39], v2 offset:20992
    v_fma_f32 v115, s49, v115, -v255
    v_mfma_f32_16x16x32_bf16 v[208:211], v[16:19], a[8:11], v[248:251]
    v_exp_f32 v88, v88
    v_mfma_f32_16x16x32_bf16 v[208:211], v[20:23], a[24:27], v[208:211]
    v_exp_f32 v89, v89
    v_mfma_f32_16x16x32_bf16 v[208:211], v[24:27], a[40:43], v[208:211]
    buffer_load_dwordx4 v9, s[12:15], s41 offen nt lds
    v_mfma_f32_16x16x32_bf16 v[212:215], v[24:27], a[44:47], v[248:251]
    v_exp_f32 v90, v90
    v_mfma_f32_16x16x32_bf16 v[212:215], v[20:23], a[28:31], v[212:215]
    v_exp_f32 v91, v91
    v_mfma_f32_16x16x32_bf16 v[212:215], v[16:19], a[12:15], v[212:215]
    s_waitcnt lgkmcnt(0)
    v_add_f32 v88, 1.0, v88
    v_add_f32 v89, 1.0, v89
    v_mfma_f32_16x16x32_bf16 v[212:215], v[28:31], a[60:63], v[212:215]
    ds_read_b64_tr_b16 v[16:17], v2 offset:24576
    v_add_f32 v90, 1.0, v90
    v_mfma_f32_16x16x32_bf16 v[212:215], v[32:35], a[76:79], v[212:215]
    s_add_u32 m0, s29, 0x9000
    ds_read_b64_tr_b16 v[18:19], v2 offset:25088
    v_add_f32 v91, 1.0, v91
    v_mfma_f32_16x16x32_bf16 v[212:215], v[36:39], a[92:95], v[212:215]
    s_mul_i32 s41, s29, 72
    ds_read_b64_tr_b16 v[20:21], v2 offset:28672
    v_mfma_f32_16x16x32_bf16 v[208:211], v[36:39], a[88:91], v[208:211]
    s_add_u32 s41, s41, s83
    ds_read_b64_tr_b16 v[22:23], v2 offset:29184
    v_mfma_f32_16x16x32_bf16 v[208:211], v[32:35], a[72:75], v[208:211]
    ds_read_b64_tr_b16 v[24:25], v2 offset:32768
    v_mfma_f32_16x16x32_bf16 v[208:211], v[28:31], a[56:59], v[208:211]
    ds_read_b64_tr_b16 v[26:27], v2 offset:33280
    v_mfma_f32_16x16x32_bf16 v[204:207], v[28:31], a[52:55], v[204:207]
    v_add_u32 v2, 0xfffee000, v2
    v_mfma_f32_16x16x32_bf16 v[204:207], v[32:35], a[68:71], v[204:207]
    v_rcp_f32 v88, v88
    v_mfma_f32_16x16x32_bf16 v[204:207], v[36:39], a[84:87], v[204:207]
    buffer_load_dwordx4 v9, s[12:15], s41 offen nt lds
    v_mfma_f32_16x16x32_bf16 v[200:203], v[36:39], a[80:83], v[200:203]
    v_rcp_f32 v89, v89
    v_mfma_f32_16x16x32_bf16 v[200:203], v[32:35], a[64:67], v[200:203]
    v_rcp_f32 v90, v90
    v_mfma_f32_16x16x32_bf16 v[200:203], v[28:31], a[48:51], v[200:203]
    s_waitcnt lgkmcnt(0)
    v_rcp_f32 v91, v91
    v_mfma_f32_16x16x32_bf16 v[200:203], v[16:19], a[96:99], v[200:203]
    ds_read_b64_tr_b16 v[28:29], v3 offset:24576
    v_mul_f32 v152, v152, v88
    v_mfma_f32_16x16x32_bf16 v[200:203], v[20:23], a[112:115], v[200:203]
    s_add_u32 m0, s30, 0x9000
    ds_read_b64_tr_b16 v[30:31], v3 offset:25088
    v_mul_f32 v153, v153, v89
    v_mfma_f32_16x16x32_bf16 v[200:203], v[24:27], a[128:131], v[200:203]
    s_mul_i32 s41, s30, 72
    ds_read_b64_tr_b16 v[32:33], v3 offset:28672
    v_mul_f32 v154, v154, v90
    v_mfma_f32_16x16x32_bf16 v[204:207], v[24:27], a[132:135], v[204:207]
    s_add_u32 s41, s41, s83
    ds_read_b64_tr_b16 v[34:35], v3 offset:29184
    v_mul_f32 v155, v155, v91
    v_mfma_f32_16x16x32_bf16 v[204:207], v[20:23], a[116:119], v[204:207]
    ds_read_b64_tr_b16 v[36:37], v3 offset:32768
    v_cvt_pk_bf16_f32 v138, v152, v153
    v_mfma_f32_16x16x32_bf16 v[204:207], v[16:19], a[100:103], v[204:207]
    ds_read_b64_tr_b16 v[38:39], v3 offset:33280
    v_cvt_pk_bf16_f32 v139, v154, v155
    v_mfma_f32_16x16x32_bf16 v[208:211], v[16:19], a[104:107], v[208:211]
    v_exp_f32 v104, v104
    v_mfma_f32_16x16x32_bf16 v[208:211], v[20:23], a[120:123], v[208:211]
    v_exp_f32 v105, v105
    v_mfma_f32_16x16x32_bf16 v[208:211], v[24:27], a[136:139], v[208:211]
    buffer_load_dwordx4 v9, s[12:15], s41 offen nt lds
    v_mfma_f32_16x16x32_bf16 v[212:215], v[24:27], a[140:143], v[212:215]
    v_exp_f32 v106, v106
    v_mfma_f32_16x16x32_bf16 v[212:215], v[20:23], a[124:127], v[212:215]
    v_exp_f32 v107, v107
    v_mfma_f32_16x16x32_bf16 v[212:215], v[16:19], a[108:111], v[212:215]
    s_waitcnt lgkmcnt(0)
    v_add_f32 v104, 1.0, v104
    v_add_f32 v105, 1.0, v105
    v_mfma_f32_16x16x32_bf16 v[228:231], v[28:31], a[108:111], v[248:251]
    ds_read_b64_tr_b16 v[16:17], v3 offset:12288
    v_add_f32 v106, 1.0, v106
    v_mfma_f32_16x16x32_bf16 v[228:231], v[32:35], a[124:127], v[228:231]
    s_add_u32 m0, s31, 0x9000
    ds_read_b64_tr_b16 v[18:19], v3 offset:12800
    v_add_f32 v107, 1.0, v107
    v_mfma_f32_16x16x32_bf16 v[228:231], v[36:39], a[140:143], v[228:231]
    s_mul_i32 s41, s31, 72
    ds_read_b64_tr_b16 v[20:21], v3 offset:16384
    v_fma_f32 v116, s49, v116, -v255
    v_mfma_f32_16x16x32_bf16 v[224:227], v[36:39], a[136:139], v[248:251]
    s_add_u32 s41, s41, s83
    ds_read_b64_tr_b16 v[22:23], v3 offset:16896
    v_fma_f32 v117, s49, v117, -v255
    v_mfma_f32_16x16x32_bf16 v[224:227], v[32:35], a[120:123], v[224:227]
    ds_read_b64_tr_b16 v[24:25], v3 offset:20480
    v_fma_f32 v118, s49, v118, -v255
    v_mfma_f32_16x16x32_bf16 v[224:227], v[28:31], a[104:107], v[224:227]
    ds_read_b64_tr_b16 v[26:27], v3 offset:20992
    v_fma_f32 v119, s49, v119, -v255
    v_mfma_f32_16x16x32_bf16 v[220:223], v[28:31], a[100:103], v[248:251]
    v_rcp_f32 v104, v104
    v_mfma_f32_16x16x32_bf16 v[220:223], v[32:35], a[116:119], v[220:223]
    buffer_store_dwordx4 v[136:139], v1, s[4:7], s56 offen offset:0 sc1
    v_mfma_f32_16x16x32_bf16 v[220:223], v[36:39], a[132:135], v[220:223]
    buffer_load_dwordx4 v9, s[12:15], s41 offen nt lds
    v_mfma_f32_16x16x32_bf16 v[216:219], v[36:39], a[128:131], v[248:251]
    v_rcp_f32 v105, v105
    v_mfma_f32_16x16x32_bf16 v[216:219], v[32:35], a[112:115], v[216:219]
    v_rcp_f32 v106, v106
    v_mfma_f32_16x16x32_bf16 v[216:219], v[28:31], a[96:99], v[216:219]
    s_waitcnt lgkmcnt(0)
    v_rcp_f32 v107, v107
    v_mfma_f32_16x16x32_bf16 v[216:219], v[16:19], a[48:51], v[216:219]
    ds_read_b64_tr_b16 v[28:29], v3 offset:0
    v_mul_f32 v168, v168, v104
    v_mfma_f32_16x16x32_bf16 v[216:219], v[20:23], a[64:67], v[216:219]
    s_add_u32 m0, s46, 0x9000
    ds_read_b64_tr_b16 v[30:31], v3 offset:512
    v_mul_f32 v169, v169, v105
    v_mfma_f32_16x16x32_bf16 v[216:219], v[24:27], a[80:83], v[216:219]
    s_mul_i32 s41, s46, 72
    ds_read_b64_tr_b16 v[32:33], v3 offset:4096
    v_mul_f32 v170, v170, v106
    v_mfma_f32_16x16x32_bf16 v[220:223], v[24:27], a[84:87], v[220:223]
    s_add_u32 s41, s41, s83
    ds_read_b64_tr_b16 v[34:35], v3 offset:4608
    v_mul_f32 v171, v171, v107
    v_mfma_f32_16x16x32_bf16 v[220:223], v[20:23], a[68:71], v[220:223]
    ds_read_b64_tr_b16 v[36:37], v3 offset:8192
    v_cvt_pk_bf16_f32 v104, v168, v169
    v_mfma_f32_16x16x32_bf16 v[220:223], v[16:19], a[52:55], v[220:223]
    ds_read_b64_tr_b16 v[38:39], v3 offset:8704
    v_cvt_pk_bf16_f32 v105, v170, v171
    v_mfma_f32_16x16x32_bf16 v[224:227], v[16:19], a[56:59], v[224:227]
    v_add_u32 v3, 0xfffee000, v3
    v_fma_f32 v132, s49, v132, -v255
    v_mfma_f32_16x16x32_bf16 v[224:227], v[20:23], a[72:75], v[224:227]
    v_exp_f32 v108, v108
    v_mfma_f32_16x16x32_bf16 v[224:227], v[24:27], a[88:91], v[224:227]
    buffer_load_dwordx4 v9, s[12:15], s41 offen nt lds
    v_mfma_f32_16x16x32_bf16 v[228:231], v[24:27], a[92:95], v[228:231]
    v_exp_f32 v109, v109
    v_mfma_f32_16x16x32_bf16 v[228:231], v[20:23], a[76:79], v[228:231]
    v_exp_f32 v110, v110
    v_mfma_f32_16x16x32_bf16 v[228:231], v[16:19], a[60:63], v[228:231]
    s_waitcnt lgkmcnt(0)
    v_exp_f32 v111, v111
    v_mfma_f32_16x16x32_bf16 v[228:231], v[28:31], a[12:15], v[228:231]
    ds_read_b64_tr_b16 v[16:17], v4 offset:0
    v_add_f32 v108, 1.0, v108
    v_mfma_f32_16x16x32_bf16 v[228:231], v[32:35], a[28:31], v[228:231]
    s_add_u32 m0, s47, 0x9000
    ds_read_b64_tr_b16 v[18:19], v4 offset:512
    v_add_f32 v109, 1.0, v109
    v_mfma_f32_16x16x32_bf16 v[228:231], v[36:39], a[44:47], v[228:231]
    s_mul_i32 s41, s47, 72
    ds_read_b64_tr_b16 v[20:21], v4 offset:4096
    v_add_f32 v110, 1.0, v110
    v_mfma_f32_16x16x32_bf16 v[224:227], v[36:39], a[40:43], v[224:227]
    s_add_u32 s41, s41, s83
    ds_read_b64_tr_b16 v[22:23], v4 offset:4608
    v_add_f32 v111, 1.0, v111
    v_mfma_f32_16x16x32_bf16 v[224:227], v[32:35], a[24:27], v[224:227]
    ds_read_b64_tr_b16 v[24:25], v4 offset:8192
    v_fma_f32 v133, s49, v133, -v255
    v_mfma_f32_16x16x32_bf16 v[224:227], v[28:31], a[8:11], v[224:227]
    ds_read_b64_tr_b16 v[26:27], v4 offset:8704
    v_fma_f32 v134, s49, v134, -v255
    v_mfma_f32_16x16x32_bf16 v[220:223], v[28:31], a[4:7], v[220:223]
    v_rcp_f32 v108, v108
    v_mfma_f32_16x16x32_bf16 v[220:223], v[32:35], a[20:23], v[220:223]
    v_rcp_f32 v109, v109
    v_mfma_f32_16x16x32_bf16 v[220:223], v[36:39], a[36:39], v[220:223]
    buffer_load_dwordx4 v9, s[12:15], s41 offen nt lds
    v_mfma_f32_16x16x32_bf16 v[216:219], v[36:39], a[32:35], v[216:219]
    v_rcp_f32 v110, v110
    v_mfma_f32_16x16x32_bf16 v[216:219], v[32:35], a[16:19], v[216:219]
    v_rcp_f32 v111, v111
    v_mfma_f32_16x16x32_bf16 v[216:219], v[28:31], a[0:3], v[216:219]
    s_waitcnt lgkmcnt(0)
    v_mul_f32 v172, v172, v108
    v_mul_f32 v173, v173, v109
    v_mfma_f32_16x16x32_bf16 v[72:75], v[16:19], a[0:3], v[248:251]
    ds_read_b64_tr_b16 v[28:29], v4 offset:12288
    v_mul_f32 v174, v174, v110
    v_mfma_f32_16x16x32_bf16 v[72:75], v[20:23], a[16:19], v[72:75]
    s_add_u32 m0, s48, 0x9000
    ds_read_b64_tr_b16 v[30:31], v4 offset:12800
    v_mul_f32 v175, v175, v111
    v_mfma_f32_16x16x32_bf16 v[72:75], v[24:27], a[32:35], v[72:75]
    s_mul_i32 s41, s48, 72
    ds_read_b64_tr_b16 v[32:33], v4 offset:16384
    v_cvt_pk_bf16_f32 v108, v172, v173
    v_mfma_f32_16x16x32_bf16 v[76:79], v[24:27], a[36:39], v[248:251]
    s_add_u32 s41, s41, s83
    ds_read_b64_tr_b16 v[34:35], v4 offset:16896
    v_cvt_pk_bf16_f32 v109, v174, v175
    v_mfma_f32_16x16x32_bf16 v[76:79], v[20:23], a[20:23], v[76:79]
    ds_read_b64_tr_b16 v[36:37], v4 offset:20480
    v_fma_f32 v135, s49, v135, -v255
    v_mfma_f32_16x16x32_bf16 v[76:79], v[16:19], a[4:7], v[76:79]
    ds_read_b64_tr_b16 v[38:39], v4 offset:20992
    v_fma_f32 v128, s49, v128, -v255
    v_mfma_f32_16x16x32_bf16 v[80:83], v[16:19], a[8:11], v[248:251]
    v_exp_f32 v112, v112
    v_mfma_f32_16x16x32_bf16 v[80:83], v[20:23], a[24:27], v[80:83]
    v_exp_f32 v113, v113
    v_mfma_f32_16x16x32_bf16 v[80:83], v[24:27], a[40:43], v[80:83]
    buffer_load_dwordx4 v9, s[12:15], s41 offen nt lds
    v_mfma_f32_16x16x32_bf16 v[84:87], v[24:27], a[44:47], v[248:251]
    v_exp_f32 v114, v114
    v_mfma_f32_16x16x32_bf16 v[84:87], v[20:23], a[28:31], v[84:87]
    v_exp_f32 v115, v115
    v_mfma_f32_16x16x32_bf16 v[84:87], v[16:19], a[12:15], v[84:87]
    s_waitcnt lgkmcnt(0)
    v_add_f32 v112, 1.0, v112
    v_add_f32 v113, 1.0, v113
    v_mfma_f32_16x16x32_bf16 v[84:87], v[28:31], a[60:63], v[84:87]
    ds_read_b64_tr_b16 v[16:17], v4 offset:24576
    v_add_f32 v114, 1.0, v114
    v_mfma_f32_16x16x32_bf16 v[84:87], v[32:35], a[76:79], v[84:87]
    s_add_u32 m0, s82, 0x9000
    ds_read_b64_tr_b16 v[18:19], v4 offset:25088
    v_add_f32 v115, 1.0, v115
    v_mfma_f32_16x16x32_bf16 v[84:87], v[36:39], a[92:95], v[84:87]
    s_mul_i32 s41, s82, 72
    ds_read_b64_tr_b16 v[20:21], v4 offset:28672
    v_fma_f32 v129, s49, v129, -v255
    v_mfma_f32_16x16x32_bf16 v[80:83], v[36:39], a[88:91], v[80:83]
    s_add_u32 s41, s41, s83
    ds_read_b64_tr_b16 v[22:23], v4 offset:29184
    v_fma_f32 v130, s49, v130, -v255
    v_mfma_f32_16x16x32_bf16 v[80:83], v[32:35], a[72:75], v[80:83]
    ds_read_b64_tr_b16 v[24:25], v4 offset:32768
    v_fma_f32 v131, s49, v131, -v255
    v_mfma_f32_16x16x32_bf16 v[80:83], v[28:31], a[56:59], v[80:83]
    ds_read_b64_tr_b16 v[26:27], v4 offset:33280
    v_mfma_f32_16x16x32_bf16 v[76:79], v[28:31], a[52:55], v[76:79]
    v_add_u32 v4, 0xfffee000, v4
    v_mfma_f32_16x16x32_bf16 v[76:79], v[32:35], a[68:71], v[76:79]
    v_rcp_f32 v112, v112
    v_mfma_f32_16x16x32_bf16 v[76:79], v[36:39], a[84:87], v[76:79]
    buffer_load_dwordx4 v9, s[12:15], s41 offen nt lds
    v_mfma_f32_16x16x32_bf16 v[72:75], v[36:39], a[80:83], v[72:75]
    v_rcp_f32 v113, v113
    v_mfma_f32_16x16x32_bf16 v[72:75], v[32:35], a[64:67], v[72:75]
    v_rcp_f32 v114, v114
    v_mfma_f32_16x16x32_bf16 v[72:75], v[28:31], a[48:51], v[72:75]
    s_waitcnt lgkmcnt(0)
    v_rcp_f32 v115, v115
    v_mfma_f32_16x16x32_bf16 v[72:75], v[16:19], a[96:99], v[72:75]
    ds_read_b64_tr_b16 v[28:29], v5 offset:24576
    v_mul_f32 v176, v176, v112
    v_mfma_f32_16x16x32_bf16 v[72:75], v[20:23], a[112:115], v[72:75]
    s_add_u32 m0, s84, 0x9000
    ds_read_b64_tr_b16 v[30:31], v5 offset:25088
    v_mul_f32 v177, v177, v113
    v_mfma_f32_16x16x32_bf16 v[72:75], v[24:27], a[128:131], v[72:75]
    s_mul_i32 s41, s84, 72
    ds_read_b64_tr_b16 v[32:33], v5 offset:28672
    v_mul_f32 v178, v178, v114
    v_mfma_f32_16x16x32_bf16 v[76:79], v[24:27], a[132:135], v[76:79]
    s_add_u32 s41, s41, s83
    ds_read_b64_tr_b16 v[34:35], v5 offset:29184
    v_mul_f32 v179, v179, v115
    v_mfma_f32_16x16x32_bf16 v[76:79], v[20:23], a[116:119], v[76:79]
    ds_read_b64_tr_b16 v[36:37], v5 offset:32768
    v_cvt_pk_bf16_f32 v112, v176, v177
    v_mfma_f32_16x16x32_bf16 v[76:79], v[16:19], a[100:103], v[76:79]
    ds_read_b64_tr_b16 v[38:39], v5 offset:33280
    v_cvt_pk_bf16_f32 v113, v178, v179
    v_mfma_f32_16x16x32_bf16 v[80:83], v[16:19], a[104:107], v[80:83]
    v_exp_f32 v116, v116
    v_mfma_f32_16x16x32_bf16 v[80:83], v[20:23], a[120:123], v[80:83]
    v_exp_f32 v117, v117
    v_mfma_f32_16x16x32_bf16 v[80:83], v[24:27], a[136:139], v[80:83]
    buffer_load_dwordx4 v9, s[12:15], s41 offen nt lds
    v_mfma_f32_16x16x32_bf16 v[84:87], v[24:27], a[140:143], v[84:87]
    v_exp_f32 v118, v118
    v_mfma_f32_16x16x32_bf16 v[84:87], v[20:23], a[124:127], v[84:87]
    v_exp_f32 v119, v119
    v_mfma_f32_16x16x32_bf16 v[84:87], v[16:19], a[108:111], v[84:87]
    s_waitcnt lgkmcnt(0)
    v_add_f32 v116, 1.0, v116
    v_add_f32 v117, 1.0, v117
    v_mfma_f32_16x16x32_bf16 v[100:103], v[28:31], a[108:111], v[248:251]
    ds_read_b64_tr_b16 v[16:17], v5 offset:12288
    v_add_f32 v118, 1.0, v118
    v_mfma_f32_16x16x32_bf16 v[100:103], v[32:35], a[124:127], v[100:103]
    ds_read_b64_tr_b16 v[18:19], v5 offset:12800
    v_add_f32 v119, 1.0, v119
    v_mfma_f32_16x16x32_bf16 v[100:103], v[36:39], a[140:143], v[100:103]
    ds_read_b64_tr_b16 v[20:21], v5 offset:16384
    v_fma_f32 v124, s49, v124, -v255
    v_mfma_f32_16x16x32_bf16 v[96:99], v[36:39], a[136:139], v[248:251]
    ds_read_b64_tr_b16 v[22:23], v5 offset:16896
    v_fma_f32 v125, s49, v125, -v255
    v_mfma_f32_16x16x32_bf16 v[96:99], v[32:35], a[120:123], v[96:99]
    ds_read_b64_tr_b16 v[24:25], v5 offset:20480
    v_fma_f32 v126, s49, v126, -v255
    v_mfma_f32_16x16x32_bf16 v[96:99], v[28:31], a[104:107], v[96:99]
    ds_read_b64_tr_b16 v[26:27], v5 offset:20992
    v_fma_f32 v127, s49, v127, -v255
    v_mfma_f32_16x16x32_bf16 v[92:95], v[28:31], a[100:103], v[248:251]
    buffer_store_dwordx4 v[140:143], v1, s[4:7], s56 offen offset:1024 sc1
    v_mfma_f32_16x16x32_bf16 v[92:95], v[32:35], a[116:119], v[92:95]
    v_rcp_f32 v116, v116
    v_mfma_f32_16x16x32_bf16 v[92:95], v[36:39], a[132:135], v[92:95]
    v_rcp_f32 v117, v117
    v_mfma_f32_16x16x32_bf16 v[88:91], v[36:39], a[128:131], v[248:251]
    v_rcp_f32 v118, v118
    v_mfma_f32_16x16x32_bf16 v[88:91], v[32:35], a[112:115], v[88:91]
    v_rcp_f32 v119, v119
    v_mfma_f32_16x16x32_bf16 v[88:91], v[28:31], a[96:99], v[88:91]
    s_waitcnt lgkmcnt(0)
    v_mul_f32 v180, v180, v116
    v_mul_f32 v181, v181, v117
    v_mfma_f32_16x16x32_bf16 v[88:91], v[16:19], a[48:51], v[88:91]
    ds_read_b64_tr_b16 v[28:29], v5 offset:0
    v_mul_f32 v182, v182, v118
    v_mfma_f32_16x16x32_bf16 v[88:91], v[20:23], a[64:67], v[88:91]
    ds_read_b64_tr_b16 v[30:31], v5 offset:512
    v_mul_f32 v183, v183, v119
    v_mfma_f32_16x16x32_bf16 v[88:91], v[24:27], a[80:83], v[88:91]
    ds_read_b64_tr_b16 v[32:33], v5 offset:4096
    v_cvt_pk_bf16_f32 v116, v180, v181
    v_mfma_f32_16x16x32_bf16 v[92:95], v[24:27], a[84:87], v[92:95]
    ds_read_b64_tr_b16 v[34:35], v5 offset:4608
    v_cvt_pk_bf16_f32 v117, v182, v183
    v_mfma_f32_16x16x32_bf16 v[92:95], v[20:23], a[68:71], v[92:95]
    ds_read_b64_tr_b16 v[36:37], v5 offset:8192
    v_fma_f32 v120, s49, v120, -v255
    v_mfma_f32_16x16x32_bf16 v[92:95], v[16:19], a[52:55], v[92:95]
    ds_read_b64_tr_b16 v[38:39], v5 offset:8704
    v_fma_f32 v121, s49, v121, -v255
    v_mfma_f32_16x16x32_bf16 v[96:99], v[16:19], a[56:59], v[96:99]
    v_add_u32 v5, 0xfffee000, v5
    v_fma_f32 v122, s49, v122, -v255
    v_mfma_f32_16x16x32_bf16 v[96:99], v[20:23], a[72:75], v[96:99]
    v_exp_f32 v132, v132
    v_mfma_f32_16x16x32_bf16 v[96:99], v[24:27], a[88:91], v[96:99]
    v_exp_f32 v133, v133
    v_mfma_f32_16x16x32_bf16 v[100:103], v[24:27], a[92:95], v[100:103]
    v_exp_f32 v134, v134
    v_mfma_f32_16x16x32_bf16 v[100:103], v[20:23], a[76:79], v[100:103]
    v_exp_f32 v135, v135
    v_mfma_f32_16x16x32_bf16 v[100:103], v[16:19], a[60:63], v[100:103]
    s_waitcnt vmcnt(11) lgkmcnt(0)
    s_barrier
    v_add_f32 v132, 1.0, v132
    v_add_f32 v133, 1.0, v133
    v_mfma_f32_16x16x32_bf16 v[100:103], v[28:31], a[12:15], v[100:103]
    ds_read_b64_tr_b16 v[16:17], v2 offset:0
    v_add_f32 v134, 1.0, v134
    v_mfma_f32_16x16x32_bf16 v[100:103], v[32:35], a[28:31], v[100:103]
    ds_read_b64_tr_b16 v[18:19], v2 offset:512
    v_add_f32 v135, 1.0, v135
    v_mfma_f32_16x16x32_bf16 v[100:103], v[36:39], a[44:47], v[100:103]
    ds_read_b64_tr_b16 v[20:21], v2 offset:4096
    v_fma_f32 v123, s49, v123, -v255
    v_mfma_f32_16x16x32_bf16 v[96:99], v[36:39], a[40:43], v[96:99]
    ds_read_b64_tr_b16 v[22:23], v2 offset:4608
    v_mfma_f32_16x16x32_bf16 v[96:99], v[32:35], a[24:27], v[96:99]
    ds_read_b64_tr_b16 v[24:25], v2 offset:8192
    v_mfma_f32_16x16x32_bf16 v[96:99], v[28:31], a[8:11], v[96:99]
    ds_read_b64_tr_b16 v[26:27], v2 offset:8704
    v_mfma_f32_16x16x32_bf16 v[92:95], v[28:31], a[4:7], v[92:95]
    v_rcp_f32 v132, v132
    v_mfma_f32_16x16x32_bf16 v[92:95], v[32:35], a[20:23], v[92:95]
    v_rcp_f32 v133, v133
    v_mfma_f32_16x16x32_bf16 v[92:95], v[36:39], a[36:39], v[92:95]
    v_rcp_f32 v134, v134
    v_mfma_f32_16x16x32_bf16 v[88:91], v[36:39], a[32:35], v[88:91]
    v_rcp_f32 v135, v135
    v_mfma_f32_16x16x32_bf16 v[88:91], v[32:35], a[16:19], v[88:91]
    v_mul_f32 v196, v196, v132
    v_mul_f32 v197, v197, v133
    v_mfma_f32_16x16x32_bf16 v[88:91], v[28:31], a[0:3], v[88:91]
    s_waitcnt lgkmcnt(0)
    v_mul_f32 v198, v198, v134
    v_mul_f32 v199, v199, v135
    v_mfma_f32_16x16x32_bf16 v[200:203], v[16:19], a[144:147], v[200:203]
    ds_read_b64_tr_b16 v[28:29], v2 offset:12288
    v_cvt_pk_bf16_f32 v118, v196, v197
    v_mfma_f32_16x16x32_bf16 v[200:203], v[20:23], a[160:163], v[200:203]
    s_add_u32 m0, s28, 0x12000
    ds_read_b64_tr_b16 v[30:31], v2 offset:12800
    v_cvt_pk_bf16_f32 v119, v198, v199
    v_mfma_f32_16x16x32_bf16 v[200:203], v[24:27], a[176:179], v[200:203]
    s_mul_i32 s41, s28, 72
    ds_read_b64_tr_b16 v[32:33], v2 offset:16384
    v_mfma_f32_16x16x32_bf16 v[204:207], v[24:27], a[180:183], v[204:207]
    s_add_u32 s41, s41, s83
    ds_read_b64_tr_b16 v[34:35], v2 offset:16896
    v_mfma_f32_16x16x32_bf16 v[204:207], v[20:23], a[164:167], v[204:207]
    s_add_u32 s41, s41, 0x288000
    ds_read_b64_tr_b16 v[36:37], v2 offset:20480
    v_mfma_f32_16x16x32_bf16 v[204:207], v[16:19], a[148:151], v[204:207]
    ds_read_b64_tr_b16 v[38:39], v2 offset:20992
    v_mfma_f32_16x16x32_bf16 v[208:211], v[16:19], a[152:155], v[208:211]
    v_exp_f32 v128, v128
    v_mfma_f32_16x16x32_bf16 v[208:211], v[20:23], a[168:171], v[208:211]
    v_exp_f32 v129, v129
    v_mfma_f32_16x16x32_bf16 v[208:211], v[24:27], a[184:187], v[208:211]
    buffer_load_dwordx4 v9, s[12:15], s41 offen nt lds
    v_mfma_f32_16x16x32_bf16 v[212:215], v[24:27], a[188:191], v[212:215]
    v_exp_f32 v130, v130
    v_mfma_f32_16x16x32_bf16 v[212:215], v[20:23], a[172:175], v[212:215]
    v_exp_f32 v131, v131
    v_mfma_f32_16x16x32_bf16 v[212:215], v[16:19], a[156:159], v[212:215]
    s_waitcnt lgkmcnt(0)
    v_add_f32 v128, 1.0, v128
    v_add_f32 v129, 1.0, v129
    v_mfma_f32_16x16x32_bf16 v[212:215], v[28:31], a[204:207], v[212:215]
    ds_read_b64_tr_b16 v[16:17], v2 offset:24576
    v_add_f32 v130, 1.0, v130
    v_mfma_f32_16x16x32_bf16 v[212:215], v[32:35], a[220:223], v[212:215]
    s_add_u32 m0, s29, 0x12000
    ds_read_b64_tr_b16 v[18:19], v2 offset:25088
    v_add_f32 v131, 1.0, v131
    v_mfma_f32_16x16x32_bf16 v[212:215], v[36:39], a[236:239], v[212:215]
    s_mul_i32 s41, s29, 72
    ds_read_b64_tr_b16 v[20:21], v2 offset:28672
    v_mfma_f32_16x16x32_bf16 v[208:211], v[36:39], a[232:235], v[208:211]
    s_add_u32 s41, s41, s83
    ds_read_b64_tr_b16 v[22:23], v2 offset:29184
    v_mfma_f32_16x16x32_bf16 v[208:211], v[32:35], a[216:219], v[208:211]
    s_add_u32 s41, s41, 0x288000
    ds_read_b64_tr_b16 v[24:25], v2 offset:32768
    v_mfma_f32_16x16x32_bf16 v[208:211], v[28:31], a[200:203], v[208:211]
    ds_read_b64_tr_b16 v[26:27], v2 offset:33280
    v_mfma_f32_16x16x32_bf16 v[204:207], v[28:31], a[196:199], v[204:207]
    v_add_u32 v2, 0x9000, v2
    v_mfma_f32_16x16x32_bf16 v[204:207], v[32:35], a[212:215], v[204:207]
    v_rcp_f32 v128, v128
    v_mfma_f32_16x16x32_bf16 v[204:207], v[36:39], a[228:231], v[204:207]
    buffer_load_dwordx4 v9, s[12:15], s41 offen nt lds
    v_mfma_f32_16x16x32_bf16 v[200:203], v[36:39], a[224:227], v[200:203]
    v_rcp_f32 v129, v129
    v_mfma_f32_16x16x32_bf16 v[200:203], v[32:35], a[208:211], v[200:203]
    v_rcp_f32 v130, v130
    v_mfma_f32_16x16x32_bf16 v[200:203], v[28:31], a[192:195], v[200:203]
    s_waitcnt lgkmcnt(0)
    v_rcp_f32 v131, v131
    v_mfma_f32_16x16x32_bf16 v[200:203], v[16:19], a[240:243], v[200:203]
    ds_read_b64_tr_b16 v[28:29], v3 offset:24576
    v_mul_f32 v192, v192, v128
    v_mfma_f32_16x16x32_bf16 v[200:203], v[20:23], v[40:43], v[200:203]
    s_add_u32 m0, s30, 0x12000
    ds_read_b64_tr_b16 v[30:31], v3 offset:25088
    v_mul_f32 v193, v193, v129
    v_mfma_f32_16x16x32_bf16 v[200:203], v[24:27], v[56:59], v[200:203]
    s_mul_i32 s41, s30, 72
    ds_read_b64_tr_b16 v[32:33], v3 offset:28672
    v_mul_f32 v194, v194, v130
    v_mfma_f32_16x16x32_bf16 v[204:207], v[24:27], v[60:63], v[204:207]
    s_add_u32 s41, s41, s83
    ds_read_b64_tr_b16 v[34:35], v3 offset:29184
    v_mul_f32 v195, v195, v131
    v_mfma_f32_16x16x32_bf16 v[204:207], v[20:23], v[44:47], v[204:207]
    s_add_u32 s41, s41, 0x288000
    ds_read_b64_tr_b16 v[36:37], v3 offset:32768
    v_cvt_pk_bf16_f32 v114, v192, v193
    v_mfma_f32_16x16x32_bf16 v[204:207], v[16:19], a[244:247], v[204:207]
    ds_read_b64_tr_b16 v[38:39], v3 offset:33280
    v_cvt_pk_bf16_f32 v115, v194, v195
    v_mfma_f32_16x16x32_bf16 v[208:211], v[16:19], a[248:251], v[208:211]
    v_exp_f32 v124, v124
    v_mfma_f32_16x16x32_bf16 v[208:211], v[20:23], v[48:51], v[208:211]
    buffer_store_dwordx4 v[144:147], v1, s[4:7], s56 offen offset:2048 sc1
    v_mfma_f32_16x16x32_bf16 v[208:211], v[24:27], v[64:67], v[208:211]
    buffer_load_dwordx4 v9, s[12:15], s41 offen nt lds
    v_mfma_f32_16x16x32_bf16 v[212:215], v[24:27], v[68:71], v[212:215]
    v_exp_f32 v125, v125
    v_mfma_f32_16x16x32_bf16 v[212:215], v[20:23], v[52:55], v[212:215]
    v_exp_f32 v126, v126
    v_mfma_f32_16x16x32_bf16 v[212:215], v[16:19], a[252:255], v[212:215]
    s_waitcnt lgkmcnt(0)
    v_exp_f32 v127, v127
    v_mfma_f32_16x16x32_bf16 v[228:231], v[28:31], a[252:255], v[228:231]
    ds_read_b64_tr_b16 v[16:17], v3 offset:12288
    v_add_f32 v124, 1.0, v124
    v_mfma_f32_16x16x32_bf16 v[228:231], v[32:35], v[52:55], v[228:231]
    s_add_u32 m0, s31, 0x12000
    ds_read_b64_tr_b16 v[18:19], v3 offset:12800
    v_add_f32 v125, 1.0, v125
    v_mfma_f32_16x16x32_bf16 v[228:231], v[36:39], v[68:71], v[228:231]
    s_mul_i32 s41, s31, 72
    ds_read_b64_tr_b16 v[20:21], v3 offset:16384
    v_add_f32 v126, 1.0, v126
    v_mfma_f32_16x16x32_bf16 v[224:227], v[36:39], v[64:67], v[224:227]
    s_add_u32 s41, s41, s83
    ds_read_b64_tr_b16 v[22:23], v3 offset:16896
    v_add_f32 v127, 1.0, v127
    v_mfma_f32_16x16x32_bf16 v[224:227], v[32:35], v[48:51], v[224:227]
    s_add_u32 s41, s41, 0x288000
    ds_read_b64_tr_b16 v[24:25], v3 offset:20480
    v_fma_f32 v208, s49, v208, -v255
    v_mfma_f32_16x16x32_bf16 v[224:227], v[28:31], a[248:251], v[224:227]
    ds_read_b64_tr_b16 v[26:27], v3 offset:20992
    v_fma_f32 v212, s49, v212, -v255
    v_mfma_f32_16x16x32_bf16 v[220:223], v[28:31], a[244:247], v[220:223]
    v_rcp_f32 v124, v124
    v_mfma_f32_16x16x32_bf16 v[220:223], v[32:35], v[44:47], v[220:223]
    v_rcp_f32 v125, v125
    v_mfma_f32_16x16x32_bf16 v[220:223], v[36:39], v[60:63], v[220:223]
    buffer_load_dwordx4 v9, s[12:15], s41 offen nt lds
    v_mfma_f32_16x16x32_bf16 v[216:219], v[36:39], v[56:59], v[216:219]
    v_rcp_f32 v126, v126
    v_mfma_f32_16x16x32_bf16 v[216:219], v[32:35], v[40:43], v[216:219]
    v_rcp_f32 v127, v127
    v_mfma_f32_16x16x32_bf16 v[216:219], v[28:31], a[240:243], v[216:219]
    s_waitcnt lgkmcnt(0)
    v_mul_f32 v188, v188, v124
    v_mul_f32 v189, v189, v125
    v_mfma_f32_16x16x32_bf16 v[216:219], v[16:19], a[192:195], v[216:219]
    ds_read_b64_tr_b16 v[28:29], v3 offset:0
    v_mul_f32 v190, v190, v126
    v_mfma_f32_16x16x32_bf16 v[216:219], v[20:23], a[208:211], v[216:219]
    s_add_u32 m0, s46, 0x12000
    ds_read_b64_tr_b16 v[30:31], v3 offset:512
    v_mul_f32 v191, v191, v127
    v_mfma_f32_16x16x32_bf16 v[216:219], v[24:27], a[224:227], v[216:219]
    s_mul_i32 s41, s46, 72
    ds_read_b64_tr_b16 v[32:33], v3 offset:4096
    v_cvt_pk_bf16_f32 v110, v188, v189
    v_mfma_f32_16x16x32_bf16 v[220:223], v[24:27], a[228:231], v[220:223]
    s_add_u32 s41, s41, s83
    ds_read_b64_tr_b16 v[34:35], v3 offset:4608
    v_cvt_pk_bf16_f32 v111, v190, v191
    v_mfma_f32_16x16x32_bf16 v[220:223], v[20:23], a[212:215], v[220:223]
    s_add_u32 s41, s41, 0x288000
    ds_read_b64_tr_b16 v[36:37], v3 offset:8192
    v_fma_f32 v213, s49, v213, -v255
    v_mfma_f32_16x16x32_bf16 v[220:223], v[16:19], a[196:199], v[220:223]
    ds_read_b64_tr_b16 v[38:39], v3 offset:8704
    v_fma_f32 v214, s49, v214, -v255
    v_mfma_f32_16x16x32_bf16 v[224:227], v[16:19], a[200:203], v[224:227]
    v_add_u32 v3, 0x9000, v3
    v_fma_f32 v215, s49, v215, -v255
    v_mfma_f32_16x16x32_bf16 v[224:227], v[20:23], a[216:219], v[224:227]
    v_exp_f32 v120, v120
    v_mfma_f32_16x16x32_bf16 v[224:227], v[24:27], a[232:235], v[224:227]
    buffer_load_dwordx4 v9, s[12:15], s41 offen nt lds
    v_mfma_f32_16x16x32_bf16 v[228:231], v[24:27], a[236:239], v[228:231]
    v_exp_f32 v121, v121
    v_mfma_f32_16x16x32_bf16 v[228:231], v[20:23], a[220:223], v[228:231]
    v_exp_f32 v122, v122
    v_mfma_f32_16x16x32_bf16 v[228:231], v[16:19], a[204:207], v[228:231]
    s_waitcnt lgkmcnt(0)
    v_exp_f32 v123, v123
    v_mfma_f32_16x16x32_bf16 v[228:231], v[28:31], a[156:159], v[228:231]
    ds_read_b64_tr_b16 v[16:17], v4 offset:0
    v_add_f32 v120, 1.0, v120
    v_mfma_f32_16x16x32_bf16 v[228:231], v[32:35], a[172:175], v[228:231]
    s_add_u32 m0, s47, 0x12000
    ds_read_b64_tr_b16 v[18:19], v4 offset:512
    v_add_f32 v121, 1.0, v121
    v_mfma_f32_16x16x32_bf16 v[228:231], v[36:39], a[188:191], v[228:231]
    s_mul_i32 s41, s47, 72
    ds_read_b64_tr_b16 v[20:21], v4 offset:4096
    v_add_f32 v122, 1.0, v122
    v_mfma_f32_16x16x32_bf16 v[224:227], v[36:39], a[184:187], v[224:227]
    s_add_u32 s41, s41, s83
    ds_read_b64_tr_b16 v[22:23], v4 offset:4608
    v_add_f32 v123, 1.0, v123
    v_mfma_f32_16x16x32_bf16 v[224:227], v[32:35], a[168:171], v[224:227]
    s_add_u32 s41, s41, 0x288000
    ds_read_b64_tr_b16 v[24:25], v4 offset:8192
    v_fma_f32 v209, s49, v209, -v255
    v_mfma_f32_16x16x32_bf16 v[224:227], v[28:31], a[152:155], v[224:227]
    ds_read_b64_tr_b16 v[26:27], v4 offset:8704
    v_fma_f32 v210, s49, v210, -v255
    v_mfma_f32_16x16x32_bf16 v[220:223], v[28:31], a[148:151], v[220:223]
    v_rcp_f32 v120, v120
    v_mfma_f32_16x16x32_bf16 v[220:223], v[32:35], a[164:167], v[220:223]
    v_rcp_f32 v121, v121
    v_mfma_f32_16x16x32_bf16 v[220:223], v[36:39], a[180:183], v[220:223]
    buffer_load_dwordx4 v9, s[12:15], s41 offen nt lds
    v_mfma_f32_16x16x32_bf16 v[216:219], v[36:39], a[176:179], v[216:219]
    v_rcp_f32 v122, v122
    v_mfma_f32_16x16x32_bf16 v[216:219], v[32:35], a[160:163], v[216:219]
    v_rcp_f32 v123, v123
    v_mfma_f32_16x16x32_bf16 v[216:219], v[28:31], a[144:147], v[216:219]
    s_waitcnt lgkmcnt(0)
    v_mul_f32 v184, v184, v120
    v_mul_f32 v185, v185, v121
    v_mfma_f32_16x16x32_bf16 v[72:75], v[16:19], a[144:147], v[72:75]
    ds_read_b64_tr_b16 v[28:29], v4 offset:12288
    v_mul_f32 v186, v186, v122
    v_mfma_f32_16x16x32_bf16 v[72:75], v[20:23], a[160:163], v[72:75]
    s_add_u32 m0, s48, 0x12000
    ds_read_b64_tr_b16 v[30:31], v4 offset:12800
    v_mul_f32 v187, v187, v123
    v_mfma_f32_16x16x32_bf16 v[72:75], v[24:27], a[176:179], v[72:75]
    s_mul_i32 s41, s48, 72
    ds_read_b64_tr_b16 v[32:33], v4 offset:16384
    v_cvt_pk_bf16_f32 v106, v184, v185
    v_mfma_f32_16x16x32_bf16 v[76:79], v[24:27], a[180:183], v[76:79]
    s_add_u32 s41, s41, s83
L_hop0_4:
    s_cbranch_execz L_hop0_13
    ds_read_b64_tr_b16 v[34:35], v4 offset:16896
    v_cvt_pk_bf16_f32 v107, v186, v187
    v_mfma_f32_16x16x32_bf16 v[76:79], v[20:23], a[164:167], v[76:79]
    s_add_u32 s41, s41, 0x288000
    ds_read_b64_tr_b16 v[36:37], v4 offset:20480
    v_fma_f32 v211, s49, v211, -v255
    v_mfma_f32_16x16x32_bf16 v[76:79], v[16:19], a[148:151], v[76:79]
    ds_read_b64_tr_b16 v[38:39], v4 offset:20992
    v_fma_f32 v204, s49, v204, -v255
    v_mfma_f32_16x16x32_bf16 v[80:83], v[16:19], a[152:155], v[80:83]
    v_exp_f32 v212, v212
    v_mfma_f32_16x16x32_bf16 v[80:83], v[20:23], a[168:171], v[80:83]
    v_exp_f32 v213, v213
    v_mfma_f32_16x16x32_bf16 v[80:83], v[24:27], a[184:187], v[80:83]
    buffer_load_dwordx4 v9, s[12:15], s41 offen nt lds
    v_mfma_f32_16x16x32_bf16 v[84:87], v[24:27], a[188:191], v[84:87]
    v_exp_f32 v214, v214
    v_mfma_f32_16x16x32_bf16 v[84:87], v[20:23], a[172:175], v[84:87]
    v_exp_f32 v215, v215
    v_mfma_f32_16x16x32_bf16 v[84:87], v[16:19], a[156:159], v[84:87]
    s_waitcnt lgkmcnt(0)
    v_add_f32 v212, 1.0, v212
    v_add_f32 v213, 1.0, v213
    v_mfma_f32_16x16x32_bf16 v[84:87], v[28:31], a[204:207], v[84:87]
    ds_read_b64_tr_b16 v[16:17], v4 offset:24576
    v_add_f32 v214, 1.0, v214
    v_mfma_f32_16x16x32_bf16 v[84:87], v[32:35], a[220:223], v[84:87]
    s_add_u32 m0, s82, 0x12000
    ds_read_b64_tr_b16 v[18:19], v4 offset:25088
    v_add_f32 v215, 1.0, v215
    v_mfma_f32_16x16x32_bf16 v[84:87], v[36:39], a[236:239], v[84:87]
    s_mul_i32 s41, s82, 72
    ds_read_b64_tr_b16 v[20:21], v4 offset:28672
    v_fma_f32 v205, s49, v205, -v255
    v_mfma_f32_16x16x32_bf16 v[80:83], v[36:39], a[232:235], v[80:83]
    s_add_u32 s41, s41, s83
    ds_read_b64_tr_b16 v[22:23], v4 offset:29184
    v_fma_f32 v206, s49, v206, -v255
    v_mfma_f32_16x16x32_bf16 v[80:83], v[32:35], a[216:219], v[80:83]
    s_add_u32 s41, s41, 0x288000
    ds_read_b64_tr_b16 v[24:25], v4 offset:32768
    v_fma_f32 v207, s49, v207, -v255
    v_mfma_f32_16x16x32_bf16 v[80:83], v[28:31], a[200:203], v[80:83]
    ds_read_b64_tr_b16 v[26:27], v4 offset:33280
    v_fma_f32 v200, s49, v200, -v255
    v_mfma_f32_16x16x32_bf16 v[76:79], v[28:31], a[196:199], v[76:79]
    v_add_u32 v4, 0x9000, v4
    v_fma_f32 v201, s49, v201, -v255
    v_mfma_f32_16x16x32_bf16 v[76:79], v[32:35], a[212:215], v[76:79]
    v_rcp_f32 v212, v212
    v_mfma_f32_16x16x32_bf16 v[76:79], v[36:39], a[228:231], v[76:79]
    buffer_load_dwordx4 v9, s[12:15], s41 offen nt lds
    v_mfma_f32_16x16x32_bf16 v[72:75], v[36:39], a[224:227], v[72:75]
    v_rcp_f32 v213, v213
    v_mfma_f32_16x16x32_bf16 v[72:75], v[32:35], a[208:211], v[72:75]
    v_rcp_f32 v214, v214
    v_mfma_f32_16x16x32_bf16 v[72:75], v[28:31], a[192:195], v[72:75]
    s_waitcnt lgkmcnt(0)
    v_rcp_f32 v215, v215
    v_mfma_f32_16x16x32_bf16 v[72:75], v[16:19], a[240:243], v[72:75]
    ds_read_b64_tr_b16 v[28:29], v5 offset:24576
    v_fma_f32 v202, s49, v202, -v255
    v_mfma_f32_16x16x32_bf16 v[72:75], v[20:23], v[40:43], v[72:75]
    s_add_u32 m0, s84, 0x12000
    ds_read_b64_tr_b16 v[30:31], v5 offset:25088
    v_fma_f32 v203, s49, v203, -v255
    v_mfma_f32_16x16x32_bf16 v[72:75], v[24:27], v[56:59], v[72:75]
    s_mul_i32 s41, s84, 72
    ds_read_b64_tr_b16 v[32:33], v5 offset:28672
    v_fma_f32 v228, s49, v228, -v255
    v_mfma_f32_16x16x32_bf16 v[76:79], v[24:27], v[60:63], v[76:79]
    s_add_u32 s41, s41, s83
    ds_read_b64_tr_b16 v[34:35], v5 offset:29184
    v_fma_f32 v229, s49, v229, -v255
    v_mfma_f32_16x16x32_bf16 v[76:79], v[20:23], v[44:47], v[76:79]
    s_add_u32 s41, s41, 0x288000
    ds_read_b64_tr_b16 v[36:37], v5 offset:32768
    v_fma_f32 v230, s49, v230, -v255
    v_mfma_f32_16x16x32_bf16 v[76:79], v[16:19], a[244:247], v[76:79]
    ds_read_b64_tr_b16 v[38:39], v5 offset:33280
    v_fma_f32 v231, s49, v231, -v255
    v_mfma_f32_16x16x32_bf16 v[80:83], v[16:19], a[248:251], v[80:83]
    buffer_store_dwordx4 v[148:151], v1, s[4:7], s56 offen offset:3072 sc1
    v_mfma_f32_16x16x32_bf16 v[80:83], v[20:23], v[48:51], v[80:83]
    v_exp_f32 v208, v208
    v_mfma_f32_16x16x32_bf16 v[80:83], v[24:27], v[64:67], v[80:83]
    buffer_load_dwordx4 v9, s[12:15], s41 offen nt lds
    v_mfma_f32_16x16x32_bf16 v[84:87], v[24:27], v[68:71], v[84:87]
    v_fma_f32 v72, s49, v72, -v255
    v_fma_f32 v73, s49, v73, -v255
    v_mfma_f32_16x16x32_bf16 v[84:87], v[20:23], v[52:55], v[84:87]
    v_fma_f32 v74, s49, v74, -v255
    v_fma_f32 v75, s49, v75, -v255
    v_mfma_f32_16x16x32_bf16 v[84:87], v[16:19], a[252:255], v[84:87]
    s_waitcnt lgkmcnt(0)
    v_exp_f32 v72, v72
    v_mfma_f32_16x16x32_bf16 v[100:103], v[28:31], a[252:255], v[100:103]
    ds_read_b64_tr_b16 v[16:17], v5 offset:12288
    v_add_f32 v72, 1.0, v72
    v_mfma_f32_16x16x32_bf16 v[100:103], v[32:35], v[52:55], v[100:103]
    s_add_u32 m0, s39, 0x1b000
    ds_read_b64_tr_b16 v[18:19], v5 offset:12800
    v_fma_f32 v76, s49, v76, -v255
    v_mfma_f32_16x16x32_bf16 v[100:103], v[36:39], v[68:71], v[100:103]
    s_add_u32 s41, s38, 0x0
    ds_read_b64_tr_b16 v[20:21], v5 offset:16384
    v_fma_f32 v77, s49, v77, -v255
    v_mfma_f32_16x16x32_bf16 v[96:99], v[36:39], v[64:67], v[96:99]
    ds_read_b64_tr_b16 v[22:23], v5 offset:16896
    v_fma_f32 v78, s49, v78, -v255
    v_mfma_f32_16x16x32_bf16 v[96:99], v[32:35], v[48:51], v[96:99]
    ds_read_b64_tr_b16 v[24:25], v5 offset:20480
    v_fma_f32 v79, s49, v79, -v255
    v_mfma_f32_16x16x32_bf16 v[96:99], v[28:31], a[248:251], v[96:99]
    ds_read_b64_tr_b16 v[26:27], v5 offset:20992
    v_fma_f32 v80, s49, v80, -v255
    v_mfma_f32_16x16x32_bf16 v[92:95], v[28:31], a[244:247], v[92:95]
    v_exp_f32 v73, v73
    v_mfma_f32_16x16x32_bf16 v[92:95], v[32:35], v[44:47], v[92:95]
    v_exp_f32 v74, v74
    v_mfma_f32_16x16x32_bf16 v[92:95], v[36:39], v[60:63], v[92:95]
    buffer_load_dwordx4 v1, s[4:7], s41 offen sc1 lds
    v_mfma_f32_16x16x32_bf16 v[88:91], v[36:39], v[56:59], v[88:91]
    v_exp_f32 v75, v75
    v_mfma_f32_16x16x32_bf16 v[88:91], v[32:35], v[40:43], v[88:91]
    v_add_f32 v73, 1.0, v73
    v_add_f32 v74, 1.0, v74
    v_mfma_f32_16x16x32_bf16 v[88:91], v[28:31], a[240:243], v[88:91]
    s_waitcnt lgkmcnt(0)
    v_add_f32 v75, 1.0, v75
    v_fma_f32 v81, s49, v81, -v255
    v_mfma_f32_16x16x32_bf16 v[88:91], v[16:19], a[192:195], v[88:91]
    ds_read_b64_tr_b16 v[28:29], v5 offset:0
    v_fma_f32 v82, s49, v82, -v255
    v_mfma_f32_16x16x32_bf16 v[88:91], v[20:23], a[208:211], v[88:91]
    s_add_u32 m0, s39, 0x1b400
    ds_read_b64_tr_b16 v[30:31], v5 offset:512
    v_fma_f32 v83, s49, v83, -v255
    v_mfma_f32_16x16x32_bf16 v[88:91], v[24:27], a[224:227], v[88:91]
    s_add_u32 s41, s38, 0x400
    ds_read_b64_tr_b16 v[32:33], v5 offset:4096
    v_fma_f32 v84, s49, v84, -v255
    v_mfma_f32_16x16x32_bf16 v[92:95], v[24:27], a[228:231], v[92:95]
    ds_read_b64_tr_b16 v[34:35], v5 offset:4608
    v_fma_f32 v85, s49, v85, -v255
    v_mfma_f32_16x16x32_bf16 v[92:95], v[20:23], a[212:215], v[92:95]
    ds_read_b64_tr_b16 v[36:37], v5 offset:8192
    v_fma_f32 v86, s49, v86, -v255
    v_mfma_f32_16x16x32_bf16 v[92:95], v[16:19], a[196:199], v[92:95]
    ds_read_b64_tr_b16 v[38:39], v5 offset:8704
    v_fma_f32 v87, s49, v87, -v255
    v_mfma_f32_16x16x32_bf16 v[96:99], v[16:19], a[200:203], v[96:99]
    v_add_u32 v5, 0x9000, v5
    v_add_f32 v208, 1.0, v208
    v_mfma_f32_16x16x32_bf16 v[96:99], v[20:23], a[216:219], v[96:99]
    v_rcp_f32 v72, v72
    v_mfma_f32_16x16x32_bf16 v[96:99], v[24:27], a[232:235], v[96:99]
    buffer_load_dwordx4 v1, s[4:7], s41 offen sc1 lds
    v_mfma_f32_16x16x32_bf16 v[100:103], v[24:27], a[236:239], v[100:103]
    v_rcp_f32 v73, v73
    v_mfma_f32_16x16x32_bf16 v[100:103], v[20:23], a[220:223], v[100:103]
    v_rcp_f32 v74, v74
    v_mfma_f32_16x16x32_bf16 v[100:103], v[16:19], a[204:207], v[100:103]
    s_waitcnt vmcnt(14) lgkmcnt(0)
    s_barrier
    v_rcp_f32 v75, v75
    v_mfma_f32_16x16x32_bf16 v[100:103], v[28:31], a[156:159], v[100:103]
    ds_read_b64_tr_b16 v[16:17], v2 offset:0
    v_mfma_f32_16x16x32_bf16 v[100:103], v[32:35], a[172:175], v[100:103]
    s_add_u32 m0, s39, 0x1b800
    ds_read_b64_tr_b16 v[18:19], v2 offset:512
    v_mfma_f32_16x16x32_bf16 v[100:103], v[36:39], a[188:191], v[100:103]
    s_add_u32 s41, s38, 0x800
    ds_read_b64_tr_b16 v[20:21], v2 offset:4096
    v_mfma_f32_16x16x32_bf16 v[96:99], v[36:39], a[184:187], v[96:99]
    ds_read_b64_tr_b16 v[22:23], v2 offset:4608
    v_mfma_f32_16x16x32_bf16 v[96:99], v[32:35], a[168:171], v[96:99]
    ds_read_b64_tr_b16 v[24:25], v2 offset:8192
    v_mfma_f32_16x16x32_bf16 v[96:99], v[28:31], a[152:155], v[96:99]
    ds_read_b64_tr_b16 v[26:27], v2 offset:8704
    v_mfma_f32_16x16x32_bf16 v[92:95], v[28:31], a[148:151], v[92:95]
    v_exp_f32 v76, v76
    v_mfma_f32_16x16x32_bf16 v[92:95], v[32:35], a[164:167], v[92:95]
    v_exp_f32 v77, v77
    v_mfma_f32_16x16x32_bf16 v[92:95], v[36:39], a[180:183], v[92:95]
    buffer_load_dwordx4 v1, s[4:7], s41 offen sc1 lds
    v_mfma_f32_16x16x32_bf16 v[88:91], v[36:39], a[176:179], v[88:91]
    v_exp_f32 v78, v78
    v_mfma_f32_16x16x32_bf16 v[88:91], v[32:35], a[160:163], v[88:91]
    v_exp_f32 v79, v79
    v_mfma_f32_16x16x32_bf16 v[88:91], v[28:31], a[144:147], v[88:91]
    s_waitcnt lgkmcnt(0)
    v_add_f32 v76, 1.0, v76
    v_add_f32 v77, 1.0, v77
    v_mfma_f32_16x16x32_bf16 v[136:139], v[16:19], a[0:3], 0
    ds_read_b64_tr_b16 v[28:29], v2 offset:12288
    v_add_f32 v78, 1.0, v78
    v_mfma_f32_16x16x32_bf16 v[136:139], v[20:23], a[16:19], v[136:139]
    s_add_u32 m0, s39, 0x1bc00
    ds_read_b64_tr_b16 v[30:31], v2 offset:12800
    v_add_f32 v79, 1.0, v79
    v_mfma_f32_16x16x32_bf16 v[136:139], v[24:27], a[32:35], v[136:139]
    s_add_u32 s41, s38, 0xc00
    ds_read_b64_tr_b16 v[32:33], v2 offset:16384
    v_fma_f32 v92, s49, v92, -v255
    v_mfma_f32_16x16x32_bf16 v[140:143], v[24:27], a[36:39], 0
    ds_read_b64_tr_b16 v[34:35], v2 offset:16896
    v_fma_f32 v93, s49, v93, -v255
    v_mfma_f32_16x16x32_bf16 v[140:143], v[20:23], a[20:23], v[140:143]
    ds_read_b64_tr_b16 v[36:37], v2 offset:20480
    v_fma_f32 v94, s49, v94, -v255
    v_mfma_f32_16x16x32_bf16 v[140:143], v[16:19], a[4:7], v[140:143]
    ds_read_b64_tr_b16 v[38:39], v2 offset:20992
    v_fma_f32 v88, s49, v88, -v255
    v_mfma_f32_16x16x32_bf16 v[144:147], v[16:19], a[8:11], 0
    v_rcp_f32 v76, v76
    v_mfma_f32_16x16x32_bf16 v[144:147], v[20:23], a[24:27], v[144:147]
    v_rcp_f32 v77, v77
    v_mfma_f32_16x16x32_bf16 v[144:147], v[24:27], a[40:43], v[144:147]
    buffer_load_dwordx4 v1, s[4:7], s41 offen sc1 lds
    v_mfma_f32_16x16x32_bf16 v[148:151], v[24:27], a[44:47], 0
    v_rcp_f32 v78, v78
    v_mfma_f32_16x16x32_bf16 v[148:151], v[20:23], a[28:31], v[148:151]
    v_rcp_f32 v79, v79
    v_mfma_f32_16x16x32_bf16 v[148:151], v[16:19], a[12:15], v[148:151]
    s_waitcnt lgkmcnt(0)
    v_exp_f32 v80, v80
    v_mfma_f32_16x16x32_bf16 v[148:151], v[28:31], a[60:63], v[148:151]
    ds_read_b64_tr_b16 v[16:17], v2 offset:24576
    v_add_f32 v80, 1.0, v80
    v_mfma_f32_16x16x32_bf16 v[148:151], v[32:35], a[76:79], v[148:151]
    s_add_u32 m0, s39, 0x1c000
    ds_read_b64_tr_b16 v[18:19], v2 offset:25088
    v_fma_f32 v89, s49, v89, -v255
    v_mfma_f32_16x16x32_bf16 v[148:151], v[36:39], a[92:95], v[148:151]
    s_add_u32 s41, s38, 0x1000
    ds_read_b64_tr_b16 v[20:21], v2 offset:28672
    v_fma_f32 v90, s49, v90, -v255
    v_mfma_f32_16x16x32_bf16 v[144:147], v[36:39], a[88:91], v[144:147]
    ds_read_b64_tr_b16 v[22:23], v2 offset:29184
    v_fma_f32 v91, s49, v91, -v255
    v_mfma_f32_16x16x32_bf16 v[144:147], v[32:35], a[72:75], v[144:147]
    ds_read_b64_tr_b16 v[24:25], v2 offset:32768
    v_mfma_f32_16x16x32_bf16 v[144:147], v[28:31], a[56:59], v[144:147]
    ds_read_b64_tr_b16 v[26:27], v2 offset:33280
    v_mfma_f32_16x16x32_bf16 v[140:143], v[28:31], a[52:55], v[140:143]
    v_add_u32 v2, 0x9000, v2
    v_mfma_f32_16x16x32_bf16 v[140:143], v[32:35], a[68:71], v[140:143]
    buffer_store_dwordx4 v[104:107], v1, s[4:7], s57 offen offset:0 sc1
    v_mfma_f32_16x16x32_bf16 v[140:143], v[36:39], a[84:87], v[140:143]
    buffer_load_dwordx4 v1, s[4:7], s41 offen sc1 lds
    v_mfma_f32_16x16x32_bf16 v[136:139], v[36:39], a[80:83], v[136:139]
    v_exp_f32 v81, v81
    v_mfma_f32_16x16x32_bf16 v[136:139], v[32:35], a[64:67], v[136:139]
    v_exp_f32 v82, v82
    v_mfma_f32_16x16x32_bf16 v[136:139], v[28:31], a[48:51], v[136:139]
    s_waitcnt lgkmcnt(0)
    v_exp_f32 v83, v83
    v_mfma_f32_16x16x32_bf16 v[136:139], v[16:19], a[96:99], v[136:139]
    ds_read_b64_tr_b16 v[28:29], v3 offset:24576
    v_add_f32 v81, 1.0, v81
    v_mfma_f32_16x16x32_bf16 v[136:139], v[20:23], a[112:115], v[136:139]
    s_add_u32 m0, s39, 0x1c400
    ds_read_b64_tr_b16 v[30:31], v3 offset:25088
    v_add_f32 v82, 1.0, v82
    v_mfma_f32_16x16x32_bf16 v[136:139], v[24:27], a[128:131], v[136:139]
    s_add_u32 s41, s38, 0x1400
    ds_read_b64_tr_b16 v[32:33], v3 offset:28672
    v_add_f32 v83, 1.0, v83
    v_mfma_f32_16x16x32_bf16 v[140:143], v[24:27], a[132:135], v[140:143]
    ds_read_b64_tr_b16 v[34:35], v3 offset:29184
    v_fma_f32 v95, s49, v95, -v255
    v_mfma_f32_16x16x32_bf16 v[140:143], v[20:23], a[116:119], v[140:143]
    ds_read_b64_tr_b16 v[36:37], v3 offset:32768
    v_mfma_f32_16x16x32_bf16 v[140:143], v[16:19], a[100:103], v[140:143]
    ds_read_b64_tr_b16 v[38:39], v3 offset:33280
    v_mfma_f32_16x16x32_bf16 v[144:147], v[16:19], a[104:107], v[144:147]
    v_rcp_f32 v80, v80
    v_mfma_f32_16x16x32_bf16 v[144:147], v[20:23], a[120:123], v[144:147]
    v_rcp_f32 v81, v81
    v_mfma_f32_16x16x32_bf16 v[144:147], v[24:27], a[136:139], v[144:147]
    buffer_load_dwordx4 v1, s[4:7], s41 offen sc1 lds
    v_mfma_f32_16x16x32_bf16 v[148:151], v[24:27], a[140:143], v[148:151]
    v_rcp_f32 v82, v82
    v_mfma_f32_16x16x32_bf16 v[148:151], v[20:23], a[124:127], v[148:151]
    v_rcp_f32 v83, v83
    v_mfma_f32_16x16x32_bf16 v[148:151], v[16:19], a[108:111], v[148:151]
    s_waitcnt lgkmcnt(0)
    v_exp_f32 v84, v84
    v_mfma_f32_16x16x32_bf16 v[164:167], v[28:31], a[108:111], 0
    ds_read_b64_tr_b16 v[16:17], v3 offset:12288
    v_add_f32 v84, 1.0, v84
    v_mfma_f32_16x16x32_bf16 v[164:167], v[32:35], a[124:127], v[164:167]
    s_add_u32 m0, s39, 0x1c800
    ds_read_b64_tr_b16 v[18:19], v3 offset:12800
    v_mfma_f32_16x16x32_bf16 v[164:167], v[36:39], a[140:143], v[164:167]
    s_add_u32 s41, s38, 0x1800
    ds_read_b64_tr_b16 v[20:21], v3 offset:16384
    v_mfma_f32_16x16x32_bf16 v[160:163], v[36:39], a[136:139], 0
    ds_read_b64_tr_b16 v[22:23], v3 offset:16896
    v_mfma_f32_16x16x32_bf16 v[160:163], v[32:35], a[120:123], v[160:163]
    ds_read_b64_tr_b16 v[24:25], v3 offset:20480
    v_mfma_f32_16x16x32_bf16 v[160:163], v[28:31], a[104:107], v[160:163]
    ds_read_b64_tr_b16 v[26:27], v3 offset:20992
    v_mfma_f32_16x16x32_bf16 v[156:159], v[28:31], a[100:103], 0
    v_exp_f32 v85, v85
    v_mfma_f32_16x16x32_bf16 v[156:159], v[32:35], a[116:119], v[156:159]
    v_exp_f32 v86, v86
    v_mfma_f32_16x16x32_bf16 v[156:159], v[36:39], a[132:135], v[156:159]
    buffer_load_dwordx4 v1, s[4:7], s41 offen sc1 lds
    v_mfma_f32_16x16x32_bf16 v[152:155], v[36:39], a[128:131], 0
    v_exp_f32 v87, v87
    v_mfma_f32_16x16x32_bf16 v[152:155], v[32:35], a[112:115], v[152:155]
    v_add_f32 v85, 1.0, v85
    v_add_f32 v86, 1.0, v86
    v_mfma_f32_16x16x32_bf16 v[152:155], v[28:31], a[96:99], v[152:155]
    s_waitcnt lgkmcnt(0)
    v_add_f32 v87, 1.0, v87
    v_fma_f32 v96, s49, v96, -v255
    v_mfma_f32_16x16x32_bf16 v[152:155], v[16:19], a[48:51], v[152:155]
    ds_read_b64_tr_b16 v[28:29], v3 offset:0
    v_fma_f32 v97, s49, v97, -v255
    v_mfma_f32_16x16x32_bf16 v[152:155], v[20:23], a[64:67], v[152:155]
    s_add_u32 m0, s39, 0x1cc00
    ds_read_b64_tr_b16 v[30:31], v3 offset:512
    v_fma_f32 v98, s49, v98, -v255
    v_mfma_f32_16x16x32_bf16 v[152:155], v[24:27], a[80:83], v[152:155]
    s_add_u32 s41, s38, 0x1c00
    ds_read_b64_tr_b16 v[32:33], v3 offset:4096
    v_fma_f32 v99, s49, v99, -v255
    v_mfma_f32_16x16x32_bf16 v[156:159], v[24:27], a[84:87], v[156:159]
    ds_read_b64_tr_b16 v[34:35], v3 offset:4608
    v_mfma_f32_16x16x32_bf16 v[156:159], v[20:23], a[68:71], v[156:159]
    ds_read_b64_tr_b16 v[36:37], v3 offset:8192
    v_mfma_f32_16x16x32_bf16 v[156:159], v[16:19], a[52:55], v[156:159]
    ds_read_b64_tr_b16 v[38:39], v3 offset:8704
    v_mfma_f32_16x16x32_bf16 v[160:163], v[16:19], a[56:59], v[160:163]
    v_add_u32 v3, 0x9000, v3
    v_mfma_f32_16x16x32_bf16 v[160:163], v[20:23], a[72:75], v[160:163]
    v_rcp_f32 v84, v84
    v_mfma_f32_16x16x32_bf16 v[160:163], v[24:27], a[88:91], v[160:163]
    buffer_load_dwordx4 v1, s[4:7], s41 offen sc1 lds
    v_mfma_f32_16x16x32_bf16 v[164:167], v[24:27], a[92:95], v[164:167]
    v_rcp_f32 v85, v85
    v_mfma_f32_16x16x32_bf16 v[164:167], v[20:23], a[76:79], v[164:167]
    v_rcp_f32 v86, v86
    v_mfma_f32_16x16x32_bf16 v[164:167], v[16:19], a[60:63], v[164:167]
    s_waitcnt lgkmcnt(0)
    v_rcp_f32 v87, v87
    v_mfma_f32_16x16x32_bf16 v[164:167], v[28:31], a[12:15], v[164:167]
    ds_read_b64_tr_b16 v[16:17], v4 offset:0
    v_mfma_f32_16x16x32_bf16 v[164:167], v[32:35], a[28:31], v[164:167]
    s_add_u32 m0, s39, 0x1d000
    ds_read_b64_tr_b16 v[18:19], v4 offset:512
    v_mfma_f32_16x16x32_bf16 v[164:167], v[36:39], a[44:47], v[164:167]
    s_add_u32 s41, s38, 0x2000
    ds_read_b64_tr_b16 v[20:21], v4 offset:4096
    v_mfma_f32_16x16x32_bf16 v[160:163], v[36:39], a[40:43], v[160:163]
    ds_read_b64_tr_b16 v[22:23], v4 offset:4608
    v_mfma_f32_16x16x32_bf16 v[160:163], v[32:35], a[24:27], v[160:163]
    ds_read_b64_tr_b16 v[24:25], v4 offset:8192
    v_mfma_f32_16x16x32_bf16 v[160:163], v[28:31], a[8:11], v[160:163]
    ds_read_b64_tr_b16 v[26:27], v4 offset:8704
    v_mfma_f32_16x16x32_bf16 v[156:159], v[28:31], a[4:7], v[156:159]
    v_exp_f32 v209, v209
    v_mfma_f32_16x16x32_bf16 v[156:159], v[32:35], a[20:23], v[156:159]
    v_exp_f32 v210, v210
    v_mfma_f32_16x16x32_bf16 v[156:159], v[36:39], a[36:39], v[156:159]
    buffer_load_dwordx4 v1, s[4:7], s41 offen sc1 lds
    v_mfma_f32_16x16x32_bf16 v[152:155], v[36:39], a[32:35], v[152:155]
    v_exp_f32 v211, v211
    v_mfma_f32_16x16x32_bf16 v[152:155], v[32:35], a[16:19], v[152:155]
    v_add_f32 v209, 1.0, v209
    v_add_f32 v210, 1.0, v210
    v_mfma_f32_16x16x32_bf16 v[152:155], v[28:31], a[0:3], v[152:155]
    s_waitcnt lgkmcnt(0)
    v_add_f32 v211, 1.0, v211
    v_mfma_f32_16x16x32_bf16 v[168:171], v[16:19], a[0:3], 0
    ds_read_b64_tr_b16 v[28:29], v4 offset:12288
    v_mfma_f32_16x16x32_bf16 v[168:171], v[20:23], a[16:19], v[168:171]
    s_add_u32 m0, s28, 0x0
    ds_read_b64_tr_b16 v[30:31], v4 offset:12800
    v_mfma_f32_16x16x32_bf16 v[168:171], v[24:27], a[32:35], v[168:171]
    s_mul_i32 s41, s28, 64
    ds_read_b64_tr_b16 v[32:33], v4 offset:16384
    v_mfma_f32_16x16x32_bf16 v[172:175], v[24:27], a[36:39], 0
    s_add_u32 s41, s41, s37
    ds_read_b64_tr_b16 v[34:35], v4 offset:16896
    v_mfma_f32_16x16x32_bf16 v[172:175], v[20:23], a[20:23], v[172:175]
    ds_read_b64_tr_b16 v[36:37], v4 offset:20480
    v_mfma_f32_16x16x32_bf16 v[172:175], v[16:19], a[4:7], v[172:175]
    ds_read_b64_tr_b16 v[38:39], v4 offset:20992
    v_mfma_f32_16x16x32_bf16 v[176:179], v[16:19], a[8:11], 0
    v_rcp_f32 v208, v208
    v_mfma_f32_16x16x32_bf16 v[176:179], v[20:23], a[24:27], v[176:179]
    v_rcp_f32 v209, v209
    v_mfma_f32_16x16x32_bf16 v[176:179], v[24:27], a[40:43], v[176:179]
    buffer_load_dwordx4 v10, s[16:19], s41 offen nt lds
    v_mfma_f32_16x16x32_bf16 v[180:183], v[24:27], a[44:47], 0
    v_rcp_f32 v210, v210
    v_mfma_f32_16x16x32_bf16 v[180:183], v[20:23], a[28:31], v[180:183]
    v_rcp_f32 v211, v211
    v_mfma_f32_16x16x32_bf16 v[180:183], v[16:19], a[12:15], v[180:183]
    s_waitcnt lgkmcnt(0)
    v_exp_f32 v204, v204
    v_mfma_f32_16x16x32_bf16 v[180:183], v[28:31], a[60:63], v[180:183]
    ds_read_b64_tr_b16 v[16:17], v4 offset:24576
    v_add_f32 v204, 1.0, v204
    v_mfma_f32_16x16x32_bf16 v[180:183], v[32:35], a[76:79], v[180:183]
    s_add_u32 m0, s29, 0x0
    ds_read_b64_tr_b16 v[18:19], v4 offset:25088
    v_fma_f32 v100, s49, v100, -v255
    v_mfma_f32_16x16x32_bf16 v[180:183], v[36:39], a[92:95], v[180:183]
    s_mul_i32 s41, s29, 64
    ds_read_b64_tr_b16 v[20:21], v4 offset:28672
    v_fma_f32 v101, s49, v101, -v255
    v_mfma_f32_16x16x32_bf16 v[176:179], v[36:39], a[88:91], v[176:179]
    s_add_u32 s41, s41, s37
    ds_read_b64_tr_b16 v[22:23], v4 offset:29184
    v_fma_f32 v102, s49, v102, -v255
    v_mfma_f32_16x16x32_bf16 v[176:179], v[32:35], a[72:75], v[176:179]
    ds_read_b64_tr_b16 v[24:25], v4 offset:32768
    v_fma_f32 v103, s49, v103, -v255
    v_mfma_f32_16x16x32_bf16 v[176:179], v[28:31], a[56:59], v[176:179]
    ds_read_b64_tr_b16 v[26:27], v4 offset:33280
    v_mfma_f32_16x16x32_bf16 v[172:175], v[28:31], a[52:55], v[172:175]
    v_add_u32 v4, 0x9000, v4
    v_mfma_f32_16x16x32_bf16 v[172:175], v[32:35], a[68:71], v[172:175]
    buffer_store_dwordx4 v[108:111], v1, s[4:7], s57 offen offset:1024 sc1
    v_mfma_f32_16x16x32_bf16 v[172:175], v[36:39], a[84:87], v[172:175]
    buffer_load_dwordx4 v10, s[16:19], s41 offen nt lds
    v_mfma_f32_16x16x32_bf16 v[168:171], v[36:39], a[80:83], v[168:171]
    v_exp_f32 v205, v205
    v_mfma_f32_16x16x32_bf16 v[168:171], v[32:35], a[64:67], v[168:171]
    v_exp_f32 v206, v206
    v_mfma_f32_16x16x32_bf16 v[168:171], v[28:31], a[48:51], v[168:171]
    s_waitcnt lgkmcnt(0)
    v_exp_f32 v207, v207
    v_mfma_f32_16x16x32_bf16 v[168:171], v[16:19], a[96:99], v[168:171]
    ds_read_b64_tr_b16 v[28:29], v5 offset:24576
    v_add_f32 v205, 1.0, v205
    v_mfma_f32_16x16x32_bf16 v[168:171], v[20:23], a[112:115], v[168:171]
    s_add_u32 m0, s30, 0x0
    ds_read_b64_tr_b16 v[30:31], v5 offset:25088
    v_add_f32 v206, 1.0, v206
    v_mfma_f32_16x16x32_bf16 v[168:171], v[24:27], a[128:131], v[168:171]
    s_mul_i32 s41, s30, 64
    ds_read_b64_tr_b16 v[32:33], v5 offset:28672
    v_add_f32 v207, 1.0, v207
    v_mfma_f32_16x16x32_bf16 v[172:175], v[24:27], a[132:135], v[172:175]
    s_add_u32 s41, s41, s37
    ds_read_b64_tr_b16 v[34:35], v5 offset:29184
    v_mfma_f32_16x16x32_bf16 v[172:175], v[20:23], a[116:119], v[172:175]
    ds_read_b64_tr_b16 v[36:37], v5 offset:32768
    v_mfma_f32_16x16x32_bf16 v[172:175], v[16:19], a[100:103], v[172:175]
    ds_read_b64_tr_b16 v[38:39], v5 offset:33280
    v_mfma_f32_16x16x32_bf16 v[176:179], v[16:19], a[104:107], v[176:179]
    v_rcp_f32 v204, v204
    v_mfma_f32_16x16x32_bf16 v[176:179], v[20:23], a[120:123], v[176:179]
    v_rcp_f32 v205, v205
    v_mfma_f32_16x16x32_bf16 v[176:179], v[24:27], a[136:139], v[176:179]
    buffer_load_dwordx4 v10, s[16:19], s41 offen nt lds
    v_mfma_f32_16x16x32_bf16 v[180:183], v[24:27], a[140:143], v[180:183]
    v_rcp_f32 v206, v206
    v_mfma_f32_16x16x32_bf16 v[180:183], v[20:23], a[124:127], v[180:183]
    v_rcp_f32 v207, v207
    v_mfma_f32_16x16x32_bf16 v[180:183], v[16:19], a[108:111], v[180:183]
    s_waitcnt lgkmcnt(0)
    v_exp_f32 v200, v200
    v_mfma_f32_16x16x32_bf16 v[196:199], v[28:31], a[108:111], 0
    ds_read_b64_tr_b16 v[16:17], v5 offset:12288
    v_add_f32 v200, 1.0, v200
    v_mfma_f32_16x16x32_bf16 v[196:199], v[32:35], a[124:127], v[196:199]
    s_add_u32 m0, s31, 0x0
    ds_read_b64_tr_b16 v[18:19], v5 offset:12800
    v_mfma_f32_16x16x32_bf16 v[196:199], v[36:39], a[140:143], v[196:199]
    s_mul_i32 s41, s31, 64
    ds_read_b64_tr_b16 v[20:21], v5 offset:16384
    v_mfma_f32_16x16x32_bf16 v[192:195], v[36:39], a[136:139], 0
    s_add_u32 s41, s41, s37
    ds_read_b64_tr_b16 v[22:23], v5 offset:16896
    v_mfma_f32_16x16x32_bf16 v[192:195], v[32:35], a[120:123], v[192:195]
    ds_read_b64_tr_b16 v[24:25], v5 offset:20480
    v_mfma_f32_16x16x32_bf16 v[192:195], v[28:31], a[104:107], v[192:195]
    ds_read_b64_tr_b16 v[26:27], v5 offset:20992
    v_mfma_f32_16x16x32_bf16 v[188:191], v[28:31], a[100:103], 0
    v_exp_f32 v201, v201
    v_mfma_f32_16x16x32_bf16 v[188:191], v[32:35], a[116:119], v[188:191]
    v_exp_f32 v202, v202
    v_mfma_f32_16x16x32_bf16 v[188:191], v[36:39], a[132:135], v[188:191]
    buffer_load_dwordx4 v10, s[16:19], s41 offen nt lds
    v_mfma_f32_16x16x32_bf16 v[184:187], v[36:39], a[128:131], 0
    v_exp_f32 v203, v203
    v_mfma_f32_16x16x32_bf16 v[184:187], v[32:35], a[112:115], v[184:187]
    v_add_f32 v201, 1.0, v201
    v_add_f32 v202, 1.0, v202
    v_mfma_f32_16x16x32_bf16 v[184:187], v[28:31], a[96:99], v[184:187]
    s_waitcnt lgkmcnt(0)
    v_add_f32 v203, 1.0, v203
    v_mfma_f32_16x16x32_bf16 v[184:187], v[16:19], a[48:51], v[184:187]
    ds_read_b64_tr_b16 v[28:29], v5 offset:0
    v_mfma_f32_16x16x32_bf16 v[184:187], v[20:23], a[64:67], v[184:187]
    s_add_u32 m0, s46, 0x0
    ds_read_b64_tr_b16 v[30:31], v5 offset:512
    v_mfma_f32_16x16x32_bf16 v[184:187], v[24:27], a[80:83], v[184:187]
    s_mul_i32 s41, s46, 64
    ds_read_b64_tr_b16 v[32:33], v5 offset:4096
    v_mfma_f32_16x16x32_bf16 v[188:191], v[24:27], a[84:87], v[188:191]
    s_add_u32 s41, s41, s37
    ds_read_b64_tr_b16 v[34:35], v5 offset:4608
    v_mfma_f32_16x16x32_bf16 v[188:191], v[20:23], a[68:71], v[188:191]
    ds_read_b64_tr_b16 v[36:37], v5 offset:8192
    v_mfma_f32_16x16x32_bf16 v[188:191], v[16:19], a[52:55], v[188:191]
    ds_read_b64_tr_b16 v[38:39], v5 offset:8704
    v_mfma_f32_16x16x32_bf16 v[192:195], v[16:19], a[56:59], v[192:195]
    v_add_u32 v5, 0x9000, v5
    v_mfma_f32_16x16x32_bf16 v[192:195], v[20:23], a[72:75], v[192:195]
    v_rcp_f32 v200, v200
    v_mfma_f32_16x16x32_bf16 v[192:195], v[24:27], a[88:91], v[192:195]
    buffer_load_dwordx4 v10, s[16:19], s41 offen nt lds
    v_mfma_f32_16x16x32_bf16 v[196:199], v[24:27], a[92:95], v[196:199]
    v_rcp_f32 v201, v201
    v_mfma_f32_16x16x32_bf16 v[196:199], v[20:23], a[76:79], v[196:199]
    v_rcp_f32 v202, v202
    v_mfma_f32_16x16x32_bf16 v[196:199], v[16:19], a[60:63], v[196:199]
    s_waitcnt vmcnt(16) lgkmcnt(0)
    s_barrier
    v_rcp_f32 v203, v203
    v_mfma_f32_16x16x32_bf16 v[196:199], v[28:31], a[12:15], v[196:199]
    ds_read_b64_tr_b16 v[16:17], v2 offset:0
    v_fma_f32 v224, s49, v224, -v255
    v_mfma_f32_16x16x32_bf16 v[196:199], v[32:35], a[28:31], v[196:199]
    s_add_u32 m0, s47, 0x0
    ds_read_b64_tr_b16 v[18:19], v2 offset:512
    v_fma_f32 v225, s49, v225, -v255
    v_mfma_f32_16x16x32_bf16 v[196:199], v[36:39], a[44:47], v[196:199]
    s_mul_i32 s41, s47, 64
    ds_read_b64_tr_b16 v[20:21], v2 offset:4096
    v_fma_f32 v226, s49, v226, -v255
    v_mfma_f32_16x16x32_bf16 v[192:195], v[36:39], a[40:43], v[192:195]
    s_add_u32 s41, s41, s37
    ds_read_b64_tr_b16 v[22:23], v2 offset:4608
    v_fma_f32 v227, s49, v227, -v255
    v_mfma_f32_16x16x32_bf16 v[192:195], v[32:35], a[24:27], v[192:195]
    ds_read_b64_tr_b16 v[24:25], v2 offset:8192
    v_mfma_f32_16x16x32_bf16 v[192:195], v[28:31], a[8:11], v[192:195]
    ds_read_b64_tr_b16 v[26:27], v2 offset:8704
    v_mfma_f32_16x16x32_bf16 v[188:191], v[28:31], a[4:7], v[188:191]
    v_exp_f32 v88, v88
    v_mfma_f32_16x16x32_bf16 v[188:191], v[32:35], a[20:23], v[188:191]
    v_exp_f32 v89, v89
    v_mfma_f32_16x16x32_bf16 v[188:191], v[36:39], a[36:39], v[188:191]
    buffer_load_dwordx4 v10, s[16:19], s41 offen nt lds
    v_mfma_f32_16x16x32_bf16 v[184:187], v[36:39], a[32:35], v[184:187]
    v_exp_f32 v90, v90
    v_mfma_f32_16x16x32_bf16 v[184:187], v[32:35], a[16:19], v[184:187]
    v_exp_f32 v91, v91
    v_mfma_f32_16x16x32_bf16 v[184:187], v[28:31], a[0:3], v[184:187]
    s_waitcnt lgkmcnt(0)
    v_add_f32 v88, 1.0, v88
    v_add_f32 v89, 1.0, v89
    v_mfma_f32_16x16x32_bf16 v[136:139], v[16:19], a[144:147], v[136:139]
    ds_read_b64_tr_b16 v[28:29], v2 offset:12288
    v_add_f32 v90, 1.0, v90
    v_mfma_f32_16x16x32_bf16 v[136:139], v[20:23], a[160:163], v[136:139]
    s_add_u32 m0, s48, 0x0
    ds_read_b64_tr_b16 v[30:31], v2 offset:12800
    v_add_f32 v91, 1.0, v91
    v_mfma_f32_16x16x32_bf16 v[136:139], v[24:27], a[176:179], v[136:139]
    s_mul_i32 s41, s48, 64
    ds_read_b64_tr_b16 v[32:33], v2 offset:16384
    v_mfma_f32_16x16x32_bf16 v[140:143], v[24:27], a[180:183], v[140:143]
    s_add_u32 s41, s41, s37
    ds_read_b64_tr_b16 v[34:35], v2 offset:16896
    v_mfma_f32_16x16x32_bf16 v[140:143], v[20:23], a[164:167], v[140:143]
    ds_read_b64_tr_b16 v[36:37], v2 offset:20480
    v_mfma_f32_16x16x32_bf16 v[140:143], v[16:19], a[148:151], v[140:143]
    ds_read_b64_tr_b16 v[38:39], v2 offset:20992
    v_mfma_f32_16x16x32_bf16 v[144:147], v[16:19], a[152:155], v[144:147]
    v_rcp_f32 v88, v88
    v_mfma_f32_16x16x32_bf16 v[144:147], v[20:23], a[168:171], v[144:147]
    buffer_store_dwordx4 v[112:115], v1, s[4:7], s57 offen offset:2048 sc1
    v_mfma_f32_16x16x32_bf16 v[144:147], v[24:27], a[184:187], v[144:147]
    buffer_load_dwordx4 v10, s[16:19], s41 offen nt lds
    v_mfma_f32_16x16x32_bf16 v[148:151], v[24:27], a[188:191], v[148:151]
L_hop0_5:
    s_cbranch_execz L_hop0_14
    v_rcp_f32 v89, v89
    v_mfma_f32_16x16x32_bf16 v[148:151], v[20:23], a[172:175], v[148:151]
    v_rcp_f32 v90, v90
    v_mfma_f32_16x16x32_bf16 v[148:151], v[16:19], a[156:159], v[148:151]
    s_waitcnt lgkmcnt(0)
    v_rcp_f32 v91, v91
    v_mfma_f32_16x16x32_bf16 v[148:151], v[28:31], a[204:207], v[148:151]
    ds_read_b64_tr_b16 v[16:17], v2 offset:24576
    v_fma_f32 v220, s49, v220, -v255
    v_mfma_f32_16x16x32_bf16 v[148:151], v[32:35], a[220:223], v[148:151]
    s_add_u32 m0, s82, 0x0
    ds_read_b64_tr_b16 v[18:19], v2 offset:25088
    v_fma_f32 v221, s49, v221, -v255
    v_mfma_f32_16x16x32_bf16 v[148:151], v[36:39], a[236:239], v[148:151]
    s_mul_i32 s41, s82, 64
    ds_read_b64_tr_b16 v[20:21], v2 offset:28672
    v_fma_f32 v222, s49, v222, -v255
    v_mfma_f32_16x16x32_bf16 v[144:147], v[36:39], a[232:235], v[144:147]
    s_add_u32 s41, s41, s37
    ds_read_b64_tr_b16 v[22:23], v2 offset:29184
    v_fma_f32 v223, s49, v223, -v255
    v_mfma_f32_16x16x32_bf16 v[144:147], v[32:35], a[216:219], v[144:147]
    ds_read_b64_tr_b16 v[24:25], v2 offset:32768
    v_mfma_f32_16x16x32_bf16 v[144:147], v[28:31], a[200:203], v[144:147]
    ds_read_b64_tr_b16 v[26:27], v2 offset:33280
    v_mfma_f32_16x16x32_bf16 v[140:143], v[28:31], a[196:199], v[140:143]
    v_exp_f32 v92, v92
    v_mfma_f32_16x16x32_bf16 v[140:143], v[32:35], a[212:215], v[140:143]
    v_exp_f32 v93, v93
    v_mfma_f32_16x16x32_bf16 v[140:143], v[36:39], a[228:231], v[140:143]
    buffer_load_dwordx4 v10, s[16:19], s41 offen nt lds
    v_mfma_f32_16x16x32_bf16 v[136:139], v[36:39], a[224:227], v[136:139]
    v_exp_f32 v94, v94
    v_mfma_f32_16x16x32_bf16 v[136:139], v[32:35], a[208:211], v[136:139]
    v_exp_f32 v95, v95
    v_mfma_f32_16x16x32_bf16 v[136:139], v[28:31], a[192:195], v[136:139]
    s_waitcnt lgkmcnt(0)
    v_add_f32 v92, 1.0, v92
    v_add_f32 v93, 1.0, v93
    v_mfma_f32_16x16x32_bf16 v[136:139], v[16:19], a[240:243], v[136:139]
    ds_read_b64_tr_b16 v[28:29], v3 offset:24576
    v_add_f32 v94, 1.0, v94
    v_mfma_f32_16x16x32_bf16 v[136:139], v[20:23], v[40:43], v[136:139]
    s_add_u32 m0, s84, 0x0
    ds_read_b64_tr_b16 v[30:31], v3 offset:25088
    v_add_f32 v95, 1.0, v95
    v_mfma_f32_16x16x32_bf16 v[136:139], v[24:27], v[56:59], v[136:139]
    s_mul_i32 s41, s84, 64
    ds_read_b64_tr_b16 v[32:33], v3 offset:28672
    v_mfma_f32_16x16x32_bf16 v[140:143], v[24:27], v[60:63], v[140:143]
    s_add_u32 s41, s41, s37
    ds_read_b64_tr_b16 v[34:35], v3 offset:29184
    v_mfma_f32_16x16x32_bf16 v[140:143], v[20:23], v[44:47], v[140:143]
    ds_read_b64_tr_b16 v[36:37], v3 offset:32768
    v_mfma_f32_16x16x32_bf16 v[140:143], v[16:19], a[244:247], v[140:143]
    ds_read_b64_tr_b16 v[38:39], v3 offset:33280
    v_mfma_f32_16x16x32_bf16 v[144:147], v[16:19], a[248:251], v[144:147]
    v_rcp_f32 v92, v92
    v_mfma_f32_16x16x32_bf16 v[144:147], v[20:23], v[48:51], v[144:147]
    v_rcp_f32 v93, v93
    v_mfma_f32_16x16x32_bf16 v[144:147], v[24:27], v[64:67], v[144:147]
    buffer_load_dwordx4 v10, s[16:19], s41 offen nt lds
    v_mfma_f32_16x16x32_bf16 v[148:151], v[24:27], v[68:71], v[148:151]
    v_mul_f32 v136, v136, v200
    v_mul_f32 v137, v137, v201
    v_mfma_f32_16x16x32_bf16 v[148:151], v[20:23], v[52:55], v[148:151]
    v_mul_f32 v138, v138, v202
    v_mul_f32 v139, v139, v203
    v_mfma_f32_16x16x32_bf16 v[148:151], v[16:19], a[252:255], v[148:151]
    s_waitcnt lgkmcnt(0)
    v_mul_f32 v140, v140, v204
    v_mul_f32 v141, v141, v205
    v_mfma_f32_16x16x32_bf16 v[164:167], v[28:31], a[252:255], v[164:167]
    ds_read_b64_tr_b16 v[16:17], v3 offset:12288
    v_mul_f32 v142, v142, v206
    v_mfma_f32_16x16x32_bf16 v[164:167], v[32:35], v[52:55], v[164:167]
    s_add_u32 m0, s28, 0x9000
    ds_read_b64_tr_b16 v[18:19], v3 offset:12800
    v_mul_f32 v143, v143, v207
    v_mfma_f32_16x16x32_bf16 v[164:167], v[36:39], v[68:71], v[164:167]
    s_mul_i32 s41, s28, 64
    ds_read_b64_tr_b16 v[20:21], v3 offset:16384
    v_mul_f32 v144, v144, v208
    v_mfma_f32_16x16x32_bf16 v[160:163], v[36:39], v[64:67], v[160:163]
    s_add_u32 s41, s41, s37
    ds_read_b64_tr_b16 v[22:23], v3 offset:16896
    v_mul_f32 v145, v145, v209
    v_mfma_f32_16x16x32_bf16 v[160:163], v[32:35], v[48:51], v[160:163]
    s_add_u32 s41, s41, 0x240000
    ds_read_b64_tr_b16 v[24:25], v3 offset:20480
    v_mul_f32 v146, v146, v210
    v_mfma_f32_16x16x32_bf16 v[160:163], v[28:31], a[248:251], v[160:163]
    ds_read_b64_tr_b16 v[26:27], v3 offset:20992
    v_mul_f32 v148, v148, v212
    v_mfma_f32_16x16x32_bf16 v[156:159], v[28:31], a[244:247], v[156:159]
    v_mul_f32 v149, v149, v213
    v_mul_f32 v150, v150, v214
    v_mfma_f32_16x16x32_bf16 v[156:159], v[32:35], v[44:47], v[156:159]
    v_mul_f32 v151, v151, v215
    v_mul_f32 v147, v147, v211
    v_mfma_f32_16x16x32_bf16 v[156:159], v[36:39], v[60:63], v[156:159]
    buffer_load_dwordx4 v10, s[16:19], s41 offen nt lds
    v_mfma_f32_16x16x32_bf16 v[152:155], v[36:39], v[56:59], v[152:155]
    v_rcp_f32 v94, v94
    v_mfma_f32_16x16x32_bf16 v[152:155], v[32:35], v[40:43], v[152:155]
    v_rcp_f32 v95, v95
    v_mfma_f32_16x16x32_bf16 v[152:155], v[28:31], a[240:243], v[152:155]
    s_waitcnt lgkmcnt(0)
    v_exp_f32 v96, v96
    v_mfma_f32_16x16x32_bf16 v[152:155], v[16:19], a[192:195], v[152:155]
    ds_read_b64_tr_b16 v[28:29], v3 offset:0
    v_add_f32 v96, 1.0, v96
    v_mfma_f32_16x16x32_bf16 v[152:155], v[20:23], a[208:211], v[152:155]
    s_add_u32 m0, s29, 0x9000
    ds_read_b64_tr_b16 v[30:31], v3 offset:512
    v_fma_f32 v216, s49, v216, -v255
    v_mfma_f32_16x16x32_bf16 v[152:155], v[24:27], a[224:227], v[152:155]
    s_mul_i32 s41, s29, 64
    ds_read_b64_tr_b16 v[32:33], v3 offset:4096
    v_fma_f32 v217, s49, v217, -v255
    v_mfma_f32_16x16x32_bf16 v[156:159], v[24:27], a[228:231], v[156:159]
    s_add_u32 s41, s41, s37
    ds_read_b64_tr_b16 v[34:35], v3 offset:4608
    v_fma_f32 v218, s49, v218, -v255
    v_mfma_f32_16x16x32_bf16 v[156:159], v[20:23], a[212:215], v[156:159]
    s_add_u32 s41, s41, 0x240000
    ds_read_b64_tr_b16 v[36:37], v3 offset:8192
    v_fma_f32 v219, s49, v219, -v255
    v_mfma_f32_16x16x32_bf16 v[156:159], v[16:19], a[196:199], v[156:159]
    ds_read_b64_tr_b16 v[38:39], v3 offset:8704
    v_mfma_f32_16x16x32_bf16 v[160:163], v[16:19], a[200:203], v[160:163]
    v_exp_f32 v97, v97
    v_mfma_f32_16x16x32_bf16 v[160:163], v[20:23], a[216:219], v[160:163]
    v_exp_f32 v98, v98
    v_mfma_f32_16x16x32_bf16 v[160:163], v[24:27], a[232:235], v[160:163]
    buffer_load_dwordx4 v10, s[16:19], s41 offen nt lds
    v_mfma_f32_16x16x32_bf16 v[164:167], v[24:27], a[236:239], v[164:167]
    v_exp_f32 v99, v99
    v_mfma_f32_16x16x32_bf16 v[164:167], v[20:23], a[220:223], v[164:167]
    v_add_f32 v97, 1.0, v97
    v_add_f32 v98, 1.0, v98
    v_mfma_f32_16x16x32_bf16 v[164:167], v[16:19], a[204:207], v[164:167]
    s_waitcnt lgkmcnt(0)
    v_add_f32 v99, 1.0, v99
    v_mfma_f32_16x16x32_bf16 v[164:167], v[28:31], a[156:159], v[164:167]
    ds_read_b64_tr_b16 v[16:17], v4 offset:0
    v_mfma_f32_16x16x32_bf16 v[164:167], v[32:35], a[172:175], v[164:167]
    s_add_u32 m0, s30, 0x9000
    ds_read_b64_tr_b16 v[18:19], v4 offset:512
    v_mfma_f32_16x16x32_bf16 v[164:167], v[36:39], a[188:191], v[164:167]
    s_mul_i32 s41, s30, 64
    ds_read_b64_tr_b16 v[20:21], v4 offset:4096
    v_mfma_f32_16x16x32_bf16 v[160:163], v[36:39], a[184:187], v[160:163]
    s_add_u32 s41, s41, s37
    ds_read_b64_tr_b16 v[22:23], v4 offset:4608
    v_mfma_f32_16x16x32_bf16 v[160:163], v[32:35], a[168:171], v[160:163]
    s_add_u32 s41, s41, 0x240000
    ds_read_b64_tr_b16 v[24:25], v4 offset:8192
    v_mfma_f32_16x16x32_bf16 v[160:163], v[28:31], a[152:155], v[160:163]
    ds_read_b64_tr_b16 v[26:27], v4 offset:8704
    v_mfma_f32_16x16x32_bf16 v[156:159], v[28:31], a[148:151], v[156:159]
    v_rcp_f32 v96, v96
    v_mfma_f32_16x16x32_bf16 v[156:159], v[32:35], a[164:167], v[156:159]
    v_rcp_f32 v97, v97
    v_mfma_f32_16x16x32_bf16 v[156:159], v[36:39], a[180:183], v[156:159]
    buffer_load_dwordx4 v10, s[16:19], s41 offen nt lds
    v_mfma_f32_16x16x32_bf16 v[152:155], v[36:39], a[176:179], v[152:155]
    v_rcp_f32 v98, v98
    v_mfma_f32_16x16x32_bf16 v[152:155], v[32:35], a[160:163], v[152:155]
    v_rcp_f32 v99, v99
    v_mfma_f32_16x16x32_bf16 v[152:155], v[28:31], a[144:147], v[152:155]
    s_waitcnt lgkmcnt(0)
    v_exp_f32 v100, v100
    v_mfma_f32_16x16x32_bf16 v[168:171], v[16:19], a[144:147], v[168:171]
    ds_read_b64_tr_b16 v[28:29], v4 offset:12288
    v_add_f32 v100, 1.0, v100
    v_mfma_f32_16x16x32_bf16 v[168:171], v[20:23], a[160:163], v[168:171]
    s_add_u32 m0, s31, 0x9000
    ds_read_b64_tr_b16 v[30:31], v4 offset:12800
    v_mfma_f32_16x16x32_bf16 v[168:171], v[24:27], a[176:179], v[168:171]
    s_mul_i32 s41, s31, 64
    ds_read_b64_tr_b16 v[32:33], v4 offset:16384
    v_mfma_f32_16x16x32_bf16 v[172:175], v[24:27], a[180:183], v[172:175]
    s_add_u32 s41, s41, s37
    ds_read_b64_tr_b16 v[34:35], v4 offset:16896
    v_mfma_f32_16x16x32_bf16 v[172:175], v[20:23], a[164:167], v[172:175]
    s_add_u32 s41, s41, 0x240000
    ds_read_b64_tr_b16 v[36:37], v4 offset:20480
    v_mfma_f32_16x16x32_bf16 v[172:175], v[16:19], a[148:151], v[172:175]
    ds_read_b64_tr_b16 v[38:39], v4 offset:20992
    v_mfma_f32_16x16x32_bf16 v[176:179], v[16:19], a[152:155], v[176:179]
    buffer_store_dwordx4 v[116:119], v1, s[4:7], s57 offen offset:3072 sc1
    v_mfma_f32_16x16x32_bf16 v[176:179], v[20:23], a[168:171], v[176:179]
    v_exp_f32 v101, v101
    v_mfma_f32_16x16x32_bf16 v[176:179], v[24:27], a[184:187], v[176:179]
    buffer_load_dwordx4 v10, s[16:19], s41 offen nt lds
    v_mfma_f32_16x16x32_bf16 v[180:183], v[24:27], a[188:191], v[180:183]
    v_exp_f32 v102, v102
    v_mfma_f32_16x16x32_bf16 v[180:183], v[20:23], a[172:175], v[180:183]
    v_exp_f32 v103, v103
    v_mfma_f32_16x16x32_bf16 v[180:183], v[16:19], a[156:159], v[180:183]
    s_waitcnt lgkmcnt(0)
    v_add_f32 v101, 1.0, v101
    v_add_f32 v102, 1.0, v102
    v_mfma_f32_16x16x32_bf16 v[180:183], v[28:31], a[204:207], v[180:183]
    ds_read_b64_tr_b16 v[16:17], v4 offset:24576
    v_add_f32 v103, 1.0, v103
    v_mfma_f32_16x16x32_bf16 v[180:183], v[32:35], a[220:223], v[180:183]
    s_add_u32 m0, s46, 0x9000
    ds_read_b64_tr_b16 v[18:19], v4 offset:25088
    v_mfma_f32_16x16x32_bf16 v[180:183], v[36:39], a[236:239], v[180:183]
    s_mul_i32 s41, s46, 64
    ds_read_b64_tr_b16 v[20:21], v4 offset:28672
    v_mfma_f32_16x16x32_bf16 v[176:179], v[36:39], a[232:235], v[176:179]
    s_add_u32 s41, s41, s37
    ds_read_b64_tr_b16 v[22:23], v4 offset:29184
    v_mfma_f32_16x16x32_bf16 v[176:179], v[32:35], a[216:219], v[176:179]
    s_add_u32 s41, s41, 0x240000
    ds_read_b64_tr_b16 v[24:25], v4 offset:32768
    v_mfma_f32_16x16x32_bf16 v[176:179], v[28:31], a[200:203], v[176:179]
    ds_read_b64_tr_b16 v[26:27], v4 offset:33280
    v_mfma_f32_16x16x32_bf16 v[172:175], v[28:31], a[196:199], v[172:175]
    v_rcp_f32 v100, v100
    v_mfma_f32_16x16x32_bf16 v[172:175], v[32:35], a[212:215], v[172:175]
    v_rcp_f32 v101, v101
    v_mfma_f32_16x16x32_bf16 v[172:175], v[36:39], a[228:231], v[172:175]
    buffer_load_dwordx4 v10, s[16:19], s41 offen nt lds
    v_mfma_f32_16x16x32_bf16 v[168:171], v[36:39], a[224:227], v[168:171]
    v_rcp_f32 v102, v102
    v_mfma_f32_16x16x32_bf16 v[168:171], v[32:35], a[208:211], v[168:171]
    v_rcp_f32 v103, v103
    v_mfma_f32_16x16x32_bf16 v[168:171], v[28:31], a[192:195], v[168:171]
    s_waitcnt lgkmcnt(0)
    v_exp_f32 v228, v228
    v_mfma_f32_16x16x32_bf16 v[168:171], v[16:19], a[240:243], v[168:171]
    ds_read_b64_tr_b16 v[28:29], v5 offset:24576
    v_add_f32 v228, 1.0, v228
    v_mfma_f32_16x16x32_bf16 v[168:171], v[20:23], v[40:43], v[168:171]
    s_add_u32 m0, s47, 0x9000
    ds_read_b64_tr_b16 v[30:31], v5 offset:25088
    v_cvt_pk_bf16_f32 v136, v136, v137
    v_mfma_f32_16x16x32_bf16 v[168:171], v[24:27], v[56:59], v[168:171]
    s_mul_i32 s41, s47, 64
    ds_read_b64_tr_b16 v[32:33], v5 offset:28672
    v_cvt_pk_bf16_f32 v137, v138, v139
    v_mfma_f32_16x16x32_bf16 v[172:175], v[24:27], v[60:63], v[172:175]
    s_add_u32 s41, s41, s37
    ds_read_b64_tr_b16 v[34:35], v5 offset:29184
    v_mfma_f32_16x16x32_bf16 v[172:175], v[20:23], v[44:47], v[172:175]
    s_add_u32 s41, s41, 0x240000
    ds_read_b64_tr_b16 v[36:37], v5 offset:32768
    v_mfma_f32_16x16x32_bf16 v[172:175], v[16:19], a[244:247], v[172:175]
    ds_read_b64_tr_b16 v[38:39], v5 offset:33280
    v_mfma_f32_16x16x32_bf16 v[176:179], v[16:19], a[248:251], v[176:179]
    v_exp_f32 v229, v229
    v_mfma_f32_16x16x32_bf16 v[176:179], v[20:23], v[48:51], v[176:179]
    v_exp_f32 v230, v230
    v_mfma_f32_16x16x32_bf16 v[176:179], v[24:27], v[64:67], v[176:179]
    buffer_load_dwordx4 v10, s[16:19], s41 offen nt lds
    v_mfma_f32_16x16x32_bf16 v[180:183], v[24:27], v[68:71], v[180:183]
    v_mul_f32 v168, v168, v72
    v_mul_f32 v169, v169, v73
    v_mfma_f32_16x16x32_bf16 v[180:183], v[20:23], v[52:55], v[180:183]
    v_mul_f32 v170, v170, v74
    v_mul_f32 v171, v171, v75
    v_mfma_f32_16x16x32_bf16 v[180:183], v[16:19], a[252:255], v[180:183]
    s_waitcnt lgkmcnt(0)
    v_mul_f32 v172, v172, v76
    v_mul_f32 v173, v173, v77
    v_mfma_f32_16x16x32_bf16 v[196:199], v[28:31], a[252:255], v[196:199]
    ds_read_b64_tr_b16 v[16:17], v5 offset:12288
    v_mul_f32 v174, v174, v78
    v_mfma_f32_16x16x32_bf16 v[196:199], v[32:35], v[52:55], v[196:199]
    s_add_u32 m0, s48, 0x9000
    ds_read_b64_tr_b16 v[18:19], v5 offset:12800
    v_mul_f32 v175, v175, v79
    v_mfma_f32_16x16x32_bf16 v[196:199], v[36:39], v[68:71], v[196:199]
    s_mul_i32 s41, s48, 64
    ds_read_b64_tr_b16 v[20:21], v5 offset:16384
    v_mul_f32 v176, v176, v80
    v_mfma_f32_16x16x32_bf16 v[192:195], v[36:39], v[64:67], v[192:195]
    s_add_u32 s41, s41, s37
    ds_read_b64_tr_b16 v[22:23], v5 offset:16896
    v_mul_f32 v177, v177, v81
    v_mfma_f32_16x16x32_bf16 v[192:195], v[32:35], v[48:51], v[192:195]
    s_add_u32 s41, s41, 0x240000
    ds_read_b64_tr_b16 v[24:25], v5 offset:20480
    v_mul_f32 v178, v178, v82
    v_mfma_f32_16x16x32_bf16 v[192:195], v[28:31], a[248:251], v[192:195]
    ds_read_b64_tr_b16 v[26:27], v5 offset:20992
    v_mul_f32 v179, v179, v83
    v_mfma_f32_16x16x32_bf16 v[188:191], v[28:31], a[244:247], v[188:191]
    v_mul_f32 v180, v180, v84
    v_mul_f32 v181, v181, v85
    v_mfma_f32_16x16x32_bf16 v[188:191], v[32:35], v[44:47], v[188:191]
    v_mul_f32 v182, v182, v86
    v_mul_f32 v183, v183, v87
    v_mfma_f32_16x16x32_bf16 v[188:191], v[36:39], v[60:63], v[188:191]
    buffer_load_dwordx4 v10, s[16:19], s41 offen nt lds
    v_mfma_f32_16x16x32_bf16 v[184:187], v[36:39], v[56:59], v[184:187]
    v_exp_f32 v231, v231
    v_mfma_f32_16x16x32_bf16 v[184:187], v[32:35], v[40:43], v[184:187]
    v_add_f32 v229, 1.0, v229
    v_add_f32 v230, 1.0, v230
    v_mfma_f32_16x16x32_bf16 v[184:187], v[28:31], a[240:243], v[184:187]
    s_waitcnt lgkmcnt(0)
    v_add_f32 v231, 1.0, v231
    v_cvt_pk_bf16_f32 v140, v140, v141
    v_mfma_f32_16x16x32_bf16 v[184:187], v[16:19], a[192:195], v[184:187]
    ds_read_b64_tr_b16 v[28:29], v5 offset:0
    v_cvt_pk_bf16_f32 v141, v142, v143
    v_mfma_f32_16x16x32_bf16 v[184:187], v[20:23], a[208:211], v[184:187]
    s_add_u32 m0, s82, 0x9000
    ds_read_b64_tr_b16 v[30:31], v5 offset:512
    v_cvt_pk_bf16_f32 v144, v144, v145
    v_mfma_f32_16x16x32_bf16 v[184:187], v[24:27], a[224:227], v[184:187]
    s_mul_i32 s41, s82, 64
    ds_read_b64_tr_b16 v[32:33], v5 offset:4096
    v_cvt_pk_bf16_f32 v145, v146, v147
    v_mfma_f32_16x16x32_bf16 v[188:191], v[24:27], a[228:231], v[188:191]
    s_add_u32 s41, s41, s37
    ds_read_b64_tr_b16 v[34:35], v5 offset:4608
    v_cvt_pk_bf16_f32 v148, v148, v149
    v_mfma_f32_16x16x32_bf16 v[188:191], v[20:23], a[212:215], v[188:191]
    s_add_u32 s41, s41, 0x240000
    ds_read_b64_tr_b16 v[36:37], v5 offset:8192
    v_cvt_pk_bf16_f32 v149, v150, v151
    v_mfma_f32_16x16x32_bf16 v[188:191], v[16:19], a[196:199], v[188:191]
    ds_read_b64_tr_b16 v[38:39], v5 offset:8704
    v_mfma_f32_16x16x32_bf16 v[192:195], v[16:19], a[200:203], v[192:195]
    v_rcp_f32 v228, v228
    v_mfma_f32_16x16x32_bf16 v[192:195], v[20:23], a[216:219], v[192:195]
    v_rcp_f32 v229, v229
    v_mfma_f32_16x16x32_bf16 v[192:195], v[24:27], a[232:235], v[192:195]
    buffer_load_dwordx4 v10, s[16:19], s41 offen nt lds
    v_mfma_f32_16x16x32_bf16 v[196:199], v[24:27], a[236:239], v[196:199]
    v_rcp_f32 v230, v230
    v_mfma_f32_16x16x32_bf16 v[196:199], v[20:23], a[220:223], v[196:199]
    v_rcp_f32 v231, v231
    v_mfma_f32_16x16x32_bf16 v[196:199], v[16:19], a[204:207], v[196:199]
    s_waitcnt vmcnt(20) lgkmcnt(0)
    s_barrier
    v_mul_f32 v164, v164, v228
    v_mul_f32 v165, v165, v229
    v_mfma_f32_16x16x32_bf16 v[196:199], v[28:31], a[156:159], v[196:199]
    ds_read_b64_tr_b16 v[16:17], v8 offset:0
    v_mul_f32 v166, v166, v230
    v_mfma_f32_16x16x32_bf16 v[196:199], v[32:35], a[172:175], v[196:199]
    s_add_u32 m0, s84, 0x9000
    ds_read_b64_tr_b16 v[18:19], v8 offset:512
    v_mul_f32 v167, v167, v231
    v_mfma_f32_16x16x32_bf16 v[196:199], v[36:39], a[188:191], v[196:199]
    s_mul_i32 s41, s84, 64
    ds_read_b64_tr_b16 v[20:21], v8 offset:1024
    v_cvt_pk_bf16_f32 v150, v164, v165
    v_mfma_f32_16x16x32_bf16 v[192:195], v[36:39], a[184:187], v[192:195]
    s_add_u32 s41, s41, s37
    ds_read_b64_tr_b16 v[22:23], v8 offset:1536
    v_cvt_pk_bf16_f32 v151, v166, v167
    v_mfma_f32_16x16x32_bf16 v[192:195], v[32:35], a[168:171], v[192:195]
    s_add_u32 s41, s41, 0x240000
    ds_read_b64_tr_b16 v[24:25], v8 offset:2048
    v_cvt_pk_bf16_f32 v168, v168, v169
    v_mfma_f32_16x16x32_bf16 v[192:195], v[28:31], a[152:155], v[192:195]
    ds_read_b64_tr_b16 v[26:27], v8 offset:2560
    v_cvt_pk_bf16_f32 v169, v170, v171
    v_mfma_f32_16x16x32_bf16 v[188:191], v[28:31], a[148:151], v[188:191]
    v_exp_f32 v224, v224
    v_mfma_f32_16x16x32_bf16 v[188:191], v[32:35], a[164:167], v[188:191]
    v_exp_f32 v225, v225
    v_mfma_f32_16x16x32_bf16 v[188:191], v[36:39], a[180:183], v[188:191]
    buffer_load_dwordx4 v10, s[16:19], s41 offen nt lds
    v_mfma_f32_16x16x32_bf16 v[184:187], v[36:39], a[176:179], v[184:187]
    v_mul_f32 v196, v196, v100
    v_mul_f32 v197, v197, v101
    v_mfma_f32_16x16x32_bf16 v[184:187], v[32:35], a[160:163], v[184:187]
    v_mul_f32 v198, v198, v102
    v_mul_f32 v199, v199, v103
    v_mfma_f32_16x16x32_bf16 v[184:187], v[28:31], a[144:147], v[184:187]
    s_waitcnt lgkmcnt(0)
    v_mul_f32 v192, v192, v96
    v_mul_f32 v193, v193, v97
    v_mfma_f32_16x16x32_bf16 v[104:107], v[16:19], a[0:3], v[248:251]
    ds_read_b64_tr_b16 v[28:29], v8 offset:3072
    v_mul_f32 v194, v194, v98
    v_mfma_f32_16x16x32_bf16 v[104:107], v[20:23], a[16:19], v[104:107]
    s_add_u32 m0, s28, 0x12000
    ds_read_b64_tr_b16 v[30:31], v8 offset:3584
    v_mul_f32 v195, v195, v99
    v_mfma_f32_16x16x32_bf16 v[104:107], v[24:27], a[32:35], v[104:107]
    s_mul_i32 s41, s28, 64
    ds_read_b64_tr_b16 v[32:33], v8 offset:4096
    v_mul_f32 v188, v188, v92
    v_mfma_f32_16x16x32_bf16 v[108:111], v[24:27], a[36:39], v[248:251]
    s_add_u32 s41, s41, s37
    ds_read_b64_tr_b16 v[34:35], v8 offset:4608
    v_mul_f32 v189, v189, v93
    v_mfma_f32_16x16x32_bf16 v[108:111], v[20:23], a[20:23], v[108:111]
    s_add_u32 s41, s41, 0x80
    ds_read_b64_tr_b16 v[36:37], v8 offset:5120
    v_mul_f32 v190, v190, v94
    v_mfma_f32_16x16x32_bf16 v[108:111], v[16:19], a[4:7], v[108:111]
    ds_read_b64_tr_b16 v[38:39], v8 offset:5632
    v_mul_f32 v184, v184, v88
    v_mfma_f32_16x16x32_bf16 v[112:115], v[16:19], a[8:11], v[248:251]
    v_mul_f32 v185, v185, v89
    v_mul_f32 v186, v186, v90
    v_mfma_f32_16x16x32_bf16 v[112:115], v[20:23], a[24:27], v[112:115]
    v_mul_f32 v187, v187, v91
    v_mul_f32 v191, v191, v95
    v_mfma_f32_16x16x32_bf16 v[112:115], v[24:27], a[40:43], v[112:115]
    buffer_load_dwordx4 v10, s[16:19], s41 offen nt lds
    v_mfma_f32_16x16x32_bf16 v[116:119], v[24:27], a[44:47], v[248:251]
    v_exp_f32 v226, v226
    v_mfma_f32_16x16x32_bf16 v[116:119], v[20:23], a[28:31], v[116:119]
    v_exp_f32 v227, v227
    v_mfma_f32_16x16x32_bf16 v[116:119], v[16:19], a[12:15], v[116:119]
    s_waitcnt lgkmcnt(0)
    v_add_f32 v224, 1.0, v224
    v_add_f32 v225, 1.0, v225
    v_mfma_f32_16x16x32_bf16 v[116:119], v[28:31], a[60:63], v[116:119]
    ds_read_b64_tr_b16 v[16:17], v8 offset:6144
    v_add_f32 v226, 1.0, v226
    v_mfma_f32_16x16x32_bf16 v[116:119], v[32:35], a[76:79], v[116:119]
    s_add_u32 m0, s29, 0x12000
    ds_read_b64_tr_b16 v[18:19], v8 offset:6656
    v_add_f32 v227, 1.0, v227
    v_mfma_f32_16x16x32_bf16 v[116:119], v[36:39], a[92:95], v[116:119]
    s_mul_i32 s41, s29, 64
    ds_read_b64_tr_b16 v[20:21], v8 offset:7168
    v_cvt_pk_bf16_f32 v170, v184, v185
    v_mfma_f32_16x16x32_bf16 v[112:115], v[36:39], a[88:91], v[112:115]
    s_add_u32 s41, s41, s37
    ds_read_b64_tr_b16 v[22:23], v8 offset:7680
    v_cvt_pk_bf16_f32 v171, v186, v187
    v_mfma_f32_16x16x32_bf16 v[112:115], v[32:35], a[72:75], v[112:115]
    s_add_u32 s41, s41, 0x80
    ds_read_b64_tr_b16 v[24:25], v8 offset:8192
    v_cvt_pk_bf16_f32 v172, v172, v173
    v_mfma_f32_16x16x32_bf16 v[112:115], v[28:31], a[56:59], v[112:115]
    ds_read_b64_tr_b16 v[26:27], v8 offset:8704
    v_cvt_pk_bf16_f32 v173, v174, v175
    v_mfma_f32_16x16x32_bf16 v[108:111], v[28:31], a[52:55], v[108:111]
    v_rcp_f32 v224, v224
    v_mfma_f32_16x16x32_bf16 v[108:111], v[32:35], a[68:71], v[108:111]
    v_rcp_f32 v225, v225
    v_mfma_f32_16x16x32_bf16 v[108:111], v[36:39], a[84:87], v[108:111]
    buffer_load_dwordx4 v10, s[16:19], s41 offen nt lds
    v_mfma_f32_16x16x32_bf16 v[104:107], v[36:39], a[80:83], v[104:107]
    v_rcp_f32 v226, v226
    v_mfma_f32_16x16x32_bf16 v[104:107], v[32:35], a[64:67], v[104:107]
    v_rcp_f32 v227, v227
    v_mfma_f32_16x16x32_bf16 v[104:107], v[28:31], a[48:51], v[104:107]
    s_waitcnt lgkmcnt(0)
    v_mul_f32 v160, v160, v224
    v_mul_f32 v161, v161, v225
    v_mfma_f32_16x16x32_bf16 v[104:107], v[16:19], a[96:99], v[104:107]
    ds_read_b64_tr_b16 v[28:29], v8 offset:9216
    v_mul_f32 v162, v162, v226
    v_mfma_f32_16x16x32_bf16 v[104:107], v[20:23], a[112:115], v[104:107]
    s_add_u32 m0, s30, 0x12000
    ds_read_b64_tr_b16 v[30:31], v8 offset:9728
    v_mul_f32 v163, v163, v227
    v_mfma_f32_16x16x32_bf16 v[104:107], v[24:27], a[128:131], v[104:107]
    s_mul_i32 s41, s30, 64
    ds_read_b64_tr_b16 v[32:33], v8 offset:10240
    v_cvt_pk_bf16_f32 v146, v160, v161
    v_mfma_f32_16x16x32_bf16 v[108:111], v[24:27], a[132:135], v[108:111]
    s_add_u32 s41, s41, s37
    ds_read_b64_tr_b16 v[34:35], v8 offset:10752
    v_cvt_pk_bf16_f32 v147, v162, v163
    v_mfma_f32_16x16x32_bf16 v[108:111], v[20:23], a[116:119], v[108:111]
    s_add_u32 s41, s41, 0x80
    ds_read_b64_tr_b16 v[36:37], v8 offset:11264
    v_cvt_pk_bf16_f32 v174, v188, v189
    v_mfma_f32_16x16x32_bf16 v[108:111], v[16:19], a[100:103], v[108:111]
    ds_read_b64_tr_b16 v[38:39], v8 offset:11776
    v_cvt_pk_bf16_f32 v175, v190, v191
    v_mfma_f32_16x16x32_bf16 v[112:115], v[16:19], a[104:107], v[112:115]
    v_exp_f32 v220, v220
    v_mfma_f32_16x16x32_bf16 v[112:115], v[20:23], a[120:123], v[112:115]
    v_exp_f32 v221, v221
    v_mfma_f32_16x16x32_bf16 v[112:115], v[24:27], a[136:139], v[112:115]
    buffer_load_dwordx4 v10, s[16:19], s41 offen nt lds
    v_mfma_f32_16x16x32_bf16 v[116:119], v[24:27], a[140:143], v[116:119]
    v_exp_f32 v222, v222
    v_mfma_f32_16x16x32_bf16 v[116:119], v[20:23], a[124:127], v[116:119]
    v_exp_f32 v223, v223
    v_mfma_f32_16x16x32_bf16 v[116:119], v[16:19], a[108:111], v[116:119]
    s_waitcnt lgkmcnt(0)
    v_add_f32 v220, 1.0, v220
    v_add_f32 v221, 1.0, v221
    v_mfma_f32_16x16x32_bf16 v[116:119], v[28:31], a[156:159], v[116:119]
    ds_read_b64_tr_b16 v[16:17], v8 offset:12288
    v_add_f32 v222, 1.0, v222
    v_mfma_f32_16x16x32_bf16 v[116:119], v[32:35], a[172:175], v[116:119]
    s_add_u32 m0, s31, 0x12000
    ds_read_b64_tr_b16 v[18:19], v8 offset:12800
    v_add_f32 v223, 1.0, v223
    v_mfma_f32_16x16x32_bf16 v[116:119], v[36:39], a[188:191], v[116:119]
    s_mul_i32 s41, s31, 64
    ds_read_b64_tr_b16 v[20:21], v8 offset:13312
    v_cvt_pk_bf16_f32 v176, v176, v177
    v_mfma_f32_16x16x32_bf16 v[112:115], v[36:39], a[184:187], v[112:115]
    s_add_u32 s41, s41, s37
    ds_read_b64_tr_b16 v[22:23], v8 offset:13824
    v_cvt_pk_bf16_f32 v177, v178, v179
    v_mfma_f32_16x16x32_bf16 v[112:115], v[32:35], a[168:171], v[112:115]
    s_add_u32 s41, s41, 0x80
    ds_read_b64_tr_b16 v[24:25], v8 offset:14336
    v_cvt_pk_bf16_f32 v178, v192, v193
    v_mfma_f32_16x16x32_bf16 v[112:115], v[28:31], a[152:155], v[112:115]
    ds_read_b64_tr_b16 v[26:27], v8 offset:14848
    v_cvt_pk_bf16_f32 v179, v194, v195
    v_mfma_f32_16x16x32_bf16 v[108:111], v[28:31], a[148:151], v[108:111]
    v_rcp_f32 v220, v220
    v_mfma_f32_16x16x32_bf16 v[108:111], v[32:35], a[164:167], v[108:111]
    v_rcp_f32 v221, v221
    v_mfma_f32_16x16x32_bf16 v[108:111], v[36:39], a[180:183], v[108:111]
    buffer_load_dwordx4 v10, s[16:19], s41 offen nt lds
    v_mfma_f32_16x16x32_bf16 v[104:107], v[36:39], a[176:179], v[104:107]
    v_rcp_f32 v222, v222
    v_mfma_f32_16x16x32_bf16 v[104:107], v[32:35], a[160:163], v[104:107]
    v_rcp_f32 v223, v223
    v_mfma_f32_16x16x32_bf16 v[104:107], v[28:31], a[144:147], v[104:107]
    s_waitcnt lgkmcnt(0)
    v_mul_f32 v156, v156, v220
    v_mul_f32 v157, v157, v221
    v_mfma_f32_16x16x32_bf16 v[104:107], v[16:19], a[192:195], v[104:107]
    ds_read_b64_tr_b16 v[28:29], v8 offset:15360
    v_mul_f32 v158, v158, v222
    v_mfma_f32_16x16x32_bf16 v[104:107], v[20:23], a[208:211], v[104:107]
    s_add_u32 m0, s46, 0x12000
    ds_read_b64_tr_b16 v[30:31], v8 offset:15872
    v_mul_f32 v159, v159, v223
    v_mfma_f32_16x16x32_bf16 v[104:107], v[24:27], a[224:227], v[104:107]
    s_mul_i32 s41, s46, 64
    ds_read_b64_tr_b16 v[32:33], v8 offset:16384
    v_cvt_pk_bf16_f32 v142, v156, v157
    v_mfma_f32_16x16x32_bf16 v[108:111], v[24:27], a[228:231], v[108:111]
    s_add_u32 s41, s41, s37
    ds_read_b64_tr_b16 v[34:35], v8 offset:16896
    v_cvt_pk_bf16_f32 v143, v158, v159
    v_mfma_f32_16x16x32_bf16 v[108:111], v[20:23], a[212:215], v[108:111]
    s_add_u32 s41, s41, 0x80
    ds_read_b64_tr_b16 v[36:37], v8 offset:17408
    v_cvt_pk_bf16_f32 v180, v180, v181
    v_mfma_f32_16x16x32_bf16 v[108:111], v[16:19], a[196:199], v[108:111]
    ds_read_b64_tr_b16 v[38:39], v8 offset:17920
    v_cvt_pk_bf16_f32 v181, v182, v183
    v_mfma_f32_16x16x32_bf16 v[112:115], v[16:19], a[200:203], v[112:115]
    v_exp_f32 v216, v216
    v_mfma_f32_16x16x32_bf16 v[112:115], v[20:23], a[216:219], v[112:115]
    v_exp_f32 v217, v217
    v_mfma_f32_16x16x32_bf16 v[112:115], v[24:27], a[232:235], v[112:115]
    buffer_load_dwordx4 v10, s[16:19], s41 offen nt lds
    v_mfma_f32_16x16x32_bf16 v[116:119], v[24:27], a[236:239], v[116:119]
    v_exp_f32 v218, v218
    v_mfma_f32_16x16x32_bf16 v[116:119], v[20:23], a[220:223], v[116:119]
    v_exp_f32 v219, v219
    v_mfma_f32_16x16x32_bf16 v[116:119], v[16:19], a[204:207], v[116:119]
    s_waitcnt lgkmcnt(0)
    v_add_f32 v216, 1.0, v216
    v_add_f32 v217, 1.0, v217
    v_mfma_f32_16x16x32_bf16 v[116:119], v[28:31], a[252:255], v[116:119]
    ds_read_b64_tr_b16 v[16:17], v8 offset:33792
    v_add_f32 v218, 1.0, v218
    v_mfma_f32_16x16x32_bf16 v[116:119], v[32:35], v[52:55], v[116:119]
    s_add_u32 m0, s47, 0x12000
    ds_read_b64_tr_b16 v[18:19], v8 offset:34304
    v_add_f32 v219, 1.0, v219
    v_mfma_f32_16x16x32_bf16 v[116:119], v[36:39], v[68:71], v[116:119]
    s_mul_i32 s41, s47, 64
    ds_read_b64_tr_b16 v[20:21], v8 offset:34816
    v_cvt_pk_bf16_f32 v182, v196, v197
    v_mfma_f32_16x16x32_bf16 v[112:115], v[36:39], v[64:67], v[112:115]
    s_add_u32 s41, s41, s37
    ds_read_b64_tr_b16 v[22:23], v8 offset:35328
    v_cvt_pk_bf16_f32 v183, v198, v199
    v_mfma_f32_16x16x32_bf16 v[112:115], v[32:35], v[48:51], v[112:115]
    s_add_u32 s41, s41, 0x80
    ds_read_b64_tr_b16 v[24:25], v8 offset:35840
    v_mfma_f32_16x16x32_bf16 v[112:115], v[28:31], a[248:251], v[112:115]
    ds_read_b64_tr_b16 v[26:27], v8 offset:36352
    v_mfma_f32_16x16x32_bf16 v[108:111], v[28:31], a[244:247], v[108:111]
    v_rcp_f32 v216, v216
    v_mfma_f32_16x16x32_bf16 v[108:111], v[32:35], v[44:47], v[108:111]
    v_rcp_f32 v217, v217
    v_mfma_f32_16x16x32_bf16 v[108:111], v[36:39], v[60:63], v[108:111]
    buffer_load_dwordx4 v10, s[16:19], s41 offen nt lds
    v_mfma_f32_16x16x32_bf16 v[104:107], v[36:39], v[56:59], v[104:107]
    v_rcp_f32 v218, v218
    v_mfma_f32_16x16x32_bf16 v[104:107], v[32:35], v[40:43], v[104:107]
    v_rcp_f32 v219, v219
    v_mfma_f32_16x16x32_bf16 v[104:107], v[28:31], a[240:243], v[104:107]
    s_waitcnt lgkmcnt(0)
    v_mul_f32 v152, v152, v216
    v_mul_f32 v153, v153, v217
    v_mfma_f32_16x16x32_bf16 v[120:123], v[16:19], a[240:243], 0
    ds_read_b64_tr_b16 v[28:29], v8 offset:30720
    v_mul_f32 v154, v154, v218
    v_mfma_f32_16x16x32_bf16 v[120:123], v[20:23], v[40:43], v[120:123]
    s_add_u32 m0, s48, 0x12000
    ds_read_b64_tr_b16 v[30:31], v8 offset:31232
    v_mul_f32 v155, v155, v219
    v_mfma_f32_16x16x32_bf16 v[120:123], v[24:27], v[56:59], v[120:123]
    s_mul_i32 s41, s48, 64
    ds_read_b64_tr_b16 v[32:33], v8 offset:31744
    v_cvt_pk_bf16_f32 v138, v152, v153
    v_mfma_f32_16x16x32_bf16 v[124:127], v[24:27], v[60:63], 0
    s_add_u32 s41, s41, s37
    ds_read_b64_tr_b16 v[34:35], v8 offset:32256
    v_cvt_pk_bf16_f32 v139, v154, v155
    v_mfma_f32_16x16x32_bf16 v[124:127], v[20:23], v[44:47], v[124:127]
    s_add_u32 s41, s41, 0x80
    ds_read_b64_tr_b16 v[36:37], v8 offset:32768
    v_fma_f32 v108, s49, v108, -v255
L_hop0_6:
    s_cbranch_execz L_hop0_15
    v_mfma_f32_16x16x32_bf16 v[124:127], v[16:19], a[244:247], v[124:127]
    ds_read_b64_tr_b16 v[38:39], v8 offset:33280
    v_fma_f32 v104, s49, v104, -v255
    v_mfma_f32_16x16x32_bf16 v[128:131], v[16:19], a[248:251], 0
    buffer_store_dwordx4 v[136:139], v1, s[4:7], s58 offen offset:0 sc1
    v_mfma_f32_16x16x32_bf16 v[128:131], v[20:23], v[48:51], v[128:131]
    buffer_store_dwordx4 v[140:143], v1, s[4:7], s58 offen offset:1024 sc1
    v_mfma_f32_16x16x32_bf16 v[128:131], v[24:27], v[64:67], v[128:131]
    buffer_load_dwordx4 v10, s[16:19], s41 offen nt lds
    v_mfma_f32_16x16x32_bf16 v[132:135], v[24:27], v[68:71], 0
    v_fma_f32 v105, s49, v105, -v255
    v_fma_f32 v106, s49, v106, -v255
    v_mfma_f32_16x16x32_bf16 v[132:135], v[20:23], v[52:55], v[132:135]
    v_fma_f32 v107, s49, v107, -v255
    v_fma_f32 v109, s49, v109, -v255
    v_mfma_f32_16x16x32_bf16 v[132:135], v[16:19], a[252:255], v[132:135]
    s_waitcnt lgkmcnt(0)
    v_exp_f32 v104, v104
    v_mfma_f32_16x16x32_bf16 v[132:135], v[28:31], a[204:207], v[132:135]
    ds_read_b64_tr_b16 v[16:17], v8 offset:27648
    v_add_f32 v104, 1.0, v104
    v_mfma_f32_16x16x32_bf16 v[132:135], v[32:35], a[220:223], v[132:135]
    s_add_u32 m0, s82, 0x12000
    ds_read_b64_tr_b16 v[18:19], v8 offset:28160
    v_fma_f32 v110, s49, v110, -v255
    v_mfma_f32_16x16x32_bf16 v[132:135], v[36:39], a[236:239], v[132:135]
    s_mul_i32 s41, s82, 64
    ds_read_b64_tr_b16 v[20:21], v8 offset:28672
    v_fma_f32 v111, s49, v111, -v255
    v_mfma_f32_16x16x32_bf16 v[128:131], v[36:39], a[232:235], v[128:131]
    s_add_u32 s41, s41, s37
    ds_read_b64_tr_b16 v[22:23], v8 offset:29184
    v_fma_f32 v112, s49, v112, -v255
    v_mfma_f32_16x16x32_bf16 v[128:131], v[32:35], a[216:219], v[128:131]
    s_add_u32 s41, s41, 0x80
    ds_read_b64_tr_b16 v[24:25], v8 offset:29696
    v_fma_f32 v113, s49, v113, -v255
    v_mfma_f32_16x16x32_bf16 v[128:131], v[28:31], a[200:203], v[128:131]
    ds_read_b64_tr_b16 v[26:27], v8 offset:30208
    v_fma_f32 v114, s49, v114, -v255
    v_mfma_f32_16x16x32_bf16 v[124:127], v[28:31], a[196:199], v[124:127]
    v_exp_f32 v105, v105
    v_mfma_f32_16x16x32_bf16 v[124:127], v[32:35], a[212:215], v[124:127]
    v_exp_f32 v106, v106
    v_mfma_f32_16x16x32_bf16 v[124:127], v[36:39], a[228:231], v[124:127]
    buffer_load_dwordx4 v10, s[16:19], s41 offen nt lds
    v_mfma_f32_16x16x32_bf16 v[120:123], v[36:39], a[224:227], v[120:123]
    v_exp_f32 v107, v107
    v_mfma_f32_16x16x32_bf16 v[120:123], v[32:35], a[208:211], v[120:123]
    v_add_f32 v105, 1.0, v105
    v_add_f32 v106, 1.0, v106
    v_mfma_f32_16x16x32_bf16 v[120:123], v[28:31], a[192:195], v[120:123]
    s_waitcnt lgkmcnt(0)
    v_add_f32 v107, 1.0, v107
    v_fma_f32 v115, s49, v115, -v255
    v_mfma_f32_16x16x32_bf16 v[120:123], v[16:19], a[144:147], v[120:123]
    ds_read_b64_tr_b16 v[28:29], v8 offset:24576
    v_fma_f32 v116, s49, v116, -v255
    v_mfma_f32_16x16x32_bf16 v[120:123], v[20:23], a[160:163], v[120:123]
    s_add_u32 m0, s84, 0x12000
    ds_read_b64_tr_b16 v[30:31], v8 offset:25088
    v_fma_f32 v117, s49, v117, -v255
    v_mfma_f32_16x16x32_bf16 v[120:123], v[24:27], a[176:179], v[120:123]
    s_mul_i32 s41, s84, 64
    ds_read_b64_tr_b16 v[32:33], v8 offset:25600
    v_fma_f32 v118, s49, v118, -v255
    v_mfma_f32_16x16x32_bf16 v[124:127], v[24:27], a[180:183], v[124:127]
    s_add_u32 s41, s41, s37
    ds_read_b64_tr_b16 v[34:35], v8 offset:26112
    v_fma_f32 v119, s49, v119, -v255
    v_mfma_f32_16x16x32_bf16 v[124:127], v[20:23], a[164:167], v[124:127]
    s_add_u32 s41, s41, 0x80
    ds_read_b64_tr_b16 v[36:37], v8 offset:26624
    v_mfma_f32_16x16x32_bf16 v[124:127], v[16:19], a[148:151], v[124:127]
    ds_read_b64_tr_b16 v[38:39], v8 offset:27136
    v_mfma_f32_16x16x32_bf16 v[128:131], v[16:19], a[152:155], v[128:131]
    v_rcp_f32 v104, v104
    v_mfma_f32_16x16x32_bf16 v[128:131], v[20:23], a[168:171], v[128:131]
    v_rcp_f32 v105, v105
    v_mfma_f32_16x16x32_bf16 v[128:131], v[24:27], a[184:187], v[128:131]
    buffer_load_dwordx4 v10, s[16:19], s41 offen nt lds
    v_mfma_f32_16x16x32_bf16 v[132:135], v[24:27], a[188:191], v[132:135]
    v_rcp_f32 v106, v106
    v_mfma_f32_16x16x32_bf16 v[132:135], v[20:23], a[172:175], v[132:135]
    v_rcp_f32 v107, v107
    v_mfma_f32_16x16x32_bf16 v[132:135], v[16:19], a[156:159], v[132:135]
    s_waitcnt lgkmcnt(0)
    v_exp_f32 v108, v108
    v_mfma_f32_16x16x32_bf16 v[132:135], v[28:31], a[108:111], v[132:135]
    ds_read_b64_tr_b16 v[16:17], v8 offset:21504
    v_add_f32 v108, 1.0, v108
    v_mfma_f32_16x16x32_bf16 v[132:135], v[32:35], a[124:127], v[132:135]
    ds_read_b64_tr_b16 v[18:19], v8 offset:22016
    v_mfma_f32_16x16x32_bf16 v[132:135], v[36:39], a[140:143], v[132:135]
    ds_read_b64_tr_b16 v[20:21], v8 offset:22528
    v_mfma_f32_16x16x32_bf16 v[128:131], v[36:39], a[136:139], v[128:131]
    ds_read_b64_tr_b16 v[22:23], v8 offset:23040
    v_mfma_f32_16x16x32_bf16 v[128:131], v[32:35], a[120:123], v[128:131]
    ds_read_b64_tr_b16 v[24:25], v8 offset:23552
    v_mfma_f32_16x16x32_bf16 v[128:131], v[28:31], a[104:107], v[128:131]
    ds_read_b64_tr_b16 v[26:27], v8 offset:24064
    v_mfma_f32_16x16x32_bf16 v[124:127], v[28:31], a[100:103], v[124:127]
    buffer_store_dwordx4 v[144:147], v1, s[4:7], s58 offen offset:2048 sc1
    v_mfma_f32_16x16x32_bf16 v[124:127], v[32:35], a[116:119], v[124:127]
    v_exp_f32 v109, v109
    v_mfma_f32_16x16x32_bf16 v[124:127], v[36:39], a[132:135], v[124:127]
    v_exp_f32 v110, v110
    v_mfma_f32_16x16x32_bf16 v[120:123], v[36:39], a[128:131], v[120:123]
    v_exp_f32 v111, v111
    v_mfma_f32_16x16x32_bf16 v[120:123], v[32:35], a[112:115], v[120:123]
    v_add_f32 v109, 1.0, v109
    v_add_f32 v110, 1.0, v110
    v_mfma_f32_16x16x32_bf16 v[120:123], v[28:31], a[96:99], v[120:123]
    s_waitcnt lgkmcnt(0)
    v_add_f32 v111, 1.0, v111
    v_mfma_f32_16x16x32_bf16 v[120:123], v[16:19], a[48:51], v[120:123]
    ds_read_b64_tr_b16 v[28:29], v8 offset:18432
    v_mfma_f32_16x16x32_bf16 v[120:123], v[20:23], a[64:67], v[120:123]
    ds_read_b64_tr_b16 v[30:31], v8 offset:18944
    v_mfma_f32_16x16x32_bf16 v[120:123], v[24:27], a[80:83], v[120:123]
    ds_read_b64_tr_b16 v[32:33], v8 offset:19456
    v_mfma_f32_16x16x32_bf16 v[124:127], v[24:27], a[84:87], v[124:127]
    ds_read_b64_tr_b16 v[34:35], v8 offset:19968
    v_mfma_f32_16x16x32_bf16 v[124:127], v[20:23], a[68:71], v[124:127]
    ds_read_b64_tr_b16 v[36:37], v8 offset:20480
    v_mfma_f32_16x16x32_bf16 v[124:127], v[16:19], a[52:55], v[124:127]
    ds_read_b64_tr_b16 v[38:39], v8 offset:20992
    v_mfma_f32_16x16x32_bf16 v[128:131], v[16:19], a[56:59], v[128:131]
    v_rcp_f32 v108, v108
    v_mfma_f32_16x16x32_bf16 v[128:131], v[20:23], a[72:75], v[128:131]
    v_rcp_f32 v109, v109
    v_mfma_f32_16x16x32_bf16 v[128:131], v[24:27], a[88:91], v[128:131]
    v_rcp_f32 v110, v110
    v_mfma_f32_16x16x32_bf16 v[132:135], v[24:27], a[92:95], v[132:135]
    v_rcp_f32 v111, v111
    v_mfma_f32_16x16x32_bf16 v[132:135], v[20:23], a[76:79], v[132:135]
    v_exp_f32 v112, v112
    v_mfma_f32_16x16x32_bf16 v[132:135], v[16:19], a[60:63], v[132:135]
    s_waitcnt vmcnt(22) lgkmcnt(0)
    s_barrier
    v_exp_f32 v113, v113
    v_mfma_f32_16x16x32_bf16 v[132:135], v[28:31], a[12:15], v[132:135]
    ds_read_b64_tr_b16 v[16:17], v6 offset:0
    v_add_f32 v112, 1.0, v112
    v_mfma_f32_16x16x32_bf16 v[132:135], v[32:35], a[28:31], v[132:135]
    ds_read_b64_tr_b16 v[18:19], v6 offset:512
    v_add_f32 v113, 1.0, v113
    v_mfma_f32_16x16x32_bf16 v[132:135], v[36:39], a[44:47], v[132:135]
    ds_read_b64_tr_b16 v[20:21], v6 offset:4096
    v_mfma_f32_16x16x32_bf16 v[128:131], v[36:39], a[40:43], v[128:131]
    ds_read_b64_tr_b16 v[22:23], v6 offset:4608
    v_mfma_f32_16x16x32_bf16 v[128:131], v[32:35], a[24:27], v[128:131]
    ds_read_b64_tr_b16 v[24:25], v6 offset:8192
    v_mfma_f32_16x16x32_bf16 v[128:131], v[28:31], a[8:11], v[128:131]
    ds_read_b64_tr_b16 v[26:27], v6 offset:8704
    v_mfma_f32_16x16x32_bf16 v[124:127], v[28:31], a[4:7], v[124:127]
    v_exp_f32 v114, v114
    v_mfma_f32_16x16x32_bf16 v[124:127], v[32:35], a[20:23], v[124:127]
    v_exp_f32 v115, v115
    v_mfma_f32_16x16x32_bf16 v[124:127], v[36:39], a[36:39], v[124:127]
    v_add_f32 v114, 1.0, v114
    v_add_f32 v115, 1.0, v115
    v_mfma_f32_16x16x32_bf16 v[120:123], v[36:39], a[32:35], v[120:123]
    v_rcp_f32 v112, v112
    v_mfma_f32_16x16x32_bf16 v[120:123], v[32:35], a[16:19], v[120:123]
    v_rcp_f32 v113, v113
    v_mfma_f32_16x16x32_bf16 v[120:123], v[28:31], a[0:3], v[120:123]
    s_waitcnt lgkmcnt(0)
    v_rcp_f32 v114, v114
    v_mfma_f32_16x16x32_bf16 v[72:75], v[16:19], a[0:3], 0
    ds_read_b64_tr_b16 v[28:29], v6 offset:12288
    v_mul_f32 v128, v128, v112
    v_mfma_f32_16x16x32_bf16 v[72:75], v[20:23], a[16:19], v[72:75]
    s_add_u32 m0, s28, 0x1b000
    ds_read_b64_tr_b16 v[30:31], v6 offset:12800
    v_mul_f32 v129, v129, v113
    v_mfma_f32_16x16x32_bf16 v[72:75], v[24:27], a[32:35], v[72:75]
    s_mul_i32 s41, s28, 64
    ds_read_b64_tr_b16 v[32:33], v6 offset:16384
    v_mul_f32 v124, v124, v108
    v_mfma_f32_16x16x32_bf16 v[76:79], v[24:27], a[36:39], 0
    s_add_u32 s41, s41, s37
    ds_read_b64_tr_b16 v[34:35], v6 offset:16896
    v_mul_f32 v125, v125, v109
    v_mfma_f32_16x16x32_bf16 v[76:79], v[20:23], a[20:23], v[76:79]
    s_add_u32 s41, s41, 0x240080
    ds_read_b64_tr_b16 v[36:37], v6 offset:20480
    v_mul_f32 v126, v126, v110
    v_mfma_f32_16x16x32_bf16 v[76:79], v[16:19], a[4:7], v[76:79]
    ds_read_b64_tr_b16 v[38:39], v6 offset:20992
    v_mul_f32 v120, v120, v104
    v_mfma_f32_16x16x32_bf16 v[80:83], v[16:19], a[8:11], 0
    v_mul_f32 v121, v121, v105
    v_mul_f32 v122, v122, v106
    v_mfma_f32_16x16x32_bf16 v[80:83], v[20:23], a[24:27], v[80:83]
    v_mul_f32 v123, v123, v107
    v_cvt_pk_bf16_f32 v104, v120, v121
    v_mfma_f32_16x16x32_bf16 v[80:83], v[24:27], a[40:43], v[80:83]
    buffer_load_dwordx4 v10, s[16:19], s41 offen nt lds
    v_mfma_f32_16x16x32_bf16 v[84:87], v[24:27], a[44:47], 0
    v_cvt_pk_bf16_f32 v105, v122, v123
    v_mul_f32 v127, v127, v111
    v_mfma_f32_16x16x32_bf16 v[84:87], v[20:23], a[28:31], v[84:87]
    v_cvt_pk_bf16_f32 v108, v124, v125
    v_cvt_pk_bf16_f32 v109, v126, v127
    v_mfma_f32_16x16x32_bf16 v[84:87], v[16:19], a[12:15], v[84:87]
    s_waitcnt lgkmcnt(0)
    v_rcp_f32 v115, v115
    v_mfma_f32_16x16x32_bf16 v[84:87], v[28:31], a[60:63], v[84:87]
    ds_read_b64_tr_b16 v[16:17], v6 offset:24576
    v_mul_f32 v130, v130, v114
    v_mfma_f32_16x16x32_bf16 v[84:87], v[32:35], a[76:79], v[84:87]
    s_add_u32 m0, s29, 0x1b000
    ds_read_b64_tr_b16 v[18:19], v6 offset:25088
    v_mul_f32 v131, v131, v115
    v_mfma_f32_16x16x32_bf16 v[84:87], v[36:39], a[92:95], v[84:87]
    s_mul_i32 s41, s29, 64
    ds_read_b64_tr_b16 v[20:21], v6 offset:28672
    v_cvt_pk_bf16_f32 v112, v128, v129
    v_mfma_f32_16x16x32_bf16 v[80:83], v[36:39], a[88:91], v[80:83]
    s_add_u32 s41, s41, s37
    ds_read_b64_tr_b16 v[22:23], v6 offset:29184
    v_cvt_pk_bf16_f32 v113, v130, v131
    v_mfma_f32_16x16x32_bf16 v[80:83], v[32:35], a[72:75], v[80:83]
    s_add_u32 s41, s41, 0x240080
    ds_read_b64_tr_b16 v[24:25], v6 offset:32768
    v_mfma_f32_16x16x32_bf16 v[80:83], v[28:31], a[56:59], v[80:83]
    ds_read_b64_tr_b16 v[26:27], v6 offset:33280
    v_mfma_f32_16x16x32_bf16 v[76:79], v[28:31], a[52:55], v[76:79]
    buffer_store_dwordx4 v[148:151], v1, s[4:7], s58 offen offset:3072 sc1
    v_mfma_f32_16x16x32_bf16 v[76:79], v[32:35], a[68:71], v[76:79]
    v_exp_f32 v116, v116
    v_mfma_f32_16x16x32_bf16 v[76:79], v[36:39], a[84:87], v[76:79]
    buffer_load_dwordx4 v10, s[16:19], s41 offen nt lds
    v_mfma_f32_16x16x32_bf16 v[72:75], v[36:39], a[80:83], v[72:75]
    v_exp_f32 v117, v117
    v_mfma_f32_16x16x32_bf16 v[72:75], v[32:35], a[64:67], v[72:75]
    v_exp_f32 v118, v118
    v_mfma_f32_16x16x32_bf16 v[72:75], v[28:31], a[48:51], v[72:75]
    s_waitcnt lgkmcnt(0)
    v_exp_f32 v119, v119
    v_mfma_f32_16x16x32_bf16 v[72:75], v[16:19], a[96:99], v[72:75]
    ds_read_b64_tr_b16 v[28:29], v6 offset:24584
    v_add_f32 v116, 1.0, v116
    v_mfma_f32_16x16x32_bf16 v[72:75], v[20:23], a[112:115], v[72:75]
    s_add_u32 m0, s30, 0x1b000
    ds_read_b64_tr_b16 v[30:31], v6 offset:25096
    v_add_f32 v117, 1.0, v117
    v_mfma_f32_16x16x32_bf16 v[72:75], v[24:27], a[128:131], v[72:75]
    s_mul_i32 s41, s30, 64
    ds_read_b64_tr_b16 v[32:33], v6 offset:28680
    v_add_f32 v118, 1.0, v118
    v_mfma_f32_16x16x32_bf16 v[76:79], v[24:27], a[132:135], v[76:79]
    s_add_u32 s41, s41, s37
    ds_read_b64_tr_b16 v[34:35], v6 offset:29192
    v_add_f32 v119, 1.0, v119
    v_mfma_f32_16x16x32_bf16 v[76:79], v[20:23], a[116:119], v[76:79]
    s_add_u32 s41, s41, 0x240080
    ds_read_b64_tr_b16 v[36:37], v6 offset:32776
    v_mfma_f32_16x16x32_bf16 v[76:79], v[16:19], a[100:103], v[76:79]
    ds_read_b64_tr_b16 v[38:39], v6 offset:33288
    v_mfma_f32_16x16x32_bf16 v[80:83], v[16:19], a[104:107], v[80:83]
    v_rcp_f32 v116, v116
    v_mfma_f32_16x16x32_bf16 v[80:83], v[20:23], a[120:123], v[80:83]
    v_rcp_f32 v117, v117
    v_mfma_f32_16x16x32_bf16 v[80:83], v[24:27], a[136:139], v[80:83]
    buffer_load_dwordx4 v10, s[16:19], s41 offen nt lds
    v_mfma_f32_16x16x32_bf16 v[84:87], v[24:27], a[140:143], v[84:87]
    v_rcp_f32 v118, v118
    v_mfma_f32_16x16x32_bf16 v[84:87], v[20:23], a[124:127], v[84:87]
    v_rcp_f32 v119, v119
    v_mfma_f32_16x16x32_bf16 v[84:87], v[16:19], a[108:111], v[84:87]
    s_waitcnt lgkmcnt(0)
    v_mul_f32 v132, v132, v116
    v_mul_f32 v133, v133, v117
    v_mfma_f32_16x16x32_bf16 v[212:215], v[28:31], a[108:111], 0
    ds_read_b64_tr_b16 v[16:17], v6 offset:12296
    v_mul_f32 v134, v134, v118
    v_mfma_f32_16x16x32_bf16 v[212:215], v[32:35], a[124:127], v[212:215]
    s_add_u32 m0, s31, 0x1b000
    ds_read_b64_tr_b16 v[18:19], v6 offset:12808
    v_mul_f32 v135, v135, v119
    v_mfma_f32_16x16x32_bf16 v[212:215], v[36:39], a[140:143], v[212:215]
    s_mul_i32 s41, s31, 64
    ds_read_b64_tr_b16 v[20:21], v6 offset:16392
    v_cvt_pk_bf16_f32 v116, v132, v133
    v_mfma_f32_16x16x32_bf16 v[208:211], v[36:39], a[136:139], 0
    s_add_u32 s41, s41, s37
    ds_read_b64_tr_b16 v[22:23], v6 offset:16904
    v_cvt_pk_bf16_f32 v117, v134, v135
    v_mfma_f32_16x16x32_bf16 v[208:211], v[32:35], a[120:123], v[208:211]
    s_add_u32 s41, s41, 0x240080
    ds_read_b64_tr_b16 v[24:25], v6 offset:20488
    v_mfma_f32_16x16x32_bf16 v[208:211], v[28:31], a[104:107], v[208:211]
    ds_read_b64_tr_b16 v[26:27], v6 offset:21000
    v_mfma_f32_16x16x32_bf16 v[204:207], v[28:31], a[100:103], 0
    v_mfma_f32_16x16x32_bf16 v[204:207], v[32:35], a[116:119], v[204:207]
    v_mfma_f32_16x16x32_bf16 v[204:207], v[36:39], a[132:135], v[204:207]
    buffer_load_dwordx4 v10, s[16:19], s41 offen nt lds
    v_mfma_f32_16x16x32_bf16 v[200:203], v[36:39], a[128:131], 0
    v_mfma_f32_16x16x32_bf16 v[200:203], v[32:35], a[112:115], v[200:203]
    v_mfma_f32_16x16x32_bf16 v[200:203], v[28:31], a[96:99], v[200:203]
    s_waitcnt lgkmcnt(0)
    v_mfma_f32_16x16x32_bf16 v[200:203], v[16:19], a[48:51], v[200:203]
    ds_read_b64_tr_b16 v[28:29], v6 offset:8
    v_mfma_f32_16x16x32_bf16 v[200:203], v[20:23], a[64:67], v[200:203]
    s_add_u32 m0, s46, 0x1b000
    ds_read_b64_tr_b16 v[30:31], v6 offset:520
    v_mfma_f32_16x16x32_bf16 v[200:203], v[24:27], a[80:83], v[200:203]
    s_mul_i32 s41, s46, 64
    ds_read_b64_tr_b16 v[32:33], v6 offset:4104
    v_mfma_f32_16x16x32_bf16 v[204:207], v[24:27], a[84:87], v[204:207]
    s_add_u32 s41, s41, s37
    ds_read_b64_tr_b16 v[34:35], v6 offset:4616
    v_mfma_f32_16x16x32_bf16 v[204:207], v[20:23], a[68:71], v[204:207]
    s_add_u32 s41, s41, 0x240080
    ds_read_b64_tr_b16 v[36:37], v6 offset:8200
    v_mfma_f32_16x16x32_bf16 v[204:207], v[16:19], a[52:55], v[204:207]
    ds_read_b64_tr_b16 v[38:39], v6 offset:8712
    v_mfma_f32_16x16x32_bf16 v[208:211], v[16:19], a[56:59], v[208:211]
    v_add_u32 v6, 0x9000, v6
    v_mfma_f32_16x16x32_bf16 v[208:211], v[20:23], a[72:75], v[208:211]
    v_mfma_f32_16x16x32_bf16 v[208:211], v[24:27], a[88:91], v[208:211]
    buffer_load_dwordx4 v10, s[16:19], s41 offen nt lds
    v_mfma_f32_16x16x32_bf16 v[212:215], v[24:27], a[92:95], v[212:215]
    v_mfma_f32_16x16x32_bf16 v[212:215], v[20:23], a[76:79], v[212:215]
    v_mfma_f32_16x16x32_bf16 v[212:215], v[16:19], a[60:63], v[212:215]
    s_waitcnt lgkmcnt(0)
    v_mfma_f32_16x16x32_bf16 v[212:215], v[28:31], a[12:15], v[212:215]
    ds_read_b64_tr_b16 v[16:17], v7 offset:0
    v_mfma_f32_16x16x32_bf16 v[212:215], v[32:35], a[28:31], v[212:215]
    s_add_u32 m0, s47, 0x1b000
    ds_read_b64_tr_b16 v[18:19], v7 offset:512
    v_mfma_f32_16x16x32_bf16 v[212:215], v[36:39], a[44:47], v[212:215]
    s_mul_i32 s41, s47, 64
    ds_read_b64_tr_b16 v[20:21], v7 offset:4096
    v_mfma_f32_16x16x32_bf16 v[208:211], v[36:39], a[40:43], v[208:211]
    s_add_u32 s41, s41, s37
    ds_read_b64_tr_b16 v[22:23], v7 offset:4608
    v_mfma_f32_16x16x32_bf16 v[208:211], v[32:35], a[24:27], v[208:211]
    s_add_u32 s41, s41, 0x240080
    ds_read_b64_tr_b16 v[24:25], v7 offset:8192
    v_mfma_f32_16x16x32_bf16 v[208:211], v[28:31], a[8:11], v[208:211]
    ds_read_b64_tr_b16 v[26:27], v7 offset:8704
    v_mfma_f32_16x16x32_bf16 v[204:207], v[28:31], a[4:7], v[204:207]
    v_mfma_f32_16x16x32_bf16 v[204:207], v[32:35], a[20:23], v[204:207]
    v_mfma_f32_16x16x32_bf16 v[204:207], v[36:39], a[36:39], v[204:207]
    buffer_load_dwordx4 v10, s[16:19], s41 offen nt lds
    v_mfma_f32_16x16x32_bf16 v[200:203], v[36:39], a[32:35], v[200:203]
    v_mfma_f32_16x16x32_bf16 v[200:203], v[32:35], a[16:19], v[200:203]
    v_mfma_f32_16x16x32_bf16 v[200:203], v[28:31], a[0:3], v[200:203]
    s_waitcnt lgkmcnt(0)
    v_mfma_f32_16x16x32_bf16 v[88:91], v[16:19], a[0:3], 0
    ds_read_b64_tr_b16 v[28:29], v7 offset:12288
    v_mfma_f32_16x16x32_bf16 v[88:91], v[20:23], a[16:19], v[88:91]
    s_add_u32 m0, s48, 0x1b000
    ds_read_b64_tr_b16 v[30:31], v7 offset:12800
    v_mfma_f32_16x16x32_bf16 v[88:91], v[24:27], a[32:35], v[88:91]
    s_mul_i32 s41, s48, 64
    ds_read_b64_tr_b16 v[32:33], v7 offset:16384
    v_mfma_f32_16x16x32_bf16 v[92:95], v[24:27], a[36:39], 0
    s_add_u32 s41, s41, s37
    ds_read_b64_tr_b16 v[34:35], v7 offset:16896
    v_mfma_f32_16x16x32_bf16 v[92:95], v[20:23], a[20:23], v[92:95]
    s_add_u32 s41, s41, 0x240080
    ds_read_b64_tr_b16 v[36:37], v7 offset:20480
    v_mfma_f32_16x16x32_bf16 v[92:95], v[16:19], a[4:7], v[92:95]
    ds_read_b64_tr_b16 v[38:39], v7 offset:20992
    v_mfma_f32_16x16x32_bf16 v[96:99], v[16:19], a[8:11], 0
    buffer_store_dwordx4 v[168:171], v1, s[4:7], s59 offen offset:0 sc1
    v_mfma_f32_16x16x32_bf16 v[96:99], v[20:23], a[24:27], v[96:99]
    v_mfma_f32_16x16x32_bf16 v[96:99], v[24:27], a[40:43], v[96:99]
    buffer_load_dwordx4 v10, s[16:19], s41 offen nt lds
    v_mfma_f32_16x16x32_bf16 v[100:103], v[24:27], a[44:47], 0
    v_mfma_f32_16x16x32_bf16 v[100:103], v[20:23], a[28:31], v[100:103]
    v_mfma_f32_16x16x32_bf16 v[100:103], v[16:19], a[12:15], v[100:103]
    s_waitcnt lgkmcnt(0)
    v_mfma_f32_16x16x32_bf16 v[100:103], v[28:31], a[60:63], v[100:103]
    ds_read_b64_tr_b16 v[16:17], v7 offset:24576
    v_mfma_f32_16x16x32_bf16 v[100:103], v[32:35], a[76:79], v[100:103]
    s_add_u32 m0, s82, 0x1b000
    ds_read_b64_tr_b16 v[18:19], v7 offset:25088
    v_mfma_f32_16x16x32_bf16 v[100:103], v[36:39], a[92:95], v[100:103]
    s_mul_i32 s41, s82, 64
    ds_read_b64_tr_b16 v[20:21], v7 offset:28672
    v_mfma_f32_16x16x32_bf16 v[96:99], v[36:39], a[88:91], v[96:99]
    s_add_u32 s41, s41, s37
    ds_read_b64_tr_b16 v[22:23], v7 offset:29184
    v_mfma_f32_16x16x32_bf16 v[96:99], v[32:35], a[72:75], v[96:99]
    s_add_u32 s41, s41, 0x240080
    ds_read_b64_tr_b16 v[24:25], v7 offset:32768
    v_mfma_f32_16x16x32_bf16 v[96:99], v[28:31], a[56:59], v[96:99]
    ds_read_b64_tr_b16 v[26:27], v7 offset:33280
    v_mfma_f32_16x16x32_bf16 v[92:95], v[28:31], a[52:55], v[92:95]
    v_mfma_f32_16x16x32_bf16 v[92:95], v[32:35], a[68:71], v[92:95]
    v_mfma_f32_16x16x32_bf16 v[92:95], v[36:39], a[84:87], v[92:95]
    buffer_load_dwordx4 v10, s[16:19], s41 offen nt lds
    v_mfma_f32_16x16x32_bf16 v[88:91], v[36:39], a[80:83], v[88:91]
    v_mfma_f32_16x16x32_bf16 v[88:91], v[32:35], a[64:67], v[88:91]
    v_mfma_f32_16x16x32_bf16 v[88:91], v[28:31], a[48:51], v[88:91]
    s_waitcnt lgkmcnt(0)
    v_mfma_f32_16x16x32_bf16 v[88:91], v[16:19], a[96:99], v[88:91]
    ds_read_b64_tr_b16 v[28:29], v7 offset:24584
    v_mfma_f32_16x16x32_bf16 v[88:91], v[20:23], a[112:115], v[88:91]
    s_add_u32 m0, s84, 0x1b000
    ds_read_b64_tr_b16 v[30:31], v7 offset:25096
    v_mfma_f32_16x16x32_bf16 v[88:91], v[24:27], a[128:131], v[88:91]
    s_mul_i32 s41, s84, 64
    ds_read_b64_tr_b16 v[32:33], v7 offset:28680
    v_mfma_f32_16x16x32_bf16 v[92:95], v[24:27], a[132:135], v[92:95]
    s_add_u32 s41, s41, s37
    ds_read_b64_tr_b16 v[34:35], v7 offset:29192
    v_mfma_f32_16x16x32_bf16 v[92:95], v[20:23], a[116:119], v[92:95]
    s_add_u32 s41, s41, 0x240080
    ds_read_b64_tr_b16 v[36:37], v7 offset:32776
    v_mfma_f32_16x16x32_bf16 v[92:95], v[16:19], a[100:103], v[92:95]
    ds_read_b64_tr_b16 v[38:39], v7 offset:33288
    v_mfma_f32_16x16x32_bf16 v[96:99], v[16:19], a[104:107], v[96:99]
    v_mfma_f32_16x16x32_bf16 v[96:99], v[20:23], a[120:123], v[96:99]
    v_mfma_f32_16x16x32_bf16 v[96:99], v[24:27], a[136:139], v[96:99]
    buffer_load_dwordx4 v10, s[16:19], s41 offen nt lds
    v_mfma_f32_16x16x32_bf16 v[100:103], v[24:27], a[140:143], v[100:103]
    v_mfma_f32_16x16x32_bf16 v[100:103], v[20:23], a[124:127], v[100:103]
    v_mfma_f32_16x16x32_bf16 v[100:103], v[16:19], a[108:111], v[100:103]
    s_waitcnt lgkmcnt(0)
    v_mfma_f32_16x16x32_bf16 v[228:231], v[28:31], a[108:111], 0
    ds_read_b64_tr_b16 v[16:17], v7 offset:12296
    v_mfma_f32_16x16x32_bf16 v[228:231], v[32:35], a[124:127], v[228:231]
    ds_read_b64_tr_b16 v[18:19], v7 offset:12808
    v_mfma_f32_16x16x32_bf16 v[228:231], v[36:39], a[140:143], v[228:231]
    ds_read_b64_tr_b16 v[20:21], v7 offset:16392
    v_mfma_f32_16x16x32_bf16 v[224:227], v[36:39], a[136:139], 0
    ds_read_b64_tr_b16 v[22:23], v7 offset:16904
    v_mfma_f32_16x16x32_bf16 v[224:227], v[32:35], a[120:123], v[224:227]
    ds_read_b64_tr_b16 v[24:25], v7 offset:20488
    v_mfma_f32_16x16x32_bf16 v[224:227], v[28:31], a[104:107], v[224:227]
    ds_read_b64_tr_b16 v[26:27], v7 offset:21000
    v_mfma_f32_16x16x32_bf16 v[220:223], v[28:31], a[100:103], 0
    v_mfma_f32_16x16x32_bf16 v[220:223], v[32:35], a[116:119], v[220:223]
    v_mfma_f32_16x16x32_bf16 v[220:223], v[36:39], a[132:135], v[220:223]
    v_mfma_f32_16x16x32_bf16 v[216:219], v[36:39], a[128:131], 0
    v_mfma_f32_16x16x32_bf16 v[216:219], v[32:35], a[112:115], v[216:219]
    v_mfma_f32_16x16x32_bf16 v[216:219], v[28:31], a[96:99], v[216:219]
    s_waitcnt lgkmcnt(0)
    v_mfma_f32_16x16x32_bf16 v[216:219], v[16:19], a[48:51], v[216:219]
    ds_read_b64_tr_b16 v[28:29], v7 offset:8
    v_mfma_f32_16x16x32_bf16 v[216:219], v[20:23], a[64:67], v[216:219]
    ds_read_b64_tr_b16 v[30:31], v7 offset:520
    v_mfma_f32_16x16x32_bf16 v[216:219], v[24:27], a[80:83], v[216:219]
    ds_read_b64_tr_b16 v[32:33], v7 offset:4104
    v_mfma_f32_16x16x32_bf16 v[220:223], v[24:27], a[84:87], v[220:223]
    ds_read_b64_tr_b16 v[34:35], v7 offset:4616
    v_mfma_f32_16x16x32_bf16 v[220:223], v[20:23], a[68:71], v[220:223]
    ds_read_b64_tr_b16 v[36:37], v7 offset:8200
    v_mfma_f32_16x16x32_bf16 v[220:223], v[16:19], a[52:55], v[220:223]
    ds_read_b64_tr_b16 v[38:39], v7 offset:8712
    v_mfma_f32_16x16x32_bf16 v[224:227], v[16:19], a[56:59], v[224:227]
    v_add_u32 v7, 0x9000, v7
    v_mfma_f32_16x16x32_bf16 v[224:227], v[20:23], a[72:75], v[224:227]
    buffer_store_dwordx4 v[172:175], v1, s[4:7], s59 offen offset:1024 sc1
    v_mfma_f32_16x16x32_bf16 v[224:227], v[24:27], a[88:91], v[224:227]
    v_mfma_f32_16x16x32_bf16 v[228:231], v[24:27], a[92:95], v[228:231]
    v_mfma_f32_16x16x32_bf16 v[228:231], v[20:23], a[76:79], v[228:231]
    v_mfma_f32_16x16x32_bf16 v[228:231], v[16:19], a[60:63], v[228:231]
    s_waitcnt vmcnt(24) lgkmcnt(0)
    s_barrier
    v_mfma_f32_16x16x32_bf16 v[228:231], v[28:31], a[12:15], v[228:231]
    ds_read_b64_tr_b16 v[16:17], v6 offset:0
    v_mfma_f32_16x16x32_bf16 v[228:231], v[32:35], a[28:31], v[228:231]
    ds_read_b64_tr_b16 v[18:19], v6 offset:512
    v_mfma_f32_16x16x32_bf16 v[228:231], v[36:39], a[44:47], v[228:231]
    ds_read_b64_tr_b16 v[20:21], v6 offset:4096
    v_mfma_f32_16x16x32_bf16 v[224:227], v[36:39], a[40:43], v[224:227]
    ds_read_b64_tr_b16 v[22:23], v6 offset:4608
    v_mfma_f32_16x16x32_bf16 v[224:227], v[32:35], a[24:27], v[224:227]
    ds_read_b64_tr_b16 v[24:25], v6 offset:8192
    v_mfma_f32_16x16x32_bf16 v[224:227], v[28:31], a[8:11], v[224:227]
    ds_read_b64_tr_b16 v[26:27], v6 offset:8704
    v_mfma_f32_16x16x32_bf16 v[220:223], v[28:31], a[4:7], v[220:223]
    v_mfma_f32_16x16x32_bf16 v[220:223], v[32:35], a[20:23], v[220:223]
    v_mfma_f32_16x16x32_bf16 v[220:223], v[36:39], a[36:39], v[220:223]
    v_mfma_f32_16x16x32_bf16 v[216:219], v[36:39], a[32:35], v[216:219]
    v_mfma_f32_16x16x32_bf16 v[216:219], v[32:35], a[16:19], v[216:219]
    v_mfma_f32_16x16x32_bf16 v[216:219], v[28:31], a[0:3], v[216:219]
    s_waitcnt lgkmcnt(0)
    v_mfma_f32_16x16x32_bf16 v[72:75], v[16:19], a[144:147], v[72:75]
    s_mov_b32 s8, s80
    ds_read_b64_tr_b16 v[28:29], v6 offset:12288
    v_mfma_f32_16x16x32_bf16 v[72:75], v[20:23], a[160:163], v[72:75]
    s_add_u32 m0, s35, 0x0
    ds_read_b64_tr_b16 v[30:31], v6 offset:12800
    v_mfma_f32_16x16x32_bf16 v[72:75], v[24:27], a[176:179], v[72:75]
    s_add_u32 s41, s52, 0x4000
    ds_read_b64_tr_b16 v[32:33], v6 offset:16384
    v_mfma_f32_16x16x32_bf16 v[76:79], v[24:27], a[180:183], v[76:79]
    s_and_b32 s9, s81, 0xffff
    ds_read_b64_tr_b16 v[34:35], v6 offset:16896
    v_mfma_f32_16x16x32_bf16 v[76:79], v[20:23], a[164:167], v[76:79]
    s_mov_b32 s10, 0x240000
    ds_read_b64_tr_b16 v[36:37], v6 offset:20480
    v_mfma_f32_16x16x32_bf16 v[76:79], v[16:19], a[148:151], v[76:79]
    s_mov_b32 s11, 0x20000
    ds_read_b64_tr_b16 v[38:39], v6 offset:20992
    v_mfma_f32_16x16x32_bf16 v[80:83], v[16:19], a[152:155], v[80:83]
    v_mfma_f32_16x16x32_bf16 v[80:83], v[20:23], a[168:171], v[80:83]
    v_mfma_f32_16x16x32_bf16 v[80:83], v[24:27], a[184:187], v[80:83]
    buffer_load_dwordx4 v12, s[20:23], s41 offen nt lds
    v_mfma_f32_16x16x32_bf16 v[84:87], v[24:27], a[188:191], v[84:87]
    v_mfma_f32_16x16x32_bf16 v[84:87], v[20:23], a[172:175], v[84:87]
    v_mfma_f32_16x16x32_bf16 v[84:87], v[16:19], a[156:159], v[84:87]
    s_waitcnt lgkmcnt(0)
    v_mfma_f32_16x16x32_bf16 v[84:87], v[28:31], a[204:207], v[84:87]
    s_mov_b32 s16, s60
    ds_read_b64_tr_b16 v[16:17], v6 offset:24576
    v_mfma_f32_16x16x32_bf16 v[84:87], v[32:35], a[220:223], v[84:87]
    s_add_u32 m0, s35, 0x1000
    ds_read_b64_tr_b16 v[18:19], v6 offset:25088
    v_mfma_f32_16x16x32_bf16 v[84:87], v[36:39], a[236:239], v[84:87]
    s_add_u32 s41, s52, 0x5000
    ds_read_b64_tr_b16 v[20:21], v6 offset:28672
    v_mfma_f32_16x16x32_bf16 v[80:83], v[36:39], a[232:235], v[80:83]
    s_and_b32 s17, s61, 0xffff
    ds_read_b64_tr_b16 v[22:23], v6 offset:29184
    v_mfma_f32_16x16x32_bf16 v[80:83], v[32:35], a[216:219], v[80:83]
    s_mov_b32 s18, 0x0
    ds_read_b64_tr_b16 v[24:25], v6 offset:32768
    v_mfma_f32_16x16x32_bf16 v[80:83], v[28:31], a[200:203], v[80:83]
    s_mov_b32 s19, 0x20000
    ds_read_b64_tr_b16 v[26:27], v6 offset:33280
    v_mfma_f32_16x16x32_bf16 v[76:79], v[28:31], a[196:199], v[76:79]
    v_mfma_f32_16x16x32_bf16 v[76:79], v[32:35], a[212:215], v[76:79]
    v_mfma_f32_16x16x32_bf16 v[76:79], v[36:39], a[228:231], v[76:79]
    buffer_load_dwordx4 v12, s[20:23], s41 offen nt lds
    v_mfma_f32_16x16x32_bf16 v[72:75], v[36:39], a[224:227], v[72:75]
    v_mfma_f32_16x16x32_bf16 v[72:75], v[32:35], a[208:211], v[72:75]
    v_mfma_f32_16x16x32_bf16 v[72:75], v[28:31], a[192:195], v[72:75]
    s_waitcnt lgkmcnt(0)
    v_mfma_f32_16x16x32_bf16 v[72:75], v[16:19], a[240:243], v[72:75]
    s_bfe_u32 s42, s2, 0x20001
    ds_read_b64_tr_b16 v[28:29], v6 offset:24584
    v_mfma_f32_16x16x32_bf16 v[72:75], v[20:23], v[40:43], v[72:75]
    s_add_u32 m0, s35, 0x2000
    ds_read_b64_tr_b16 v[30:31], v6 offset:25096
    v_mfma_f32_16x16x32_bf16 v[72:75], v[24:27], v[56:59], v[72:75]
    s_add_u32 s41, s52, 0x6000
    ds_read_b64_tr_b16 v[32:33], v6 offset:28680
    v_mfma_f32_16x16x32_bf16 v[76:79], v[24:27], v[60:63], v[76:79]
    s_xor_b32 s54, s42, s32
    ds_read_b64_tr_b16 v[34:35], v6 offset:29192
    v_mfma_f32_16x16x32_bf16 v[76:79], v[20:23], v[44:47], v[76:79]
    s_min_u32 s54, s54, 1
    ds_read_b64_tr_b16 v[36:37], v6 offset:32776
    v_mfma_f32_16x16x32_bf16 v[76:79], v[16:19], a[244:247], v[76:79]
    s_sub_u32 s54, 1, s54
    ds_read_b64_tr_b16 v[38:39], v6 offset:33288
    v_mfma_f32_16x16x32_bf16 v[80:83], v[16:19], a[248:251], v[80:83]
    v_mfma_f32_16x16x32_bf16 v[80:83], v[20:23], v[48:51], v[80:83]
    v_mfma_f32_16x16x32_bf16 v[80:83], v[24:27], v[64:67], v[80:83]
    buffer_load_dwordx4 v12, s[20:23], s41 offen nt lds
    v_mfma_f32_16x16x32_bf16 v[84:87], v[24:27], v[68:71], v[84:87]
    v_mul_f32 v72, s50, v72
    v_mul_f32 v73, s50, v73
    v_mfma_f32_16x16x32_bf16 v[84:87], v[20:23], v[52:55], v[84:87]
    v_mul_f32 v74, s50, v74
    v_mul_f32 v75, s50, v75
    v_mfma_f32_16x16x32_bf16 v[84:87], v[16:19], a[252:255], v[84:87]
    s_waitcnt lgkmcnt(0)
    v_cvt_pk_bf16_f32 v72, v72, v73
    v_cvt_pk_bf16_f32 v73, v74, v75
    v_mfma_f32_16x16x32_bf16 v[212:215], v[28:31], a[252:255], v[212:215]
    s_lshl_b32 s18, s54, 28
    ds_read_b64_tr_b16 v[16:17], v6 offset:12296
L_hop0_7:
    s_cbranch_execz L_hop0_16
    v_mul_f32 v76, s50, v76
    v_mfma_f32_16x16x32_bf16 v[212:215], v[32:35], v[52:55], v[212:215]
    s_add_u32 m0, s35, 0x3000
    ds_read_b64_tr_b16 v[18:19], v6 offset:12808
    v_mul_f32 v77, s50, v77
    v_mfma_f32_16x16x32_bf16 v[212:215], v[36:39], v[68:71], v[212:215]
    s_add_u32 s41, s52, 0x7000
    ds_read_b64_tr_b16 v[20:21], v6 offset:16392
    v_mul_f32 v78, s50, v78
    v_mfma_f32_16x16x32_bf16 v[208:211], v[36:39], v[64:67], v[208:211]
    s_lshr_b32 s54, s2, 5
    ds_read_b64_tr_b16 v[22:23], v6 offset:16904
    v_mul_f32 v79, s50, v79
    v_mfma_f32_16x16x32_bf16 v[208:211], v[32:35], v[48:51], v[208:211]
    s_lshl_b32 s54, s54, 1
    ds_read_b64_tr_b16 v[24:25], v6 offset:20488
    v_cvt_pk_bf16_f32 v76, v76, v77
    v_mfma_f32_16x16x32_bf16 v[208:211], v[28:31], a[248:251], v[208:211]
    s_add_u32 s54, s54, s3
    ds_read_b64_tr_b16 v[26:27], v6 offset:21000
    v_cvt_pk_bf16_f32 v77, v78, v79
    v_mfma_f32_16x16x32_bf16 v[204:207], v[28:31], a[244:247], v[204:207]
    buffer_store_dwordx4 v[176:179], v1, s[4:7], s59 offen offset:2048 sc1
    v_mfma_f32_16x16x32_bf16 v[204:207], v[32:35], v[44:47], v[204:207]
    v_mul_f32 v80, s50, v80
    v_mul_f32 v81, s50, v81
    v_mfma_f32_16x16x32_bf16 v[204:207], v[36:39], v[60:63], v[204:207]
    buffer_load_dwordx4 v12, s[20:23], s41 offen nt lds
    v_mfma_f32_16x16x32_bf16 v[200:203], v[36:39], v[56:59], v[200:203]
    v_mul_f32 v82, s50, v82
    v_mul_f32 v83, s50, v83
    v_mfma_f32_16x16x32_bf16 v[200:203], v[32:35], v[40:43], v[200:203]
    v_cvt_pk_bf16_f32 v80, v80, v81
    v_cvt_pk_bf16_f32 v81, v82, v83
    v_mfma_f32_16x16x32_bf16 v[200:203], v[28:31], a[240:243], v[200:203]
    s_waitcnt lgkmcnt(0)
    v_mul_f32 v84, s50, v84
    v_mul_f32 v85, s50, v85
    v_mfma_f32_16x16x32_bf16 v[200:203], v[16:19], a[192:195], v[200:203]
    s_lshl_b32 s55, s54, 2
    ds_read_b64_tr_b16 v[28:29], v6 offset:8
    v_mul_f32 v86, s50, v86
    v_mfma_f32_16x16x32_bf16 v[200:203], v[20:23], a[208:211], v[200:203]
    s_add_u32 m0, s35, 0x4000
    ds_read_b64_tr_b16 v[30:31], v6 offset:520
    v_mul_f32 v87, s50, v87
    v_mfma_f32_16x16x32_bf16 v[200:203], v[24:27], a[224:227], v[200:203]
    s_add_u32 s41, s52, 0x8000
    ds_read_b64_tr_b16 v[32:33], v6 offset:4104
    v_cvt_pk_bf16_f32 v84, v84, v85
    v_mfma_f32_16x16x32_bf16 v[204:207], v[24:27], a[228:231], v[204:207]
    s_add_u32 s55, s55, s32
    ds_read_b64_tr_b16 v[34:35], v6 offset:4616
    v_cvt_pk_bf16_f32 v85, v86, v87
    v_mfma_f32_16x16x32_bf16 v[204:207], v[20:23], a[212:215], v[204:207]
    s_mul_i32 s83, s55, 36864
    ds_read_b64_tr_b16 v[36:37], v6 offset:8200
    v_mfma_f32_16x16x32_bf16 v[204:207], v[16:19], a[196:199], v[204:207]
    s_lshr_b32 s54, s55, 1
    ds_read_b64_tr_b16 v[38:39], v6 offset:8712
    v_mfma_f32_16x16x32_bf16 v[208:211], v[16:19], a[200:203], v[208:211]
    v_add_u32 v6, 0x9000, v6
    v_mfma_f32_16x16x32_bf16 v[208:211], v[20:23], a[216:219], v[208:211]
    v_mfma_f32_16x16x32_bf16 v[208:211], v[24:27], a[232:235], v[208:211]
    buffer_load_dwordx4 v12, s[20:23], s41 offen nt lds
    v_mfma_f32_16x16x32_bf16 v[212:215], v[24:27], a[236:239], v[212:215]
    v_mfma_f32_16x16x32_bf16 v[212:215], v[20:23], a[220:223], v[212:215]
    v_mfma_f32_16x16x32_bf16 v[212:215], v[16:19], a[204:207], v[212:215]
    s_waitcnt lgkmcnt(0)
    v_mfma_f32_16x16x32_bf16 v[212:215], v[28:31], a[156:159], v[212:215]
    s_and_b32 s55, s55, 1
    ds_read_b64_tr_b16 v[16:17], v7 offset:0
    v_mfma_f32_16x16x32_bf16 v[212:215], v[32:35], a[172:175], v[212:215]
    s_add_u32 m0, s35, 0x5000
    ds_read_b64_tr_b16 v[18:19], v7 offset:512
    v_mfma_f32_16x16x32_bf16 v[212:215], v[36:39], a[188:191], v[212:215]
    s_add_u32 s41, s52, 0x9000
    ds_read_b64_tr_b16 v[20:21], v7 offset:4096
    v_mfma_f32_16x16x32_bf16 v[208:211], v[36:39], a[184:187], v[208:211]
    s_lshl_b32 s53, s54, 2
    ds_read_b64_tr_b16 v[22:23], v7 offset:4608
    v_mfma_f32_16x16x32_bf16 v[208:211], v[32:35], a[168:171], v[208:211]
    s_add_u32 s53, s53, s42
    ds_read_b64_tr_b16 v[24:25], v7 offset:8192
    v_mfma_f32_16x16x32_bf16 v[208:211], v[28:31], a[152:155], v[208:211]
    s_lshl_b32 s81, s53, 5
    ds_read_b64_tr_b16 v[26:27], v7 offset:8704
    v_mfma_f32_16x16x32_bf16 v[204:207], v[28:31], a[148:151], v[204:207]
    v_mfma_f32_16x16x32_bf16 v[204:207], v[32:35], a[164:167], v[204:207]
    v_mfma_f32_16x16x32_bf16 v[204:207], v[36:39], a[180:183], v[204:207]
    buffer_load_dwordx4 v12, s[20:23], s41 offen nt lds
    v_mfma_f32_16x16x32_bf16 v[200:203], v[36:39], a[176:179], v[200:203]
    v_mul_f32 v212, s50, v212
    v_mul_f32 v213, s50, v213
    v_mfma_f32_16x16x32_bf16 v[200:203], v[32:35], a[160:163], v[200:203]
    v_mul_f32 v214, s50, v214
    v_mul_f32 v215, s50, v215
    v_mfma_f32_16x16x32_bf16 v[200:203], v[28:31], a[144:147], v[200:203]
    s_waitcnt lgkmcnt(0)
    v_mul_f32 v208, s50, v208
    v_mul_f32 v209, s50, v209
    v_mfma_f32_16x16x32_bf16 v[88:91], v[16:19], a[144:147], v[88:91]
    s_add_u32 s81, s81, 0x3400000
    ds_read_b64_tr_b16 v[28:29], v7 offset:12288
    v_mul_f32 v210, s50, v210
    v_mfma_f32_16x16x32_bf16 v[88:91], v[20:23], a[160:163], v[88:91]
    s_add_u32 m0, s35, 0x6000
    ds_read_b64_tr_b16 v[30:31], v7 offset:12800
    v_mul_f32 v211, s50, v211
    v_mfma_f32_16x16x32_bf16 v[88:91], v[24:27], a[176:179], v[88:91]
    s_add_u32 s41, s52, 0xa000
    ds_read_b64_tr_b16 v[32:33], v7 offset:16384
    v_mul_f32 v204, s50, v204
    v_mfma_f32_16x16x32_bf16 v[92:95], v[24:27], a[180:183], v[92:95]
    s_lshl_b32 s43, s53, 17
    ds_read_b64_tr_b16 v[34:35], v7 offset:16896
    v_mul_f32 v205, s50, v205
    v_mfma_f32_16x16x32_bf16 v[92:95], v[20:23], a[164:167], v[92:95]
    s_lshl_b32 s82, s53, 14
    ds_read_b64_tr_b16 v[36:37], v7 offset:20480
    v_mul_f32 v206, s50, v206
    v_mfma_f32_16x16x32_bf16 v[92:95], v[16:19], a[148:151], v[92:95]
    s_lshl_b32 s53, s55, 11
    ds_read_b64_tr_b16 v[38:39], v7 offset:20992
    v_mul_f32 v200, s50, v200
    v_mfma_f32_16x16x32_bf16 v[96:99], v[16:19], a[152:155], v[96:99]
    v_mul_f32 v201, s50, v201
    v_mul_f32 v202, s50, v202
    v_mfma_f32_16x16x32_bf16 v[96:99], v[20:23], a[168:171], v[96:99]
    v_mul_f32 v203, s50, v203
    v_cvt_pk_bf16_f32 v74, v200, v201
    v_mfma_f32_16x16x32_bf16 v[96:99], v[24:27], a[184:187], v[96:99]
    buffer_load_dwordx4 v12, s[20:23], s41 offen nt lds
    v_mfma_f32_16x16x32_bf16 v[100:103], v[24:27], a[188:191], v[100:103]
    v_cvt_pk_bf16_f32 v75, v202, v203
    v_mul_f32 v207, s50, v207
    v_mfma_f32_16x16x32_bf16 v[100:103], v[20:23], a[172:175], v[100:103]
    v_cvt_pk_bf16_f32 v78, v204, v205
    v_cvt_pk_bf16_f32 v79, v206, v207
    v_mfma_f32_16x16x32_bf16 v[100:103], v[16:19], a[156:159], v[100:103]
    s_waitcnt lgkmcnt(0)
    v_cvt_pk_bf16_f32 v82, v208, v209
    v_cvt_pk_bf16_f32 v83, v210, v211
    v_mfma_f32_16x16x32_bf16 v[100:103], v[28:31], a[204:207], v[100:103]
    s_add_u32 s43, s43, s53
    ds_read_b64_tr_b16 v[16:17], v7 offset:24576
    v_cvt_pk_bf16_f32 v86, v212, v213
    v_mfma_f32_16x16x32_bf16 v[100:103], v[32:35], a[220:223], v[100:103]
    s_add_u32 m0, s35, 0x7000
    ds_read_b64_tr_b16 v[18:19], v7 offset:25088
    v_cvt_pk_bf16_f32 v87, v214, v215
    v_mfma_f32_16x16x32_bf16 v[100:103], v[36:39], a[236:239], v[100:103]
    s_add_u32 s41, s52, 0xb000
    ds_read_b64_tr_b16 v[20:21], v7 offset:28672
    v_mfma_f32_16x16x32_bf16 v[96:99], v[36:39], a[232:235], v[96:99]
    s_lshl_b32 s53, s55, 10
    ds_read_b64_tr_b16 v[22:23], v7 offset:29184
    v_mfma_f32_16x16x32_bf16 v[96:99], v[32:35], a[216:219], v[96:99]
    s_add_u32 s82, s82, s53
    ds_read_b64_tr_b16 v[24:25], v7 offset:32768
    v_mfma_f32_16x16x32_bf16 v[96:99], v[28:31], a[200:203], v[96:99]
    s_lshl_b32 s53, s34, 5
    ds_read_b64_tr_b16 v[26:27], v7 offset:33280
    v_mfma_f32_16x16x32_bf16 v[92:95], v[28:31], a[196:199], v[92:95]
    buffer_store_dwordx4 v[180:183], v1, s[4:7], s59 offen offset:3072 sc1
    v_mfma_f32_16x16x32_bf16 v[92:95], v[32:35], a[212:215], v[92:95]
    v_mfma_f32_16x16x32_bf16 v[92:95], v[36:39], a[228:231], v[92:95]
    buffer_load_dwordx4 v12, s[20:23], s41 offen nt lds
    v_mfma_f32_16x16x32_bf16 v[88:91], v[36:39], a[224:227], v[88:91]
    v_mfma_f32_16x16x32_bf16 v[88:91], v[32:35], a[208:211], v[88:91]
    v_mfma_f32_16x16x32_bf16 v[88:91], v[28:31], a[192:195], v[88:91]
    s_waitcnt lgkmcnt(0)
    v_mfma_f32_16x16x32_bf16 v[88:91], v[16:19], a[240:243], v[88:91]
    s_add_u32 s53, s53, s33
    ds_read_b64_tr_b16 v[28:29], v7 offset:24584
    v_mfma_f32_16x16x32_bf16 v[88:91], v[20:23], v[40:43], v[88:91]
    s_lshl_b32 s53, s53, 2
    ds_read_b64_tr_b16 v[30:31], v7 offset:25096
    v_mfma_f32_16x16x32_bf16 v[88:91], v[24:27], v[56:59], v[88:91]
    s_add_u32 s80, s53, 0x3400000
    ds_read_b64_tr_b16 v[32:33], v7 offset:28680
    v_mfma_f32_16x16x32_bf16 v[92:95], v[24:27], v[60:63], v[92:95]
    s_bfe_u32 s54, s2, 0x20003
    ds_read_b64_tr_b16 v[34:35], v7 offset:29192
    v_mfma_f32_16x16x32_bf16 v[92:95], v[20:23], v[44:47], v[92:95]
    s_mul_i32 s55, s54, 288
    ds_read_b64_tr_b16 v[36:37], v7 offset:32776
    v_mfma_f32_16x16x32_bf16 v[92:95], v[16:19], a[244:247], v[92:95]
    s_add_u32 s83, s83, s55
    ds_read_b64_tr_b16 v[38:39], v7 offset:33288
    v_mfma_f32_16x16x32_bf16 v[96:99], v[16:19], a[248:251], v[96:99]
    v_mfma_f32_16x16x32_bf16 v[96:99], v[20:23], v[48:51], v[96:99]
    v_mfma_f32_16x16x32_bf16 v[96:99], v[24:27], v[64:67], v[96:99]
    v_mul_f32 v88, s50, v88
    v_mul_f32 v89, s50, v89
    v_mfma_f32_16x16x32_bf16 v[100:103], v[24:27], v[68:71], v[100:103]
    v_mul_f32 v90, s50, v90
    v_mul_f32 v91, s50, v91
    v_mfma_f32_16x16x32_bf16 v[100:103], v[20:23], v[52:55], v[100:103]
    v_cvt_pk_bf16_f32 v88, v88, v89
    v_cvt_pk_bf16_f32 v89, v90, v91
    v_mfma_f32_16x16x32_bf16 v[100:103], v[16:19], a[252:255], v[100:103]
    s_waitcnt lgkmcnt(0)
    v_mul_f32 v92, s50, v92
    v_mul_f32 v93, s50, v93
    v_mfma_f32_16x16x32_bf16 v[228:231], v[28:31], a[252:255], v[228:231]
    s_mul_i32 s54, s54, 9216
    ds_read_b64_tr_b16 v[16:17], v7 offset:12296
    v_mul_f32 v94, s50, v94
    v_mfma_f32_16x16x32_bf16 v[228:231], v[32:35], v[52:55], v[228:231]
    s_lshl_b32 s55, s42, 5
    ds_read_b64_tr_b16 v[18:19], v7 offset:12808
    v_mul_f32 v95, s50, v95
    v_mfma_f32_16x16x32_bf16 v[228:231], v[36:39], v[68:71], v[228:231]
    s_add_u32 s55, s55, s32
    ds_read_b64_tr_b16 v[20:21], v7 offset:16392
    v_cvt_pk_bf16_f32 v92, v92, v93
    v_mfma_f32_16x16x32_bf16 v[224:227], v[36:39], v[64:67], v[224:227]
    s_mul_i32 s55, s55, 36864
    ds_read_b64_tr_b16 v[22:23], v7 offset:16904
    v_cvt_pk_bf16_f32 v93, v94, v95
    v_mfma_f32_16x16x32_bf16 v[224:227], v[32:35], v[48:51], v[224:227]
    s_add_u32 s53, s54, s55
    ds_read_b64_tr_b16 v[24:25], v7 offset:20488
    v_mul_f32 v96, s50, v96
    v_mfma_f32_16x16x32_bf16 v[224:227], v[28:31], a[248:251], v[224:227]
    s_mul_i32 s54, s42, 28
    ds_read_b64_tr_b16 v[26:27], v7 offset:21000
    v_mul_f32 v97, s50, v97
    v_mfma_f32_16x16x32_bf16 v[220:223], v[28:31], a[244:247], v[220:223]
    v_mul_f32 v98, s50, v98
    v_mul_f32 v99, s50, v99
    v_mfma_f32_16x16x32_bf16 v[220:223], v[32:35], v[44:47], v[220:223]
    v_cvt_pk_bf16_f32 v96, v96, v97
    v_cvt_pk_bf16_f32 v97, v98, v99
    v_mfma_f32_16x16x32_bf16 v[220:223], v[36:39], v[60:63], v[220:223]
    v_mul_f32 v100, s50, v100
    v_mul_f32 v101, s50, v101
    v_mfma_f32_16x16x32_bf16 v[216:219], v[36:39], v[56:59], v[216:219]
    v_mul_f32 v102, s50, v102
    v_mul_f32 v103, s50, v103
    v_mfma_f32_16x16x32_bf16 v[216:219], v[32:35], v[40:43], v[216:219]
    v_cvt_pk_bf16_f32 v100, v100, v101
    v_cvt_pk_bf16_f32 v101, v102, v103
    v_mfma_f32_16x16x32_bf16 v[216:219], v[28:31], a[240:243], v[216:219]
    s_waitcnt lgkmcnt(0)
    v_mfma_f32_16x16x32_bf16 v[216:219], v[16:19], a[192:195], v[216:219]
    s_sub_u32 s54, 128, s54
    ds_read_b64_tr_b16 v[28:29], v7 offset:8
    v_mfma_f32_16x16x32_bf16 v[216:219], v[20:23], a[208:211], v[216:219]
    s_mul_i32 s84, s54, 36864
    ds_read_b64_tr_b16 v[30:31], v7 offset:520
    v_mfma_f32_16x16x32_bf16 v[216:219], v[24:27], a[224:227], v[216:219]
    s_and_b32 s46, s2, 6
    ds_read_b64_tr_b16 v[32:33], v7 offset:4104
    v_mfma_f32_16x16x32_bf16 v[220:223], v[24:27], a[228:231], v[220:223]
    s_add_u32 s54, s46, 0
    ds_read_b64_tr_b16 v[34:35], v7 offset:4616
    v_mfma_f32_16x16x32_bf16 v[220:223], v[20:23], a[212:215], v[220:223]
    s_and_b32 s54, s54, 7
    ds_read_b64_tr_b16 v[36:37], v7 offset:8200
    v_mfma_f32_16x16x32_bf16 v[220:223], v[16:19], a[196:199], v[220:223]
    s_lshl_b32 s54, s54, 10
    ds_read_b64_tr_b16 v[38:39], v7 offset:8712
    v_mfma_f32_16x16x32_bf16 v[224:227], v[16:19], a[200:203], v[224:227]
    v_add_u32 v7, 0x9000, v7
    v_mfma_f32_16x16x32_bf16 v[224:227], v[20:23], a[216:219], v[224:227]
    v_mfma_f32_16x16x32_bf16 v[224:227], v[24:27], a[232:235], v[224:227]
    v_mfma_f32_16x16x32_bf16 v[228:231], v[24:27], a[236:239], v[228:231]
    v_mfma_f32_16x16x32_bf16 v[228:231], v[20:23], a[220:223], v[228:231]
    v_mfma_f32_16x16x32_bf16 v[228:231], v[16:19], a[204:207], v[228:231]
    s_waitcnt vmcnt(23) lgkmcnt(0)
    s_barrier
    v_mfma_f32_16x16x32_bf16 v[228:231], v[28:31], a[156:159], v[228:231]
    s_add_u32 s28, s54, s53
    ds_read_b64_tr_b16 v[16:17], v6 offset:0
    v_mfma_f32_16x16x32_bf16 v[228:231], v[32:35], a[172:175], v[228:231]
    s_add_u32 s54, s46, 1
    ds_read_b64_tr_b16 v[18:19], v6 offset:512
    v_mfma_f32_16x16x32_bf16 v[228:231], v[36:39], a[188:191], v[228:231]
    s_and_b32 s54, s54, 7
    ds_read_b64_tr_b16 v[20:21], v6 offset:4096
    v_mfma_f32_16x16x32_bf16 v[224:227], v[36:39], a[184:187], v[224:227]
    s_lshl_b32 s54, s54, 10
    ds_read_b64_tr_b16 v[22:23], v6 offset:4608
    v_mfma_f32_16x16x32_bf16 v[224:227], v[32:35], a[168:171], v[224:227]
    s_add_u32 s29, s54, s53
    ds_read_b64_tr_b16 v[24:25], v6 offset:8192
    v_mfma_f32_16x16x32_bf16 v[224:227], v[28:31], a[152:155], v[224:227]
    s_mov_b32 s54, 8
    ds_read_b64_tr_b16 v[26:27], v6 offset:8704
    v_mfma_f32_16x16x32_bf16 v[220:223], v[28:31], a[148:151], v[220:223]
    v_mfma_f32_16x16x32_bf16 v[220:223], v[32:35], a[164:167], v[220:223]
    v_mfma_f32_16x16x32_bf16 v[220:223], v[36:39], a[180:183], v[220:223]
    v_mul_f32 v228, s50, v228
    v_mul_f32 v229, s50, v229
    v_mfma_f32_16x16x32_bf16 v[216:219], v[36:39], a[176:179], v[216:219]
    v_mul_f32 v230, s50, v230
    v_mul_f32 v231, s50, v231
    v_mfma_f32_16x16x32_bf16 v[216:219], v[32:35], a[160:163], v[216:219]
    v_cvt_pk_bf16_f32 v102, v228, v229
    v_cvt_pk_bf16_f32 v103, v230, v231
    v_mfma_f32_16x16x32_bf16 v[216:219], v[28:31], a[144:147], v[216:219]
    s_waitcnt lgkmcnt(0)
    v_mul_f32 v224, s50, v224
    v_mul_f32 v225, s50, v225
    v_mfma_f32_16x16x32_bf16 v[136:139], v[16:19], a[0:3], 0
    s_lshl_b32 s54, s54, 10
    ds_read_b64_tr_b16 v[28:29], v6 offset:12288
    v_mul_f32 v226, s50, v226
    v_mfma_f32_16x16x32_bf16 v[136:139], v[20:23], a[16:19], v[136:139]
    s_add_u32 m0, s35, 0xc000
    ds_read_b64_tr_b16 v[30:31], v6 offset:12800
    v_mul_f32 v227, s50, v227
    v_mfma_f32_16x16x32_bf16 v[136:139], v[24:27], a[32:35], v[136:139]
    s_add_u32 s41, s52, 0x0
    ds_read_b64_tr_b16 v[32:33], v6 offset:16384
    v_mul_f32 v220, s50, v220
    v_mfma_f32_16x16x32_bf16 v[140:143], v[24:27], a[36:39], 0
    s_add_u32 s30, s54, s53
    ds_read_b64_tr_b16 v[34:35], v6 offset:16896
    v_mul_f32 v221, s50, v221
    v_mfma_f32_16x16x32_bf16 v[140:143], v[20:23], a[20:23], v[140:143]
    s_add_u32 s54, s46, 2
    ds_read_b64_tr_b16 v[36:37], v6 offset:20480
    v_mul_f32 v222, s50, v222
    v_mfma_f32_16x16x32_bf16 v[140:143], v[16:19], a[4:7], v[140:143]
    s_and_b32 s54, s54, 7
    ds_read_b64_tr_b16 v[38:39], v6 offset:20992
    v_mul_f32 v216, s50, v216
    v_mfma_f32_16x16x32_bf16 v[144:147], v[16:19], a[8:11], 0
    buffer_store_dwordx2 v[104:105], v8, s[4:7], s44 offen offset:0 sc1
    v_mfma_f32_16x16x32_bf16 v[144:147], v[20:23], a[24:27], v[144:147]
    v_mul_f32 v217, s50, v217
    v_mul_f32 v218, s50, v218
    v_mfma_f32_16x16x32_bf16 v[144:147], v[24:27], a[40:43], v[144:147]
    buffer_load_dwordx4 v12, s[20:23], s41 offen nt lds
    v_mfma_f32_16x16x32_bf16 v[148:151], v[24:27], a[44:47], 0
    v_mul_f32 v219, s50, v219
    v_cvt_pk_bf16_f32 v90, v216, v217
    v_mfma_f32_16x16x32_bf16 v[148:151], v[20:23], a[28:31], v[148:151]
    v_cvt_pk_bf16_f32 v91, v218, v219
    v_mul_f32 v223, s50, v223
    v_mfma_f32_16x16x32_bf16 v[148:151], v[16:19], a[12:15], v[148:151]
    s_waitcnt lgkmcnt(0)
    v_cvt_pk_bf16_f32 v94, v220, v221
    v_cvt_pk_bf16_f32 v95, v222, v223
    v_mfma_f32_16x16x32_bf16 v[148:151], v[28:31], a[60:63], v[148:151]
    s_lshl_b32 s54, s54, 10
    ds_read_b64_tr_b16 v[16:17], v6 offset:24576
    v_cvt_pk_bf16_f32 v98, v224, v225
    v_mfma_f32_16x16x32_bf16 v[148:151], v[32:35], a[76:79], v[148:151]
    s_add_u32 m0, s35, 0xd000
    ds_read_b64_tr_b16 v[18:19], v6 offset:25088
    v_cvt_pk_bf16_f32 v99, v226, v227
    v_mfma_f32_16x16x32_bf16 v[148:151], v[36:39], a[92:95], v[148:151]
    s_add_u32 s41, s52, 0x1000
    ds_read_b64_tr_b16 v[20:21], v6 offset:28672
    v_mfma_f32_16x16x32_bf16 v[144:147], v[36:39], a[88:91], v[144:147]
    s_add_u32 s31, s54, s53
    ds_read_b64_tr_b16 v[22:23], v6 offset:29184
    v_mfma_f32_16x16x32_bf16 v[144:147], v[32:35], a[72:75], v[144:147]
    s_add_u32 s54, s46, 3
    ds_read_b64_tr_b16 v[24:25], v6 offset:32768
    v_mfma_f32_16x16x32_bf16 v[144:147], v[28:31], a[56:59], v[144:147]
    s_and_b32 s54, s54, 7
    ds_read_b64_tr_b16 v[26:27], v6 offset:33280
    v_mfma_f32_16x16x32_bf16 v[140:143], v[28:31], a[52:55], v[140:143]
    v_mfma_f32_16x16x32_bf16 v[140:143], v[32:35], a[68:71], v[140:143]
    v_mfma_f32_16x16x32_bf16 v[140:143], v[36:39], a[84:87], v[140:143]
    buffer_load_dwordx4 v12, s[20:23], s41 offen nt lds
    v_mfma_f32_16x16x32_bf16 v[136:139], v[36:39], a[80:83], v[136:139]
    v_mfma_f32_16x16x32_bf16 v[136:139], v[32:35], a[64:67], v[136:139]
    v_mfma_f32_16x16x32_bf16 v[136:139], v[28:31], a[48:51], v[136:139]
    s_waitcnt lgkmcnt(0)
    v_mfma_f32_16x16x32_bf16 v[136:139], v[16:19], a[96:99], v[136:139]
    s_lshl_b32 s54, s54, 10
    ds_read_b64_tr_b16 v[28:29], v6 offset:24584
    v_mfma_f32_16x16x32_bf16 v[136:139], v[20:23], a[112:115], v[136:139]
    s_add_u32 m0, s35, 0xe000
    ds_read_b64_tr_b16 v[30:31], v6 offset:25096
    v_mfma_f32_16x16x32_bf16 v[136:139], v[24:27], a[128:131], v[136:139]
    s_add_u32 s41, s52, 0x2000
    ds_read_b64_tr_b16 v[32:33], v6 offset:28680
    v_mfma_f32_16x16x32_bf16 v[140:143], v[24:27], a[132:135], v[140:143]
    s_add_u32 s36, s54, s53
    ds_read_b64_tr_b16 v[34:35], v6 offset:29192
    v_mfma_f32_16x16x32_bf16 v[140:143], v[20:23], a[116:119], v[140:143]
    s_add_u32 s54, s46, 4
    ds_read_b64_tr_b16 v[36:37], v6 offset:32776
    v_mfma_f32_16x16x32_bf16 v[140:143], v[16:19], a[100:103], v[140:143]
    s_and_b32 s54, s54, 7
    ds_read_b64_tr_b16 v[38:39], v6 offset:33288
    v_mfma_f32_16x16x32_bf16 v[144:147], v[16:19], a[104:107], v[144:147]
    buffer_store_dwordx2 v[108:109], v8, s[4:7], s44 offen offset:512 sc1
    v_mfma_f32_16x16x32_bf16 v[144:147], v[20:23], a[120:123], v[144:147]
    v_mfma_f32_16x16x32_bf16 v[144:147], v[24:27], a[136:139], v[144:147]
    buffer_load_dwordx4 v12, s[20:23], s41 offen nt lds
    v_mfma_f32_16x16x32_bf16 v[148:151], v[24:27], a[140:143], v[148:151]
    v_mfma_f32_16x16x32_bf16 v[148:151], v[20:23], a[124:127], v[148:151]
    v_mfma_f32_16x16x32_bf16 v[148:151], v[16:19], a[108:111], v[148:151]
    s_waitcnt lgkmcnt(0)
    v_mfma_f32_16x16x32_bf16 v[164:167], v[28:31], a[108:111], 0
    s_lshl_b32 s54, s54, 10
    ds_read_b64_tr_b16 v[16:17], v6 offset:12296
    v_mfma_f32_16x16x32_bf16 v[164:167], v[32:35], a[124:127], v[164:167]
    s_add_u32 m0, s35, 0xf000
    ds_read_b64_tr_b16 v[18:19], v6 offset:12808
    v_mfma_f32_16x16x32_bf16 v[164:167], v[36:39], a[140:143], v[164:167]
    s_add_u32 s41, s52, 0x3000
    ds_read_b64_tr_b16 v[20:21], v6 offset:16392
    v_mfma_f32_16x16x32_bf16 v[160:163], v[36:39], a[136:139], 0
    s_add_u32 s37, s54, s53
    ds_read_b64_tr_b16 v[22:23], v6 offset:16904
    v_mfma_f32_16x16x32_bf16 v[160:163], v[32:35], a[120:123], v[160:163]
    s_add_u32 s54, s46, 5
    ds_read_b64_tr_b16 v[24:25], v6 offset:20488
    v_mfma_f32_16x16x32_bf16 v[160:163], v[28:31], a[104:107], v[160:163]
    s_and_b32 s54, s54, 7
    ds_read_b64_tr_b16 v[26:27], v6 offset:21000
    v_mfma_f32_16x16x32_bf16 v[156:159], v[28:31], a[100:103], 0
    v_mfma_f32_16x16x32_bf16 v[156:159], v[32:35], a[116:119], v[156:159]
    v_mfma_f32_16x16x32_bf16 v[156:159], v[36:39], a[132:135], v[156:159]
    buffer_load_dwordx4 v12, s[20:23], s41 offen nt lds
    v_mfma_f32_16x16x32_bf16 v[152:155], v[36:39], a[128:131], 0
    v_mfma_f32_16x16x32_bf16 v[152:155], v[32:35], a[112:115], v[152:155]
    v_mfma_f32_16x16x32_bf16 v[152:155], v[28:31], a[96:99], v[152:155]
    s_waitcnt lgkmcnt(0)
    v_mfma_f32_16x16x32_bf16 v[152:155], v[16:19], a[48:51], v[152:155]
    s_lshl_b32 s54, s54, 10
    ds_read_b64_tr_b16 v[28:29], v6 offset:8
    v_mfma_f32_16x16x32_bf16 v[152:155], v[20:23], a[64:67], v[152:155]
    s_add_u32 s38, s54, s53
    ds_read_b64_tr_b16 v[30:31], v6 offset:520
    v_mfma_f32_16x16x32_bf16 v[152:155], v[24:27], a[80:83], v[152:155]
    s_add_u32 s54, s46, 6
    ds_read_b64_tr_b16 v[32:33], v6 offset:4104
    v_mfma_f32_16x16x32_bf16 v[156:159], v[24:27], a[84:87], v[156:159]
    s_and_b32 s54, s54, 7
    ds_read_b64_tr_b16 v[34:35], v6 offset:4616
    v_mfma_f32_16x16x32_bf16 v[156:159], v[20:23], a[68:71], v[156:159]
    s_lshl_b32 s54, s54, 10
    ds_read_b64_tr_b16 v[36:37], v6 offset:8200
    v_mfma_f32_16x16x32_bf16 v[156:159], v[16:19], a[52:55], v[156:159]
    s_add_u32 s39, s54, s53
    ds_read_b64_tr_b16 v[38:39], v6 offset:8712
    v_mfma_f32_16x16x32_bf16 v[160:163], v[16:19], a[56:59], v[160:163]
    v_add_u32 v6, 0x9000, v6
    v_mfma_f32_16x16x32_bf16 v[160:163], v[20:23], a[72:75], v[160:163]
    v_mfma_f32_16x16x32_bf16 v[160:163], v[24:27], a[88:91], v[160:163]
    v_mfma_f32_16x16x32_bf16 v[164:167], v[24:27], a[92:95], v[164:167]
    v_mfma_f32_16x16x32_bf16 v[164:167], v[20:23], a[76:79], v[164:167]
    v_mfma_f32_16x16x32_bf16 v[164:167], v[16:19], a[60:63], v[164:167]
    s_waitcnt lgkmcnt(0)
    v_mfma_f32_16x16x32_bf16 v[164:167], v[28:31], a[12:15], v[164:167]
    s_add_u32 s54, s46, 7
    ds_read_b64_tr_b16 v[16:17], v7 offset:0
    v_mfma_f32_16x16x32_bf16 v[164:167], v[32:35], a[28:31], v[164:167]
    s_and_b32 s54, s54, 7
    ds_read_b64_tr_b16 v[18:19], v7 offset:512
    v_mfma_f32_16x16x32_bf16 v[164:167], v[36:39], a[44:47], v[164:167]
    s_lshl_b32 s54, s54, 10
    ds_read_b64_tr_b16 v[20:21], v7 offset:4096
    v_mfma_f32_16x16x32_bf16 v[160:163], v[36:39], a[40:43], v[160:163]
    s_add_u32 s40, s54, s53
    ds_read_b64_tr_b16 v[22:23], v7 offset:4608
    v_mfma_f32_16x16x32_bf16 v[160:163], v[32:35], a[24:27], v[160:163]
    s_add_u32 s1, s83, 256
    ds_read_b64_tr_b16 v[24:25], v7 offset:8192
    v_mfma_f32_16x16x32_bf16 v[160:163], v[28:31], a[8:11], v[160:163]
    s_lshl_b32 s54, s46, 5
    ds_read_b64_tr_b16 v[26:27], v7 offset:8704
    v_mfma_f32_16x16x32_bf16 v[156:159], v[28:31], a[4:7], v[156:159]
    buffer_store_dwordx2 v[112:113], v8, s[4:7], s44 offen offset:1024 sc1
    v_mfma_f32_16x16x32_bf16 v[156:159], v[32:35], a[20:23], v[156:159]
    v_mfma_f32_16x16x32_bf16 v[156:159], v[36:39], a[36:39], v[156:159]
    v_mfma_f32_16x16x32_bf16 v[152:155], v[36:39], a[32:35], v[152:155]
    v_mfma_f32_16x16x32_bf16 v[152:155], v[32:35], a[16:19], v[152:155]
    v_mfma_f32_16x16x32_bf16 v[152:155], v[28:31], a[0:3], v[152:155]
    s_waitcnt lgkmcnt(0)
    v_mfma_f32_16x16x32_bf16 v[168:171], v[16:19], a[0:3], 0
    s_add_u32 s83, s83, s54
    ds_read_b64_tr_b16 v[28:29], v7 offset:12288
    v_mfma_f32_16x16x32_bf16 v[168:171], v[20:23], a[16:19], v[168:171]
    s_lshr_b32 s47, s2, 3
    ds_read_b64_tr_b16 v[30:31], v7 offset:12800
    v_mfma_f32_16x16x32_bf16 v[168:171], v[24:27], a[32:35], v[168:171]
    s_lshl_b32 s47, s47, 1
    ds_read_b64_tr_b16 v[32:33], v7 offset:16384
    v_mfma_f32_16x16x32_bf16 v[172:175], v[24:27], a[36:39], 0
    s_add_u32 s47, s47, s3
    ds_read_b64_tr_b16 v[34:35], v7 offset:16896
    v_mfma_f32_16x16x32_bf16 v[172:175], v[20:23], a[20:23], v[172:175]
    s_lshl_b32 s47, s47, 2
    ds_read_b64_tr_b16 v[36:37], v7 offset:20480
    v_mfma_f32_16x16x32_bf16 v[172:175], v[16:19], a[4:7], v[172:175]
    s_add_u32 s47, s47, s32
    ds_read_b64_tr_b16 v[38:39], v7 offset:20992
    v_mfma_f32_16x16x32_bf16 v[176:179], v[16:19], a[8:11], 0
    v_mfma_f32_16x16x32_bf16 v[176:179], v[20:23], a[24:27], v[176:179]
    v_mfma_f32_16x16x32_bf16 v[176:179], v[24:27], a[40:43], v[176:179]
    v_mfma_f32_16x16x32_bf16 v[180:183], v[24:27], a[44:47], 0
    v_mfma_f32_16x16x32_bf16 v[180:183], v[20:23], a[28:31], v[180:183]
    v_mfma_f32_16x16x32_bf16 v[180:183], v[16:19], a[12:15], v[180:183]
    s_waitcnt lgkmcnt(0)
    v_mfma_f32_16x16x32_bf16 v[180:183], v[28:31], a[60:63], v[180:183]
    s_mul_i32 s47, s47, 73728
    ds_read_b64_tr_b16 v[16:17], v7 offset:24576
    v_mfma_f32_16x16x32_bf16 v[180:183], v[32:35], a[76:79], v[180:183]
    s_add_u32 s47, s47, 0x4000000
    ds_read_b64_tr_b16 v[18:19], v7 offset:25088
    v_mfma_f32_16x16x32_bf16 v[180:183], v[36:39], a[92:95], v[180:183]
    s_lshl_b32 s54, s46, 11
    ds_read_b64_tr_b16 v[20:21], v7 offset:28672
    v_mfma_f32_16x16x32_bf16 v[176:179], v[36:39], a[88:91], v[176:179]
    s_add_u32 s47, s47, s54
    ds_read_b64_tr_b16 v[22:23], v7 offset:29184
    v_mfma_f32_16x16x32_bf16 v[176:179], v[32:35], a[72:75], v[176:179]
    s_add_u32 s54, s42, 1
    ds_read_b64_tr_b16 v[24:25], v7 offset:32768
    v_mfma_f32_16x16x32_bf16 v[176:179], v[28:31], a[56:59], v[176:179]
    s_and_b32 s54, s54, 3
    ds_read_b64_tr_b16 v[26:27], v7 offset:33280
    v_mfma_f32_16x16x32_bf16 v[172:175], v[28:31], a[52:55], v[172:175]
    buffer_store_dwordx2 v[116:117], v8, s[4:7], s44 offen offset:1536 sc1
    v_mfma_f32_16x16x32_bf16 v[172:175], v[32:35], a[68:71], v[172:175]
    v_mfma_f32_16x16x32_bf16 v[172:175], v[36:39], a[84:87], v[172:175]
    v_mfma_f32_16x16x32_bf16 v[168:171], v[36:39], a[80:83], v[168:171]
    v_mfma_f32_16x16x32_bf16 v[168:171], v[32:35], a[64:67], v[168:171]
    v_mfma_f32_16x16x32_bf16 v[168:171], v[28:31], a[48:51], v[168:171]
    s_waitcnt lgkmcnt(0)
    v_mfma_f32_16x16x32_bf16 v[168:171], v[16:19], a[96:99], v[168:171]
    s_mul_i32 s54, s54, 18432
    ds_read_b64_tr_b16 v[28:29], v7 offset:24584
    v_mfma_f32_16x16x32_bf16 v[168:171], v[20:23], a[112:115], v[168:171]
    s_add_u32 s85, s54, s47
    ds_read_b64_tr_b16 v[30:31], v7 offset:25096
    v_mfma_f32_16x16x32_bf16 v[168:171], v[24:27], a[128:131], v[168:171]
    s_add_u32 s54, s42, 2
    ds_read_b64_tr_b16 v[32:33], v7 offset:28680
    v_mfma_f32_16x16x32_bf16 v[172:175], v[24:27], a[132:135], v[172:175]
    s_and_b32 s54, s54, 3
    ds_read_b64_tr_b16 v[34:35], v7 offset:29192
    v_mfma_f32_16x16x32_bf16 v[172:175], v[20:23], a[116:119], v[172:175]
    s_mul_i32 s54, s54, 18432
    ds_read_b64_tr_b16 v[36:37], v7 offset:32776
    v_mfma_f32_16x16x32_bf16 v[172:175], v[16:19], a[100:103], v[172:175]
    s_add_u32 s86, s54, s47
    ds_read_b64_tr_b16 v[38:39], v7 offset:33288
    v_mfma_f32_16x16x32_bf16 v[176:179], v[16:19], a[104:107], v[176:179]
    v_mfma_f32_16x16x32_bf16 v[176:179], v[20:23], a[120:123], v[176:179]
    v_mfma_f32_16x16x32_bf16 v[176:179], v[24:27], a[136:139], v[176:179]
    v_mfma_f32_16x16x32_bf16 v[180:183], v[24:27], a[140:143], v[180:183]
    v_mfma_f32_16x16x32_bf16 v[180:183], v[20:23], a[124:127], v[180:183]
    v_mfma_f32_16x16x32_bf16 v[180:183], v[16:19], a[108:111], v[180:183]
    s_waitcnt lgkmcnt(0)
    v_mfma_f32_16x16x32_bf16 v[196:199], v[28:31], a[108:111], 0
    s_add_u32 s54, s42, 3
    ds_read_b64_tr_b16 v[16:17], v7 offset:12296
    v_mfma_f32_16x16x32_bf16 v[196:199], v[32:35], a[124:127], v[196:199]
    s_and_b32 s54, s54, 3
    ds_read_b64_tr_b16 v[18:19], v7 offset:12808
    v_mfma_f32_16x16x32_bf16 v[196:199], v[36:39], a[140:143], v[196:199]
    s_mul_i32 s54, s54, 18432
    ds_read_b64_tr_b16 v[20:21], v7 offset:16392
    v_mfma_f32_16x16x32_bf16 v[192:195], v[36:39], a[136:139], 0
    s_add_u32 s87, s54, s47
    ds_read_b64_tr_b16 v[22:23], v7 offset:16904
    v_mfma_f32_16x16x32_bf16 v[192:195], v[32:35], a[120:123], v[192:195]
    s_lshl_b32 s53, s32, 2
    ds_read_b64_tr_b16 v[24:25], v7 offset:20488
    v_mfma_f32_16x16x32_bf16 v[192:195], v[28:31], a[104:107], v[192:195]
    s_lshr_b32 s54, 0x9876, s53
    ds_read_b64_tr_b16 v[26:27], v7 offset:21000
    v_mfma_f32_16x16x32_bf16 v[188:191], v[28:31], a[100:103], 0
    v_mfma_f32_16x16x32_bf16 v[188:191], v[32:35], a[116:119], v[188:191]
    v_mfma_f32_16x16x32_bf16 v[188:191], v[36:39], a[132:135], v[188:191]
    v_mfma_f32_16x16x32_bf16 v[184:187], v[36:39], a[128:131], 0
    v_mfma_f32_16x16x32_bf16 v[184:187], v[32:35], a[112:115], v[184:187]
    v_mfma_f32_16x16x32_bf16 v[184:187], v[28:31], a[96:99], v[184:187]
    s_waitcnt lgkmcnt(0)
    v_mfma_f32_16x16x32_bf16 v[184:187], v[16:19], a[48:51], v[184:187]
    s_and_b32 s54, s54, 15
    ds_read_b64_tr_b16 v[28:29], v7 offset:8
    v_mfma_f32_16x16x32_bf16 v[184:187], v[20:23], a[64:67], v[184:187]
    s_add_u32 s55, s54, 4
    ds_read_b64_tr_b16 v[30:31], v7 offset:520
    v_mfma_f32_16x16x32_bf16 v[184:187], v[24:27], a[80:83], v[184:187]
    s_lshr_b32 s55, s55, 4
    ds_read_b64_tr_b16 v[32:33], v7 offset:4104
    v_mfma_f32_16x16x32_bf16 v[188:191], v[24:27], a[84:87], v[188:191]
    s_mul_i32 s55, s55, 16320
    ds_read_b64_tr_b16 v[34:35], v7 offset:4616
L_hop0_8:
    s_cbranch_execz L_hop0_17
    v_mfma_f32_16x16x32_bf16 v[188:191], v[20:23], a[68:71], v[188:191]
    s_mul_i32 s54, s54, 9216
    ds_read_b64_tr_b16 v[36:37], v7 offset:8200
    v_mfma_f32_16x16x32_bf16 v[188:191], v[16:19], a[52:55], v[188:191]
    s_add_u32 s69, s54, s55
    ds_read_b64_tr_b16 v[38:39], v7 offset:8712
    v_mfma_f32_16x16x32_bf16 v[192:195], v[16:19], a[56:59], v[192:195]
    v_add_u32 v7, 0x9000, v7
    v_mfma_f32_16x16x32_bf16 v[192:195], v[20:23], a[72:75], v[192:195]
    v_mfma_f32_16x16x32_bf16 v[192:195], v[24:27], a[88:91], v[192:195]
    v_mfma_f32_16x16x32_bf16 v[196:199], v[24:27], a[92:95], v[196:199]
    v_mfma_f32_16x16x32_bf16 v[196:199], v[20:23], a[76:79], v[196:199]
    v_mfma_f32_16x16x32_bf16 v[196:199], v[16:19], a[60:63], v[196:199]
    s_waitcnt vmcnt(2) lgkmcnt(0)
    s_barrier
    v_mfma_f32_16x16x32_bf16 v[196:199], v[28:31], a[12:15], v[196:199]
    s_lshr_b32 s54, 0xd210, s53
    ds_read_b64_tr_b16 v[16:17], v6 offset:0
    v_mfma_f32_16x16x32_bf16 v[196:199], v[32:35], a[28:31], v[196:199]
    s_and_b32 s54, s54, 15
    ds_read_b64_tr_b16 v[18:19], v6 offset:512
    v_mfma_f32_16x16x32_bf16 v[196:199], v[36:39], a[44:47], v[196:199]
    s_add_u32 s55, s54, 4
    ds_read_b64_tr_b16 v[20:21], v6 offset:4096
    v_mfma_f32_16x16x32_bf16 v[192:195], v[36:39], a[40:43], v[192:195]
    s_lshr_b32 s55, s55, 4
    ds_read_b64_tr_b16 v[22:23], v6 offset:4608
    v_mfma_f32_16x16x32_bf16 v[192:195], v[32:35], a[24:27], v[192:195]
    s_mul_i32 s55, s55, 16320
    ds_read_b64_tr_b16 v[24:25], v6 offset:8192
    v_mfma_f32_16x16x32_bf16 v[192:195], v[28:31], a[8:11], v[192:195]
    s_mul_i32 s54, s54, 9216
    ds_read_b64_tr_b16 v[26:27], v6 offset:8704
    v_mfma_f32_16x16x32_bf16 v[188:191], v[28:31], a[4:7], v[188:191]
    v_mfma_f32_16x16x32_bf16 v[188:191], v[32:35], a[20:23], v[188:191]
    v_mfma_f32_16x16x32_bf16 v[188:191], v[36:39], a[36:39], v[188:191]
    v_mfma_f32_16x16x32_bf16 v[184:187], v[36:39], a[32:35], v[184:187]
    v_mfma_f32_16x16x32_bf16 v[184:187], v[32:35], a[16:19], v[184:187]
    v_mfma_f32_16x16x32_bf16 v[184:187], v[28:31], a[0:3], v[184:187]
    s_waitcnt lgkmcnt(0)
    v_mfma_f32_16x16x32_bf16 v[136:139], v[16:19], a[144:147], v[136:139]
    s_add_u32 s72, s54, s55
    ds_read_b64_tr_b16 v[28:29], v6 offset:12288
    v_mfma_f32_16x16x32_bf16 v[136:139], v[20:23], a[160:163], v[136:139]
    s_add_u32 m0, s35, 0x10000
    ds_read_b64_tr_b16 v[30:31], v6 offset:12800
    v_mfma_f32_16x16x32_bf16 v[136:139], v[24:27], a[176:179], v[136:139]
    s_add_u32 s41, s52, 0x0
    ds_read_b64_tr_b16 v[32:33], v6 offset:16384
    v_mfma_f32_16x16x32_bf16 v[140:143], v[24:27], a[180:183], v[140:143]
    s_lshr_b32 s54, 0x43fe, s53
    ds_read_b64_tr_b16 v[34:35], v6 offset:16896
    v_mfma_f32_16x16x32_bf16 v[140:143], v[20:23], a[164:167], v[140:143]
    s_and_b32 s54, s54, 15
    ds_read_b64_tr_b16 v[36:37], v6 offset:20480
    v_mfma_f32_16x16x32_bf16 v[140:143], v[16:19], a[148:151], v[140:143]
    s_add_u32 s55, s54, 4
    ds_read_b64_tr_b16 v[38:39], v6 offset:20992
    v_mfma_f32_16x16x32_bf16 v[144:147], v[16:19], a[152:155], v[144:147]
    v_mfma_f32_16x16x32_bf16 v[144:147], v[20:23], a[168:171], v[144:147]
    v_mfma_f32_16x16x32_bf16 v[144:147], v[24:27], a[184:187], v[144:147]
    buffer_load_dwordx4 v13, s[24:27], s41 offen nt lds
    v_mfma_f32_16x16x32_bf16 v[148:151], v[24:27], a[188:191], v[148:151]
    v_mfma_f32_16x16x32_bf16 v[148:151], v[20:23], a[172:175], v[148:151]
    v_mfma_f32_16x16x32_bf16 v[148:151], v[16:19], a[156:159], v[148:151]
    s_waitcnt lgkmcnt(0)
    v_mfma_f32_16x16x32_bf16 v[148:151], v[28:31], a[204:207], v[148:151]
    s_lshr_b32 s55, s55, 4
    ds_read_b64_tr_b16 v[16:17], v6 offset:24576
    v_mfma_f32_16x16x32_bf16 v[148:151], v[32:35], a[220:223], v[148:151]
    s_add_u32 m0, s35, 0x11000
    ds_read_b64_tr_b16 v[18:19], v6 offset:25088
    v_mfma_f32_16x16x32_bf16 v[148:151], v[36:39], a[236:239], v[148:151]
    s_add_u32 s41, s52, 0x1000
    ds_read_b64_tr_b16 v[20:21], v6 offset:28672
    v_mfma_f32_16x16x32_bf16 v[144:147], v[36:39], a[232:235], v[144:147]
    s_mul_i32 s55, s55, 16320
    ds_read_b64_tr_b16 v[22:23], v6 offset:29184
    v_mfma_f32_16x16x32_bf16 v[144:147], v[32:35], a[216:219], v[144:147]
    s_mul_i32 s54, s54, 9216
    ds_read_b64_tr_b16 v[24:25], v6 offset:32768
    v_mfma_f32_16x16x32_bf16 v[144:147], v[28:31], a[200:203], v[144:147]
    s_add_u32 s73, s54, s55
    ds_read_b64_tr_b16 v[26:27], v6 offset:33280
    v_mfma_f32_16x16x32_bf16 v[140:143], v[28:31], a[196:199], v[140:143]
    v_mfma_f32_16x16x32_bf16 v[140:143], v[32:35], a[212:215], v[140:143]
    v_mfma_f32_16x16x32_bf16 v[140:143], v[36:39], a[228:231], v[140:143]
    buffer_load_dwordx4 v13, s[24:27], s41 offen nt lds
    v_mfma_f32_16x16x32_bf16 v[136:139], v[36:39], a[224:227], v[136:139]
    v_mfma_f32_16x16x32_bf16 v[136:139], v[32:35], a[208:211], v[136:139]
    v_mfma_f32_16x16x32_bf16 v[136:139], v[28:31], a[192:195], v[136:139]
    s_waitcnt lgkmcnt(0)
    v_mfma_f32_16x16x32_bf16 v[136:139], v[16:19], a[240:243], v[136:139]
    s_lshr_b32 s54, 0xcba5, s53
    ds_read_b64_tr_b16 v[28:29], v6 offset:24584
    v_mfma_f32_16x16x32_bf16 v[136:139], v[20:23], v[40:43], v[136:139]
    s_add_u32 m0, s35, 0x12000
    ds_read_b64_tr_b16 v[30:31], v6 offset:25096
    v_mfma_f32_16x16x32_bf16 v[136:139], v[24:27], v[56:59], v[136:139]
    s_add_u32 s41, s52, 0x2000
    ds_read_b64_tr_b16 v[32:33], v6 offset:28680
    v_mfma_f32_16x16x32_bf16 v[140:143], v[24:27], v[60:63], v[140:143]
    s_and_b32 s54, s54, 15
    ds_read_b64_tr_b16 v[34:35], v6 offset:29192
    v_mfma_f32_16x16x32_bf16 v[140:143], v[20:23], v[44:47], v[140:143]
    s_add_u32 s55, s54, 4
    ds_read_b64_tr_b16 v[36:37], v6 offset:32776
    v_mfma_f32_16x16x32_bf16 v[140:143], v[16:19], a[244:247], v[140:143]
    s_lshr_b32 s55, s55, 4
    ds_read_b64_tr_b16 v[38:39], v6 offset:33288
    v_mfma_f32_16x16x32_bf16 v[144:147], v[16:19], a[248:251], v[144:147]
    v_mfma_f32_16x16x32_bf16 v[144:147], v[20:23], v[48:51], v[144:147]
    v_mfma_f32_16x16x32_bf16 v[144:147], v[24:27], v[64:67], v[144:147]
    buffer_load_dwordx4 v13, s[24:27], s41 offen nt lds
    v_mfma_f32_16x16x32_bf16 v[148:151], v[24:27], v[68:71], v[148:151]
    v_mul_f32 v136, s50, v136
    v_mul_f32 v137, s50, v137
    v_mfma_f32_16x16x32_bf16 v[148:151], v[20:23], v[52:55], v[148:151]
    v_mul_f32 v138, s50, v138
    v_mul_f32 v139, s50, v139
    v_mfma_f32_16x16x32_bf16 v[148:151], v[16:19], a[252:255], v[148:151]
    s_waitcnt lgkmcnt(0)
    v_cvt_pk_bf16_f32 v136, v136, v137
    v_cvt_pk_bf16_f32 v137, v138, v139
    v_mfma_f32_16x16x32_bf16 v[164:167], v[28:31], a[252:255], v[164:167]
    s_mul_i32 s55, s55, 16320
    ds_read_b64_tr_b16 v[16:17], v6 offset:12296
    v_mul_f32 v140, s50, v140
    v_mfma_f32_16x16x32_bf16 v[164:167], v[32:35], v[52:55], v[164:167]
    s_add_u32 m0, s35, 0x13000
    ds_read_b64_tr_b16 v[18:19], v6 offset:12808
    v_mul_f32 v141, s50, v141
    v_mfma_f32_16x16x32_bf16 v[164:167], v[36:39], v[68:71], v[164:167]
    s_add_u32 s41, s52, 0x3000
    ds_read_b64_tr_b16 v[20:21], v6 offset:16392
    v_mul_f32 v142, s50, v142
    v_mfma_f32_16x16x32_bf16 v[160:163], v[36:39], v[64:67], v[160:163]
    s_mul_i32 s54, s54, 9216
    ds_read_b64_tr_b16 v[22:23], v6 offset:16904
    v_mul_f32 v143, s50, v143
    v_mfma_f32_16x16x32_bf16 v[160:163], v[32:35], v[48:51], v[160:163]
    s_add_u32 s74, s54, s55
    ds_read_b64_tr_b16 v[24:25], v6 offset:20488
    v_cvt_pk_bf16_f32 v140, v140, v141
    v_mfma_f32_16x16x32_bf16 v[160:163], v[28:31], a[248:251], v[160:163]
    ds_read_b64_tr_b16 v[26:27], v6 offset:21000
    v_cvt_pk_bf16_f32 v141, v142, v143
    v_mfma_f32_16x16x32_bf16 v[156:159], v[28:31], a[244:247], v[156:159]
    v_mul_f32 v144, s50, v144
    v_mul_f32 v145, s50, v145
    v_mfma_f32_16x16x32_bf16 v[156:159], v[32:35], v[44:47], v[156:159]
    v_mul_f32 v146, s50, v146
    v_mul_f32 v147, s50, v147
    v_mfma_f32_16x16x32_bf16 v[156:159], v[36:39], v[60:63], v[156:159]
    buffer_load_dwordx4 v13, s[24:27], s41 offen nt lds
    v_mfma_f32_16x16x32_bf16 v[152:155], v[36:39], v[56:59], v[152:155]
    v_cvt_pk_bf16_f32 v144, v144, v145
    v_cvt_pk_bf16_f32 v145, v146, v147
    v_mfma_f32_16x16x32_bf16 v[152:155], v[32:35], v[40:43], v[152:155]
    v_mul_f32 v148, s50, v148
    v_mul_f32 v149, s50, v149
    v_mfma_f32_16x16x32_bf16 v[152:155], v[28:31], a[240:243], v[152:155]
    s_waitcnt lgkmcnt(0)
    v_mul_f32 v150, s50, v150
    v_mul_f32 v151, s50, v151
    v_mfma_f32_16x16x32_bf16 v[152:155], v[16:19], a[192:195], v[152:155]
    ds_read_b64_tr_b16 v[28:29], v6 offset:8
    v_cvt_pk_bf16_f32 v148, v148, v149
    v_mfma_f32_16x16x32_bf16 v[152:155], v[20:23], a[208:211], v[152:155]
    s_add_u32 m0, s35, 0x14000
    ds_read_b64_tr_b16 v[30:31], v6 offset:520
    v_cvt_pk_bf16_f32 v149, v150, v151
    v_mfma_f32_16x16x32_bf16 v[152:155], v[24:27], a[224:227], v[152:155]
    s_add_u32 s41, s52, 0x4000
    ds_read_b64_tr_b16 v[32:33], v6 offset:4104
    v_mfma_f32_16x16x32_bf16 v[156:159], v[24:27], a[228:231], v[156:159]
    ds_read_b64_tr_b16 v[34:35], v6 offset:4616
    v_mfma_f32_16x16x32_bf16 v[156:159], v[20:23], a[212:215], v[156:159]
    ds_read_b64_tr_b16 v[36:37], v6 offset:8200
    v_mfma_f32_16x16x32_bf16 v[156:159], v[16:19], a[196:199], v[156:159]
    ds_read_b64_tr_b16 v[38:39], v6 offset:8712
    v_mfma_f32_16x16x32_bf16 v[160:163], v[16:19], a[200:203], v[160:163]
    v_mfma_f32_16x16x32_bf16 v[160:163], v[20:23], a[216:219], v[160:163]
    v_mfma_f32_16x16x32_bf16 v[160:163], v[24:27], a[232:235], v[160:163]
    buffer_load_dwordx4 v13, s[24:27], s41 offen nt lds
    v_mfma_f32_16x16x32_bf16 v[164:167], v[24:27], a[236:239], v[164:167]
    v_mfma_f32_16x16x32_bf16 v[164:167], v[20:23], a[220:223], v[164:167]
    v_mfma_f32_16x16x32_bf16 v[164:167], v[16:19], a[204:207], v[164:167]
    s_waitcnt lgkmcnt(0)
    v_mfma_f32_16x16x32_bf16 v[164:167], v[28:31], a[156:159], v[164:167]
    ds_read_b64_tr_b16 v[16:17], v7 offset:0
    v_lshrrev_b32 v248, 4, v0
    v_mfma_f32_16x16x32_bf16 v[164:167], v[32:35], a[172:175], v[164:167]
    s_add_u32 m0, s35, 0x15000
    ds_read_b64_tr_b16 v[18:19], v7 offset:512
    v_lshlrev_b32 v248, 4, v248
    v_mfma_f32_16x16x32_bf16 v[164:167], v[36:39], a[188:191], v[164:167]
    s_add_u32 s41, s52, 0x5000
    ds_read_b64_tr_b16 v[20:21], v7 offset:4096
    v_mfma_f32_16x16x32_bf16 v[160:163], v[36:39], a[184:187], v[160:163]
    ds_read_b64_tr_b16 v[22:23], v7 offset:4608
    v_mfma_f32_16x16x32_bf16 v[160:163], v[32:35], a[168:171], v[160:163]
    ds_read_b64_tr_b16 v[24:25], v7 offset:8192
    v_mfma_f32_16x16x32_bf16 v[160:163], v[28:31], a[152:155], v[160:163]
    ds_read_b64_tr_b16 v[26:27], v7 offset:8704
    v_mfma_f32_16x16x32_bf16 v[156:159], v[28:31], a[148:151], v[156:159]
    v_mfma_f32_16x16x32_bf16 v[156:159], v[32:35], a[164:167], v[156:159]
    v_mfma_f32_16x16x32_bf16 v[156:159], v[36:39], a[180:183], v[156:159]
    buffer_load_dwordx4 v13, s[24:27], s41 offen nt lds
    v_mfma_f32_16x16x32_bf16 v[152:155], v[36:39], a[176:179], v[152:155]
    v_mul_f32 v164, s50, v164
    v_mul_f32 v165, s50, v165
    v_mfma_f32_16x16x32_bf16 v[152:155], v[32:35], a[160:163], v[152:155]
    v_mul_f32 v166, s50, v166
    v_mul_f32 v167, s50, v167
    v_mfma_f32_16x16x32_bf16 v[152:155], v[28:31], a[144:147], v[152:155]
    s_waitcnt lgkmcnt(0)
    v_mul_f32 v160, s50, v160
    v_mul_f32 v161, s50, v161
    v_mfma_f32_16x16x32_bf16 v[168:171], v[16:19], a[144:147], v[168:171]
    ds_read_b64_tr_b16 v[28:29], v7 offset:12288
    v_and_b32 v5, 15, v0
    v_mfma_f32_16x16x32_bf16 v[168:171], v[20:23], a[160:163], v[168:171]
    s_add_u32 m0, s35, 0x16000
    ds_read_b64_tr_b16 v[30:31], v7 offset:12800
    v_mul_f32 v162, s50, v162
    v_mfma_f32_16x16x32_bf16 v[168:171], v[24:27], a[176:179], v[168:171]
    s_add_u32 s41, s52, 0x6000
    ds_read_b64_tr_b16 v[32:33], v7 offset:16384
    v_mul_f32 v156, s50, v156
    v_mfma_f32_16x16x32_bf16 v[172:175], v[24:27], a[180:183], v[172:175]
    ds_read_b64_tr_b16 v[34:35], v7 offset:16896
    v_mul_f32 v157, s50, v157
    v_mfma_f32_16x16x32_bf16 v[172:175], v[20:23], a[164:167], v[172:175]
    ds_read_b64_tr_b16 v[36:37], v7 offset:20480
    v_mul_f32 v158, s50, v158
    v_mfma_f32_16x16x32_bf16 v[172:175], v[16:19], a[148:151], v[172:175]
    ds_read_b64_tr_b16 v[38:39], v7 offset:20992
    v_mul_f32 v152, s50, v152
    v_mfma_f32_16x16x32_bf16 v[176:179], v[16:19], a[152:155], v[176:179]
    v_mul_f32 v153, s50, v153
    v_mul_f32 v154, s50, v154
    v_mfma_f32_16x16x32_bf16 v[176:179], v[20:23], a[168:171], v[176:179]
    v_mul_f32 v155, s50, v155
    v_cvt_pk_bf16_f32 v138, v152, v153
    v_mfma_f32_16x16x32_bf16 v[176:179], v[24:27], a[184:187], v[176:179]
    buffer_load_dwordx4 v13, s[24:27], s41 offen nt lds
    v_mfma_f32_16x16x32_bf16 v[180:183], v[24:27], a[188:191], v[180:183]
    v_cvt_pk_bf16_f32 v139, v154, v155
    v_mul_f32 v159, s50, v159
    v_mfma_f32_16x16x32_bf16 v[180:183], v[20:23], a[172:175], v[180:183]
    v_cvt_pk_bf16_f32 v142, v156, v157
    v_cvt_pk_bf16_f32 v143, v158, v159
    v_mfma_f32_16x16x32_bf16 v[180:183], v[16:19], a[156:159], v[180:183]
    s_waitcnt lgkmcnt(0)
    v_mul_f32 v163, s50, v163
    v_cvt_pk_bf16_f32 v146, v160, v161
    v_mfma_f32_16x16x32_bf16 v[180:183], v[28:31], a[204:207], v[180:183]
    ds_read_b64_tr_b16 v[16:17], v7 offset:24576
    v_mul_u32_u24 v5, 1152, v5
    v_mfma_f32_16x16x32_bf16 v[180:183], v[32:35], a[220:223], v[180:183]
    s_add_u32 m0, s35, 0x17000
    ds_read_b64_tr_b16 v[18:19], v7 offset:25088
    v_cvt_pk_bf16_f32 v147, v162, v163
    v_mfma_f32_16x16x32_bf16 v[180:183], v[36:39], a[236:239], v[180:183]
    s_add_u32 s41, s52, 0x7000
    ds_read_b64_tr_b16 v[20:21], v7 offset:28672
    v_cvt_pk_bf16_f32 v150, v164, v165
    v_mfma_f32_16x16x32_bf16 v[176:179], v[36:39], a[232:235], v[176:179]
    ds_read_b64_tr_b16 v[22:23], v7 offset:29184
    v_cvt_pk_bf16_f32 v151, v166, v167
    v_mfma_f32_16x16x32_bf16 v[176:179], v[32:35], a[216:219], v[176:179]
    ds_read_b64_tr_b16 v[24:25], v7 offset:32768
    v_mfma_f32_16x16x32_bf16 v[176:179], v[28:31], a[200:203], v[176:179]
    ds_read_b64_tr_b16 v[26:27], v7 offset:33280
    v_mfma_f32_16x16x32_bf16 v[172:175], v[28:31], a[196:199], v[172:175]
    v_mfma_f32_16x16x32_bf16 v[172:175], v[32:35], a[212:215], v[172:175]
    v_mfma_f32_16x16x32_bf16 v[172:175], v[36:39], a[228:231], v[172:175]
    buffer_load_dwordx4 v13, s[24:27], s41 offen nt lds
    v_mfma_f32_16x16x32_bf16 v[168:171], v[36:39], a[224:227], v[168:171]
    v_mfma_f32_16x16x32_bf16 v[168:171], v[32:35], a[208:211], v[168:171]
    v_mfma_f32_16x16x32_bf16 v[168:171], v[28:31], a[192:195], v[168:171]
    s_waitcnt lgkmcnt(0)
    v_mfma_f32_16x16x32_bf16 v[168:171], v[16:19], a[240:243], v[168:171]
    ds_read_b64_tr_b16 v[28:29], v7 offset:24584
    v_lshrrev_b32 v6, 4, v0
    v_mfma_f32_16x16x32_bf16 v[168:171], v[20:23], v[40:43], v[168:171]
    ds_read_b64_tr_b16 v[30:31], v7 offset:25096
    v_mfma_f32_16x16x32_bf16 v[168:171], v[24:27], v[56:59], v[168:171]
    ds_read_b64_tr_b16 v[32:33], v7 offset:28680
    v_mfma_f32_16x16x32_bf16 v[172:175], v[24:27], v[60:63], v[172:175]
    ds_read_b64_tr_b16 v[34:35], v7 offset:29192
    v_mfma_f32_16x16x32_bf16 v[172:175], v[20:23], v[44:47], v[172:175]
    ds_read_b64_tr_b16 v[36:37], v7 offset:32776
    v_mfma_f32_16x16x32_bf16 v[172:175], v[16:19], a[244:247], v[172:175]
    ds_read_b64_tr_b16 v[38:39], v7 offset:33288
    v_mfma_f32_16x16x32_bf16 v[176:179], v[16:19], a[248:251], v[176:179]
    ds_read_b128 v[200:203], v248 offset:49152
    v_mfma_f32_16x16x32_bf16 v[176:179], v[20:23], v[48:51], v[176:179]
    ds_read_b128 v[204:207], v248 offset:49216
    v_mfma_f32_16x16x32_bf16 v[176:179], v[24:27], v[64:67], v[176:179]
    ds_read_b128 v[208:211], v248 offset:49280
    v_mul_f32 v168, s50, v168
    v_mfma_f32_16x16x32_bf16 v[180:183], v[24:27], v[68:71], v[180:183]
    ds_read_b128 v[212:215], v248 offset:49344
    v_mul_f32 v169, s50, v169
    v_mfma_f32_16x16x32_bf16 v[180:183], v[20:23], v[52:55], v[180:183]
    v_mul_f32 v170, s50, v170
    v_mul_f32 v171, s50, v171
    v_mfma_f32_16x16x32_bf16 v[180:183], v[16:19], a[252:255], v[180:183]
    s_waitcnt lgkmcnt(0)
    v_cvt_pk_bf16_f32 v168, v168, v169
    v_cvt_pk_bf16_f32 v169, v170, v171
    v_mfma_f32_16x16x32_bf16 v[196:199], v[28:31], a[252:255], v[196:199]
    ds_read_b64_tr_b16 v[16:17], v7 offset:12296
    v_lshl_add_u32 v5, v6, 3, v5
    v_mfma_f32_16x16x32_bf16 v[196:199], v[32:35], v[52:55], v[196:199]
    ds_read_b64_tr_b16 v[18:19], v7 offset:12808
    v_mul_f32 v172, s50, v172
    v_mfma_f32_16x16x32_bf16 v[196:199], v[36:39], v[68:71], v[196:199]
    ds_read_b64_tr_b16 v[20:21], v7 offset:16392
    v_mul_f32 v173, s50, v173
    v_mfma_f32_16x16x32_bf16 v[192:195], v[36:39], v[64:67], v[192:195]
    ds_read_b64_tr_b16 v[22:23], v7 offset:16904
    v_mul_f32 v174, s50, v174
    v_mfma_f32_16x16x32_bf16 v[192:195], v[32:35], v[48:51], v[192:195]
    ds_read_b64_tr_b16 v[24:25], v7 offset:20488
    v_mul_f32 v175, s50, v175
    v_mfma_f32_16x16x32_bf16 v[192:195], v[28:31], a[248:251], v[192:195]
    ds_read_b64_tr_b16 v[26:27], v7 offset:21000
    v_cvt_pk_bf16_f32 v172, v172, v173
    v_mfma_f32_16x16x32_bf16 v[188:191], v[28:31], a[244:247], v[188:191]
    v_xor_b32 v200, 0x80008000, v200
    v_xor_b32 v201, 0x80008000, v201
    v_mfma_f32_16x16x32_bf16 v[188:191], v[32:35], v[44:47], v[188:191]
    v_xor_b32 v202, 0x80008000, v202
    v_xor_b32 v203, 0x80008000, v203
    v_mfma_f32_16x16x32_bf16 v[188:191], v[36:39], v[60:63], v[188:191]
    v_xor_b32 v204, 0x80008000, v204
    v_xor_b32 v205, 0x80008000, v205
    v_mfma_f32_16x16x32_bf16 v[184:187], v[36:39], v[56:59], v[184:187]
    v_xor_b32 v206, 0x80008000, v206
    v_xor_b32 v207, 0x80008000, v207
    v_mfma_f32_16x16x32_bf16 v[184:187], v[32:35], v[40:43], v[184:187]
    v_xor_b32 v208, 0x80008000, v208
    v_xor_b32 v209, 0x80008000, v209
    v_mfma_f32_16x16x32_bf16 v[184:187], v[28:31], a[240:243], v[184:187]
    s_waitcnt lgkmcnt(0)
    v_cvt_pk_bf16_f32 v173, v174, v175
    v_mul_f32 v176, s50, v176
    v_mfma_f32_16x16x32_bf16 v[184:187], v[16:19], a[192:195], v[184:187]
    ds_read_b64_tr_b16 v[28:29], v7 offset:8
    v_add_u32 v6, 18432, v5
    v_mfma_f32_16x16x32_bf16 v[184:187], v[20:23], a[208:211], v[184:187]
    ds_read_b64_tr_b16 v[30:31], v7 offset:520
    v_mul_f32 v177, s50, v177
    v_mfma_f32_16x16x32_bf16 v[184:187], v[24:27], a[224:227], v[184:187]
    ds_read_b64_tr_b16 v[32:33], v7 offset:4104
    v_mul_f32 v178, s50, v178
    v_mfma_f32_16x16x32_bf16 v[188:191], v[24:27], a[228:231], v[188:191]
    ds_read_b64_tr_b16 v[34:35], v7 offset:4616
    v_mul_f32 v179, s50, v179
    v_mfma_f32_16x16x32_bf16 v[188:191], v[20:23], a[212:215], v[188:191]
    ds_read_b64_tr_b16 v[36:37], v7 offset:8200
    v_cvt_pk_bf16_f32 v176, v176, v177
    v_mfma_f32_16x16x32_bf16 v[188:191], v[16:19], a[196:199], v[188:191]
    ds_read_b64_tr_b16 v[38:39], v7 offset:8712
    v_cvt_pk_bf16_f32 v177, v178, v179
    v_mfma_f32_16x16x32_bf16 v[192:195], v[16:19], a[200:203], v[192:195]
    v_xor_b32 v210, 0x80008000, v210
    v_xor_b32 v211, 0x80008000, v211
    v_mfma_f32_16x16x32_bf16 v[192:195], v[20:23], a[216:219], v[192:195]
    v_xor_b32 v212, 0x80008000, v212
    v_xor_b32 v213, 0x80008000, v213
    v_mfma_f32_16x16x32_bf16 v[192:195], v[24:27], a[232:235], v[192:195]
    v_xor_b32 v214, 0x80008000, v214
    v_xor_b32 v215, 0x80008000, v215
    v_mfma_f32_16x16x32_bf16 v[196:199], v[24:27], a[236:239], v[196:199]
    v_mov_b32 v248, 0xc0c00000
    v_mov_b32 v249, 0xc0c00000
    v_mfma_f32_16x16x32_bf16 v[196:199], v[20:23], a[220:223], v[196:199]
    v_mov_b32 v250, 0xc0c00000
    v_mov_b32 v251, 0xc0c00000
    v_mfma_f32_16x16x32_bf16 v[196:199], v[16:19], a[204:207], v[196:199]
    s_waitcnt lgkmcnt(0)
    v_mul_f32 v180, s50, v180
    v_mul_f32 v181, s50, v181
    v_mfma_f32_16x16x32_bf16 v[196:199], v[28:31], a[156:159], v[196:199]
    ds_read_b128 v[216:219], v232 offset:49152
    v_mul_f32 v182, s50, v182
    v_mfma_f32_16x16x32_bf16 v[196:199], v[32:35], a[172:175], v[196:199]
    ds_read_b128 v[220:223], v233 offset:49152
    v_mul_f32 v183, s50, v183
    v_mfma_f32_16x16x32_bf16 v[196:199], v[36:39], a[188:191], v[196:199]
    ds_read_b128 v[224:227], v234 offset:49152
    v_cvt_pk_bf16_f32 v180, v180, v181
    v_mfma_f32_16x16x32_bf16 v[192:195], v[36:39], a[184:187], v[192:195]
    ds_read_b128 v[228:231], v235 offset:49152
    v_cvt_pk_bf16_f32 v181, v182, v183
    v_mfma_f32_16x16x32_bf16 v[192:195], v[32:35], a[168:171], v[192:195]
    v_mfma_f32_16x16x32_bf16 v[192:195], v[28:31], a[152:155], v[192:195]
    v_mfma_f32_16x16x32_bf16 v[188:191], v[28:31], a[148:151], v[188:191]
    v_mfma_f32_16x16x32_bf16 v[188:191], v[32:35], a[164:167], v[188:191]
    v_mfma_f32_16x16x32_bf16 v[188:191], v[36:39], a[180:183], v[188:191]
    v_mul_f32 v196, s50, v196
    v_mul_f32 v197, s50, v197
    v_mfma_f32_16x16x32_bf16 v[184:187], v[36:39], a[176:179], v[184:187]
    v_mul_f32 v198, s50, v198
    v_mul_f32 v199, s50, v199
    v_mfma_f32_16x16x32_bf16 v[184:187], v[32:35], a[160:163], v[184:187]
    v_cvt_pk_bf16_f32 v182, v196, v197
    v_cvt_pk_bf16_f32 v183, v198, v199
    v_mfma_f32_16x16x32_bf16 v[184:187], v[28:31], a[144:147], v[184:187]
    v_mul_f32 v192, s50, v192
    v_mul_f32 v193, s50, v193
    v_mfma_f32_16x16x32_bf16 v[40:43], v[200:203], v[72:75], v[248:251]
    buffer_load_dwordx2 a[240:241], v5, s[8:11], s83 offen offset:0
    v_mfma_f32_16x16x32_bf16 v[40:43], v[204:207], v[88:91], v[40:43]
    buffer_load_dwordx2 a[244:245], v5, s[8:11], s83 offen offset:32
    v_mfma_f32_16x16x32_bf16 v[40:43], v[208:211], v[136:139], v[40:43]
    v_mul_f32 v188, s50, v188
    v_mul_f32 v189, s50, v189
    v_mfma_f32_16x16x32_bf16 v[44:47], v[208:211], v[140:143], v[248:251]
    v_mul_f32 v190, s50, v190
    v_mul_f32 v191, s50, v191
    v_mfma_f32_16x16x32_bf16 v[44:47], v[204:207], v[92:95], v[44:47]
    v_cvt_pk_bf16_f32 v174, v188, v189
    v_cvt_pk_bf16_f32 v175, v190, v191
    v_mfma_f32_16x16x32_bf16 v[44:47], v[200:203], v[76:79], v[44:47]
    v_mul_f32 v184, s50, v184
    v_mul_f32 v185, s50, v185
    v_mfma_f32_16x16x32_bf16 v[48:51], v[200:203], v[80:83], v[248:251]
    v_mul_f32 v186, s50, v186
    v_mul_f32 v187, s50, v187
    v_mfma_f32_16x16x32_bf16 v[48:51], v[204:207], v[96:99], v[48:51]
    v_cvt_pk_bf16_f32 v170, v184, v185
    v_cvt_pk_bf16_f32 v171, v186, v187
    v_mfma_f32_16x16x32_bf16 v[48:51], v[208:211], v[144:147], v[48:51]
    v_mul_f32 v194, s50, v194
    v_mul_f32 v195, s50, v195
    v_mfma_f32_16x16x32_bf16 v[52:55], v[208:211], v[148:151], v[248:251]
    v_cvt_pk_bf16_f32 v178, v192, v193
    v_cvt_pk_bf16_f32 v179, v194, v195
    v_mfma_f32_16x16x32_bf16 v[52:55], v[204:207], v[100:103], v[52:55]
    v_mfma_f32_16x16x32_bf16 v[52:55], v[200:203], v[84:87], v[52:55]
    s_waitcnt lgkmcnt(0)
    s_nop 0
    v_mfma_f32_16x16x32_bf16 v[40:43], v[212:215], v[168:171], v[40:43]
    buffer_load_dwordx2 a[248:249], v5, s[8:11], s1 offen offset:0
    v_mfma_f32_16x16x32_bf16 v[44:47], v[212:215], v[172:175], v[44:47]
    buffer_load_dwordx2 a[242:243], v6, s[8:11], s83 offen offset:0
    v_mfma_f32_16x16x32_bf16 v[48:51], v[212:215], v[176:179], v[48:51]
    buffer_load_dwordx2 a[246:247], v6, s[8:11], s83 offen offset:32
    v_mfma_f32_16x16x32_bf16 v[52:55], v[212:215], v[180:183], v[52:55]
    buffer_load_dwordx2 a[250:251], v6, s[8:11], s1 offen offset:0
L_k2_attn:
    s_add_u32 s46, s52, 49152
    s_add_u32 s47, s52, 32768
    v_mfma_f32_16x16x32_bf16 v[16:19], v[216:219], v[72:75], v[40:43]
    ds_read_b128 v[200:203], v232 offset:53248
    v_mfma_f32_16x16x32_bf16 v[16:19], v[220:223], v[88:91], v[16:19]
    ds_read_b128 v[204:207], v233 offset:53248
    v_mfma_f32_16x16x32_bf16 v[16:19], v[224:227], v[136:139], v[16:19]
    ds_read_b128 v[208:211], v234 offset:53248
    v_mfma_f32_16x16x32_bf16 v[16:19], v[228:231], v[168:171], v[16:19]
    ds_read_b128 v[212:215], v235 offset:53248
    v_mfma_f32_16x16x32_bf16 v[20:23], v[228:231], v[172:175], v[44:47]
    v_lshrrev_b32 v36, 4, v0
    v_mfma_f32_16x16x32_bf16 v[20:23], v[224:227], v[140:143], v[20:23]
    v_lshlrev_b32 v36, 4, v36
    v_mfma_f32_16x16x32_bf16 v[20:23], v[220:223], v[92:95], v[20:23]
    v_add_u32 v36, 0x10000, v36
    v_mfma_f32_16x16x32_bf16 v[20:23], v[216:219], v[76:79], v[20:23]
    s_nop 0
    v_mfma_f32_16x16x32_bf16 v[24:27], v[216:219], v[80:83], v[48:51]
    v_exp_f32 v16, v16
    v_mfma_f32_16x16x32_bf16 v[24:27], v[220:223], v[96:99], v[24:27]
    v_exp_f32 v17, v17
    v_mfma_f32_16x16x32_bf16 v[24:27], v[224:227], v[144:147], v[24:27]
    v_exp_f32 v18, v18
    v_mfma_f32_16x16x32_bf16 v[24:27], v[228:231], v[176:179], v[24:27]
    v_exp_f32 v19, v19
    v_cvt_pk_bf16_f32 v104, v16, v17
    v_cvt_pk_bf16_f32 v105, v18, v19
    v_mfma_f32_16x16x32_bf16 v[28:31], v[228:231], v[180:183], v[52:55]
    v_exp_f32 v20, v20
    v_mfma_f32_16x16x32_bf16 v[28:31], v[224:227], v[148:151], v[28:31]
    v_exp_f32 v21, v21
    v_mfma_f32_16x16x32_bf16 v[28:31], v[220:223], v[100:103], v[28:31]
    v_exp_f32 v22, v22
    v_mfma_f32_16x16x32_bf16 v[28:31], v[216:219], v[84:87], v[28:31]
    v_exp_f32 v23, v23
    v_cvt_pk_bf16_f32 v108, v20, v21
    v_cvt_pk_bf16_f32 v109, v22, v23
    s_waitcnt lgkmcnt(0)
    v_mfma_f32_16x16x32_bf16 v[16:19], v[200:203], v[72:75], v[40:43]
    ds_read_b128 v[216:219], v232 offset:57344
    v_exp_f32 v24, v24
    v_mfma_f32_16x16x32_bf16 v[16:19], v[204:207], v[88:91], v[16:19]
    ds_read_b128 v[220:223], v233 offset:57344
    v_exp_f32 v25, v25
    v_mfma_f32_16x16x32_bf16 v[16:19], v[208:211], v[136:139], v[16:19]
    ds_read_b128 v[224:227], v234 offset:57344
    v_exp_f32 v26, v26
    v_mfma_f32_16x16x32_bf16 v[16:19], v[212:215], v[168:171], v[16:19]
    ds_read_b128 v[228:231], v235 offset:57344
    v_exp_f32 v27, v27
    v_cvt_pk_bf16_f32 v112, v24, v25
    v_cvt_pk_bf16_f32 v113, v26, v27
    v_mfma_f32_16x16x32_bf16 v[20:23], v[212:215], v[172:175], v[44:47]
    v_exp_f32 v28, v28
    v_mfma_f32_16x16x32_bf16 v[20:23], v[208:211], v[140:143], v[20:23]
    v_exp_f32 v29, v29
    v_mfma_f32_16x16x32_bf16 v[20:23], v[204:207], v[92:95], v[20:23]
    v_exp_f32 v30, v30
    v_mfma_f32_16x16x32_bf16 v[20:23], v[200:203], v[76:79], v[20:23]
    v_exp_f32 v31, v31
    v_cvt_pk_bf16_f32 v116, v28, v29
    v_cvt_pk_bf16_f32 v117, v30, v31
    v_mfma_f32_16x16x32_bf16 v[24:27], v[200:203], v[80:83], v[48:51]
    v_exp_f32 v16, v16
    v_mfma_f32_16x16x32_bf16 v[24:27], v[204:207], v[96:99], v[24:27]
    v_exp_f32 v17, v17
    v_mfma_f32_16x16x32_bf16 v[24:27], v[208:211], v[144:147], v[24:27]
    v_exp_f32 v18, v18
    v_mfma_f32_16x16x32_bf16 v[24:27], v[212:215], v[176:179], v[24:27]
    v_exp_f32 v19, v19
    v_cvt_pk_bf16_f32 v106, v16, v17
    v_cvt_pk_bf16_f32 v107, v18, v19
    v_mfma_f32_16x16x32_bf16 v[28:31], v[212:215], v[180:183], v[52:55]
    v_exp_f32 v20, v20
    v_mfma_f32_16x16x32_bf16 v[28:31], v[208:211], v[148:151], v[28:31]
    v_exp_f32 v21, v21
    v_mfma_f32_16x16x32_bf16 v[28:31], v[204:207], v[100:103], v[28:31]
    v_exp_f32 v22, v22
    v_mfma_f32_16x16x32_bf16 v[28:31], v[200:203], v[84:87], v[28:31]
    v_exp_f32 v23, v23
    v_cvt_pk_bf16_f32 v110, v20, v21
    v_cvt_pk_bf16_f32 v111, v22, v23
    s_waitcnt lgkmcnt(0)
    v_mfma_f32_16x16x32_bf16 v[16:19], v[216:219], v[72:75], v[40:43]
    ds_read_b128 v[200:203], v232 offset:61440
    v_exp_f32 v24, v24
    v_mfma_f32_16x16x32_bf16 v[16:19], v[220:223], v[88:91], v[16:19]
    ds_read_b128 v[204:207], v233 offset:61440
    v_exp_f32 v25, v25
    v_mfma_f32_16x16x32_bf16 v[16:19], v[224:227], v[136:139], v[16:19]
    ds_read_b128 v[208:211], v234 offset:61440
    v_exp_f32 v26, v26
    v_mfma_f32_16x16x32_bf16 v[16:19], v[228:231], v[168:171], v[16:19]
    ds_read_b128 v[212:215], v235 offset:61440
    v_exp_f32 v27, v27
    v_cvt_pk_bf16_f32 v114, v24, v25
    v_cvt_pk_bf16_f32 v115, v26, v27
    v_mfma_f32_16x16x32_bf16 v[20:23], v[228:231], v[172:175], v[44:47]
    v_exp_f32 v28, v28
    v_mfma_f32_16x16x32_bf16 v[20:23], v[224:227], v[140:143], v[20:23]
    v_exp_f32 v29, v29
    v_mfma_f32_16x16x32_bf16 v[20:23], v[220:223], v[92:95], v[20:23]
    v_exp_f32 v30, v30
    v_mfma_f32_16x16x32_bf16 v[20:23], v[216:219], v[76:79], v[20:23]
    v_exp_f32 v31, v31
    v_cvt_pk_bf16_f32 v118, v28, v29
    v_cvt_pk_bf16_f32 v119, v30, v31
    v_mfma_f32_16x16x32_bf16 v[24:27], v[216:219], v[80:83], v[48:51]
    v_exp_f32 v16, v16
    v_mfma_f32_16x16x32_bf16 v[24:27], v[220:223], v[96:99], v[24:27]
    v_exp_f32 v17, v17
    v_mfma_f32_16x16x32_bf16 v[24:27], v[224:227], v[144:147], v[24:27]
    v_exp_f32 v18, v18
    v_mfma_f32_16x16x32_bf16 v[24:27], v[228:231], v[176:179], v[24:27]
    v_exp_f32 v19, v19
    v_cvt_pk_bf16_f32 v120, v16, v17
    v_cvt_pk_bf16_f32 v121, v18, v19
    v_mfma_f32_16x16x32_bf16 v[28:31], v[228:231], v[180:183], v[52:55]
    v_exp_f32 v20, v20
    v_mfma_f32_16x16x32_bf16 v[28:31], v[224:227], v[148:151], v[28:31]
L_hop0_9:
    s_cbranch_execz L_hop0_ret
    v_exp_f32 v21, v21
    v_mfma_f32_16x16x32_bf16 v[28:31], v[220:223], v[100:103], v[28:31]
    v_exp_f32 v22, v22
    v_mfma_f32_16x16x32_bf16 v[28:31], v[216:219], v[84:87], v[28:31]
    v_exp_f32 v23, v23
    v_cvt_pk_bf16_f32 v124, v20, v21
    v_cvt_pk_bf16_f32 v125, v22, v23
    s_waitcnt lgkmcnt(0)
    s_waitcnt vmcnt(6)
    s_barrier
    ds_read_b128 v[32:35], v36
    v_mfma_f32_16x16x32_bf16 v[16:19], v[200:203], v[72:75], v[40:43]
    ds_read_b128 v[216:219], v232 offset:0
    v_exp_f32 v24, v24
    v_mfma_f32_16x16x32_bf16 v[16:19], v[204:207], v[88:91], v[16:19]
    ds_read_b128 v[220:223], v233 offset:0
    v_exp_f32 v25, v25
    v_mfma_f32_16x16x32_bf16 v[16:19], v[208:211], v[136:139], v[16:19]
    ds_read_b128 v[224:227], v234 offset:0
    v_exp_f32 v26, v26
    v_mfma_f32_16x16x32_bf16 v[16:19], v[212:215], v[168:171], v[16:19]
    ds_read_b128 v[228:231], v235 offset:0
    v_exp_f32 v27, v27
    v_cvt_pk_bf16_f32 v128, v24, v25
    v_cvt_pk_bf16_f32 v129, v26, v27
    v_mfma_f32_16x16x32_bf16 v[20:23], v[212:215], v[172:175], v[44:47]
    v_exp_f32 v28, v28
    v_mfma_f32_16x16x32_bf16 v[20:23], v[208:211], v[140:143], v[20:23]
    v_exp_f32 v29, v29
    v_mfma_f32_16x16x32_bf16 v[20:23], v[204:207], v[92:95], v[20:23]
    v_exp_f32 v30, v30
    v_mfma_f32_16x16x32_bf16 v[20:23], v[200:203], v[76:79], v[20:23]
    v_exp_f32 v31, v31
    v_cvt_pk_bf16_f32 v132, v28, v29
    v_cvt_pk_bf16_f32 v133, v30, v31
    v_mfma_f32_16x16x32_bf16 v[24:27], v[200:203], v[80:83], v[48:51]
    v_exp_f32 v16, v16
    v_mfma_f32_16x16x32_bf16 v[24:27], v[204:207], v[96:99], v[24:27]
    v_exp_f32 v17, v17
    v_mfma_f32_16x16x32_bf16 v[24:27], v[208:211], v[144:147], v[24:27]
    v_exp_f32 v18, v18
    v_mfma_f32_16x16x32_bf16 v[24:27], v[212:215], v[176:179], v[24:27]
    v_exp_f32 v19, v19
    v_cvt_pk_bf16_f32 v122, v16, v17
    v_cvt_pk_bf16_f32 v123, v18, v19
    v_mfma_f32_16x16x32_bf16 v[28:31], v[212:215], v[180:183], v[52:55]
    v_exp_f32 v20, v20
    v_mfma_f32_16x16x32_bf16 v[28:31], v[208:211], v[148:151], v[28:31]
    v_exp_f32 v21, v21
    v_mfma_f32_16x16x32_bf16 v[28:31], v[204:207], v[100:103], v[28:31]
    v_exp_f32 v22, v22
    v_mfma_f32_16x16x32_bf16 v[28:31], v[200:203], v[84:87], v[28:31]
    v_exp_f32 v23, v23
    v_cvt_pk_bf16_f32 v126, v20, v21
    v_cvt_pk_bf16_f32 v127, v22, v23
    s_waitcnt lgkmcnt(0)
    v_and_b32 v32, 0x7fff7fff, v32
    v_and_b32 v33, 0x7fff7fff, v33
    v_and_b32 v34, 0x7fff7fff, v34
    v_and_b32 v35, 0x7fff7fff, v35
    v_add_u32 v32, 0x2800280, v32
    v_add_u32 v33, 0x2800280, v33
    v_add_u32 v34, 0x2800280, v34
    v_add_u32 v35, 0x2800280, v35
    v_exp_f32 v24, v24
    v_exp_f32 v25, v25
    v_mfma_f32_16x16x32_bf16 v[56:59], v[32:35], v[104:107], 0
    v_exp_f32 v26, v26
    v_mfma_f32_16x16x32_bf16 v[60:63], v[32:35], v[108:111], 0
    v_exp_f32 v27, v27
    v_mfma_f32_16x16x32_bf16 v[64:67], v[32:35], v[112:115], 0
    v_cvt_pk_bf16_f32 v130, v24, v25
    v_cvt_pk_bf16_f32 v131, v26, v27
    v_mfma_f32_16x16x32_bf16 v[68:71], v[32:35], v[116:119], 0
    v_exp_f32 v28, v28
    v_exp_f32 v29, v29
    v_mfma_f32_16x16x32_bf16 v[16:19], v[216:219], v[72:75], v[40:43]
    s_lshr_b32 s54, s2, 3
    ds_read_b64_tr_b16 v[200:201], v236 offset:0
    v_cvt_pk_bf16_f32 v134, v28, v29
    v_mfma_f32_16x16x32_bf16 v[16:19], v[220:223], v[88:91], v[16:19]
    s_lshl_b32 s54, s54, 1
    v_exp_f32 v30, v30
    v_mfma_f32_16x16x32_bf16 v[16:19], v[224:227], v[136:139], v[16:19]
    s_add_u32 s54, s54, s3
    ds_read_b64_tr_b16 v[202:203], v236 offset:4096
    ds_read_b64_tr_b16 v[204:205], v236 offset:8192
    v_mfma_f32_16x16x32_bf16 v[16:19], v[228:231], v[168:171], v[16:19]
    s_add_u32 m0, s35, 0x8000
    v_exp_f32 v31, v31
    v_mfma_f32_16x16x32_bf16 v[20:23], v[228:231], v[172:175], v[44:47]
    s_add_u32 s41, s46, 0
    ds_read_b64_tr_b16 v[206:207], v236 offset:12288
    v_cvt_pk_bf16_f32 v135, v30, v31
    v_mfma_f32_16x16x32_bf16 v[20:23], v[224:227], v[140:143], v[20:23]
    buffer_load_dwordx4 v12, s[20:23], s41 offen nt lds
    v_mfma_f32_16x16x32_bf16 v[20:23], v[220:223], v[92:95], v[20:23]
    s_lshl_b32 s54, s54, 2
    ds_read_b64_tr_b16 v[208:209], v237 offset:0
    ds_read_b64_tr_b16 v[210:211], v237 offset:4096
    v_mfma_f32_16x16x32_bf16 v[20:23], v[216:219], v[76:79], v[20:23]
    s_add_u32 s54, s54, s32
    v_exp_f32 v16, v16
    v_mfma_f32_16x16x32_bf16 v[24:27], v[216:219], v[80:83], v[48:51]
    s_mul_i32 s54, s54, 73728
    ds_read_b64_tr_b16 v[212:213], v237 offset:8192
    ds_read_b64_tr_b16 v[214:215], v237 offset:12288
    v_min3_f32 v56, v56, v60, v64
    v_mfma_f32_16x16x32_bf16 v[24:27], v[220:223], v[96:99], v[24:27]
    s_add_u32 s54, s54, 0x4000000
    v_exp_f32 v17, v17
    v_min_f32 v56, v56, v68
    v_mfma_f32_16x16x32_bf16 v[24:27], v[224:227], v[144:147], v[24:27]
    s_add_u32 m0, s35, 0x9000
    v_cvt_pk_bf16_f32 v152, v16, v17
    v_and_b32 v56, 0x7f800000, v56
    v_mfma_f32_16x16x32_bf16 v[24:27], v[228:231], v[176:179], v[24:27]
    s_add_u32 s41, s46, 4096
    v_exp_f32 v18, v18
    v_mul_f32 v56, 0x3fc00000, v56
    v_mfma_f32_16x16x32_bf16 v[28:31], v[228:231], v[180:183], v[52:55]
    buffer_load_dwordx4 v12, s[20:23], s41 offen nt lds
    v_mfma_f32_16x16x32_bf16 v[28:31], v[224:227], v[148:151], v[28:31]
    s_mov_b32 s11, 0x20000
    v_exp_f32 v19, v19
    v_accvgpr_write_b32 a252, v56
    v_accvgpr_write_b32 a253, v56
    v_mfma_f32_16x16x32_bf16 v[28:31], v[220:223], v[100:103], v[28:31]
    s_bfe_u32 s55, s2, 0x20001
    v_cvt_pk_bf16_f32 v153, v18, v19
    v_accvgpr_write_b32 a254, v56
    v_accvgpr_write_b32 a255, v56
    v_mfma_f32_16x16x32_bf16 v[28:31], v[216:219], v[84:87], v[28:31]
    s_waitcnt lgkmcnt(0)
    v_exp_f32 v20, v20
    v_mfma_f32_16x16x32_bf16 a[0:3], v[204:207], v[120:123], a[252:255]
    s_mul_i32 s55, s55, 18432
    ds_read_b128 v[216:219], v232 offset:4096
    v_mov_b32 v36, -1
    v_mfma_f32_16x16x32_bf16 a[0:3], v[200:203], v[104:107], a[0:3]
    s_add_u32 s59, s55, s54
    v_exp_f32 v21, v21
    v_mfma_f32_16x16x32_bf16 a[4:7], v[200:203], v[108:111], a[252:255]
    s_lshl_b32 s42, s2, 2
    ds_read_b128 v[220:223], v233 offset:4096
    v_cvt_pk_bf16_f32 v156, v20, v21
    v_mfma_f32_16x16x32_bf16 a[4:7], v[204:207], v[124:127], a[4:7]
    s_add_u32 s75, s42, 0x3401000
    v_exp_f32 v22, v22
    v_mfma_f32_16x16x32_bf16 a[8:11], v[204:207], v[128:131], a[252:255]
    s_add_u32 s42, s42, s32
    ds_read_b128 v[224:227], v234 offset:4096
    v_mov_b32 v37, -1
    v_mfma_f32_16x16x32_bf16 a[8:11], v[200:203], v[112:115], a[8:11]
    s_lshl_b32 s58, s32, 12
    v_exp_f32 v23, v23
    v_mfma_f32_16x16x32_bf16 a[12:15], v[200:203], v[116:119], a[252:255]
    s_add_u32 m0, s35, 0xa000
    ds_read_b128 v[228:231], v235 offset:4096
    v_cvt_pk_bf16_f32 v157, v22, v23
    v_mfma_f32_16x16x32_bf16 a[12:15], v[204:207], v[132:135], a[12:15]
    s_add_u32 s41, s46, 8192
    v_exp_f32 v24, v24
    v_mfma_f32_16x16x32_bf16 a[28:31], v[212:215], v[132:135], a[252:255]
    buffer_load_dwordx4 v12, s[20:23], s41 offen nt lds
    v_mfma_f32_16x16x32_bf16 a[28:31], v[208:211], v[116:119], a[28:31]
    s_add_u32 s58, s58, 131072
    v_exp_f32 v25, v25
    v_mfma_f32_16x16x32_bf16 a[24:27], v[208:211], v[112:115], a[252:255]
    s_add_u32 m0, s35, 0xb000
    v_cvt_pk_bf16_f32 v160, v24, v25
    v_mov_b32 v38, -1
    v_mfma_f32_16x16x32_bf16 a[24:27], v[212:215], v[128:131], a[24:27]
    s_add_u32 s41, s46, 12288
    v_exp_f32 v26, v26
    v_mfma_f32_16x16x32_bf16 a[20:23], v[212:215], v[124:127], a[252:255]
    buffer_load_dwordx4 v12, s[20:23], s41 offen nt lds
    v_mfma_f32_16x16x32_bf16 a[20:23], v[208:211], v[108:111], a[20:23]
    s_lshr_b32 s54, s2, 3
    v_exp_f32 v27, v27
    v_mfma_f32_16x16x32_bf16 a[16:19], v[208:211], v[104:107], a[252:255]
    s_lshl_b32 s54, s54, 1
    v_cvt_pk_bf16_f32 v161, v26, v27
    v_mov_b32 v39, -1
    v_mfma_f32_16x16x32_bf16 a[16:19], v[212:215], v[120:123], a[16:19]
    s_add_u32 s54, s54, s3
    v_exp_f32 v28, v28
    v_mfma_f32_16x16x32_bf16 a[128:131], v[244:247], v[120:123], 0
    s_lshl_b32 s54, s54, 6
    v_mov_b32 v11, 1
    v_min_u32 v7, 1, v0
    v_mfma_f32_16x16x32_bf16 a[128:131], v[244:247], v[104:107], a[128:131]
    s_waitcnt lgkmcnt(0)
    v_exp_f32 v29, v29
    v_mfma_f32_16x16x32_bf16 v[16:19], v[216:219], v[72:75], v[40:43]
    s_min_u32 s55, s32, 1
    ds_read_b64_tr_b16 v[200:201], v238 offset:0
    v_cvt_pk_bf16_f32 v164, v28, v29
    v_mfma_f32_16x16x32_bf16 v[16:19], v[220:223], v[88:91], v[16:19]
    s_lshl_b32 s55, s55, 30
    v_exp_f32 v30, v30
    v_mfma_f32_16x16x32_bf16 v[16:19], v[224:227], v[136:139], v[16:19]
    s_add_u32 s54, s54, s55
    ds_read_b64_tr_b16 v[202:203], v238 offset:4096
    ds_read_b64_tr_b16 v[204:205], v238 offset:8192
    v_mfma_f32_16x16x32_bf16 v[16:19], v[228:231], v[168:171], v[16:19]
    s_add_u32 m0, s35, 0xc000
    v_exp_f32 v31, v31
    v_mfma_f32_16x16x32_bf16 v[20:23], v[228:231], v[172:175], v[44:47]
    s_add_u32 s41, s46, 16384
    ds_read_b64_tr_b16 v[206:207], v238 offset:12288
    v_cvt_pk_bf16_f32 v165, v30, v31
    v_mfma_f32_16x16x32_bf16 v[20:23], v[224:227], v[140:143], v[20:23]
    buffer_load_dwordx4 v12, s[20:23], s41 offen nt lds
    v_mfma_f32_16x16x32_bf16 v[20:23], v[220:223], v[92:95], v[20:23]
    s_add_u32 s44, s54, 0x3403000
    ds_read_b64_tr_b16 v[208:209], v239 offset:0
    ds_read_b64_tr_b16 v[210:211], v239 offset:4096
    v_mfma_f32_16x16x32_bf16 v[20:23], v[216:219], v[76:79], v[20:23]
    s_bfe_u32 s55, s2, 0x20001
    v_exp_f32 v16, v16
    v_mfma_f32_16x16x32_bf16 v[24:27], v[216:219], v[80:83], v[48:51]
    s_lshl_b32 s55, s55, 2
    ds_read_b64_tr_b16 v[212:213], v239 offset:8192
    ds_read_b64_tr_b16 v[214:215], v239 offset:12288
    v_mfma_f32_16x16x32_bf16 v[24:27], v[220:223], v[96:99], v[24:27]
    s_add_u32 s50, s44, s55
    v_exp_f32 v17, v17
    v_mfma_f32_16x16x32_bf16 v[24:27], v[224:227], v[144:147], v[24:27]
    s_add_u32 m0, s35, 0xd000
    v_cvt_pk_bf16_f32 v154, v16, v17
    v_lshlrev_b32 v7, 30, v7
    v_mfma_f32_16x16x32_bf16 v[24:27], v[228:231], v[176:179], v[24:27]
    s_add_u32 s41, s46, 20480
    v_exp_f32 v18, v18
    v_mfma_f32_16x16x32_bf16 v[28:31], v[228:231], v[180:183], v[52:55]
    buffer_load_dwordx4 v12, s[20:23], s41 offen nt lds
    v_mfma_f32_16x16x32_bf16 v[28:31], v[224:227], v[148:151], v[28:31]
    v_exp_f32 v19, v19
    v_mfma_f32_16x16x32_bf16 v[28:31], v[220:223], v[100:103], v[28:31]
    v_cvt_pk_bf16_f32 v155, v18, v19
    v_add_u32 v2, 0x10000, v1
    v_mfma_f32_16x16x32_bf16 v[28:31], v[216:219], v[84:87], v[28:31]
    s_waitcnt lgkmcnt(0)
    v_exp_f32 v20, v20
    v_mfma_f32_16x16x32_bf16 a[36:39], v[204:207], v[124:127], a[252:255]
    ds_read_b128 v[216:219], v232 offset:8192
    v_add_u32 v3, 0x20000, v1
    v_mfma_f32_16x16x32_bf16 a[36:39], v[200:203], v[108:111], a[36:39]
    v_exp_f32 v21, v21
    v_mfma_f32_16x16x32_bf16 a[40:43], v[200:203], v[112:115], a[252:255]
    ds_read_b128 v[220:223], v233 offset:8192
    v_cvt_pk_bf16_f32 v158, v20, v21
    v_mfma_f32_16x16x32_bf16 a[40:43], v[204:207], v[128:131], a[40:43]
    v_exp_f32 v22, v22
    v_mfma_f32_16x16x32_bf16 a[44:47], v[204:207], v[132:135], a[252:255]
    ds_read_b128 v[224:227], v234 offset:8192
    v_lshlrev_b32 v4, 3, v0
    v_mfma_f32_16x16x32_bf16 a[44:47], v[200:203], v[116:119], a[44:47]
    v_exp_f32 v23, v23
    v_mfma_f32_16x16x32_bf16 a[32:35], v[200:203], v[104:107], a[252:255]
    s_add_u32 m0, s35, 0xe000
    ds_read_b128 v[228:231], v235 offset:8192
    v_cvt_pk_bf16_f32 v159, v22, v23
    v_mfma_f32_16x16x32_bf16 a[32:35], v[204:207], v[120:123], a[32:35]
    s_add_u32 s41, s46, 24576
    v_exp_f32 v24, v24
    v_mfma_f32_16x16x32_bf16 a[48:51], v[212:215], v[120:123], a[252:255]
    buffer_load_dwordx4 v12, s[20:23], s41 offen nt lds
    v_mfma_f32_16x16x32_bf16 a[48:51], v[208:211], v[104:107], a[48:51]
    v_exp_f32 v25, v25
    v_mfma_f32_16x16x32_bf16 a[60:63], v[208:211], v[116:119], a[252:255]
    s_add_u32 m0, s35, 0xf000
    v_cvt_pk_bf16_f32 v162, v24, v25
    v_add_u32 v9, 0x1000, v1
    v_mfma_f32_16x16x32_bf16 a[60:63], v[212:215], v[132:135], a[60:63]
    s_add_u32 s41, s46, 28672
    v_exp_f32 v26, v26
    v_mfma_f32_16x16x32_bf16 a[56:59], v[212:215], v[128:131], a[252:255]
    buffer_load_dwordx4 v12, s[20:23], s41 offen nt lds
    v_mfma_f32_16x16x32_bf16 a[56:59], v[208:211], v[112:115], a[56:59]
    v_exp_f32 v27, v27
    v_mfma_f32_16x16x32_bf16 a[52:55], v[208:211], v[108:111], a[252:255]
    v_cvt_pk_bf16_f32 v163, v26, v27
    v_and_b32 v10, 7, v0
    v_mfma_f32_16x16x32_bf16 a[52:55], v[212:215], v[124:127], a[52:55]
    v_exp_f32 v28, v28
    v_mfma_f32_16x16x32_bf16 a[132:135], v[244:247], v[124:127], 0
    v_lshlrev_b32 v10, 2, v10
    v_mfma_f32_16x16x32_bf16 a[132:135], v[244:247], v[108:111], a[132:135]
    s_waitcnt lgkmcnt(0)
    v_exp_f32 v29, v29
    v_mfma_f32_16x16x32_bf16 v[16:19], v[216:219], v[72:75], v[40:43]
    ds_read_b64_tr_b16 v[200:201], v240 offset:0
    v_cvt_pk_bf16_f32 v166, v28, v29
    v_mfma_f32_16x16x32_bf16 v[16:19], v[220:223], v[88:91], v[16:19]
    v_exp_f32 v30, v30
    v_mfma_f32_16x16x32_bf16 v[16:19], v[224:227], v[136:139], v[16:19]
    ds_read_b64_tr_b16 v[202:203], v240 offset:4096
    ds_read_b64_tr_b16 v[204:205], v240 offset:8192
    v_mfma_f32_16x16x32_bf16 v[16:19], v[228:231], v[168:171], v[16:19]
    s_add_u32 m0, s35, 0x18000
    v_exp_f32 v31, v31
    v_mfma_f32_16x16x32_bf16 v[20:23], v[228:231], v[172:175], v[44:47]
    s_add_u32 s41, s47, 0
    ds_read_b64_tr_b16 v[206:207], v240 offset:12288
    v_cvt_pk_bf16_f32 v167, v30, v31
    v_mfma_f32_16x16x32_bf16 v[20:23], v[224:227], v[140:143], v[20:23]
    buffer_load_dwordx4 v13, s[24:27], s41 offen nt lds
    v_mfma_f32_16x16x32_bf16 v[20:23], v[220:223], v[92:95], v[20:23]
    ds_read_b64_tr_b16 v[208:209], v241 offset:0
    ds_read_b64_tr_b16 v[210:211], v241 offset:4096
    v_mfma_f32_16x16x32_bf16 v[20:23], v[216:219], v[76:79], v[20:23]
    v_exp_f32 v16, v16
    v_mfma_f32_16x16x32_bf16 v[24:27], v[216:219], v[80:83], v[48:51]
    ds_read_b64_tr_b16 v[212:213], v241 offset:8192
    ds_read_b64_tr_b16 v[214:215], v241 offset:12288
    v_mfma_f32_16x16x32_bf16 v[24:27], v[220:223], v[96:99], v[24:27]
    v_exp_f32 v17, v17
    v_mfma_f32_16x16x32_bf16 v[24:27], v[224:227], v[144:147], v[24:27]
    s_add_u32 m0, s35, 0x19000
    v_cvt_pk_bf16_f32 v184, v16, v17
    v_mfma_f32_16x16x32_bf16 v[24:27], v[228:231], v[176:179], v[24:27]
    s_add_u32 s41, s47, 4096
    v_exp_f32 v18, v18
    v_mfma_f32_16x16x32_bf16 v[28:31], v[228:231], v[180:183], v[52:55]
    buffer_load_dwordx4 v13, s[24:27], s41 offen nt lds
    v_mfma_f32_16x16x32_bf16 v[28:31], v[224:227], v[148:151], v[28:31]
    v_exp_f32 v19, v19
    v_mfma_f32_16x16x32_bf16 v[28:31], v[220:223], v[100:103], v[28:31]
    v_cvt_pk_bf16_f32 v185, v18, v19
    v_mfma_f32_16x16x32_bf16 v[28:31], v[216:219], v[84:87], v[28:31]
    s_waitcnt lgkmcnt(0)
    v_exp_f32 v20, v20
    v_mfma_f32_16x16x32_bf16 a[72:75], v[204:207], v[128:131], a[252:255]
    ds_read_b128 v[216:219], v232 offset:12288
    v_mfma_f32_16x16x32_bf16 a[72:75], v[200:203], v[112:115], a[72:75]
    v_exp_f32 v21, v21
    v_mfma_f32_16x16x32_bf16 a[76:79], v[200:203], v[116:119], a[252:255]
    ds_read_b128 v[220:223], v233 offset:12288
    v_cvt_pk_bf16_f32 v188, v20, v21
    v_mfma_f32_16x16x32_bf16 a[76:79], v[204:207], v[132:135], a[76:79]
    v_exp_f32 v22, v22
    v_mfma_f32_16x16x32_bf16 a[64:67], v[204:207], v[120:123], a[252:255]
    ds_read_b128 v[224:227], v234 offset:12288
    v_mfma_f32_16x16x32_bf16 a[64:67], v[200:203], v[104:107], a[64:67]
    v_exp_f32 v23, v23
    v_mfma_f32_16x16x32_bf16 a[68:71], v[200:203], v[108:111], a[252:255]
    s_add_u32 m0, s35, 0x1a000
    ds_read_b128 v[228:231], v235 offset:12288
    v_cvt_pk_bf16_f32 v189, v22, v23
    v_mfma_f32_16x16x32_bf16 a[68:71], v[204:207], v[124:127], a[68:71]
    s_add_u32 s41, s47, 8192
    v_exp_f32 v24, v24
    v_mfma_f32_16x16x32_bf16 a[84:87], v[212:215], v[124:127], a[252:255]
    buffer_load_dwordx4 v13, s[24:27], s41 offen nt lds
    v_mfma_f32_16x16x32_bf16 a[84:87], v[208:211], v[108:111], a[84:87]
    v_exp_f32 v25, v25
    v_mfma_f32_16x16x32_bf16 a[80:83], v[208:211], v[104:107], a[252:255]
    s_add_u32 m0, s35, 0x1b000
    v_cvt_pk_bf16_f32 v192, v24, v25
    v_mfma_f32_16x16x32_bf16 a[80:83], v[212:215], v[120:123], a[80:83]
    s_add_u32 s41, s47, 12288
    v_exp_f32 v26, v26
    v_mfma_f32_16x16x32_bf16 a[92:95], v[212:215], v[132:135], a[252:255]
    buffer_load_dwordx4 v13, s[24:27], s41 offen nt lds
    v_mfma_f32_16x16x32_bf16 a[92:95], v[208:211], v[116:119], a[92:95]
    v_exp_f32 v27, v27
    v_mfma_f32_16x16x32_bf16 a[88:91], v[208:211], v[112:115], a[252:255]
    v_cvt_pk_bf16_f32 v193, v26, v27
    v_mfma_f32_16x16x32_bf16 a[88:91], v[212:215], v[128:131], a[88:91]
    v_exp_f32 v28, v28
    v_mfma_f32_16x16x32_bf16 a[136:139], v[244:247], v[128:131], 0
    v_mfma_f32_16x16x32_bf16 a[136:139], v[244:247], v[112:115], a[136:139]
    s_waitcnt lgkmcnt(0)
    v_exp_f32 v29, v29
    v_mfma_f32_16x16x32_bf16 v[16:19], v[216:219], v[72:75], v[40:43]
    ds_read_b64_tr_b16 v[200:201], v242 offset:0
    v_cvt_pk_bf16_f32 v196, v28, v29
    v_mfma_f32_16x16x32_bf16 v[16:19], v[220:223], v[88:91], v[16:19]
    v_exp_f32 v30, v30
    v_mfma_f32_16x16x32_bf16 v[16:19], v[224:227], v[136:139], v[16:19]
    ds_read_b64_tr_b16 v[202:203], v242 offset:4096
    ds_read_b64_tr_b16 v[204:205], v242 offset:8192
    v_mfma_f32_16x16x32_bf16 v[16:19], v[228:231], v[168:171], v[16:19]
    s_add_u32 m0, s35, 0x1c000
    v_exp_f32 v31, v31
    v_mfma_f32_16x16x32_bf16 v[20:23], v[228:231], v[172:175], v[44:47]
    s_add_u32 s41, s47, 16384
    ds_read_b64_tr_b16 v[206:207], v242 offset:12288
    v_cvt_pk_bf16_f32 v197, v30, v31
    v_mfma_f32_16x16x32_bf16 v[20:23], v[224:227], v[140:143], v[20:23]
    buffer_load_dwordx4 v13, s[24:27], s41 offen nt lds
    v_mfma_f32_16x16x32_bf16 v[20:23], v[220:223], v[92:95], v[20:23]
    ds_read_b64_tr_b16 v[208:209], v243 offset:0
    ds_read_b64_tr_b16 v[210:211], v243 offset:4096
    v_mfma_f32_16x16x32_bf16 v[20:23], v[216:219], v[76:79], v[20:23]
    v_exp_f32 v16, v16
    v_mfma_f32_16x16x32_bf16 v[24:27], v[216:219], v[80:83], v[48:51]
    ds_read_b64_tr_b16 v[212:213], v243 offset:8192
    ds_read_b64_tr_b16 v[214:215], v243 offset:12288
    v_mfma_f32_16x16x32_bf16 v[24:27], v[220:223], v[96:99], v[24:27]
    v_exp_f32 v17, v17
    v_mfma_f32_16x16x32_bf16 v[24:27], v[224:227], v[144:147], v[24:27]
    s_add_u32 m0, s35, 0x1d000
    v_cvt_pk_bf16_f32 v186, v16, v17
    v_mfma_f32_16x16x32_bf16 v[24:27], v[228:231], v[176:179], v[24:27]
    s_add_u32 s41, s47, 20480
    v_exp_f32 v18, v18
    v_mfma_f32_16x16x32_bf16 v[28:31], v[228:231], v[180:183], v[52:55]
    buffer_load_dwordx4 v13, s[24:27], s41 offen nt lds
    v_mfma_f32_16x16x32_bf16 v[28:31], v[224:227], v[148:151], v[28:31]
    v_exp_f32 v19, v19
    v_mfma_f32_16x16x32_bf16 v[28:31], v[220:223], v[100:103], v[28:31]
    v_cvt_pk_bf16_f32 v187, v18, v19
    v_mfma_f32_16x16x32_bf16 v[28:31], v[216:219], v[84:87], v[28:31]
    s_waitcnt lgkmcnt(0)
    v_exp_f32 v20, v20
    v_mfma_f32_16x16x32_bf16 a[108:111], v[204:207], v[132:135], a[252:255]
    ds_read_b128 v[216:219], v232 offset:16384
    v_mfma_f32_16x16x32_bf16 a[108:111], v[200:203], v[116:119], a[108:111]
    v_exp_f32 v21, v21
    v_mfma_f32_16x16x32_bf16 a[96:99], v[200:203], v[104:107], a[252:255]
    ds_read_b128 v[220:223], v233 offset:16384
    v_cvt_pk_bf16_f32 v190, v20, v21
    v_mfma_f32_16x16x32_bf16 a[96:99], v[204:207], v[120:123], a[96:99]
    v_exp_f32 v22, v22
    v_mfma_f32_16x16x32_bf16 a[100:103], v[204:207], v[124:127], a[252:255]
    ds_read_b128 v[224:227], v234 offset:16384
    v_mfma_f32_16x16x32_bf16 a[100:103], v[200:203], v[108:111], a[100:103]
    v_exp_f32 v23, v23
    v_mfma_f32_16x16x32_bf16 a[104:107], v[200:203], v[112:115], a[252:255]
    s_add_u32 m0, s35, 0x1e000
    ds_read_b128 v[228:231], v235 offset:16384
    v_cvt_pk_bf16_f32 v191, v22, v23
    v_mfma_f32_16x16x32_bf16 a[104:107], v[204:207], v[128:131], a[104:107]
    s_add_u32 s41, s47, 24576
    v_exp_f32 v24, v24
    v_mfma_f32_16x16x32_bf16 a[120:123], v[212:215], v[128:131], a[252:255]
    buffer_load_dwordx4 v13, s[24:27], s41 offen nt lds
    v_mfma_f32_16x16x32_bf16 a[120:123], v[208:211], v[112:115], a[120:123]
    v_exp_f32 v25, v25
    v_mfma_f32_16x16x32_bf16 a[116:119], v[208:211], v[108:111], a[252:255]
    s_add_u32 m0, s35, 0x1f000
    v_cvt_pk_bf16_f32 v194, v24, v25
    v_mfma_f32_16x16x32_bf16 a[116:119], v[212:215], v[124:127], a[116:119]
    s_add_u32 s41, s47, 28672
    v_exp_f32 v26, v26
    v_mfma_f32_16x16x32_bf16 a[112:115], v[212:215], v[120:123], a[252:255]
    buffer_load_dwordx4 v13, s[24:27], s41 offen nt lds
    v_mfma_f32_16x16x32_bf16 a[112:115], v[208:211], v[104:107], a[112:115]
    s_add_u32 s46, s46, 32768
    v_exp_f32 v27, v27
    v_mfma_f32_16x16x32_bf16 a[124:127], v[208:211], v[116:119], a[252:255]
    s_add_u32 s47, s47, 32768
    v_cvt_pk_bf16_f32 v195, v26, v27
    v_mfma_f32_16x16x32_bf16 a[124:127], v[212:215], v[132:135], a[124:127]
    v_exp_f32 v28, v28
    v_mfma_f32_16x16x32_bf16 a[140:143], v[244:247], v[132:135], 0
    v_mfma_f32_16x16x32_bf16 a[140:143], v[244:247], v[116:119], a[140:143]
    s_waitcnt lgkmcnt(0)
    v_exp_f32 v29, v29
    s_mov_b32 s48, 7
L_k2_loopa:
    v_mfma_f32_16x16x32_bf16 v[16:19], v[216:219], v[72:75], v[40:43]
    s_mul_i32 s55, s42, 7282
    ds_read_b64_tr_b16 v[200:201], v236 offset:16384
    v_cvt_pk_bf16_f32 v198, v28, v29
    v_mfma_f32_16x16x32_bf16 v[16:19], v[220:223], v[88:91], v[16:19]
    s_lshr_b32 s55, s55, 16
    v_exp_f32 v30, v30
    v_mfma_f32_16x16x32_bf16 v[16:19], v[224:227], v[136:139], v[16:19]
    s_lshl_b32 s57, s42, 12
    ds_read_b64_tr_b16 v[202:203], v236 offset:20480
    ds_read_b64_tr_b16 v[204:205], v236 offset:24576
    v_mfma_f32_16x16x32_bf16 v[16:19], v[228:231], v[168:171], v[16:19]
    s_mul_i32 s56, s55, 9
    v_exp_f32 v31, v31
    v_mfma_f32_16x16x32_bf16 v[20:23], v[228:231], v[172:175], v[44:47]
    s_sub_u32 s54, s42, s56
    ds_read_b64_tr_b16 v[206:207], v236 offset:28672
    v_cvt_pk_bf16_f32 v199, v30, v31
    v_mfma_f32_16x16x32_bf16 v[20:23], v[224:227], v[140:143], v[20:23]
    s_lshl_b32 s54, s54, 7
    v_mfma_f32_16x16x32_bf16 v[20:23], v[220:223], v[92:95], v[20:23]
    ds_read_b64_tr_b16 v[208:209], v237 offset:16384
    ds_read_b64_tr_b16 v[210:211], v237 offset:20480
    v_mfma_f32_16x16x32_bf16 v[20:23], v[216:219], v[76:79], v[20:23]
    v_exp_f32 v16, v16
    v_mfma_f32_16x16x32_bf16 v[24:27], v[216:219], v[80:83], v[48:51]
    ds_read_b64_tr_b16 v[212:213], v237 offset:24576
    ds_read_b64_tr_b16 v[214:215], v237 offset:28672
    v_mfma_f32_16x16x32_bf16 v[24:27], v[220:223], v[96:99], v[24:27]
    v_exp_f32 v17, v17
    v_mfma_f32_16x16x32_bf16 v[24:27], v[224:227], v[144:147], v[24:27]
    v_cvt_pk_bf16_f32 v104, v16, v17
    v_mfma_f32_16x16x32_bf16 v[24:27], v[228:231], v[176:179], v[24:27]
    v_exp_f32 v18, v18
    v_mfma_f32_16x16x32_bf16 v[28:31], v[228:231], v[180:183], v[52:55]
    s_cmp_lt_u32 s55, 144
    s_cselect_b32 s8, s76, s70
    s_cselect_b32 s9, s77, s71
    v_mfma_f32_16x16x32_bf16 v[28:31], v[224:227], v[148:151], v[28:31]
    v_exp_f32 v19, v19
    v_mfma_f32_16x16x32_bf16 v[28:31], v[220:223], v[100:103], v[28:31]
    v_cvt_pk_bf16_f32 v105, v18, v19
    v_mfma_f32_16x16x32_bf16 v[28:31], v[216:219], v[84:87], v[28:31]
    s_waitcnt lgkmcnt(0)
    v_exp_f32 v20, v20
    v_mfma_f32_16x16x32_bf16 a[0:3], v[204:207], v[184:187], a[0:3]
    ds_read_b128 v[216:219], v232 offset:20480
    v_mfma_f32_16x16x32_bf16 a[0:3], v[200:203], v[152:155], a[0:3]
    v_exp_f32 v21, v21
    v_mfma_f32_16x16x32_bf16 a[4:7], v[200:203], v[156:159], a[4:7]
    ds_read_b128 v[220:223], v233 offset:20480
    v_cvt_pk_bf16_f32 v108, v20, v21
    v_mfma_f32_16x16x32_bf16 a[4:7], v[204:207], v[188:191], a[4:7]
    v_exp_f32 v22, v22
    v_mfma_f32_16x16x32_bf16 a[8:11], v[204:207], v[192:195], a[8:11]
    ds_read_b128 v[224:227], v234 offset:20480
    v_mfma_f32_16x16x32_bf16 a[8:11], v[200:203], v[160:163], a[8:11]
    v_exp_f32 v23, v23
    v_mfma_f32_16x16x32_bf16 a[12:15], v[200:203], v[164:167], a[12:15]
    ds_read_b128 v[228:231], v235 offset:20480
    v_cvt_pk_bf16_f32 v109, v22, v23
    v_mfma_f32_16x16x32_bf16 a[12:15], v[204:207], v[196:199], a[12:15]
    v_exp_f32 v24, v24
    v_mfma_f32_16x16x32_bf16 a[28:31], v[212:215], v[196:199], a[28:31]
    s_cmp_lt_u32 s55, 144
    s_cselect_b32 s56, 0, 144
    s_cselect_b32 s10, 9, 8
    v_mfma_f32_16x16x32_bf16 a[28:31], v[208:211], v[164:167], a[28:31]
    s_mul_i32 s10, s10, 589824
    v_exp_f32 v25, v25
    v_mfma_f32_16x16x32_bf16 a[24:27], v[208:211], v[160:163], a[24:27]
    s_and_b32 s9, s9, 0xffff
    v_cvt_pk_bf16_f32 v112, v24, v25
    v_mfma_f32_16x16x32_bf16 a[24:27], v[212:215], v[192:195], a[24:27]
    s_sub_u32 s55, s55, s56
    v_exp_f32 v26, v26
    v_mfma_f32_16x16x32_bf16 a[20:23], v[212:215], v[188:191], a[20:23]
    s_mul_i32 s55, s55, 36864
    v_mfma_f32_16x16x32_bf16 a[20:23], v[208:211], v[156:159], a[20:23]
    s_add_u32 s56, s55, s54
    v_exp_f32 v27, v27
    v_mfma_f32_16x16x32_bf16 a[16:19], v[208:211], v[152:155], a[16:19]
    s_add_u32 s42, s42, 1024
    v_cvt_pk_bf16_f32 v113, v26, v27
    v_mfma_f32_16x16x32_bf16 a[16:19], v[212:215], v[184:187], a[16:19]
    v_exp_f32 v28, v28
    v_mfma_f32_16x16x32_bf16 a[128:131], v[244:247], v[184:187], a[128:131]
    v_mfma_f32_16x16x32_bf16 a[128:131], v[244:247], v[152:155], a[128:131]
    s_waitcnt lgkmcnt(0)
    v_exp_f32 v29, v29
    v_mfma_f32_16x16x32_bf16 v[16:19], v[216:219], v[72:75], v[40:43]
    ds_read_b64_tr_b16 v[200:201], v238 offset:16384
    v_cvt_pk_bf16_f32 v116, v28, v29
    v_mfma_f32_16x16x32_bf16 v[16:19], v[220:223], v[88:91], v[16:19]
    v_exp_f32 v30, v30
    v_mfma_f32_16x16x32_bf16 v[16:19], v[224:227], v[136:139], v[16:19]
    ds_read_b64_tr_b16 v[202:203], v238 offset:20480
    ds_read_b64_tr_b16 v[204:205], v238 offset:24576
    v_mfma_f32_16x16x32_bf16 v[16:19], v[228:231], v[168:171], v[16:19]
    v_exp_f32 v31, v31
    v_mfma_f32_16x16x32_bf16 v[20:23], v[228:231], v[172:175], v[44:47]
    ds_read_b64_tr_b16 v[206:207], v238 offset:28672
    v_cvt_pk_bf16_f32 v117, v30, v31
    v_mfma_f32_16x16x32_bf16 v[20:23], v[224:227], v[140:143], v[20:23]
    v_mfma_f32_16x16x32_bf16 v[20:23], v[220:223], v[92:95], v[20:23]
    ds_read_b64_tr_b16 v[208:209], v239 offset:16384
    ds_read_b64_tr_b16 v[210:211], v239 offset:20480
    v_mfma_f32_16x16x32_bf16 v[20:23], v[216:219], v[76:79], v[20:23]
    v_exp_f32 v16, v16
    v_mfma_f32_16x16x32_bf16 v[24:27], v[216:219], v[80:83], v[48:51]
    ds_read_b64_tr_b16 v[212:213], v239 offset:24576
    ds_read_b64_tr_b16 v[214:215], v239 offset:28672
    v_mfma_f32_16x16x32_bf16 v[24:27], v[220:223], v[96:99], v[24:27]
    v_exp_f32 v17, v17
    v_mfma_f32_16x16x32_bf16 v[24:27], v[224:227], v[144:147], v[24:27]
    s_add_u32 m0, s58, 0x0
    v_cvt_pk_bf16_f32 v106, v16, v17
    v_mfma_f32_16x16x32_bf16 v[24:27], v[228:231], v[176:179], v[24:27]
    s_add_u32 s41, s56, 0x0
    v_exp_f32 v18, v18
    v_mfma_f32_16x16x32_bf16 v[28:31], v[228:231], v[180:183], v[52:55]
    buffer_load_dwordx4 v14, s[8:11], s41 offen nt lds
    v_mfma_f32_16x16x32_bf16 v[28:31], v[224:227], v[148:151], v[28:31]
    v_exp_f32 v19, v19
    v_mfma_f32_16x16x32_bf16 v[28:31], v[220:223], v[100:103], v[28:31]
    v_cvt_pk_bf16_f32 v107, v18, v19
    v_mfma_f32_16x16x32_bf16 v[28:31], v[216:219], v[84:87], v[28:31]
    s_waitcnt lgkmcnt(0)
    v_exp_f32 v20, v20
    v_mfma_f32_16x16x32_bf16 a[36:39], v[204:207], v[188:191], a[36:39]
    ds_read_b128 v[216:219], v232 offset:24576
    v_mfma_f32_16x16x32_bf16 a[36:39], v[200:203], v[156:159], a[36:39]
    v_exp_f32 v21, v21
    v_mfma_f32_16x16x32_bf16 a[40:43], v[200:203], v[160:163], a[40:43]
    ds_read_b128 v[220:223], v233 offset:24576
    v_cvt_pk_bf16_f32 v110, v20, v21
    v_mfma_f32_16x16x32_bf16 a[40:43], v[204:207], v[192:195], a[40:43]
L_hop0_10:
    s_cbranch_execz L_hop0_ret
    v_exp_f32 v22, v22
    v_mfma_f32_16x16x32_bf16 a[44:47], v[204:207], v[196:199], a[44:47]
    ds_read_b128 v[224:227], v234 offset:24576
    v_mfma_f32_16x16x32_bf16 a[44:47], v[200:203], v[164:167], a[44:47]
    v_exp_f32 v23, v23
    v_mfma_f32_16x16x32_bf16 a[32:35], v[200:203], v[152:155], a[32:35]
    s_add_u32 m0, s58, 0x400
    ds_read_b128 v[228:231], v235 offset:24576
    v_cvt_pk_bf16_f32 v111, v22, v23
    v_mfma_f32_16x16x32_bf16 a[32:35], v[204:207], v[184:187], a[32:35]
    s_add_u32 s41, s56, 0x2400
    v_exp_f32 v24, v24
    v_mfma_f32_16x16x32_bf16 a[48:51], v[212:215], v[184:187], a[48:51]
    buffer_load_dwordx4 v14, s[8:11], s41 offen nt lds
    v_mfma_f32_16x16x32_bf16 a[48:51], v[208:211], v[152:155], a[48:51]
    v_exp_f32 v25, v25
    v_mfma_f32_16x16x32_bf16 a[60:63], v[208:211], v[164:167], a[60:63]
    s_add_u32 m0, s58, 0x800
    v_cvt_pk_bf16_f32 v114, v24, v25
    v_mfma_f32_16x16x32_bf16 a[60:63], v[212:215], v[196:199], a[60:63]
    s_add_u32 s41, s56, 0x4800
    v_exp_f32 v26, v26
    v_mfma_f32_16x16x32_bf16 a[56:59], v[212:215], v[192:195], a[56:59]
    buffer_load_dwordx4 v14, s[8:11], s41 offen nt lds
    v_mfma_f32_16x16x32_bf16 a[56:59], v[208:211], v[160:163], a[56:59]
    v_exp_f32 v27, v27
    v_mfma_f32_16x16x32_bf16 a[52:55], v[208:211], v[156:159], a[52:55]
    s_add_u32 m0, s58, 0xc00
    v_cvt_pk_bf16_f32 v115, v26, v27
    v_mfma_f32_16x16x32_bf16 a[52:55], v[212:215], v[188:191], a[52:55]
    s_add_u32 s41, s56, 0x6c00
    v_exp_f32 v28, v28
    v_mfma_f32_16x16x32_bf16 a[132:135], v[244:247], v[188:191], a[132:135]
    buffer_load_dwordx4 v14, s[8:11], s41 offen nt lds
    v_mfma_f32_16x16x32_bf16 a[132:135], v[244:247], v[156:159], a[132:135]
    s_waitcnt lgkmcnt(0)
    v_exp_f32 v29, v29
    v_mfma_f32_16x16x32_bf16 v[16:19], v[216:219], v[72:75], v[40:43]
    ds_read_b64_tr_b16 v[200:201], v240 offset:16384
    v_cvt_pk_bf16_f32 v118, v28, v29
    v_mfma_f32_16x16x32_bf16 v[16:19], v[220:223], v[88:91], v[16:19]
    v_exp_f32 v30, v30
    v_mfma_f32_16x16x32_bf16 v[16:19], v[224:227], v[136:139], v[16:19]
    ds_read_b64_tr_b16 v[202:203], v240 offset:20480
    ds_read_b64_tr_b16 v[204:205], v240 offset:24576
    v_mfma_f32_16x16x32_bf16 v[16:19], v[228:231], v[168:171], v[16:19]
    v_exp_f32 v31, v31
    v_mfma_f32_16x16x32_bf16 v[20:23], v[228:231], v[172:175], v[44:47]
    ds_read_b64_tr_b16 v[206:207], v240 offset:28672
    v_cvt_pk_bf16_f32 v119, v30, v31
    v_mfma_f32_16x16x32_bf16 v[20:23], v[224:227], v[140:143], v[20:23]
    v_mfma_f32_16x16x32_bf16 v[20:23], v[220:223], v[92:95], v[20:23]
    ds_read_b64_tr_b16 v[208:209], v241 offset:16384
    ds_read_b64_tr_b16 v[210:211], v241 offset:20480
    v_mfma_f32_16x16x32_bf16 v[20:23], v[216:219], v[76:79], v[20:23]
    v_exp_f32 v16, v16
    v_mfma_f32_16x16x32_bf16 v[24:27], v[216:219], v[80:83], v[48:51]
    ds_read_b64_tr_b16 v[212:213], v241 offset:24576
    ds_read_b64_tr_b16 v[214:215], v241 offset:28672
    v_mfma_f32_16x16x32_bf16 v[24:27], v[220:223], v[96:99], v[24:27]
    v_exp_f32 v17, v17
    v_mfma_f32_16x16x32_bf16 v[24:27], v[224:227], v[144:147], v[24:27]
    v_cvt_pk_bf16_f32 v120, v16, v17
    v_mfma_f32_16x16x32_bf16 v[24:27], v[228:231], v[176:179], v[24:27]
    v_exp_f32 v18, v18
    v_mfma_f32_16x16x32_bf16 v[28:31], v[228:231], v[180:183], v[52:55]
    buffer_store_dwordx4 v[36:39], v1, s[4:7], s59 offen offset:1024 sc1
    v_mfma_f32_16x16x32_bf16 v[28:31], v[224:227], v[148:151], v[28:31]
    v_exp_f32 v19, v19
    v_mfma_f32_16x16x32_bf16 v[28:31], v[220:223], v[100:103], v[28:31]
    v_cvt_pk_bf16_f32 v121, v18, v19
    v_mfma_f32_16x16x32_bf16 v[28:31], v[216:219], v[84:87], v[28:31]
    s_waitcnt lgkmcnt(0)
    v_exp_f32 v20, v20
    v_mfma_f32_16x16x32_bf16 a[72:75], v[204:207], v[192:195], a[72:75]
    ds_read_b128 v[216:219], v232 offset:28672
    v_mfma_f32_16x16x32_bf16 a[72:75], v[200:203], v[160:163], a[72:75]
    v_exp_f32 v21, v21
    v_mfma_f32_16x16x32_bf16 a[76:79], v[200:203], v[164:167], a[76:79]
    ds_read_b128 v[220:223], v233 offset:28672
    v_cvt_pk_bf16_f32 v124, v20, v21
    v_mfma_f32_16x16x32_bf16 a[76:79], v[204:207], v[196:199], a[76:79]
    v_exp_f32 v22, v22
    v_mfma_f32_16x16x32_bf16 a[64:67], v[204:207], v[184:187], a[64:67]
    ds_read_b128 v[224:227], v234 offset:28672
    v_mfma_f32_16x16x32_bf16 a[64:67], v[200:203], v[152:155], a[64:67]
    v_exp_f32 v23, v23
    v_mfma_f32_16x16x32_bf16 a[68:71], v[200:203], v[156:159], a[68:71]
    ds_read_b128 v[228:231], v235 offset:28672
    v_cvt_pk_bf16_f32 v125, v22, v23
    v_mfma_f32_16x16x32_bf16 a[68:71], v[204:207], v[188:191], a[68:71]
    v_exp_f32 v24, v24
    v_mfma_f32_16x16x32_bf16 a[84:87], v[212:215], v[188:191], a[84:87]
    v_mfma_f32_16x16x32_bf16 a[84:87], v[208:211], v[156:159], a[84:87]
    v_exp_f32 v25, v25
    v_mfma_f32_16x16x32_bf16 a[80:83], v[208:211], v[152:155], a[80:83]
    v_cvt_pk_bf16_f32 v128, v24, v25
    v_mfma_f32_16x16x32_bf16 a[80:83], v[212:215], v[184:187], a[80:83]
    v_exp_f32 v26, v26
    v_mfma_f32_16x16x32_bf16 a[92:95], v[212:215], v[196:199], a[92:95]
    buffer_store_dwordx4 v[36:39], v1, s[4:7], s59 offen offset:3072 sc1
    v_mfma_f32_16x16x32_bf16 a[92:95], v[208:211], v[164:167], a[92:95]
    v_exp_f32 v27, v27
    v_mfma_f32_16x16x32_bf16 a[88:91], v[208:211], v[160:163], a[88:91]
    v_cvt_pk_bf16_f32 v129, v26, v27
    v_mfma_f32_16x16x32_bf16 a[88:91], v[212:215], v[192:195], a[88:91]
    v_exp_f32 v28, v28
    v_mfma_f32_16x16x32_bf16 a[136:139], v[244:247], v[192:195], a[136:139]
    v_mfma_f32_16x16x32_bf16 a[136:139], v[244:247], v[160:163], a[136:139]
    s_waitcnt lgkmcnt(0)
    v_exp_f32 v29, v29
    v_mfma_f32_16x16x32_bf16 v[16:19], v[216:219], v[72:75], v[40:43]
    ds_read_b64_tr_b16 v[200:201], v242 offset:16384
    v_cvt_pk_bf16_f32 v132, v28, v29
    v_mfma_f32_16x16x32_bf16 v[16:19], v[220:223], v[88:91], v[16:19]
    v_exp_f32 v30, v30
    v_mfma_f32_16x16x32_bf16 v[16:19], v[224:227], v[136:139], v[16:19]
    ds_read_b64_tr_b16 v[202:203], v242 offset:20480
    ds_read_b64_tr_b16 v[204:205], v242 offset:24576
    v_mfma_f32_16x16x32_bf16 v[16:19], v[228:231], v[168:171], v[16:19]
    v_exp_f32 v31, v31
    v_mfma_f32_16x16x32_bf16 v[20:23], v[228:231], v[172:175], v[44:47]
    ds_read_b64_tr_b16 v[206:207], v242 offset:28672
    v_cvt_pk_bf16_f32 v133, v30, v31
    v_mfma_f32_16x16x32_bf16 v[20:23], v[224:227], v[140:143], v[20:23]
    v_mfma_f32_16x16x32_bf16 v[20:23], v[220:223], v[92:95], v[20:23]
    ds_read_b64_tr_b16 v[208:209], v243 offset:16384
    ds_read_b64_tr_b16 v[210:211], v243 offset:20480
    v_mfma_f32_16x16x32_bf16 v[20:23], v[216:219], v[76:79], v[20:23]
    v_exp_f32 v16, v16
    v_mfma_f32_16x16x32_bf16 v[24:27], v[216:219], v[80:83], v[48:51]
    ds_read_b64_tr_b16 v[212:213], v243 offset:24576
    ds_read_b64_tr_b16 v[214:215], v243 offset:28672
    v_mfma_f32_16x16x32_bf16 v[24:27], v[220:223], v[96:99], v[24:27]
    v_exp_f32 v17, v17
    v_mfma_f32_16x16x32_bf16 v[24:27], v[224:227], v[144:147], v[24:27]
    v_cvt_pk_bf16_f32 v122, v16, v17
    v_mfma_f32_16x16x32_bf16 v[24:27], v[228:231], v[176:179], v[24:27]
    v_exp_f32 v18, v18
    v_mfma_f32_16x16x32_bf16 v[28:31], v[228:231], v[180:183], v[52:55]
    buffer_store_dwordx4 v[36:39], v9, s[4:7], s59 offen offset:1024 sc1
    v_mfma_f32_16x16x32_bf16 v[28:31], v[224:227], v[148:151], v[28:31]
    s_add_u32 s59, s59, 6144
    v_exp_f32 v19, v19
    v_mfma_f32_16x16x32_bf16 v[28:31], v[220:223], v[100:103], v[28:31]
    v_cvt_pk_bf16_f32 v123, v18, v19
    v_mfma_f32_16x16x32_bf16 v[28:31], v[216:219], v[84:87], v[28:31]
    s_waitcnt vmcnt(7) lgkmcnt(0)
    s_barrier
    v_exp_f32 v20, v20
    v_mfma_f32_16x16x32_bf16 a[108:111], v[204:207], v[196:199], a[108:111]
    ds_read_b128 v[216:219], v232 offset:32768
    v_mfma_f32_16x16x32_bf16 a[108:111], v[200:203], v[164:167], a[108:111]
    v_exp_f32 v21, v21
    v_mfma_f32_16x16x32_bf16 a[96:99], v[200:203], v[152:155], a[96:99]
    ds_read_b128 v[220:223], v233 offset:32768
    v_cvt_pk_bf16_f32 v126, v20, v21
    v_mfma_f32_16x16x32_bf16 a[96:99], v[204:207], v[184:187], a[96:99]
    v_exp_f32 v22, v22
    v_mfma_f32_16x16x32_bf16 a[100:103], v[204:207], v[188:191], a[100:103]
    ds_read_b128 v[224:227], v234 offset:32768
    v_mfma_f32_16x16x32_bf16 a[100:103], v[200:203], v[156:159], a[100:103]
    v_exp_f32 v23, v23
    v_mfma_f32_16x16x32_bf16 a[104:107], v[200:203], v[160:163], a[104:107]
    ds_read_b128 v[228:231], v235 offset:32768
    v_cvt_pk_bf16_f32 v127, v22, v23
    v_mfma_f32_16x16x32_bf16 a[104:107], v[204:207], v[192:195], a[104:107]
    v_exp_f32 v24, v24
    v_mfma_f32_16x16x32_bf16 a[120:123], v[212:215], v[192:195], a[120:123]
    v_mfma_f32_16x16x32_bf16 a[120:123], v[208:211], v[160:163], a[120:123]
    v_exp_f32 v25, v25
    v_mfma_f32_16x16x32_bf16 a[116:119], v[208:211], v[156:159], a[116:119]
    v_cvt_pk_bf16_f32 v130, v24, v25
    v_mfma_f32_16x16x32_bf16 a[116:119], v[212:215], v[188:191], a[116:119]
    v_exp_f32 v26, v26
    v_mfma_f32_16x16x32_bf16 a[112:115], v[212:215], v[184:187], a[112:115]
    v_mfma_f32_16x16x32_bf16 a[112:115], v[208:211], v[152:155], a[112:115]
    v_exp_f32 v27, v27
    v_mfma_f32_16x16x32_bf16 a[124:127], v[208:211], v[164:167], a[124:127]
    v_cvt_pk_bf16_f32 v131, v26, v27
    v_mfma_f32_16x16x32_bf16 a[124:127], v[212:215], v[196:199], a[124:127]
    v_exp_f32 v28, v28
    v_mfma_f32_16x16x32_bf16 a[140:143], v[244:247], v[196:199], a[140:143]
    v_mfma_f32_16x16x32_bf16 a[140:143], v[244:247], v[164:167], a[140:143]
    s_waitcnt lgkmcnt(0)
    v_exp_f32 v29, v29
    v_mfma_f32_16x16x32_bf16 v[16:19], v[216:219], v[72:75], v[40:43]
    ds_read_b64_tr_b16 v[200:201], v236 offset:32768
    v_cvt_pk_bf16_f32 v134, v28, v29
    v_mfma_f32_16x16x32_bf16 v[16:19], v[220:223], v[88:91], v[16:19]
    v_exp_f32 v30, v30
    v_mfma_f32_16x16x32_bf16 v[16:19], v[224:227], v[136:139], v[16:19]
    ds_read_b64_tr_b16 v[202:203], v236 offset:36864
    ds_read_b64_tr_b16 v[204:205], v236 offset:40960
    v_mfma_f32_16x16x32_bf16 v[16:19], v[228:231], v[168:171], v[16:19]
    s_add_u32 m0, s35, 0x0
    v_exp_f32 v31, v31
    v_mfma_f32_16x16x32_bf16 v[20:23], v[228:231], v[172:175], v[44:47]
    s_add_u32 s41, s46, 0
    ds_read_b64_tr_b16 v[206:207], v236 offset:45056
    v_cvt_pk_bf16_f32 v135, v30, v31
    v_mfma_f32_16x16x32_bf16 v[20:23], v[224:227], v[140:143], v[20:23]
    buffer_load_dwordx4 v12, s[20:23], s41 offen nt lds
    v_mfma_f32_16x16x32_bf16 v[20:23], v[220:223], v[92:95], v[20:23]
    ds_read_b64_tr_b16 v[208:209], v237 offset:32768
    ds_read_b64_tr_b16 v[210:211], v237 offset:36864
    v_mfma_f32_16x16x32_bf16 v[20:23], v[216:219], v[76:79], v[20:23]
    v_exp_f32 v16, v16
    v_mfma_f32_16x16x32_bf16 v[24:27], v[216:219], v[80:83], v[48:51]
    ds_read_b64_tr_b16 v[212:213], v237 offset:40960
    ds_read_b64_tr_b16 v[214:215], v237 offset:45056
    v_mfma_f32_16x16x32_bf16 v[24:27], v[220:223], v[96:99], v[24:27]
    v_exp_f32 v17, v17
    v_mfma_f32_16x16x32_bf16 v[24:27], v[224:227], v[144:147], v[24:27]
    s_add_u32 m0, s35, 0x1000
    v_cvt_pk_bf16_f32 v152, v16, v17
    v_mfma_f32_16x16x32_bf16 v[24:27], v[228:231], v[176:179], v[24:27]
    s_add_u32 s41, s46, 4096
    v_exp_f32 v18, v18
    v_mfma_f32_16x16x32_bf16 v[28:31], v[228:231], v[180:183], v[52:55]
    buffer_load_dwordx4 v12, s[20:23], s41 offen nt lds
    v_mfma_f32_16x16x32_bf16 v[28:31], v[224:227], v[148:151], v[28:31]
    v_exp_f32 v19, v19
    v_mfma_f32_16x16x32_bf16 v[28:31], v[220:223], v[100:103], v[28:31]
    v_cvt_pk_bf16_f32 v153, v18, v19
    v_mfma_f32_16x16x32_bf16 v[28:31], v[216:219], v[84:87], v[28:31]
    s_waitcnt lgkmcnt(0)
    v_exp_f32 v20, v20
    v_mfma_f32_16x16x32_bf16 a[0:3], v[204:207], v[120:123], a[0:3]
    ds_read_b128 v[216:219], v232 offset:36864
    v_mfma_f32_16x16x32_bf16 a[0:3], v[200:203], v[104:107], a[0:3]
    v_exp_f32 v21, v21
    v_mfma_f32_16x16x32_bf16 a[4:7], v[200:203], v[108:111], a[4:7]
    ds_read_b128 v[220:223], v233 offset:36864
    v_cvt_pk_bf16_f32 v156, v20, v21
    v_mfma_f32_16x16x32_bf16 a[4:7], v[204:207], v[124:127], a[4:7]
    v_exp_f32 v22, v22
    v_mfma_f32_16x16x32_bf16 a[8:11], v[204:207], v[128:131], a[8:11]
    ds_read_b128 v[224:227], v234 offset:36864
    v_mfma_f32_16x16x32_bf16 a[8:11], v[200:203], v[112:115], a[8:11]
    v_exp_f32 v23, v23
    v_mfma_f32_16x16x32_bf16 a[12:15], v[200:203], v[116:119], a[12:15]
    s_add_u32 m0, s35, 0x2000
    ds_read_b128 v[228:231], v235 offset:36864
    v_cvt_pk_bf16_f32 v157, v22, v23
    v_mfma_f32_16x16x32_bf16 a[12:15], v[204:207], v[132:135], a[12:15]
    s_add_u32 s41, s46, 8192
    v_exp_f32 v24, v24
    v_mfma_f32_16x16x32_bf16 a[28:31], v[212:215], v[132:135], a[28:31]
    buffer_load_dwordx4 v12, s[20:23], s41 offen nt lds
    v_mfma_f32_16x16x32_bf16 a[28:31], v[208:211], v[116:119], a[28:31]
    v_exp_f32 v25, v25
    v_mfma_f32_16x16x32_bf16 a[24:27], v[208:211], v[112:115], a[24:27]
    s_add_u32 m0, s35, 0x3000
    v_cvt_pk_bf16_f32 v160, v24, v25
    v_mfma_f32_16x16x32_bf16 a[24:27], v[212:215], v[128:131], a[24:27]
    s_add_u32 s41, s46, 12288
    v_exp_f32 v26, v26
    v_mfma_f32_16x16x32_bf16 a[20:23], v[212:215], v[124:127], a[20:23]
    buffer_load_dwordx4 v12, s[20:23], s41 offen nt lds
    v_mfma_f32_16x16x32_bf16 a[20:23], v[208:211], v[108:111], a[20:23]
    v_exp_f32 v27, v27
    v_mfma_f32_16x16x32_bf16 a[16:19], v[208:211], v[104:107], a[16:19]
    v_cvt_pk_bf16_f32 v161, v26, v27
    v_mfma_f32_16x16x32_bf16 a[16:19], v[212:215], v[120:123], a[16:19]
    v_exp_f32 v28, v28
    v_mfma_f32_16x16x32_bf16 a[128:131], v[244:247], v[120:123], a[128:131]
    v_mfma_f32_16x16x32_bf16 a[128:131], v[244:247], v[104:107], a[128:131]
    s_waitcnt lgkmcnt(0)
    v_exp_f32 v29, v29
    v_mfma_f32_16x16x32_bf16 v[16:19], v[216:219], v[72:75], v[40:43]
    ds_read_b64_tr_b16 v[200:201], v238 offset:32768
    v_cvt_pk_bf16_f32 v164, v28, v29
    v_mfma_f32_16x16x32_bf16 v[16:19], v[220:223], v[88:91], v[16:19]
    v_exp_f32 v30, v30
    v_mfma_f32_16x16x32_bf16 v[16:19], v[224:227], v[136:139], v[16:19]
    ds_read_b64_tr_b16 v[202:203], v238 offset:36864
    ds_read_b64_tr_b16 v[204:205], v238 offset:40960
    v_mfma_f32_16x16x32_bf16 v[16:19], v[228:231], v[168:171], v[16:19]
    s_add_u32 m0, s35, 0x4000
    v_exp_f32 v31, v31
    v_mfma_f32_16x16x32_bf16 v[20:23], v[228:231], v[172:175], v[44:47]
    s_add_u32 s41, s46, 16384
    ds_read_b64_tr_b16 v[206:207], v238 offset:45056
    v_cvt_pk_bf16_f32 v165, v30, v31
    v_mfma_f32_16x16x32_bf16 v[20:23], v[224:227], v[140:143], v[20:23]
    buffer_load_dwordx4 v12, s[20:23], s41 offen nt lds
    v_mfma_f32_16x16x32_bf16 v[20:23], v[220:223], v[92:95], v[20:23]
    ds_read_b64_tr_b16 v[208:209], v239 offset:32768
    ds_read_b64_tr_b16 v[210:211], v239 offset:36864
    v_mfma_f32_16x16x32_bf16 v[20:23], v[216:219], v[76:79], v[20:23]
    v_exp_f32 v16, v16
    v_mfma_f32_16x16x32_bf16 v[24:27], v[216:219], v[80:83], v[48:51]
    ds_read_b64_tr_b16 v[212:213], v239 offset:40960
    ds_read_b64_tr_b16 v[214:215], v239 offset:45056
    v_mfma_f32_16x16x32_bf16 v[24:27], v[220:223], v[96:99], v[24:27]
    v_exp_f32 v17, v17
    v_mfma_f32_16x16x32_bf16 v[24:27], v[224:227], v[144:147], v[24:27]
    s_add_u32 m0, s35, 0x5000
    v_cvt_pk_bf16_f32 v154, v16, v17
    v_mfma_f32_16x16x32_bf16 v[24:27], v[228:231], v[176:179], v[24:27]
    s_add_u32 s41, s46, 20480
    v_exp_f32 v18, v18
    v_mfma_f32_16x16x32_bf16 v[28:31], v[228:231], v[180:183], v[52:55]
    buffer_load_dwordx4 v12, s[20:23], s41 offen nt lds
    v_mfma_f32_16x16x32_bf16 v[28:31], v[224:227], v[148:151], v[28:31]
    v_exp_f32 v19, v19
    v_mfma_f32_16x16x32_bf16 v[28:31], v[220:223], v[100:103], v[28:31]
    v_cvt_pk_bf16_f32 v155, v18, v19
    v_mfma_f32_16x16x32_bf16 v[28:31], v[216:219], v[84:87], v[28:31]
    s_waitcnt lgkmcnt(0)
    v_exp_f32 v20, v20
    v_mfma_f32_16x16x32_bf16 a[36:39], v[204:207], v[124:127], a[36:39]
    ds_read_b128 v[216:219], v232 offset:40960
    v_mfma_f32_16x16x32_bf16 a[36:39], v[200:203], v[108:111], a[36:39]
    v_exp_f32 v21, v21
    v_mfma_f32_16x16x32_bf16 a[40:43], v[200:203], v[112:115], a[40:43]
    ds_read_b128 v[220:223], v233 offset:40960
    v_cvt_pk_bf16_f32 v158, v20, v21
    v_mfma_f32_16x16x32_bf16 a[40:43], v[204:207], v[128:131], a[40:43]
    v_exp_f32 v22, v22
    v_mfma_f32_16x16x32_bf16 a[44:47], v[204:207], v[132:135], a[44:47]
    ds_read_b128 v[224:227], v234 offset:40960
    v_mfma_f32_16x16x32_bf16 a[44:47], v[200:203], v[116:119], a[44:47]
    v_exp_f32 v23, v23
    v_mfma_f32_16x16x32_bf16 a[32:35], v[200:203], v[104:107], a[32:35]
    s_add_u32 m0, s35, 0x6000
    ds_read_b128 v[228:231], v235 offset:40960
    v_cvt_pk_bf16_f32 v159, v22, v23
    v_mfma_f32_16x16x32_bf16 a[32:35], v[204:207], v[120:123], a[32:35]
    s_add_u32 s41, s46, 24576
    v_exp_f32 v24, v24
    v_mfma_f32_16x16x32_bf16 a[48:51], v[212:215], v[120:123], a[48:51]
    buffer_load_dwordx4 v12, s[20:23], s41 offen nt lds
    v_mfma_f32_16x16x32_bf16 a[48:51], v[208:211], v[104:107], a[48:51]
    v_exp_f32 v25, v25
    v_mfma_f32_16x16x32_bf16 a[60:63], v[208:211], v[116:119], a[60:63]
    s_add_u32 m0, s35, 0x7000
    v_cvt_pk_bf16_f32 v162, v24, v25
    v_mfma_f32_16x16x32_bf16 a[60:63], v[212:215], v[132:135], a[60:63]
    s_add_u32 s41, s46, 28672
    v_exp_f32 v26, v26
    v_mfma_f32_16x16x32_bf16 a[56:59], v[212:215], v[128:131], a[56:59]
    buffer_load_dwordx4 v12, s[20:23], s41 offen nt lds
    v_mfma_f32_16x16x32_bf16 a[56:59], v[208:211], v[112:115], a[56:59]
    v_exp_f32 v27, v27
    v_mfma_f32_16x16x32_bf16 a[52:55], v[208:211], v[108:111], a[52:55]
    v_cvt_pk_bf16_f32 v163, v26, v27
    v_mfma_f32_16x16x32_bf16 a[52:55], v[212:215], v[124:127], a[52:55]
    v_exp_f32 v28, v28
    v_mfma_f32_16x16x32_bf16 a[132:135], v[244:247], v[124:127], a[132:135]
    v_mfma_f32_16x16x32_bf16 a[132:135], v[244:247], v[108:111], a[132:135]
    s_waitcnt lgkmcnt(0)
    v_exp_f32 v29, v29
    v_mfma_f32_16x16x32_bf16 v[16:19], v[216:219], v[72:75], v[40:43]
    ds_read_b64_tr_b16 v[200:201], v240 offset:32768
    v_cvt_pk_bf16_f32 v166, v28, v29
    v_mfma_f32_16x16x32_bf16 v[16:19], v[220:223], v[88:91], v[16:19]
    v_exp_f32 v30, v30
    v_mfma_f32_16x16x32_bf16 v[16:19], v[224:227], v[136:139], v[16:19]
    ds_read_b64_tr_b16 v[202:203], v240 offset:36864
    ds_read_b64_tr_b16 v[204:205], v240 offset:40960
    v_mfma_f32_16x16x32_bf16 v[16:19], v[228:231], v[168:171], v[16:19]
    s_add_u32 m0, s35, 0x10000
    v_exp_f32 v31, v31
    v_mfma_f32_16x16x32_bf16 v[20:23], v[228:231], v[172:175], v[44:47]
    s_add_u32 s41, s47, 0
    ds_read_b64_tr_b16 v[206:207], v240 offset:45056
    v_cvt_pk_bf16_f32 v167, v30, v31
    v_mfma_f32_16x16x32_bf16 v[20:23], v[224:227], v[140:143], v[20:23]
    buffer_load_dwordx4 v13, s[24:27], s41 offen nt lds
    v_mfma_f32_16x16x32_bf16 v[20:23], v[220:223], v[92:95], v[20:23]
    ds_read_b64_tr_b16 v[208:209], v241 offset:32768
    ds_read_b64_tr_b16 v[210:211], v241 offset:36864
    v_mfma_f32_16x16x32_bf16 v[20:23], v[216:219], v[76:79], v[20:23]
    v_exp_f32 v16, v16
    v_mfma_f32_16x16x32_bf16 v[24:27], v[216:219], v[80:83], v[48:51]
    ds_read_b64_tr_b16 v[212:213], v241 offset:40960
    ds_read_b64_tr_b16 v[214:215], v241 offset:45056
    v_mfma_f32_16x16x32_bf16 v[24:27], v[220:223], v[96:99], v[24:27]
    v_exp_f32 v17, v17
    v_mfma_f32_16x16x32_bf16 v[24:27], v[224:227], v[144:147], v[24:27]
    s_add_u32 m0, s35, 0x11000
    v_cvt_pk_bf16_f32 v184, v16, v17
    v_mfma_f32_16x16x32_bf16 v[24:27], v[228:231], v[176:179], v[24:27]
    s_add_u32 s41, s47, 4096
    v_exp_f32 v18, v18
    v_mfma_f32_16x16x32_bf16 v[28:31], v[228:231], v[180:183], v[52:55]
    buffer_load_dwordx4 v13, s[24:27], s41 offen nt lds
    v_mfma_f32_16x16x32_bf16 v[28:31], v[224:227], v[148:151], v[28:31]
    v_exp_f32 v19, v19
    v_mfma_f32_16x16x32_bf16 v[28:31], v[220:223], v[100:103], v[28:31]
    v_cvt_pk_bf16_f32 v185, v18, v19
    v_mfma_f32_16x16x32_bf16 v[28:31], v[216:219], v[84:87], v[28:31]
    s_waitcnt lgkmcnt(0)
    v_exp_f32 v20, v20
    v_mfma_f32_16x16x32_bf16 a[72:75], v[204:207], v[128:131], a[72:75]
    ds_read_b128 v[216:219], v232 offset:45056
    v_mfma_f32_16x16x32_bf16 a[72:75], v[200:203], v[112:115], a[72:75]
    v_exp_f32 v21, v21
    v_mfma_f32_16x16x32_bf16 a[76:79], v[200:203], v[116:119], a[76:79]
    ds_read_b128 v[220:223], v233 offset:45056
    v_cvt_pk_bf16_f32 v188, v20, v21
    v_mfma_f32_16x16x32_bf16 a[76:79], v[204:207], v[132:135], a[76:79]
    v_exp_f32 v22, v22
    v_mfma_f32_16x16x32_bf16 a[64:67], v[204:207], v[120:123], a[64:67]
    ds_read_b128 v[224:227], v234 offset:45056
    v_mfma_f32_16x16x32_bf16 a[64:67], v[200:203], v[104:107], a[64:67]
    v_exp_f32 v23, v23
    v_mfma_f32_16x16x32_bf16 a[68:71], v[200:203], v[108:111], a[68:71]
    s_add_u32 m0, s35, 0x12000
    ds_read_b128 v[228:231], v235 offset:45056
    v_cvt_pk_bf16_f32 v189, v22, v23
    v_mfma_f32_16x16x32_bf16 a[68:71], v[204:207], v[124:127], a[68:71]
    s_add_u32 s41, s47, 8192
    v_exp_f32 v24, v24
    v_mfma_f32_16x16x32_bf16 a[84:87], v[212:215], v[124:127], a[84:87]
    buffer_load_dwordx4 v13, s[24:27], s41 offen nt lds
    v_mfma_f32_16x16x32_bf16 a[84:87], v[208:211], v[108:111], a[84:87]
    v_exp_f32 v25, v25
    v_mfma_f32_16x16x32_bf16 a[80:83], v[208:211], v[104:107], a[80:83]
    s_add_u32 m0, s35, 0x13000
    v_cvt_pk_bf16_f32 v192, v24, v25
    v_mfma_f32_16x16x32_bf16 a[80:83], v[212:215], v[120:123], a[80:83]
    s_add_u32 s41, s47, 12288
    v_exp_f32 v26, v26
    v_mfma_f32_16x16x32_bf16 a[92:95], v[212:215], v[132:135], a[92:95]
    buffer_load_dwordx4 v13, s[24:27], s41 offen nt lds
    v_mfma_f32_16x16x32_bf16 a[92:95], v[208:211], v[116:119], a[92:95]
    v_exp_f32 v27, v27
    v_mfma_f32_16x16x32_bf16 a[88:91], v[208:211], v[112:115], a[88:91]
    v_cvt_pk_bf16_f32 v193, v26, v27
    v_mfma_f32_16x16x32_bf16 a[88:91], v[212:215], v[128:131], a[88:91]
    v_exp_f32 v28, v28
    v_mfma_f32_16x16x32_bf16 a[136:139], v[244:247], v[128:131], a[136:139]
    v_mfma_f32_16x16x32_bf16 a[136:139], v[244:247], v[112:115], a[136:139]
    s_waitcnt lgkmcnt(0)
    v_exp_f32 v29, v29
    v_mfma_f32_16x16x32_bf16 v[16:19], v[216:219], v[72:75], v[40:43]
    ds_read_b64_tr_b16 v[200:201], v242 offset:32768
    v_cvt_pk_bf16_f32 v196, v28, v29
    v_mfma_f32_16x16x32_bf16 v[16:19], v[220:223], v[88:91], v[16:19]
    v_exp_f32 v30, v30
    v_mfma_f32_16x16x32_bf16 v[16:19], v[224:227], v[136:139], v[16:19]
    ds_read_b64_tr_b16 v[202:203], v242 offset:36864
    ds_read_b64_tr_b16 v[204:205], v242 offset:40960
    v_mfma_f32_16x16x32_bf16 v[16:19], v[228:231], v[168:171], v[16:19]
    s_add_u32 m0, s35, 0x14000
    v_exp_f32 v31, v31
    v_mfma_f32_16x16x32_bf16 v[20:23], v[228:231], v[172:175], v[44:47]
    s_add_u32 s41, s47, 16384
    ds_read_b64_tr_b16 v[206:207], v242 offset:45056
    v_cvt_pk_bf16_f32 v197, v30, v31
    v_mfma_f32_16x16x32_bf16 v[20:23], v[224:227], v[140:143], v[20:23]
    buffer_load_dwordx4 v13, s[24:27], s41 offen nt lds
    v_mfma_f32_16x16x32_bf16 v[20:23], v[220:223], v[92:95], v[20:23]
    ds_read_b64_tr_b16 v[208:209], v243 offset:32768
    ds_read_b64_tr_b16 v[210:211], v243 offset:36864
    v_mfma_f32_16x16x32_bf16 v[20:23], v[216:219], v[76:79], v[20:23]
    v_exp_f32 v16, v16
    v_mfma_f32_16x16x32_bf16 v[24:27], v[216:219], v[80:83], v[48:51]
    ds_read_b64_tr_b16 v[212:213], v243 offset:40960
    ds_read_b64_tr_b16 v[214:215], v243 offset:45056
    v_mfma_f32_16x16x32_bf16 v[24:27], v[220:223], v[96:99], v[24:27]
    v_exp_f32 v17, v17
    v_mfma_f32_16x16x32_bf16 v[24:27], v[224:227], v[144:147], v[24:27]
    s_add_u32 m0, s35, 0x15000
    v_cvt_pk_bf16_f32 v186, v16, v17
    v_mfma_f32_16x16x32_bf16 v[24:27], v[228:231], v[176:179], v[24:27]
    s_add_u32 s41, s47, 20480
    v_exp_f32 v18, v18
    v_mfma_f32_16x16x32_bf16 v[28:31], v[228:231], v[180:183], v[52:55]
    buffer_load_dwordx4 v13, s[24:27], s41 offen nt lds
    v_mfma_f32_16x16x32_bf16 v[28:31], v[224:227], v[148:151], v[28:31]
    v_exp_f32 v19, v19
    v_mfma_f32_16x16x32_bf16 v[28:31], v[220:223], v[100:103], v[28:31]
    v_cvt_pk_bf16_f32 v187, v18, v19
    v_mfma_f32_16x16x32_bf16 v[28:31], v[216:219], v[84:87], v[28:31]
    s_waitcnt lgkmcnt(0)
    v_exp_f32 v20, v20
    v_mfma_f32_16x16x32_bf16 a[108:111], v[204:207], v[132:135], a[108:111]
    ds_read_b128 v[216:219], v232 offset:49152
    v_mfma_f32_16x16x32_bf16 a[108:111], v[200:203], v[116:119], a[108:111]
    v_exp_f32 v21, v21
    v_mfma_f32_16x16x32_bf16 a[96:99], v[200:203], v[104:107], a[96:99]
    ds_read_b128 v[220:223], v233 offset:49152
    v_cvt_pk_bf16_f32 v190, v20, v21
    v_mfma_f32_16x16x32_bf16 a[96:99], v[204:207], v[120:123], a[96:99]
    v_exp_f32 v22, v22
    v_mfma_f32_16x16x32_bf16 a[100:103], v[204:207], v[124:127], a[100:103]
    ds_read_b128 v[224:227], v234 offset:49152
    v_mfma_f32_16x16x32_bf16 a[100:103], v[200:203], v[108:111], a[100:103]
    v_exp_f32 v23, v23
    v_mfma_f32_16x16x32_bf16 a[104:107], v[200:203], v[112:115], a[104:107]
    s_add_u32 m0, s35, 0x16000
    ds_read_b128 v[228:231], v235 offset:49152
    v_cvt_pk_bf16_f32 v191, v22, v23
    v_mfma_f32_16x16x32_bf16 a[104:107], v[204:207], v[128:131], a[104:107]
    s_add_u32 s41, s47, 24576
    v_exp_f32 v24, v24
    v_mfma_f32_16x16x32_bf16 a[120:123], v[212:215], v[128:131], a[120:123]
    buffer_load_dwordx4 v13, s[24:27], s41 offen nt lds
    v_mfma_f32_16x16x32_bf16 a[120:123], v[208:211], v[112:115], a[120:123]
    v_exp_f32 v25, v25
    v_mfma_f32_16x16x32_bf16 a[116:119], v[208:211], v[108:111], a[116:119]
    s_add_u32 m0, s35, 0x17000
    v_cvt_pk_bf16_f32 v194, v24, v25
    v_mfma_f32_16x16x32_bf16 a[116:119], v[212:215], v[124:127], a[116:119]
    s_add_u32 s41, s47, 28672
    v_exp_f32 v26, v26
    v_mfma_f32_16x16x32_bf16 a[112:115], v[212:215], v[120:123], a[112:115]
    buffer_load_dwordx4 v13, s[24:27], s41 offen nt lds
    v_mfma_f32_16x16x32_bf16 a[112:115], v[208:211], v[104:107], a[112:115]
    s_add_u32 s46, s46, 32768
    v_exp_f32 v27, v27
    v_mfma_f32_16x16x32_bf16 a[124:127], v[208:211], v[116:119], a[124:127]
    s_add_u32 s47, s47, 32768
    v_cvt_pk_bf16_f32 v195, v26, v27
    v_mfma_f32_16x16x32_bf16 a[124:127], v[212:215], v[132:135], a[124:127]
    v_exp_f32 v28, v28
    v_mfma_f32_16x16x32_bf16 a[140:143], v[244:247], v[132:135], a[140:143]
    v_mfma_f32_16x16x32_bf16 a[140:143], v[244:247], v[116:119], a[140:143]
    s_waitcnt lgkmcnt(0)
    v_exp_f32 v29, v29
    v_mfma_f32_16x16x32_bf16 v[16:19], v[216:219], v[72:75], v[40:43]
    ds_read_b64_tr_b16 v[200:201], v236 offset:49152
    v_cvt_pk_bf16_f32 v198, v28, v29
    v_mfma_f32_16x16x32_bf16 v[16:19], v[220:223], v[88:91], v[16:19]
    v_exp_f32 v30, v30
    v_mfma_f32_16x16x32_bf16 v[16:19], v[224:227], v[136:139], v[16:19]
    ds_read_b64_tr_b16 v[202:203], v236 offset:53248
    ds_read_b64_tr_b16 v[204:205], v236 offset:57344
    v_mfma_f32_16x16x32_bf16 v[16:19], v[228:231], v[168:171], v[16:19]
    v_exp_f32 v31, v31
    v_mfma_f32_16x16x32_bf16 v[20:23], v[228:231], v[172:175], v[44:47]
    ds_read_b64_tr_b16 v[206:207], v236 offset:61440
    v_cvt_pk_bf16_f32 v199, v30, v31
    v_mfma_f32_16x16x32_bf16 v[20:23], v[224:227], v[140:143], v[20:23]
    v_mfma_f32_16x16x32_bf16 v[20:23], v[220:223], v[92:95], v[20:23]
    ds_read_b64_tr_b16 v[208:209], v237 offset:49152
    ds_read_b64_tr_b16 v[210:211], v237 offset:53248
    v_mfma_f32_16x16x32_bf16 v[20:23], v[216:219], v[76:79], v[20:23]
    v_exp_f32 v16, v16
    v_mfma_f32_16x16x32_bf16 v[24:27], v[216:219], v[80:83], v[48:51]
    ds_read_b64_tr_b16 v[212:213], v237 offset:57344
    ds_read_b64_tr_b16 v[214:215], v237 offset:61440
    v_mfma_f32_16x16x32_bf16 v[24:27], v[220:223], v[96:99], v[24:27]
    v_exp_f32 v17, v17
    v_mfma_f32_16x16x32_bf16 v[24:27], v[224:227], v[144:147], v[24:27]
    v_cvt_pk_bf16_f32 v104, v16, v17
    v_mfma_f32_16x16x32_bf16 v[24:27], v[228:231], v[176:179], v[24:27]
    v_exp_f32 v18, v18
    v_mfma_f32_16x16x32_bf16 v[28:31], v[228:231], v[180:183], v[52:55]
    v_mfma_f32_16x16x32_bf16 v[28:31], v[224:227], v[148:151], v[28:31]
    v_exp_f32 v19, v19
    v_mfma_f32_16x16x32_bf16 v[28:31], v[220:223], v[100:103], v[28:31]
    v_cvt_pk_bf16_f32 v105, v18, v19
    v_mfma_f32_16x16x32_bf16 v[28:31], v[216:219], v[84:87], v[28:31]
    s_waitcnt lgkmcnt(0)
    v_exp_f32 v20, v20
    v_mfma_f32_16x16x32_bf16 a[0:3], v[204:207], v[184:187], a[0:3]
    ds_read_b128 v[216:219], v232 offset:53248
    v_mfma_f32_16x16x32_bf16 a[0:3], v[200:203], v[152:155], a[0:3]
    v_exp_f32 v21, v21
    v_mfma_f32_16x16x32_bf16 a[4:7], v[200:203], v[156:159], a[4:7]
    ds_read_b128 v[220:223], v233 offset:53248
    v_cvt_pk_bf16_f32 v108, v20, v21
    v_mfma_f32_16x16x32_bf16 a[4:7], v[204:207], v[188:191], a[4:7]
    v_exp_f32 v22, v22
    v_mfma_f32_16x16x32_bf16 a[8:11], v[204:207], v[192:195], a[8:11]
    ds_read_b128 v[224:227], v234 offset:53248
    v_mfma_f32_16x16x32_bf16 a[8:11], v[200:203], v[160:163], a[8:11]
    v_exp_f32 v23, v23
    v_mfma_f32_16x16x32_bf16 a[12:15], v[200:203], v[164:167], a[12:15]
    ds_read_b128 v[228:231], v235 offset:53248
    v_cvt_pk_bf16_f32 v109, v22, v23
    v_mfma_f32_16x16x32_bf16 a[12:15], v[204:207], v[196:199], a[12:15]
    s_waitcnt vmcnt(19)
    v_exp_f32 v24, v24
    v_mfma_f32_16x16x32_bf16 a[28:31], v[212:215], v[196:199], a[28:31]
L_hop0_11:
    s_cbranch_execz L_hop0_ret
    ds_read_b64_tr_b16 v[56:57], v15 offset:0
    ds_read_b64_tr_b16 v[58:59], v15 offset:2048
    v_mfma_f32_16x16x32_bf16 a[28:31], v[208:211], v[164:167], a[28:31]
    v_exp_f32 v25, v25
    v_mfma_f32_16x16x32_bf16 a[24:27], v[208:211], v[160:163], a[24:27]
    v_cvt_pk_bf16_f32 v112, v24, v25
    v_mfma_f32_16x16x32_bf16 a[24:27], v[212:215], v[192:195], a[24:27]
    v_exp_f32 v26, v26
    v_mfma_f32_16x16x32_bf16 a[20:23], v[212:215], v[188:191], a[20:23]
    ds_read_b64_tr_b16 v[60:61], v15 offset:32
    ds_read_b64_tr_b16 v[62:63], v15 offset:2080
    v_mfma_f32_16x16x32_bf16 a[20:23], v[208:211], v[156:159], a[20:23]
    v_exp_f32 v27, v27
    v_mfma_f32_16x16x32_bf16 a[16:19], v[208:211], v[152:155], a[16:19]
    v_cvt_pk_bf16_f32 v113, v26, v27
    v_mfma_f32_16x16x32_bf16 a[16:19], v[212:215], v[184:187], a[16:19]
    v_exp_f32 v28, v28
    v_mfma_f32_16x16x32_bf16 a[128:131], v[244:247], v[184:187], a[128:131]
    v_mfma_f32_16x16x32_bf16 a[128:131], v[244:247], v[152:155], a[128:131]
    s_waitcnt lgkmcnt(0)
    v_exp_f32 v29, v29
    v_mfma_f32_16x16x32_bf16 v[16:19], v[216:219], v[72:75], v[40:43]
    ds_read_b64_tr_b16 v[200:201], v238 offset:49152
    v_cvt_pk_bf16_f32 v116, v28, v29
    v_mfma_f32_16x16x32_bf16 v[16:19], v[220:223], v[88:91], v[16:19]
    v_exp_f32 v30, v30
    v_mfma_f32_16x16x32_bf16 v[16:19], v[224:227], v[136:139], v[16:19]
    ds_read_b64_tr_b16 v[202:203], v238 offset:53248
    ds_read_b64_tr_b16 v[204:205], v238 offset:57344
    v_mfma_f32_16x16x32_bf16 v[16:19], v[228:231], v[168:171], v[16:19]
    v_exp_f32 v31, v31
    v_mfma_f32_16x16x32_bf16 v[20:23], v[228:231], v[172:175], v[44:47]
    ds_read_b64_tr_b16 v[206:207], v238 offset:61440
    v_cvt_pk_bf16_f32 v117, v30, v31
    v_mfma_f32_16x16x32_bf16 v[20:23], v[224:227], v[140:143], v[20:23]
    buffer_store_dwordx4 v[56:59], v1, s[88:91], s57 offen offset:0 sc1
    v_mfma_f32_16x16x32_bf16 v[20:23], v[220:223], v[92:95], v[20:23]
    ds_read_b64_tr_b16 v[208:209], v239 offset:49152
    ds_read_b64_tr_b16 v[210:211], v239 offset:53248
    v_mfma_f32_16x16x32_bf16 v[20:23], v[216:219], v[76:79], v[20:23]
    v_exp_f32 v16, v16
    v_mfma_f32_16x16x32_bf16 v[24:27], v[216:219], v[80:83], v[48:51]
    ds_read_b64_tr_b16 v[212:213], v239 offset:57344
    ds_read_b64_tr_b16 v[214:215], v239 offset:61440
    v_mfma_f32_16x16x32_bf16 v[24:27], v[220:223], v[96:99], v[24:27]
    v_exp_f32 v17, v17
    v_mfma_f32_16x16x32_bf16 v[24:27], v[224:227], v[144:147], v[24:27]
    v_cvt_pk_bf16_f32 v106, v16, v17
    v_mfma_f32_16x16x32_bf16 v[24:27], v[228:231], v[176:179], v[24:27]
    v_exp_f32 v18, v18
    v_mfma_f32_16x16x32_bf16 v[28:31], v[228:231], v[180:183], v[52:55]
    v_mfma_f32_16x16x32_bf16 v[28:31], v[224:227], v[148:151], v[28:31]
    v_exp_f32 v19, v19
    v_mfma_f32_16x16x32_bf16 v[28:31], v[220:223], v[100:103], v[28:31]
    v_cvt_pk_bf16_f32 v107, v18, v19
    v_mfma_f32_16x16x32_bf16 v[28:31], v[216:219], v[84:87], v[28:31]
    s_waitcnt lgkmcnt(0)
    v_exp_f32 v20, v20
    v_mfma_f32_16x16x32_bf16 a[36:39], v[204:207], v[188:191], a[36:39]
    ds_read_b128 v[216:219], v232 offset:57344
    v_mfma_f32_16x16x32_bf16 a[36:39], v[200:203], v[156:159], a[36:39]
    v_exp_f32 v21, v21
    v_mfma_f32_16x16x32_bf16 a[40:43], v[200:203], v[160:163], a[40:43]
    ds_read_b128 v[220:223], v233 offset:57344
    v_cvt_pk_bf16_f32 v110, v20, v21
    v_mfma_f32_16x16x32_bf16 a[40:43], v[204:207], v[192:195], a[40:43]
    v_exp_f32 v22, v22
    v_mfma_f32_16x16x32_bf16 a[44:47], v[204:207], v[196:199], a[44:47]
    ds_read_b128 v[224:227], v234 offset:57344
    v_mfma_f32_16x16x32_bf16 a[44:47], v[200:203], v[164:167], a[44:47]
    v_exp_f32 v23, v23
    v_mfma_f32_16x16x32_bf16 a[32:35], v[200:203], v[152:155], a[32:35]
    ds_read_b128 v[228:231], v235 offset:57344
    v_cvt_pk_bf16_f32 v111, v22, v23
    v_mfma_f32_16x16x32_bf16 a[32:35], v[204:207], v[184:187], a[32:35]
    v_exp_f32 v24, v24
    v_mfma_f32_16x16x32_bf16 a[48:51], v[212:215], v[184:187], a[48:51]
    ds_read_b64_tr_b16 v[64:65], v15 offset:64
    ds_read_b64_tr_b16 v[66:67], v15 offset:2112
    v_mfma_f32_16x16x32_bf16 a[48:51], v[208:211], v[152:155], a[48:51]
    v_exp_f32 v25, v25
    v_mfma_f32_16x16x32_bf16 a[60:63], v[208:211], v[164:167], a[60:63]
    v_cvt_pk_bf16_f32 v114, v24, v25
    v_mfma_f32_16x16x32_bf16 a[60:63], v[212:215], v[196:199], a[60:63]
    v_exp_f32 v26, v26
    v_mfma_f32_16x16x32_bf16 a[56:59], v[212:215], v[192:195], a[56:59]
    ds_read_b64_tr_b16 v[68:69], v15 offset:96
    ds_read_b64_tr_b16 v[70:71], v15 offset:2144
    v_mfma_f32_16x16x32_bf16 a[56:59], v[208:211], v[160:163], a[56:59]
    v_exp_f32 v27, v27
    v_mfma_f32_16x16x32_bf16 a[52:55], v[208:211], v[156:159], a[52:55]
    v_cvt_pk_bf16_f32 v115, v26, v27
    v_mfma_f32_16x16x32_bf16 a[52:55], v[212:215], v[188:191], a[52:55]
    v_exp_f32 v28, v28
    v_mfma_f32_16x16x32_bf16 a[132:135], v[244:247], v[188:191], a[132:135]
    buffer_store_dwordx4 v[60:63], v1, s[88:91], s57 offen offset:1024 sc1
    v_mfma_f32_16x16x32_bf16 a[132:135], v[244:247], v[156:159], a[132:135]
    s_waitcnt lgkmcnt(0)
    v_exp_f32 v29, v29
    v_mfma_f32_16x16x32_bf16 v[16:19], v[216:219], v[72:75], v[40:43]
    ds_read_b64_tr_b16 v[200:201], v240 offset:49152
    v_cvt_pk_bf16_f32 v118, v28, v29
    v_mfma_f32_16x16x32_bf16 v[16:19], v[220:223], v[88:91], v[16:19]
    v_exp_f32 v30, v30
    v_mfma_f32_16x16x32_bf16 v[16:19], v[224:227], v[136:139], v[16:19]
    ds_read_b64_tr_b16 v[202:203], v240 offset:53248
    ds_read_b64_tr_b16 v[204:205], v240 offset:57344
    v_mfma_f32_16x16x32_bf16 v[16:19], v[228:231], v[168:171], v[16:19]
    v_exp_f32 v31, v31
    v_mfma_f32_16x16x32_bf16 v[20:23], v[228:231], v[172:175], v[44:47]
    ds_read_b64_tr_b16 v[206:207], v240 offset:61440
    v_cvt_pk_bf16_f32 v119, v30, v31
    v_mfma_f32_16x16x32_bf16 v[20:23], v[224:227], v[140:143], v[20:23]
    buffer_store_dwordx4 v[64:67], v1, s[88:91], s57 offen offset:2048 sc1
    v_mfma_f32_16x16x32_bf16 v[20:23], v[220:223], v[92:95], v[20:23]
    ds_read_b64_tr_b16 v[208:209], v241 offset:49152
    ds_read_b64_tr_b16 v[210:211], v241 offset:53248
    v_mfma_f32_16x16x32_bf16 v[20:23], v[216:219], v[76:79], v[20:23]
    v_exp_f32 v16, v16
    v_mfma_f32_16x16x32_bf16 v[24:27], v[216:219], v[80:83], v[48:51]
    ds_read_b64_tr_b16 v[212:213], v241 offset:57344
    ds_read_b64_tr_b16 v[214:215], v241 offset:61440
    v_mfma_f32_16x16x32_bf16 v[24:27], v[220:223], v[96:99], v[24:27]
    v_exp_f32 v17, v17
    v_mfma_f32_16x16x32_bf16 v[24:27], v[224:227], v[144:147], v[24:27]
    v_cvt_pk_bf16_f32 v120, v16, v17
    v_mfma_f32_16x16x32_bf16 v[24:27], v[228:231], v[176:179], v[24:27]
    v_exp_f32 v18, v18
    v_mfma_f32_16x16x32_bf16 v[28:31], v[228:231], v[180:183], v[52:55]
    v_mfma_f32_16x16x32_bf16 v[28:31], v[224:227], v[148:151], v[28:31]
    v_exp_f32 v19, v19
    v_mfma_f32_16x16x32_bf16 v[28:31], v[220:223], v[100:103], v[28:31]
    v_cvt_pk_bf16_f32 v121, v18, v19
    v_mfma_f32_16x16x32_bf16 v[28:31], v[216:219], v[84:87], v[28:31]
    s_waitcnt lgkmcnt(0)
    v_exp_f32 v20, v20
    v_mfma_f32_16x16x32_bf16 a[72:75], v[204:207], v[192:195], a[72:75]
    ds_read_b128 v[216:219], v232 offset:61440
    v_mfma_f32_16x16x32_bf16 a[72:75], v[200:203], v[160:163], a[72:75]
    v_exp_f32 v21, v21
    v_mfma_f32_16x16x32_bf16 a[76:79], v[200:203], v[164:167], a[76:79]
    ds_read_b128 v[220:223], v233 offset:61440
    v_cvt_pk_bf16_f32 v124, v20, v21
    v_mfma_f32_16x16x32_bf16 a[76:79], v[204:207], v[196:199], a[76:79]
    v_exp_f32 v22, v22
    v_mfma_f32_16x16x32_bf16 a[64:67], v[204:207], v[184:187], a[64:67]
    ds_read_b128 v[224:227], v234 offset:61440
    v_mfma_f32_16x16x32_bf16 a[64:67], v[200:203], v[152:155], a[64:67]
    v_exp_f32 v23, v23
    v_mfma_f32_16x16x32_bf16 a[68:71], v[200:203], v[156:159], a[68:71]
    ds_read_b128 v[228:231], v235 offset:61440
    v_cvt_pk_bf16_f32 v125, v22, v23
    v_mfma_f32_16x16x32_bf16 a[68:71], v[204:207], v[188:191], a[68:71]
    v_exp_f32 v24, v24
    v_mfma_f32_16x16x32_bf16 a[84:87], v[212:215], v[188:191], a[84:87]
    buffer_store_dwordx4 v[68:71], v1, s[88:91], s57 offen offset:3072 sc1
    v_mfma_f32_16x16x32_bf16 a[84:87], v[208:211], v[156:159], a[84:87]
    v_exp_f32 v25, v25
    v_mfma_f32_16x16x32_bf16 a[80:83], v[208:211], v[152:155], a[80:83]
    v_cvt_pk_bf16_f32 v128, v24, v25
    v_mfma_f32_16x16x32_bf16 a[80:83], v[212:215], v[184:187], a[80:83]
    v_exp_f32 v26, v26
    v_mfma_f32_16x16x32_bf16 a[92:95], v[212:215], v[196:199], a[92:95]
    v_mfma_f32_16x16x32_bf16 a[92:95], v[208:211], v[164:167], a[92:95]
    v_exp_f32 v27, v27
    v_mfma_f32_16x16x32_bf16 a[88:91], v[208:211], v[160:163], a[88:91]
    v_cvt_pk_bf16_f32 v129, v26, v27
    v_mfma_f32_16x16x32_bf16 a[88:91], v[212:215], v[192:195], a[88:91]
    v_exp_f32 v28, v28
    v_mfma_f32_16x16x32_bf16 a[136:139], v[244:247], v[192:195], a[136:139]
    v_mfma_f32_16x16x32_bf16 a[136:139], v[244:247], v[160:163], a[136:139]
    s_waitcnt lgkmcnt(0)
    v_exp_f32 v29, v29
    v_mfma_f32_16x16x32_bf16 v[16:19], v[216:219], v[72:75], v[40:43]
    ds_read_b64_tr_b16 v[200:201], v242 offset:49152
    v_cvt_pk_bf16_f32 v132, v28, v29
    v_mfma_f32_16x16x32_bf16 v[16:19], v[220:223], v[88:91], v[16:19]
    v_exp_f32 v30, v30
    v_mfma_f32_16x16x32_bf16 v[16:19], v[224:227], v[136:139], v[16:19]
    ds_read_b64_tr_b16 v[202:203], v242 offset:53248
    ds_read_b64_tr_b16 v[204:205], v242 offset:57344
    v_mfma_f32_16x16x32_bf16 v[16:19], v[228:231], v[168:171], v[16:19]
    v_exp_f32 v31, v31
    v_mfma_f32_16x16x32_bf16 v[20:23], v[228:231], v[172:175], v[44:47]
    ds_read_b64_tr_b16 v[206:207], v242 offset:61440
    v_cvt_pk_bf16_f32 v133, v30, v31
    v_mfma_f32_16x16x32_bf16 v[20:23], v[224:227], v[140:143], v[20:23]
    v_mfma_f32_16x16x32_bf16 v[20:23], v[220:223], v[92:95], v[20:23]
    ds_read_b64_tr_b16 v[208:209], v243 offset:49152
    ds_read_b64_tr_b16 v[210:211], v243 offset:53248
    v_mfma_f32_16x16x32_bf16 v[20:23], v[216:219], v[76:79], v[20:23]
    v_exp_f32 v16, v16
    v_mfma_f32_16x16x32_bf16 v[24:27], v[216:219], v[80:83], v[48:51]
    ds_read_b64_tr_b16 v[212:213], v243 offset:57344
    ds_read_b64_tr_b16 v[214:215], v243 offset:61440
    v_mfma_f32_16x16x32_bf16 v[24:27], v[220:223], v[96:99], v[24:27]
    v_exp_f32 v17, v17
    v_mfma_f32_16x16x32_bf16 v[24:27], v[224:227], v[144:147], v[24:27]
    v_cvt_pk_bf16_f32 v122, v16, v17
    v_mfma_f32_16x16x32_bf16 v[24:27], v[228:231], v[176:179], v[24:27]
    v_exp_f32 v18, v18
    v_mfma_f32_16x16x32_bf16 v[28:31], v[228:231], v[180:183], v[52:55]
    v_mfma_f32_16x16x32_bf16 v[28:31], v[224:227], v[148:151], v[28:31]
    v_exp_f32 v19, v19
    v_mfma_f32_16x16x32_bf16 v[28:31], v[220:223], v[100:103], v[28:31]
    v_cvt_pk_bf16_f32 v123, v18, v19
    v_mfma_f32_16x16x32_bf16 v[28:31], v[216:219], v[84:87], v[28:31]
    s_waitcnt vmcnt(4) lgkmcnt(0)
    s_barrier
    v_exp_f32 v20, v20
    v_mfma_f32_16x16x32_bf16 a[108:111], v[204:207], v[196:199], a[108:111]
    ds_read_b128 v[216:219], v232 offset:0
    v_mfma_f32_16x16x32_bf16 a[108:111], v[200:203], v[164:167], a[108:111]
    v_exp_f32 v21, v21
    v_mfma_f32_16x16x32_bf16 a[96:99], v[200:203], v[152:155], a[96:99]
    ds_read_b128 v[220:223], v233 offset:0
    v_cvt_pk_bf16_f32 v126, v20, v21
    v_mfma_f32_16x16x32_bf16 a[96:99], v[204:207], v[184:187], a[96:99]
    v_exp_f32 v22, v22
    v_mfma_f32_16x16x32_bf16 a[100:103], v[204:207], v[188:191], a[100:103]
    ds_read_b128 v[224:227], v234 offset:0
    v_mfma_f32_16x16x32_bf16 a[100:103], v[200:203], v[156:159], a[100:103]
    v_exp_f32 v23, v23
    v_mfma_f32_16x16x32_bf16 a[104:107], v[200:203], v[160:163], a[104:107]
    ds_read_b128 v[228:231], v235 offset:0
    v_cvt_pk_bf16_f32 v127, v22, v23
    v_mfma_f32_16x16x32_bf16 a[104:107], v[204:207], v[192:195], a[104:107]
    v_exp_f32 v24, v24
    v_mfma_f32_16x16x32_bf16 a[120:123], v[212:215], v[192:195], a[120:123]
    v_mfma_f32_16x16x32_bf16 a[120:123], v[208:211], v[160:163], a[120:123]
    v_exp_f32 v25, v25
    v_mfma_f32_16x16x32_bf16 a[116:119], v[208:211], v[156:159], a[116:119]
    v_cvt_pk_bf16_f32 v130, v24, v25
    v_mfma_f32_16x16x32_bf16 a[116:119], v[212:215], v[188:191], a[116:119]
    v_exp_f32 v26, v26
    v_mfma_f32_16x16x32_bf16 a[112:115], v[212:215], v[184:187], a[112:115]
    v_mfma_f32_16x16x32_bf16 a[112:115], v[208:211], v[152:155], a[112:115]
    v_exp_f32 v27, v27
    v_mfma_f32_16x16x32_bf16 a[124:127], v[208:211], v[164:167], a[124:127]
    v_cvt_pk_bf16_f32 v131, v26, v27
    v_mfma_f32_16x16x32_bf16 a[124:127], v[212:215], v[196:199], a[124:127]
    v_exp_f32 v28, v28
    v_mfma_f32_16x16x32_bf16 a[140:143], v[244:247], v[196:199], a[140:143]
    v_mfma_f32_16x16x32_bf16 a[140:143], v[244:247], v[164:167], a[140:143]
    s_waitcnt lgkmcnt(0)
    v_exp_f32 v29, v29
    v_mfma_f32_16x16x32_bf16 v[16:19], v[216:219], v[72:75], v[40:43]
    ds_read_b64_tr_b16 v[200:201], v236 offset:0
    v_cvt_pk_bf16_f32 v134, v28, v29
    v_mfma_f32_16x16x32_bf16 v[16:19], v[220:223], v[88:91], v[16:19]
    v_exp_f32 v30, v30
    v_mfma_f32_16x16x32_bf16 v[16:19], v[224:227], v[136:139], v[16:19]
    ds_read_b64_tr_b16 v[202:203], v236 offset:4096
    ds_read_b64_tr_b16 v[204:205], v236 offset:8192
    v_mfma_f32_16x16x32_bf16 v[16:19], v[228:231], v[168:171], v[16:19]
    s_add_u32 m0, s35, 0x8000
    v_exp_f32 v31, v31
    v_mfma_f32_16x16x32_bf16 v[20:23], v[228:231], v[172:175], v[44:47]
    s_add_u32 s41, s46, 0
    ds_read_b64_tr_b16 v[206:207], v236 offset:12288
    v_cvt_pk_bf16_f32 v135, v30, v31
    v_mfma_f32_16x16x32_bf16 v[20:23], v[224:227], v[140:143], v[20:23]
    buffer_load_dwordx4 v12, s[20:23], s41 offen nt lds
    v_mfma_f32_16x16x32_bf16 v[20:23], v[220:223], v[92:95], v[20:23]
    ds_read_b64_tr_b16 v[208:209], v237 offset:0
    ds_read_b64_tr_b16 v[210:211], v237 offset:4096
    v_mfma_f32_16x16x32_bf16 v[20:23], v[216:219], v[76:79], v[20:23]
    v_exp_f32 v16, v16
    v_mfma_f32_16x16x32_bf16 v[24:27], v[216:219], v[80:83], v[48:51]
    ds_read_b64_tr_b16 v[212:213], v237 offset:8192
    ds_read_b64_tr_b16 v[214:215], v237 offset:12288
    v_mfma_f32_16x16x32_bf16 v[24:27], v[220:223], v[96:99], v[24:27]
    v_exp_f32 v17, v17
    v_mfma_f32_16x16x32_bf16 v[24:27], v[224:227], v[144:147], v[24:27]
    s_add_u32 m0, s35, 0x9000
    v_cvt_pk_bf16_f32 v152, v16, v17
    v_mfma_f32_16x16x32_bf16 v[24:27], v[228:231], v[176:179], v[24:27]
    s_add_u32 s41, s46, 4096
    v_exp_f32 v18, v18
    v_mfma_f32_16x16x32_bf16 v[28:31], v[228:231], v[180:183], v[52:55]
    buffer_load_dwordx4 v12, s[20:23], s41 offen nt lds
    v_mfma_f32_16x16x32_bf16 v[28:31], v[224:227], v[148:151], v[28:31]
    v_exp_f32 v19, v19
    v_mfma_f32_16x16x32_bf16 v[28:31], v[220:223], v[100:103], v[28:31]
    v_cvt_pk_bf16_f32 v153, v18, v19
    v_mfma_f32_16x16x32_bf16 v[28:31], v[216:219], v[84:87], v[28:31]
    s_waitcnt lgkmcnt(0)
    v_exp_f32 v20, v20
    v_mfma_f32_16x16x32_bf16 a[0:3], v[204:207], v[120:123], a[0:3]
    ds_read_b128 v[216:219], v232 offset:4096
    v_mfma_f32_16x16x32_bf16 a[0:3], v[200:203], v[104:107], a[0:3]
    v_exp_f32 v21, v21
    v_mfma_f32_16x16x32_bf16 a[4:7], v[200:203], v[108:111], a[4:7]
    ds_read_b128 v[220:223], v233 offset:4096
    v_cvt_pk_bf16_f32 v156, v20, v21
    v_mfma_f32_16x16x32_bf16 a[4:7], v[204:207], v[124:127], a[4:7]
    v_exp_f32 v22, v22
    v_mfma_f32_16x16x32_bf16 a[8:11], v[204:207], v[128:131], a[8:11]
    ds_read_b128 v[224:227], v234 offset:4096
    v_mfma_f32_16x16x32_bf16 a[8:11], v[200:203], v[112:115], a[8:11]
    v_exp_f32 v23, v23
    v_mfma_f32_16x16x32_bf16 a[12:15], v[200:203], v[116:119], a[12:15]
    s_add_u32 m0, s35, 0xa000
    ds_read_b128 v[228:231], v235 offset:4096
    v_cvt_pk_bf16_f32 v157, v22, v23
    v_mfma_f32_16x16x32_bf16 a[12:15], v[204:207], v[132:135], a[12:15]
    s_add_u32 s41, s46, 8192
    v_exp_f32 v24, v24
    v_mfma_f32_16x16x32_bf16 a[28:31], v[212:215], v[132:135], a[28:31]
    buffer_load_dwordx4 v12, s[20:23], s41 offen nt lds
    v_mfma_f32_16x16x32_bf16 a[28:31], v[208:211], v[116:119], a[28:31]
    v_exp_f32 v25, v25
    v_mfma_f32_16x16x32_bf16 a[24:27], v[208:211], v[112:115], a[24:27]
    s_add_u32 m0, s35, 0xb000
    v_cvt_pk_bf16_f32 v160, v24, v25
    v_mfma_f32_16x16x32_bf16 a[24:27], v[212:215], v[128:131], a[24:27]
    s_add_u32 s41, s46, 12288
    v_exp_f32 v26, v26
    v_mfma_f32_16x16x32_bf16 a[20:23], v[212:215], v[124:127], a[20:23]
    buffer_load_dwordx4 v12, s[20:23], s41 offen nt lds
    v_mfma_f32_16x16x32_bf16 a[20:23], v[208:211], v[108:111], a[20:23]
    v_exp_f32 v27, v27
    v_mfma_f32_16x16x32_bf16 a[16:19], v[208:211], v[104:107], a[16:19]
    v_cvt_pk_bf16_f32 v161, v26, v27
    v_mfma_f32_16x16x32_bf16 a[16:19], v[212:215], v[120:123], a[16:19]
    v_exp_f32 v28, v28
    v_mfma_f32_16x16x32_bf16 a[128:131], v[244:247], v[120:123], a[128:131]
    v_mfma_f32_16x16x32_bf16 a[128:131], v[244:247], v[104:107], a[128:131]
    s_waitcnt lgkmcnt(0)
    v_exp_f32 v29, v29
    v_mfma_f32_16x16x32_bf16 v[16:19], v[216:219], v[72:75], v[40:43]
    ds_read_b64_tr_b16 v[200:201], v238 offset:0
    v_cvt_pk_bf16_f32 v164, v28, v29
    v_mfma_f32_16x16x32_bf16 v[16:19], v[220:223], v[88:91], v[16:19]
    v_exp_f32 v30, v30
    v_mfma_f32_16x16x32_bf16 v[16:19], v[224:227], v[136:139], v[16:19]
    ds_read_b64_tr_b16 v[202:203], v238 offset:4096
    ds_read_b64_tr_b16 v[204:205], v238 offset:8192
    v_mfma_f32_16x16x32_bf16 v[16:19], v[228:231], v[168:171], v[16:19]
    s_add_u32 m0, s35, 0xc000
    v_exp_f32 v31, v31
    v_mfma_f32_16x16x32_bf16 v[20:23], v[228:231], v[172:175], v[44:47]
    s_add_u32 s41, s46, 16384
    ds_read_b64_tr_b16 v[206:207], v238 offset:12288
    v_cvt_pk_bf16_f32 v165, v30, v31
    v_mfma_f32_16x16x32_bf16 v[20:23], v[224:227], v[140:143], v[20:23]
    buffer_load_dwordx4 v12, s[20:23], s41 offen nt lds
    v_mfma_f32_16x16x32_bf16 v[20:23], v[220:223], v[92:95], v[20:23]
    ds_read_b64_tr_b16 v[208:209], v239 offset:0
    ds_read_b64_tr_b16 v[210:211], v239 offset:4096
    v_mfma_f32_16x16x32_bf16 v[20:23], v[216:219], v[76:79], v[20:23]
    v_exp_f32 v16, v16
    v_mfma_f32_16x16x32_bf16 v[24:27], v[216:219], v[80:83], v[48:51]
    ds_read_b64_tr_b16 v[212:213], v239 offset:8192
    ds_read_b64_tr_b16 v[214:215], v239 offset:12288
    v_mfma_f32_16x16x32_bf16 v[24:27], v[220:223], v[96:99], v[24:27]
    v_exp_f32 v17, v17
    v_mfma_f32_16x16x32_bf16 v[24:27], v[224:227], v[144:147], v[24:27]
    s_add_u32 m0, s35, 0xd000
    v_cvt_pk_bf16_f32 v154, v16, v17
    v_mfma_f32_16x16x32_bf16 v[24:27], v[228:231], v[176:179], v[24:27]
    s_add_u32 s41, s46, 20480
    v_exp_f32 v18, v18
    v_mfma_f32_16x16x32_bf16 v[28:31], v[228:231], v[180:183], v[52:55]
    buffer_load_dwordx4 v12, s[20:23], s41 offen nt lds
    v_mfma_f32_16x16x32_bf16 v[28:31], v[224:227], v[148:151], v[28:31]
    v_exp_f32 v19, v19
    v_mfma_f32_16x16x32_bf16 v[28:31], v[220:223], v[100:103], v[28:31]
    v_cvt_pk_bf16_f32 v155, v18, v19
    v_mfma_f32_16x16x32_bf16 v[28:31], v[216:219], v[84:87], v[28:31]
    s_waitcnt lgkmcnt(0)
    v_exp_f32 v20, v20
    v_mfma_f32_16x16x32_bf16 a[36:39], v[204:207], v[124:127], a[36:39]
    ds_read_b128 v[216:219], v232 offset:8192
    v_mfma_f32_16x16x32_bf16 a[36:39], v[200:203], v[108:111], a[36:39]
    v_exp_f32 v21, v21
    v_mfma_f32_16x16x32_bf16 a[40:43], v[200:203], v[112:115], a[40:43]
    ds_read_b128 v[220:223], v233 offset:8192
    v_cvt_pk_bf16_f32 v158, v20, v21
    v_mfma_f32_16x16x32_bf16 a[40:43], v[204:207], v[128:131], a[40:43]
    v_exp_f32 v22, v22
    v_mfma_f32_16x16x32_bf16 a[44:47], v[204:207], v[132:135], a[44:47]
    ds_read_b128 v[224:227], v234 offset:8192
    v_mfma_f32_16x16x32_bf16 a[44:47], v[200:203], v[116:119], a[44:47]
    v_exp_f32 v23, v23
    v_mfma_f32_16x16x32_bf16 a[32:35], v[200:203], v[104:107], a[32:35]
    s_add_u32 m0, s35, 0xe000
    ds_read_b128 v[228:231], v235 offset:8192
    v_cvt_pk_bf16_f32 v159, v22, v23
    v_mfma_f32_16x16x32_bf16 a[32:35], v[204:207], v[120:123], a[32:35]
    s_add_u32 s41, s46, 24576
    v_exp_f32 v24, v24
    v_mfma_f32_16x16x32_bf16 a[48:51], v[212:215], v[120:123], a[48:51]
    buffer_load_dwordx4 v12, s[20:23], s41 offen nt lds
    v_mfma_f32_16x16x32_bf16 a[48:51], v[208:211], v[104:107], a[48:51]
    v_exp_f32 v25, v25
    v_mfma_f32_16x16x32_bf16 a[60:63], v[208:211], v[116:119], a[60:63]
    s_add_u32 m0, s35, 0xf000
    v_cvt_pk_bf16_f32 v162, v24, v25
    v_mfma_f32_16x16x32_bf16 a[60:63], v[212:215], v[132:135], a[60:63]
    s_add_u32 s41, s46, 28672
    v_exp_f32 v26, v26
    v_mfma_f32_16x16x32_bf16 a[56:59], v[212:215], v[128:131], a[56:59]
    buffer_load_dwordx4 v12, s[20:23], s41 offen nt lds
    v_mfma_f32_16x16x32_bf16 a[56:59], v[208:211], v[112:115], a[56:59]
    v_exp_f32 v27, v27
    v_mfma_f32_16x16x32_bf16 a[52:55], v[208:211], v[108:111], a[52:55]
    v_cvt_pk_bf16_f32 v163, v26, v27
    v_mfma_f32_16x16x32_bf16 a[52:55], v[212:215], v[124:127], a[52:55]
    v_exp_f32 v28, v28
    v_mfma_f32_16x16x32_bf16 a[132:135], v[244:247], v[124:127], a[132:135]
    v_mfma_f32_16x16x32_bf16 a[132:135], v[244:247], v[108:111], a[132:135]
    s_waitcnt lgkmcnt(0)
    v_exp_f32 v29, v29
    v_mfma_f32_16x16x32_bf16 v[16:19], v[216:219], v[72:75], v[40:43]
    ds_read_b64_tr_b16 v[200:201], v240 offset:0
    v_cvt_pk_bf16_f32 v166, v28, v29
    v_mfma_f32_16x16x32_bf16 v[16:19], v[220:223], v[88:91], v[16:19]
    v_exp_f32 v30, v30
    v_mfma_f32_16x16x32_bf16 v[16:19], v[224:227], v[136:139], v[16:19]
    ds_read_b64_tr_b16 v[202:203], v240 offset:4096
    ds_read_b64_tr_b16 v[204:205], v240 offset:8192
    v_mfma_f32_16x16x32_bf16 v[16:19], v[228:231], v[168:171], v[16:19]
    s_add_u32 m0, s35, 0x18000
    v_exp_f32 v31, v31
    v_mfma_f32_16x16x32_bf16 v[20:23], v[228:231], v[172:175], v[44:47]
    s_add_u32 s41, s47, 0
    ds_read_b64_tr_b16 v[206:207], v240 offset:12288
    v_cvt_pk_bf16_f32 v167, v30, v31
    v_mfma_f32_16x16x32_bf16 v[20:23], v[224:227], v[140:143], v[20:23]
    buffer_load_dwordx4 v13, s[24:27], s41 offen nt lds
    v_mfma_f32_16x16x32_bf16 v[20:23], v[220:223], v[92:95], v[20:23]
    ds_read_b64_tr_b16 v[208:209], v241 offset:0
    ds_read_b64_tr_b16 v[210:211], v241 offset:4096
    v_mfma_f32_16x16x32_bf16 v[20:23], v[216:219], v[76:79], v[20:23]
    v_exp_f32 v16, v16
    v_mfma_f32_16x16x32_bf16 v[24:27], v[216:219], v[80:83], v[48:51]
    ds_read_b64_tr_b16 v[212:213], v241 offset:8192
    ds_read_b64_tr_b16 v[214:215], v241 offset:12288
    v_mfma_f32_16x16x32_bf16 v[24:27], v[220:223], v[96:99], v[24:27]
    v_exp_f32 v17, v17
    v_mfma_f32_16x16x32_bf16 v[24:27], v[224:227], v[144:147], v[24:27]
    s_add_u32 m0, s35, 0x19000
    v_cvt_pk_bf16_f32 v184, v16, v17
    v_mfma_f32_16x16x32_bf16 v[24:27], v[228:231], v[176:179], v[24:27]
    s_add_u32 s41, s47, 4096
    v_exp_f32 v18, v18
    v_mfma_f32_16x16x32_bf16 v[28:31], v[228:231], v[180:183], v[52:55]
    buffer_load_dwordx4 v13, s[24:27], s41 offen nt lds
    v_mfma_f32_16x16x32_bf16 v[28:31], v[224:227], v[148:151], v[28:31]
    v_exp_f32 v19, v19
    v_mfma_f32_16x16x32_bf16 v[28:31], v[220:223], v[100:103], v[28:31]
    v_cvt_pk_bf16_f32 v185, v18, v19
    v_mfma_f32_16x16x32_bf16 v[28:31], v[216:219], v[84:87], v[28:31]
    s_waitcnt lgkmcnt(0)
    v_exp_f32 v20, v20
    v_mfma_f32_16x16x32_bf16 a[72:75], v[204:207], v[128:131], a[72:75]
    ds_read_b128 v[216:219], v232 offset:12288
    v_mfma_f32_16x16x32_bf16 a[72:75], v[200:203], v[112:115], a[72:75]
    v_exp_f32 v21, v21
    v_mfma_f32_16x16x32_bf16 a[76:79], v[200:203], v[116:119], a[76:79]
    ds_read_b128 v[220:223], v233 offset:12288
    v_cvt_pk_bf16_f32 v188, v20, v21
    v_mfma_f32_16x16x32_bf16 a[76:79], v[204:207], v[132:135], a[76:79]
    v_exp_f32 v22, v22
    v_mfma_f32_16x16x32_bf16 a[64:67], v[204:207], v[120:123], a[64:67]
    ds_read_b128 v[224:227], v234 offset:12288
    v_mfma_f32_16x16x32_bf16 a[64:67], v[200:203], v[104:107], a[64:67]
    v_exp_f32 v23, v23
    v_mfma_f32_16x16x32_bf16 a[68:71], v[200:203], v[108:111], a[68:71]
    s_add_u32 m0, s35, 0x1a000
    ds_read_b128 v[228:231], v235 offset:12288
    v_cvt_pk_bf16_f32 v189, v22, v23
    v_mfma_f32_16x16x32_bf16 a[68:71], v[204:207], v[124:127], a[68:71]
    s_add_u32 s41, s47, 8192
    v_exp_f32 v24, v24
    v_mfma_f32_16x16x32_bf16 a[84:87], v[212:215], v[124:127], a[84:87]
    buffer_load_dwordx4 v13, s[24:27], s41 offen nt lds
    v_mfma_f32_16x16x32_bf16 a[84:87], v[208:211], v[108:111], a[84:87]
    v_exp_f32 v25, v25
    v_mfma_f32_16x16x32_bf16 a[80:83], v[208:211], v[104:107], a[80:83]
    s_add_u32 m0, s35, 0x1b000
    v_cvt_pk_bf16_f32 v192, v24, v25
    v_mfma_f32_16x16x32_bf16 a[80:83], v[212:215], v[120:123], a[80:83]
    s_add_u32 s41, s47, 12288
    v_exp_f32 v26, v26
    v_mfma_f32_16x16x32_bf16 a[92:95], v[212:215], v[132:135], a[92:95]
    buffer_load_dwordx4 v13, s[24:27], s41 offen nt lds
    v_mfma_f32_16x16x32_bf16 a[92:95], v[208:211], v[116:119], a[92:95]
    v_exp_f32 v27, v27
    v_mfma_f32_16x16x32_bf16 a[88:91], v[208:211], v[112:115], a[88:91]
    v_cvt_pk_bf16_f32 v193, v26, v27
    v_mfma_f32_16x16x32_bf16 a[88:91], v[212:215], v[128:131], a[88:91]
    v_exp_f32 v28, v28
    v_mfma_f32_16x16x32_bf16 a[136:139], v[244:247], v[128:131], a[136:139]
    v_mfma_f32_16x16x32_bf16 a[136:139], v[244:247], v[112:115], a[136:139]
    s_waitcnt lgkmcnt(0)
    v_exp_f32 v29, v29
    v_mfma_f32_16x16x32_bf16 v[16:19], v[216:219], v[72:75], v[40:43]
    ds_read_b64_tr_b16 v[200:201], v242 offset:0
    v_cvt_pk_bf16_f32 v196, v28, v29
    v_mfma_f32_16x16x32_bf16 v[16:19], v[220:223], v[88:91], v[16:19]
    v_exp_f32 v30, v30
    v_mfma_f32_16x16x32_bf16 v[16:19], v[224:227], v[136:139], v[16:19]
    ds_read_b64_tr_b16 v[202:203], v242 offset:4096
    ds_read_b64_tr_b16 v[204:205], v242 offset:8192
    v_mfma_f32_16x16x32_bf16 v[16:19], v[228:231], v[168:171], v[16:19]
    s_add_u32 m0, s35, 0x1c000
    v_exp_f32 v31, v31
    v_mfma_f32_16x16x32_bf16 v[20:23], v[228:231], v[172:175], v[44:47]
    s_add_u32 s41, s47, 16384
    ds_read_b64_tr_b16 v[206:207], v242 offset:12288
    v_cvt_pk_bf16_f32 v197, v30, v31
    v_mfma_f32_16x16x32_bf16 v[20:23], v[224:227], v[140:143], v[20:23]
    buffer_load_dwordx4 v13, s[24:27], s41 offen nt lds
    v_mfma_f32_16x16x32_bf16 v[20:23], v[220:223], v[92:95], v[20:23]
    ds_read_b64_tr_b16 v[208:209], v243 offset:0
    ds_read_b64_tr_b16 v[210:211], v243 offset:4096
    v_mfma_f32_16x16x32_bf16 v[20:23], v[216:219], v[76:79], v[20:23]
    v_exp_f32 v16, v16
    v_mfma_f32_16x16x32_bf16 v[24:27], v[216:219], v[80:83], v[48:51]
    ds_read_b64_tr_b16 v[212:213], v243 offset:8192
    ds_read_b64_tr_b16 v[214:215], v243 offset:12288
    v_mfma_f32_16x16x32_bf16 v[24:27], v[220:223], v[96:99], v[24:27]
    v_exp_f32 v17, v17
    v_mfma_f32_16x16x32_bf16 v[24:27], v[224:227], v[144:147], v[24:27]
    s_add_u32 m0, s35, 0x1d000
    v_cvt_pk_bf16_f32 v186, v16, v17
    v_mfma_f32_16x16x32_bf16 v[24:27], v[228:231], v[176:179], v[24:27]
    s_add_u32 s41, s47, 20480
    v_exp_f32 v18, v18
    v_mfma_f32_16x16x32_bf16 v[28:31], v[228:231], v[180:183], v[52:55]
    buffer_load_dwordx4 v13, s[24:27], s41 offen nt lds
    v_mfma_f32_16x16x32_bf16 v[28:31], v[224:227], v[148:151], v[28:31]
    v_exp_f32 v19, v19
    v_mfma_f32_16x16x32_bf16 v[28:31], v[220:223], v[100:103], v[28:31]
    v_cvt_pk_bf16_f32 v187, v18, v19
    v_mfma_f32_16x16x32_bf16 v[28:31], v[216:219], v[84:87], v[28:31]
    s_waitcnt lgkmcnt(0)
    v_exp_f32 v20, v20
    v_mfma_f32_16x16x32_bf16 a[108:111], v[204:207], v[132:135], a[108:111]
    ds_read_b128 v[216:219], v232 offset:16384
    v_mfma_f32_16x16x32_bf16 a[108:111], v[200:203], v[116:119], a[108:111]
    v_exp_f32 v21, v21
    v_mfma_f32_16x16x32_bf16 a[96:99], v[200:203], v[104:107], a[96:99]
    ds_read_b128 v[220:223], v233 offset:16384
    v_cvt_pk_bf16_f32 v190, v20, v21
    v_mfma_f32_16x16x32_bf16 a[96:99], v[204:207], v[120:123], a[96:99]
    v_exp_f32 v22, v22
    v_mfma_f32_16x16x32_bf16 a[100:103], v[204:207], v[124:127], a[100:103]
    ds_read_b128 v[224:227], v234 offset:16384
    v_mfma_f32_16x16x32_bf16 a[100:103], v[200:203], v[108:111], a[100:103]
    v_exp_f32 v23, v23
    v_mfma_f32_16x16x32_bf16 a[104:107], v[200:203], v[112:115], a[104:107]
    s_add_u32 m0, s35, 0x1e000
    ds_read_b128 v[228:231], v235 offset:16384
    v_cvt_pk_bf16_f32 v191, v22, v23
    v_mfma_f32_16x16x32_bf16 a[104:107], v[204:207], v[128:131], a[104:107]
    s_add_u32 s41, s47, 24576
    v_exp_f32 v24, v24
    v_mfma_f32_16x16x32_bf16 a[120:123], v[212:215], v[128:131], a[120:123]
    buffer_load_dwordx4 v13, s[24:27], s41 offen nt lds
    v_mfma_f32_16x16x32_bf16 a[120:123], v[208:211], v[112:115], a[120:123]
    v_exp_f32 v25, v25
    v_mfma_f32_16x16x32_bf16 a[116:119], v[208:211], v[108:111], a[116:119]
    s_add_u32 m0, s35, 0x1f000
    v_cvt_pk_bf16_f32 v194, v24, v25
    v_mfma_f32_16x16x32_bf16 a[116:119], v[212:215], v[124:127], a[116:119]
    s_add_u32 s41, s47, 28672
    v_exp_f32 v26, v26
    v_mfma_f32_16x16x32_bf16 a[112:115], v[212:215], v[120:123], a[112:115]
    buffer_load_dwordx4 v13, s[24:27], s41 offen nt lds
    v_mfma_f32_16x16x32_bf16 a[112:115], v[208:211], v[104:107], a[112:115]
    s_add_u32 s46, s46, 32768
    v_exp_f32 v27, v27
    v_mfma_f32_16x16x32_bf16 a[124:127], v[208:211], v[116:119], a[124:127]
    s_add_u32 s47, s47, 32768
    v_cvt_pk_bf16_f32 v195, v26, v27
    v_mfma_f32_16x16x32_bf16 a[124:127], v[212:215], v[132:135], a[124:127]
L_hop0_12:
    s_cbranch_execz L_hop0_ret
    s_sub_u32 s48, s48, 1
    v_exp_f32 v28, v28
    v_mfma_f32_16x16x32_bf16 a[140:143], v[244:247], v[132:135], a[140:143]
    s_cmp_lg_u32 s48, 4
    v_mfma_f32_16x16x32_bf16 a[140:143], v[244:247], v[116:119], a[140:143]
    s_waitcnt lgkmcnt(0)
    v_exp_f32 v29, v29
    s_cbranch_scc1 L_k2_loopa
L_k2_loopb:
    v_mfma_f32_16x16x32_bf16 v[16:19], v[216:219], v[72:75], v[40:43]
    s_lshl_b32 s54, s32, 3
    ds_read_b64_tr_b16 v[200:201], v236 offset:16384
    v_cvt_pk_bf16_f32 v198, v28, v29
    v_mfma_f32_16x16x32_bf16 v[16:19], v[220:223], v[88:91], v[16:19]
    s_add_u32 s54, s54, s48
    v_exp_f32 v30, v30
    v_mfma_f32_16x16x32_bf16 v[16:19], v[224:227], v[136:139], v[16:19]
    ds_read_b64_tr_b16 v[202:203], v236 offset:20480
    ds_read_b64_tr_b16 v[204:205], v236 offset:24576
    v_mfma_f32_16x16x32_bf16 v[16:19], v[228:231], v[168:171], v[16:19]
    v_exp_f32 v31, v31
    v_mfma_f32_16x16x32_bf16 v[20:23], v[228:231], v[172:175], v[44:47]
    ds_read_b64_tr_b16 v[206:207], v236 offset:28672
    v_cvt_pk_bf16_f32 v199, v30, v31
    v_mfma_f32_16x16x32_bf16 v[20:23], v[224:227], v[140:143], v[20:23]
    s_cmp_eq_u32 s54, 4
    s_cselect_b32 s53, s75, 0x40000000
    v_mfma_f32_16x16x32_bf16 v[20:23], v[220:223], v[92:95], v[20:23]
    ds_read_b64_tr_b16 v[208:209], v237 offset:16384
    ds_read_b64_tr_b16 v[210:211], v237 offset:20480
    v_mfma_f32_16x16x32_bf16 v[20:23], v[216:219], v[76:79], v[20:23]
    v_exp_f32 v16, v16
    v_mfma_f32_16x16x32_bf16 v[24:27], v[216:219], v[80:83], v[48:51]
    ds_read_b64_tr_b16 v[212:213], v237 offset:24576
    ds_read_b64_tr_b16 v[214:215], v237 offset:28672
    v_mfma_f32_16x16x32_bf16 v[24:27], v[220:223], v[96:99], v[24:27]
    v_exp_f32 v17, v17
    v_mfma_f32_16x16x32_bf16 v[24:27], v[224:227], v[144:147], v[24:27]
    v_cvt_pk_bf16_f32 v104, v16, v17
    v_mfma_f32_16x16x32_bf16 v[24:27], v[228:231], v[176:179], v[24:27]
    v_exp_f32 v18, v18
    v_mfma_f32_16x16x32_bf16 v[28:31], v[228:231], v[180:183], v[52:55]
    v_mfma_f32_16x16x32_bf16 v[28:31], v[224:227], v[148:151], v[28:31]
    v_exp_f32 v19, v19
    v_mfma_f32_16x16x32_bf16 v[28:31], v[220:223], v[100:103], v[28:31]
    v_cvt_pk_bf16_f32 v105, v18, v19
    v_mfma_f32_16x16x32_bf16 v[28:31], v[216:219], v[84:87], v[28:31]
    s_waitcnt lgkmcnt(0)
    v_exp_f32 v20, v20
    v_mfma_f32_16x16x32_bf16 a[0:3], v[204:207], v[184:187], a[0:3]
    ds_read_b128 v[216:219], v232 offset:20480
    v_mfma_f32_16x16x32_bf16 a[0:3], v[200:203], v[152:155], a[0:3]
    v_exp_f32 v21, v21
    v_mfma_f32_16x16x32_bf16 a[4:7], v[200:203], v[156:159], a[4:7]
    ds_read_b128 v[220:223], v233 offset:20480
    v_cvt_pk_bf16_f32 v108, v20, v21
    v_mfma_f32_16x16x32_bf16 a[4:7], v[204:207], v[188:191], a[4:7]
    v_exp_f32 v22, v22
    v_mfma_f32_16x16x32_bf16 a[8:11], v[204:207], v[192:195], a[8:11]
    ds_read_b128 v[224:227], v234 offset:20480
    v_mfma_f32_16x16x32_bf16 a[8:11], v[200:203], v[160:163], a[8:11]
    v_exp_f32 v23, v23
    v_mfma_f32_16x16x32_bf16 a[12:15], v[200:203], v[164:167], a[12:15]
    ds_read_b128 v[228:231], v235 offset:20480
    v_cvt_pk_bf16_f32 v109, v22, v23
    v_mfma_f32_16x16x32_bf16 a[12:15], v[204:207], v[196:199], a[12:15]
    v_exp_f32 v24, v24
    v_mfma_f32_16x16x32_bf16 a[28:31], v[212:215], v[196:199], a[28:31]
    v_mfma_f32_16x16x32_bf16 a[28:31], v[208:211], v[164:167], a[28:31]
    v_exp_f32 v25, v25
    v_mfma_f32_16x16x32_bf16 a[24:27], v[208:211], v[160:163], a[24:27]
    v_cvt_pk_bf16_f32 v112, v24, v25
    v_mfma_f32_16x16x32_bf16 a[24:27], v[212:215], v[192:195], a[24:27]
    v_exp_f32 v26, v26
    v_mfma_f32_16x16x32_bf16 a[20:23], v[212:215], v[188:191], a[20:23]
    v_mfma_f32_16x16x32_bf16 a[20:23], v[208:211], v[156:159], a[20:23]
    v_exp_f32 v27, v27
    v_mfma_f32_16x16x32_bf16 a[16:19], v[208:211], v[152:155], a[16:19]
    v_cvt_pk_bf16_f32 v113, v26, v27
    v_mfma_f32_16x16x32_bf16 a[16:19], v[212:215], v[184:187], a[16:19]
    v_exp_f32 v28, v28
    v_mfma_f32_16x16x32_bf16 a[128:131], v[244:247], v[184:187], a[128:131]
    v_mfma_f32_16x16x32_bf16 a[128:131], v[244:247], v[152:155], a[128:131]
    s_waitcnt lgkmcnt(0)
    v_exp_f32 v29, v29
    v_mfma_f32_16x16x32_bf16 v[16:19], v[216:219], v[72:75], v[40:43]
    ds_read_b64_tr_b16 v[200:201], v238 offset:16384
    v_cvt_pk_bf16_f32 v116, v28, v29
    v_mfma_f32_16x16x32_bf16 v[16:19], v[220:223], v[88:91], v[16:19]
    v_exp_f32 v30, v30
    v_mfma_f32_16x16x32_bf16 v[16:19], v[224:227], v[136:139], v[16:19]
    ds_read_b64_tr_b16 v[202:203], v238 offset:20480
    ds_read_b64_tr_b16 v[204:205], v238 offset:24576
    v_mfma_f32_16x16x32_bf16 v[16:19], v[228:231], v[168:171], v[16:19]
    v_exp_f32 v31, v31
    v_mfma_f32_16x16x32_bf16 v[20:23], v[228:231], v[172:175], v[44:47]
    ds_read_b64_tr_b16 v[206:207], v238 offset:28672
    v_cvt_pk_bf16_f32 v117, v30, v31
    v_mfma_f32_16x16x32_bf16 v[20:23], v[224:227], v[140:143], v[20:23]
    v_mfma_f32_16x16x32_bf16 v[20:23], v[220:223], v[92:95], v[20:23]
    ds_read_b64_tr_b16 v[208:209], v239 offset:16384
    ds_read_b64_tr_b16 v[210:211], v239 offset:20480
    v_mfma_f32_16x16x32_bf16 v[20:23], v[216:219], v[76:79], v[20:23]
    v_exp_f32 v16, v16
    v_mfma_f32_16x16x32_bf16 v[24:27], v[216:219], v[80:83], v[48:51]
    ds_read_b64_tr_b16 v[212:213], v239 offset:24576
    ds_read_b64_tr_b16 v[214:215], v239 offset:28672
    v_mfma_f32_16x16x32_bf16 v[24:27], v[220:223], v[96:99], v[24:27]
    v_exp_f32 v17, v17
    v_mfma_f32_16x16x32_bf16 v[24:27], v[224:227], v[144:147], v[24:27]
    v_cvt_pk_bf16_f32 v106, v16, v17
    v_mfma_f32_16x16x32_bf16 v[24:27], v[228:231], v[176:179], v[24:27]
    v_exp_f32 v18, v18
    v_mfma_f32_16x16x32_bf16 v[28:31], v[228:231], v[180:183], v[52:55]
    v_mfma_f32_16x16x32_bf16 v[28:31], v[224:227], v[148:151], v[28:31]
    v_exp_f32 v19, v19
    v_mfma_f32_16x16x32_bf16 v[28:31], v[220:223], v[100:103], v[28:31]
    v_cvt_pk_bf16_f32 v107, v18, v19
    v_mfma_f32_16x16x32_bf16 v[28:31], v[216:219], v[84:87], v[28:31]
    s_waitcnt lgkmcnt(0)
    v_exp_f32 v20, v20
    v_mfma_f32_16x16x32_bf16 a[36:39], v[204:207], v[188:191], a[36:39]
    ds_read_b128 v[216:219], v232 offset:24576
    v_mfma_f32_16x16x32_bf16 a[36:39], v[200:203], v[156:159], a[36:39]
    v_exp_f32 v21, v21
    v_mfma_f32_16x16x32_bf16 a[40:43], v[200:203], v[160:163], a[40:43]
    ds_read_b128 v[220:223], v233 offset:24576
    v_cvt_pk_bf16_f32 v110, v20, v21
    v_mfma_f32_16x16x32_bf16 a[40:43], v[204:207], v[192:195], a[40:43]
    v_exp_f32 v22, v22
    v_mfma_f32_16x16x32_bf16 a[44:47], v[204:207], v[196:199], a[44:47]
    ds_read_b128 v[224:227], v234 offset:24576
    v_mfma_f32_16x16x32_bf16 a[44:47], v[200:203], v[164:167], a[44:47]
    v_exp_f32 v23, v23
    v_mfma_f32_16x16x32_bf16 a[32:35], v[200:203], v[152:155], a[32:35]
    ds_read_b128 v[228:231], v235 offset:24576
    v_cvt_pk_bf16_f32 v111, v22, v23
    v_mfma_f32_16x16x32_bf16 a[32:35], v[204:207], v[184:187], a[32:35]
    v_exp_f32 v24, v24
    v_mfma_f32_16x16x32_bf16 a[48:51], v[212:215], v[184:187], a[48:51]
    v_mfma_f32_16x16x32_bf16 a[48:51], v[208:211], v[152:155], a[48:51]
    v_exp_f32 v25, v25
    v_mfma_f32_16x16x32_bf16 a[60:63], v[208:211], v[164:167], a[60:63]
    v_cvt_pk_bf16_f32 v114, v24, v25
    v_mfma_f32_16x16x32_bf16 a[60:63], v[212:215], v[196:199], a[60:63]
    v_exp_f32 v26, v26
    v_mfma_f32_16x16x32_bf16 a[56:59], v[212:215], v[192:195], a[56:59]
    v_mfma_f32_16x16x32_bf16 a[56:59], v[208:211], v[160:163], a[56:59]
    v_exp_f32 v27, v27
    v_mfma_f32_16x16x32_bf16 a[52:55], v[208:211], v[156:159], a[52:55]
    v_cvt_pk_bf16_f32 v115, v26, v27
    v_mfma_f32_16x16x32_bf16 a[52:55], v[212:215], v[188:191], a[52:55]
    v_exp_f32 v28, v28
    v_mfma_f32_16x16x32_bf16 a[132:135], v[244:247], v[188:191], a[132:135]
    v_mfma_f32_16x16x32_bf16 a[132:135], v[244:247], v[156:159], a[132:135]
    s_waitcnt lgkmcnt(0)
    v_exp_f32 v29, v29
    v_mfma_f32_16x16x32_bf16 v[16:19], v[216:219], v[72:75], v[40:43]
    ds_read_b64_tr_b16 v[200:201], v240 offset:16384
    v_cvt_pk_bf16_f32 v118, v28, v29
    v_mfma_f32_16x16x32_bf16 v[16:19], v[220:223], v[88:91], v[16:19]
    v_exp_f32 v30, v30
    v_mfma_f32_16x16x32_bf16 v[16:19], v[224:227], v[136:139], v[16:19]
    ds_read_b64_tr_b16 v[202:203], v240 offset:20480
    ds_read_b64_tr_b16 v[204:205], v240 offset:24576
    v_mfma_f32_16x16x32_bf16 v[16:19], v[228:231], v[168:171], v[16:19]
    v_exp_f32 v31, v31
    v_mfma_f32_16x16x32_bf16 v[20:23], v[228:231], v[172:175], v[44:47]
    ds_read_b64_tr_b16 v[206:207], v240 offset:28672
    v_cvt_pk_bf16_f32 v119, v30, v31
    v_mfma_f32_16x16x32_bf16 v[20:23], v[224:227], v[140:143], v[20:23]
    v_mfma_f32_16x16x32_bf16 v[20:23], v[220:223], v[92:95], v[20:23]
    ds_read_b64_tr_b16 v[208:209], v241 offset:16384
    ds_read_b64_tr_b16 v[210:211], v241 offset:20480
    v_mfma_f32_16x16x32_bf16 v[20:23], v[216:219], v[76:79], v[20:23]
    v_exp_f32 v16, v16
    v_mfma_f32_16x16x32_bf16 v[24:27], v[216:219], v[80:83], v[48:51]
    ds_read_b64_tr_b16 v[212:213], v241 offset:24576
    ds_read_b64_tr_b16 v[214:215], v241 offset:28672
    v_mfma_f32_16x16x32_bf16 v[24:27], v[220:223], v[96:99], v[24:27]
    v_exp_f32 v17, v17
    v_mfma_f32_16x16x32_bf16 v[24:27], v[224:227], v[144:147], v[24:27]
    v_cvt_pk_bf16_f32 v120, v16, v17
    v_mfma_f32_16x16x32_bf16 v[24:27], v[228:231], v[176:179], v[24:27]
    v_exp_f32 v18, v18
    v_mfma_f32_16x16x32_bf16 v[28:31], v[228:231], v[180:183], v[52:55]
    v_mfma_f32_16x16x32_bf16 v[28:31], v[224:227], v[148:151], v[28:31]
    v_exp_f32 v19, v19
    v_mfma_f32_16x16x32_bf16 v[28:31], v[220:223], v[100:103], v[28:31]
    v_cvt_pk_bf16_f32 v121, v18, v19
    v_mfma_f32_16x16x32_bf16 v[28:31], v[216:219], v[84:87], v[28:31]
    s_waitcnt lgkmcnt(0)
    v_exp_f32 v20, v20
    v_mfma_f32_16x16x32_bf16 a[72:75], v[204:207], v[192:195], a[72:75]
    ds_read_b128 v[216:219], v232 offset:28672
    v_mfma_f32_16x16x32_bf16 a[72:75], v[200:203], v[160:163], a[72:75]
    v_exp_f32 v21, v21
    v_mfma_f32_16x16x32_bf16 a[76:79], v[200:203], v[164:167], a[76:79]
    ds_read_b128 v[220:223], v233 offset:28672
    v_cvt_pk_bf16_f32 v124, v20, v21
    v_mfma_f32_16x16x32_bf16 a[76:79], v[204:207], v[196:199], a[76:79]
    v_exp_f32 v22, v22
    v_mfma_f32_16x16x32_bf16 a[64:67], v[204:207], v[184:187], a[64:67]
    ds_read_b128 v[224:227], v234 offset:28672
    v_mfma_f32_16x16x32_bf16 a[64:67], v[200:203], v[152:155], a[64:67]
    v_exp_f32 v23, v23
    v_mfma_f32_16x16x32_bf16 a[68:71], v[200:203], v[156:159], a[68:71]
    ds_read_b128 v[228:231], v235 offset:28672
    v_cvt_pk_bf16_f32 v125, v22, v23
    v_mfma_f32_16x16x32_bf16 a[68:71], v[204:207], v[188:191], a[68:71]
    v_exp_f32 v24, v24
    v_mfma_f32_16x16x32_bf16 a[84:87], v[212:215], v[188:191], a[84:87]
    v_mfma_f32_16x16x32_bf16 a[84:87], v[208:211], v[156:159], a[84:87]
    v_exp_f32 v25, v25
    v_mfma_f32_16x16x32_bf16 a[80:83], v[208:211], v[152:155], a[80:83]
    v_cvt_pk_bf16_f32 v128, v24, v25
    v_mfma_f32_16x16x32_bf16 a[80:83], v[212:215], v[184:187], a[80:83]
    v_exp_f32 v26, v26
    v_mfma_f32_16x16x32_bf16 a[92:95], v[212:215], v[196:199], a[92:95]
    v_mfma_f32_16x16x32_bf16 a[92:95], v[208:211], v[164:167], a[92:95]
    v_exp_f32 v27, v27
    v_mfma_f32_16x16x32_bf16 a[88:91], v[208:211], v[160:163], a[88:91]
    v_cvt_pk_bf16_f32 v129, v26, v27
    v_mfma_f32_16x16x32_bf16 a[88:91], v[212:215], v[192:195], a[88:91]
    v_exp_f32 v28, v28
    v_mfma_f32_16x16x32_bf16 a[136:139], v[244:247], v[192:195], a[136:139]
    buffer_atomic_add v11, v7, s[4:7], s50 offen sc1
    v_mfma_f32_16x16x32_bf16 a[136:139], v[244:247], v[160:163], a[136:139]
    s_waitcnt lgkmcnt(0)
    v_exp_f32 v29, v29
    v_mfma_f32_16x16x32_bf16 v[16:19], v[216:219], v[72:75], v[40:43]
    ds_read_b64_tr_b16 v[200:201], v242 offset:16384
    v_cvt_pk_bf16_f32 v132, v28, v29
    v_mfma_f32_16x16x32_bf16 v[16:19], v[220:223], v[88:91], v[16:19]
    v_exp_f32 v30, v30
    v_mfma_f32_16x16x32_bf16 v[16:19], v[224:227], v[136:139], v[16:19]
    ds_read_b64_tr_b16 v[202:203], v242 offset:20480
    ds_read_b64_tr_b16 v[204:205], v242 offset:24576
    v_mfma_f32_16x16x32_bf16 v[16:19], v[228:231], v[168:171], v[16:19]
    v_exp_f32 v31, v31
    v_mfma_f32_16x16x32_bf16 v[20:23], v[228:231], v[172:175], v[44:47]
    ds_read_b64_tr_b16 v[206:207], v242 offset:28672
    v_cvt_pk_bf16_f32 v133, v30, v31
    v_mfma_f32_16x16x32_bf16 v[20:23], v[224:227], v[140:143], v[20:23]
    v_mfma_f32_16x16x32_bf16 v[20:23], v[220:223], v[92:95], v[20:23]
    ds_read_b64_tr_b16 v[208:209], v243 offset:16384
    ds_read_b64_tr_b16 v[210:211], v243 offset:20480
    v_mfma_f32_16x16x32_bf16 v[20:23], v[216:219], v[76:79], v[20:23]
    v_exp_f32 v16, v16
    v_mfma_f32_16x16x32_bf16 v[24:27], v[216:219], v[80:83], v[48:51]
    ds_read_b64_tr_b16 v[212:213], v243 offset:24576
    ds_read_b64_tr_b16 v[214:215], v243 offset:28672
    v_mfma_f32_16x16x32_bf16 v[24:27], v[220:223], v[96:99], v[24:27]
    v_exp_f32 v17, v17
    v_mfma_f32_16x16x32_bf16 v[24:27], v[224:227], v[144:147], v[24:27]
    v_cvt_pk_bf16_f32 v122, v16, v17
    v_mfma_f32_16x16x32_bf16 v[24:27], v[228:231], v[176:179], v[24:27]
    v_exp_f32 v18, v18
    v_mfma_f32_16x16x32_bf16 v[28:31], v[228:231], v[180:183], v[52:55]
    v_mfma_f32_16x16x32_bf16 v[28:31], v[224:227], v[148:151], v[28:31]
    v_exp_f32 v19, v19
    v_mfma_f32_16x16x32_bf16 v[28:31], v[220:223], v[100:103], v[28:31]
    v_cvt_pk_bf16_f32 v123, v18, v19
    v_mfma_f32_16x16x32_bf16 v[28:31], v[216:219], v[84:87], v[28:31]
    s_waitcnt vmcnt(1) lgkmcnt(0)
    s_barrier
    v_exp_f32 v20, v20
    v_mfma_f32_16x16x32_bf16 a[108:111], v[204:207], v[196:199], a[108:111]
    ds_read_b128 v[216:219], v232 offset:32768
    v_mfma_f32_16x16x32_bf16 a[108:111], v[200:203], v[164:167], a[108:111]
    v_exp_f32 v21, v21
    v_mfma_f32_16x16x32_bf16 a[96:99], v[200:203], v[152:155], a[96:99]
    ds_read_b128 v[220:223], v233 offset:32768
    v_cvt_pk_bf16_f32 v126, v20, v21
    v_mfma_f32_16x16x32_bf16 a[96:99], v[204:207], v[184:187], a[96:99]
    v_exp_f32 v22, v22
    v_mfma_f32_16x16x32_bf16 a[100:103], v[204:207], v[188:191], a[100:103]
    ds_read_b128 v[224:227], v234 offset:32768
    v_mfma_f32_16x16x32_bf16 a[100:103], v[200:203], v[156:159], a[100:103]
    v_exp_f32 v23, v23
    v_mfma_f32_16x16x32_bf16 a[104:107], v[200:203], v[160:163], a[104:107]
    ds_read_b128 v[228:231], v235 offset:32768
    v_cvt_pk_bf16_f32 v127, v22, v23
    v_mfma_f32_16x16x32_bf16 a[104:107], v[204:207], v[192:195], a[104:107]
    v_exp_f32 v24, v24
    v_mfma_f32_16x16x32_bf16 a[120:123], v[212:215], v[192:195], a[120:123]
    buffer_store_dword v11, v7, s[4:7], s53 offen sc1
    v_mfma_f32_16x16x32_bf16 a[120:123], v[208:211], v[160:163], a[120:123]
    v_exp_f32 v25, v25
    v_mfma_f32_16x16x32_bf16 a[116:119], v[208:211], v[156:159], a[116:119]
    v_cvt_pk_bf16_f32 v130, v24, v25
    v_mfma_f32_16x16x32_bf16 a[116:119], v[212:215], v[188:191], a[116:119]
    v_exp_f32 v26, v26
    v_mfma_f32_16x16x32_bf16 a[112:115], v[212:215], v[184:187], a[112:115]
    v_mfma_f32_16x16x32_bf16 a[112:115], v[208:211], v[152:155], a[112:115]
    v_exp_f32 v27, v27
    v_mfma_f32_16x16x32_bf16 a[124:127], v[208:211], v[164:167], a[124:127]
    v_cvt_pk_bf16_f32 v131, v26, v27
    v_mfma_f32_16x16x32_bf16 a[124:127], v[212:215], v[196:199], a[124:127]
    v_exp_f32 v28, v28
    v_mfma_f32_16x16x32_bf16 a[140:143], v[244:247], v[196:199], a[140:143]
    v_mfma_f32_16x16x32_bf16 a[140:143], v[244:247], v[164:167], a[140:143]
    s_waitcnt lgkmcnt(0)
    v_exp_f32 v29, v29
    v_mfma_f32_16x16x32_bf16 v[16:19], v[216:219], v[72:75], v[40:43]
    ds_read_b64_tr_b16 v[200:201], v236 offset:32768
    v_cvt_pk_bf16_f32 v134, v28, v29
    v_mfma_f32_16x16x32_bf16 v[16:19], v[220:223], v[88:91], v[16:19]
    v_exp_f32 v30, v30
    v_mfma_f32_16x16x32_bf16 v[16:19], v[224:227], v[136:139], v[16:19]
    ds_read_b64_tr_b16 v[202:203], v236 offset:36864
    ds_read_b64_tr_b16 v[204:205], v236 offset:40960
    v_mfma_f32_16x16x32_bf16 v[16:19], v[228:231], v[168:171], v[16:19]
    s_add_u32 m0, s35, 0x0
    v_exp_f32 v31, v31
    v_mfma_f32_16x16x32_bf16 v[20:23], v[228:231], v[172:175], v[44:47]
    s_add_u32 s41, s46, 0
    ds_read_b64_tr_b16 v[206:207], v236 offset:45056
    v_cvt_pk_bf16_f32 v135, v30, v31
    v_mfma_f32_16x16x32_bf16 v[20:23], v[224:227], v[140:143], v[20:23]
    buffer_load_dwordx4 v12, s[20:23], s41 offen nt lds
    v_mfma_f32_16x16x32_bf16 v[20:23], v[220:223], v[92:95], v[20:23]
    ds_read_b64_tr_b16 v[208:209], v237 offset:32768
    ds_read_b64_tr_b16 v[210:211], v237 offset:36864
    v_mfma_f32_16x16x32_bf16 v[20:23], v[216:219], v[76:79], v[20:23]
    v_exp_f32 v16, v16
    v_mfma_f32_16x16x32_bf16 v[24:27], v[216:219], v[80:83], v[48:51]
    ds_read_b64_tr_b16 v[212:213], v237 offset:40960
    ds_read_b64_tr_b16 v[214:215], v237 offset:45056
    v_mfma_f32_16x16x32_bf16 v[24:27], v[220:223], v[96:99], v[24:27]
    v_exp_f32 v17, v17
    v_mfma_f32_16x16x32_bf16 v[24:27], v[224:227], v[144:147], v[24:27]
    s_add_u32 m0, s35, 0x1000
    v_cvt_pk_bf16_f32 v152, v16, v17
    v_mfma_f32_16x16x32_bf16 v[24:27], v[228:231], v[176:179], v[24:27]
    s_add_u32 s41, s46, 4096
    v_exp_f32 v18, v18
    v_mfma_f32_16x16x32_bf16 v[28:31], v[228:231], v[180:183], v[52:55]
    buffer_load_dwordx4 v12, s[20:23], s41 offen nt lds
    v_mfma_f32_16x16x32_bf16 v[28:31], v[224:227], v[148:151], v[28:31]
    v_exp_f32 v19, v19
    v_mfma_f32_16x16x32_bf16 v[28:31], v[220:223], v[100:103], v[28:31]
    v_cvt_pk_bf16_f32 v153, v18, v19
    v_mfma_f32_16x16x32_bf16 v[28:31], v[216:219], v[84:87], v[28:31]
    s_waitcnt lgkmcnt(0)
    v_exp_f32 v20, v20
    v_mfma_f32_16x16x32_bf16 a[0:3], v[204:207], v[120:123], a[0:3]
    ds_read_b128 v[216:219], v232 offset:36864
    v_mfma_f32_16x16x32_bf16 a[0:3], v[200:203], v[104:107], a[0:3]
    v_exp_f32 v21, v21
    v_mfma_f32_16x16x32_bf16 a[4:7], v[200:203], v[108:111], a[4:7]
    ds_read_b128 v[220:223], v233 offset:36864
    v_cvt_pk_bf16_f32 v156, v20, v21
    v_mfma_f32_16x16x32_bf16 a[4:7], v[204:207], v[124:127], a[4:7]
    v_exp_f32 v22, v22
    v_mfma_f32_16x16x32_bf16 a[8:11], v[204:207], v[128:131], a[8:11]
    ds_read_b128 v[224:227], v234 offset:36864
    v_mfma_f32_16x16x32_bf16 a[8:11], v[200:203], v[112:115], a[8:11]
    v_exp_f32 v23, v23
    v_mfma_f32_16x16x32_bf16 a[12:15], v[200:203], v[116:119], a[12:15]
    s_add_u32 m0, s35, 0x2000
    ds_read_b128 v[228:231], v235 offset:36864
    v_cvt_pk_bf16_f32 v157, v22, v23
    v_mfma_f32_16x16x32_bf16 a[12:15], v[204:207], v[132:135], a[12:15]
    s_add_u32 s41, s46, 8192
    v_exp_f32 v24, v24
    v_mfma_f32_16x16x32_bf16 a[28:31], v[212:215], v[132:135], a[28:31]
    buffer_load_dwordx4 v12, s[20:23], s41 offen nt lds
    v_mfma_f32_16x16x32_bf16 a[28:31], v[208:211], v[116:119], a[28:31]
    v_exp_f32 v25, v25
    v_mfma_f32_16x16x32_bf16 a[24:27], v[208:211], v[112:115], a[24:27]
    s_add_u32 m0, s35, 0x3000
    v_cvt_pk_bf16_f32 v160, v24, v25
    v_mfma_f32_16x16x32_bf16 a[24:27], v[212:215], v[128:131], a[24:27]
    s_add_u32 s41, s46, 12288
    v_exp_f32 v26, v26
    v_mfma_f32_16x16x32_bf16 a[20:23], v[212:215], v[124:127], a[20:23]
    buffer_load_dwordx4 v12, s[20:23], s41 offen nt lds
    v_mfma_f32_16x16x32_bf16 a[20:23], v[208:211], v[108:111], a[20:23]
    v_exp_f32 v27, v27
    v_mfma_f32_16x16x32_bf16 a[16:19], v[208:211], v[104:107], a[16:19]
    v_cvt_pk_bf16_f32 v161, v26, v27
    v_mfma_f32_16x16x32_bf16 a[16:19], v[212:215], v[120:123], a[16:19]
    v_exp_f32 v28, v28
    v_mfma_f32_16x16x32_bf16 a[128:131], v[244:247], v[120:123], a[128:131]
    v_mfma_f32_16x16x32_bf16 a[128:131], v[244:247], v[104:107], a[128:131]
    s_waitcnt lgkmcnt(0)
    v_exp_f32 v29, v29
    v_mfma_f32_16x16x32_bf16 v[16:19], v[216:219], v[72:75], v[40:43]
    ds_read_b64_tr_b16 v[200:201], v238 offset:32768
    v_cvt_pk_bf16_f32 v164, v28, v29
    v_mfma_f32_16x16x32_bf16 v[16:19], v[220:223], v[88:91], v[16:19]
    v_exp_f32 v30, v30
    v_mfma_f32_16x16x32_bf16 v[16:19], v[224:227], v[136:139], v[16:19]
    ds_read_b64_tr_b16 v[202:203], v238 offset:36864
    ds_read_b64_tr_b16 v[204:205], v238 offset:40960
    v_mfma_f32_16x16x32_bf16 v[16:19], v[228:231], v[168:171], v[16:19]
    s_add_u32 m0, s35, 0x4000
    v_exp_f32 v31, v31
    v_mfma_f32_16x16x32_bf16 v[20:23], v[228:231], v[172:175], v[44:47]
    s_add_u32 s41, s46, 16384
    ds_read_b64_tr_b16 v[206:207], v238 offset:45056
    v_cvt_pk_bf16_f32 v165, v30, v31
    v_mfma_f32_16x16x32_bf16 v[20:23], v[224:227], v[140:143], v[20:23]
    buffer_load_dwordx4 v12, s[20:23], s41 offen nt lds
    v_mfma_f32_16x16x32_bf16 v[20:23], v[220:223], v[92:95], v[20:23]
    ds_read_b64_tr_b16 v[208:209], v239 offset:32768
    ds_read_b64_tr_b16 v[210:211], v239 offset:36864
    v_mfma_f32_16x16x32_bf16 v[20:23], v[216:219], v[76:79], v[20:23]
    v_exp_f32 v16, v16
    v_mfma_f32_16x16x32_bf16 v[24:27], v[216:219], v[80:83], v[48:51]
    ds_read_b64_tr_b16 v[212:213], v239 offset:40960
    ds_read_b64_tr_b16 v[214:215], v239 offset:45056
    v_mfma_f32_16x16x32_bf16 v[24:27], v[220:223], v[96:99], v[24:27]
    v_exp_f32 v17, v17
    v_mfma_f32_16x16x32_bf16 v[24:27], v[224:227], v[144:147], v[24:27]
    s_add_u32 m0, s35, 0x5000
    v_cvt_pk_bf16_f32 v154, v16, v17
    v_mfma_f32_16x16x32_bf16 v[24:27], v[228:231], v[176:179], v[24:27]
    s_add_u32 s41, s46, 20480
    v_exp_f32 v18, v18
    v_mfma_f32_16x16x32_bf16 v[28:31], v[228:231], v[180:183], v[52:55]
    buffer_load_dwordx4 v12, s[20:23], s41 offen nt lds
    v_mfma_f32_16x16x32_bf16 v[28:31], v[224:227], v[148:151], v[28:31]
    v_exp_f32 v19, v19
    v_mfma_f32_16x16x32_bf16 v[28:31], v[220:223], v[100:103], v[28:31]
    v_cvt_pk_bf16_f32 v155, v18, v19
    v_mfma_f32_16x16x32_bf16 v[28:31], v[216:219], v[84:87], v[28:31]
    s_waitcnt lgkmcnt(0)
    v_exp_f32 v20, v20
    v_mfma_f32_16x16x32_bf16 a[36:39], v[204:207], v[124:127], a[36:39]
    ds_read_b128 v[216:219], v232 offset:40960
    v_mfma_f32_16x16x32_bf16 a[36:39], v[200:203], v[108:111], a[36:39]
    v_exp_f32 v21, v21
    v_mfma_f32_16x16x32_bf16 a[40:43], v[200:203], v[112:115], a[40:43]
    ds_read_b128 v[220:223], v233 offset:40960
    v_cvt_pk_bf16_f32 v158, v20, v21
    v_mfma_f32_16x16x32_bf16 a[40:43], v[204:207], v[128:131], a[40:43]
    v_exp_f32 v22, v22
    v_mfma_f32_16x16x32_bf16 a[44:47], v[204:207], v[132:135], a[44:47]
    ds_read_b128 v[224:227], v234 offset:40960
    v_mfma_f32_16x16x32_bf16 a[44:47], v[200:203], v[116:119], a[44:47]
    v_exp_f32 v23, v23
    v_mfma_f32_16x16x32_bf16 a[32:35], v[200:203], v[104:107], a[32:35]
    s_add_u32 m0, s35, 0x6000
    ds_read_b128 v[228:231], v235 offset:40960
    v_cvt_pk_bf16_f32 v159, v22, v23
    v_mfma_f32_16x16x32_bf16 a[32:35], v[204:207], v[120:123], a[32:35]
    s_add_u32 s41, s46, 24576
    v_exp_f32 v24, v24
    v_mfma_f32_16x16x32_bf16 a[48:51], v[212:215], v[120:123], a[48:51]
    buffer_load_dwordx4 v12, s[20:23], s41 offen nt lds
    v_mfma_f32_16x16x32_bf16 a[48:51], v[208:211], v[104:107], a[48:51]
    v_exp_f32 v25, v25
    v_mfma_f32_16x16x32_bf16 a[60:63], v[208:211], v[116:119], a[60:63]
    s_add_u32 m0, s35, 0x7000
    v_cvt_pk_bf16_f32 v162, v24, v25
    v_mfma_f32_16x16x32_bf16 a[60:63], v[212:215], v[132:135], a[60:63]
    s_add_u32 s41, s46, 28672
    v_exp_f32 v26, v26
    v_mfma_f32_16x16x32_bf16 a[56:59], v[212:215], v[128:131], a[56:59]
    buffer_load_dwordx4 v12, s[20:23], s41 offen nt lds
    v_mfma_f32_16x16x32_bf16 a[56:59], v[208:211], v[112:115], a[56:59]
    v_exp_f32 v27, v27
    v_mfma_f32_16x16x32_bf16 a[52:55], v[208:211], v[108:111], a[52:55]
    v_cvt_pk_bf16_f32 v163, v26, v27
    v_mfma_f32_16x16x32_bf16 a[52:55], v[212:215], v[124:127], a[52:55]
    v_exp_f32 v28, v28
    v_mfma_f32_16x16x32_bf16 a[132:135], v[244:247], v[124:127], a[132:135]
    v_mfma_f32_16x16x32_bf16 a[132:135], v[244:247], v[108:111], a[132:135]
    s_waitcnt lgkmcnt(0)
    v_exp_f32 v29, v29
    v_mfma_f32_16x16x32_bf16 v[16:19], v[216:219], v[72:75], v[40:43]
    ds_read_b64_tr_b16 v[200:201], v240 offset:32768
    v_cvt_pk_bf16_f32 v166, v28, v29
    v_mfma_f32_16x16x32_bf16 v[16:19], v[220:223], v[88:91], v[16:19]
    v_exp_f32 v30, v30
    v_mfma_f32_16x16x32_bf16 v[16:19], v[224:227], v[136:139], v[16:19]
    ds_read_b64_tr_b16 v[202:203], v240 offset:36864
    ds_read_b64_tr_b16 v[204:205], v240 offset:40960
    v_mfma_f32_16x16x32_bf16 v[16:19], v[228:231], v[168:171], v[16:19]
    s_add_u32 m0, s35, 0x10000
    v_exp_f32 v31, v31
    v_mfma_f32_16x16x32_bf16 v[20:23], v[228:231], v[172:175], v[44:47]
    s_add_u32 s41, s47, 0
    ds_read_b64_tr_b16 v[206:207], v240 offset:45056
    v_cvt_pk_bf16_f32 v167, v30, v31
    v_mfma_f32_16x16x32_bf16 v[20:23], v[224:227], v[140:143], v[20:23]
    buffer_load_dwordx4 v13, s[24:27], s41 offen nt lds
    v_mfma_f32_16x16x32_bf16 v[20:23], v[220:223], v[92:95], v[20:23]
    ds_read_b64_tr_b16 v[208:209], v241 offset:32768
    ds_read_b64_tr_b16 v[210:211], v241 offset:36864
    v_mfma_f32_16x16x32_bf16 v[20:23], v[216:219], v[76:79], v[20:23]
    v_exp_f32 v16, v16
    v_mfma_f32_16x16x32_bf16 v[24:27], v[216:219], v[80:83], v[48:51]
    ds_read_b64_tr_b16 v[212:213], v241 offset:40960
    ds_read_b64_tr_b16 v[214:215], v241 offset:45056
    v_mfma_f32_16x16x32_bf16 v[24:27], v[220:223], v[96:99], v[24:27]
    v_exp_f32 v17, v17
    v_mfma_f32_16x16x32_bf16 v[24:27], v[224:227], v[144:147], v[24:27]
    s_add_u32 m0, s35, 0x11000
    v_cvt_pk_bf16_f32 v184, v16, v17
    v_mfma_f32_16x16x32_bf16 v[24:27], v[228:231], v[176:179], v[24:27]
    s_add_u32 s41, s47, 4096
    v_exp_f32 v18, v18
    v_mfma_f32_16x16x32_bf16 v[28:31], v[228:231], v[180:183], v[52:55]
    buffer_load_dwordx4 v13, s[24:27], s41 offen nt lds
    v_mfma_f32_16x16x32_bf16 v[28:31], v[224:227], v[148:151], v[28:31]
    v_exp_f32 v19, v19
    v_mfma_f32_16x16x32_bf16 v[28:31], v[220:223], v[100:103], v[28:31]
    v_cvt_pk_bf16_f32 v185, v18, v19
    v_mfma_f32_16x16x32_bf16 v[28:31], v[216:219], v[84:87], v[28:31]
    s_waitcnt lgkmcnt(0)
    v_exp_f32 v20, v20
    v_mfma_f32_16x16x32_bf16 a[72:75], v[204:207], v[128:131], a[72:75]
    ds_read_b128 v[216:219], v232 offset:45056
    v_mfma_f32_16x16x32_bf16 a[72:75], v[200:203], v[112:115], a[72:75]
    v_exp_f32 v21, v21
    v_mfma_f32_16x16x32_bf16 a[76:79], v[200:203], v[116:119], a[76:79]
    ds_read_b128 v[220:223], v233 offset:45056
    v_cvt_pk_bf16_f32 v188, v20, v21
    v_mfma_f32_16x16x32_bf16 a[76:79], v[204:207], v[132:135], a[76:79]
    v_exp_f32 v22, v22
    v_mfma_f32_16x16x32_bf16 a[64:67], v[204:207], v[120:123], a[64:67]
    ds_read_b128 v[224:227], v234 offset:45056
    v_mfma_f32_16x16x32_bf16 a[64:67], v[200:203], v[104:107], a[64:67]
    v_exp_f32 v23, v23
    v_mfma_f32_16x16x32_bf16 a[68:71], v[200:203], v[108:111], a[68:71]
    s_add_u32 m0, s35, 0x12000
    ds_read_b128 v[228:231], v235 offset:45056
    v_cvt_pk_bf16_f32 v189, v22, v23
    v_mfma_f32_16x16x32_bf16 a[68:71], v[204:207], v[124:127], a[68:71]
    s_add_u32 s41, s47, 8192
    v_exp_f32 v24, v24
    v_mfma_f32_16x16x32_bf16 a[84:87], v[212:215], v[124:127], a[84:87]
    buffer_load_dwordx4 v13, s[24:27], s41 offen nt lds
    v_mfma_f32_16x16x32_bf16 a[84:87], v[208:211], v[108:111], a[84:87]
    v_exp_f32 v25, v25
    v_mfma_f32_16x16x32_bf16 a[80:83], v[208:211], v[104:107], a[80:83]
    s_add_u32 m0, s35, 0x13000
    v_cvt_pk_bf16_f32 v192, v24, v25
    v_mfma_f32_16x16x32_bf16 a[80:83], v[212:215], v[120:123], a[80:83]
    s_add_u32 s41, s47, 12288
    v_exp_f32 v26, v26
    v_mfma_f32_16x16x32_bf16 a[92:95], v[212:215], v[132:135], a[92:95]
    buffer_load_dwordx4 v13, s[24:27], s41 offen nt lds
    v_mfma_f32_16x16x32_bf16 a[92:95], v[208:211], v[116:119], a[92:95]
    v_exp_f32 v27, v27
    v_mfma_f32_16x16x32_bf16 a[88:91], v[208:211], v[112:115], a[88:91]
    v_cvt_pk_bf16_f32 v193, v26, v27
    v_mfma_f32_16x16x32_bf16 a[88:91], v[212:215], v[128:131], a[88:91]
    v_exp_f32 v28, v28
    v_mfma_f32_16x16x32_bf16 a[136:139], v[244:247], v[128:131], a[136:139]
    buffer_atomic_add v11, v7, s[4:7], s50 offen sc1
    v_mfma_f32_16x16x32_bf16 a[136:139], v[244:247], v[112:115], a[136:139]
    s_waitcnt lgkmcnt(0)
    v_exp_f32 v29, v29
    v_mfma_f32_16x16x32_bf16 v[16:19], v[216:219], v[72:75], v[40:43]
    ds_read_b64_tr_b16 v[200:201], v242 offset:32768
    v_cvt_pk_bf16_f32 v196, v28, v29
    v_mfma_f32_16x16x32_bf16 v[16:19], v[220:223], v[88:91], v[16:19]
    v_exp_f32 v30, v30
    v_mfma_f32_16x16x32_bf16 v[16:19], v[224:227], v[136:139], v[16:19]
    ds_read_b64_tr_b16 v[202:203], v242 offset:36864
    ds_read_b64_tr_b16 v[204:205], v242 offset:40960
    v_mfma_f32_16x16x32_bf16 v[16:19], v[228:231], v[168:171], v[16:19]
    s_add_u32 m0, s35, 0x14000
    v_exp_f32 v31, v31
    v_mfma_f32_16x16x32_bf16 v[20:23], v[228:231], v[172:175], v[44:47]
    s_add_u32 s41, s47, 16384
    ds_read_b64_tr_b16 v[206:207], v242 offset:45056
    v_cvt_pk_bf16_f32 v197, v30, v31
    v_mfma_f32_16x16x32_bf16 v[20:23], v[224:227], v[140:143], v[20:23]
    buffer_load_dwordx4 v13, s[24:27], s41 offen nt lds
    v_mfma_f32_16x16x32_bf16 v[20:23], v[220:223], v[92:95], v[20:23]
    ds_read_b64_tr_b16 v[208:209], v243 offset:32768
    ds_read_b64_tr_b16 v[210:211], v243 offset:36864
    v_mfma_f32_16x16x32_bf16 v[20:23], v[216:219], v[76:79], v[20:23]
L_hop0_13:
    s_cbranch_execz L_hop0_ret
    v_exp_f32 v16, v16
    v_mfma_f32_16x16x32_bf16 v[24:27], v[216:219], v[80:83], v[48:51]
    ds_read_b64_tr_b16 v[212:213], v243 offset:40960
    ds_read_b64_tr_b16 v[214:215], v243 offset:45056
    v_mfma_f32_16x16x32_bf16 v[24:27], v[220:223], v[96:99], v[24:27]
    v_exp_f32 v17, v17
    v_mfma_f32_16x16x32_bf16 v[24:27], v[224:227], v[144:147], v[24:27]
    s_add_u32 m0, s35, 0x15000
    v_cvt_pk_bf16_f32 v186, v16, v17
    v_mfma_f32_16x16x32_bf16 v[24:27], v[228:231], v[176:179], v[24:27]
    s_add_u32 s41, s47, 20480
    v_exp_f32 v18, v18
    v_mfma_f32_16x16x32_bf16 v[28:31], v[228:231], v[180:183], v[52:55]
    buffer_load_dwordx4 v13, s[24:27], s41 offen nt lds
    v_mfma_f32_16x16x32_bf16 v[28:31], v[224:227], v[148:151], v[28:31]
    v_exp_f32 v19, v19
    v_mfma_f32_16x16x32_bf16 v[28:31], v[220:223], v[100:103], v[28:31]
    v_cvt_pk_bf16_f32 v187, v18, v19
    v_mfma_f32_16x16x32_bf16 v[28:31], v[216:219], v[84:87], v[28:31]
    s_waitcnt lgkmcnt(0)
    v_exp_f32 v20, v20
    v_mfma_f32_16x16x32_bf16 a[108:111], v[204:207], v[132:135], a[108:111]
    ds_read_b128 v[216:219], v232 offset:49152
    v_mfma_f32_16x16x32_bf16 a[108:111], v[200:203], v[116:119], a[108:111]
    v_exp_f32 v21, v21
    v_mfma_f32_16x16x32_bf16 a[96:99], v[200:203], v[104:107], a[96:99]
    ds_read_b128 v[220:223], v233 offset:49152
    v_cvt_pk_bf16_f32 v190, v20, v21
    v_mfma_f32_16x16x32_bf16 a[96:99], v[204:207], v[120:123], a[96:99]
    v_exp_f32 v22, v22
    v_mfma_f32_16x16x32_bf16 a[100:103], v[204:207], v[124:127], a[100:103]
    ds_read_b128 v[224:227], v234 offset:49152
    v_mfma_f32_16x16x32_bf16 a[100:103], v[200:203], v[108:111], a[100:103]
    v_exp_f32 v23, v23
    v_mfma_f32_16x16x32_bf16 a[104:107], v[200:203], v[112:115], a[104:107]
    s_add_u32 m0, s35, 0x16000
    ds_read_b128 v[228:231], v235 offset:49152
    v_cvt_pk_bf16_f32 v191, v22, v23
    v_mfma_f32_16x16x32_bf16 a[104:107], v[204:207], v[128:131], a[104:107]
    s_add_u32 s41, s47, 24576
    v_exp_f32 v24, v24
    v_mfma_f32_16x16x32_bf16 a[120:123], v[212:215], v[128:131], a[120:123]
    buffer_load_dwordx4 v13, s[24:27], s41 offen nt lds
    v_mfma_f32_16x16x32_bf16 a[120:123], v[208:211], v[112:115], a[120:123]
    v_exp_f32 v25, v25
    v_mfma_f32_16x16x32_bf16 a[116:119], v[208:211], v[108:111], a[116:119]
    s_add_u32 m0, s35, 0x17000
    v_cvt_pk_bf16_f32 v194, v24, v25
    v_mfma_f32_16x16x32_bf16 a[116:119], v[212:215], v[124:127], a[116:119]
    s_add_u32 s41, s47, 28672
    v_exp_f32 v26, v26
    v_mfma_f32_16x16x32_bf16 a[112:115], v[212:215], v[120:123], a[112:115]
    buffer_load_dwordx4 v13, s[24:27], s41 offen nt lds
    v_mfma_f32_16x16x32_bf16 a[112:115], v[208:211], v[104:107], a[112:115]
    s_add_u32 s46, s46, 32768
    v_exp_f32 v27, v27
    v_mfma_f32_16x16x32_bf16 a[124:127], v[208:211], v[116:119], a[124:127]
    s_add_u32 s47, s47, 32768
    v_cvt_pk_bf16_f32 v195, v26, v27
    v_mfma_f32_16x16x32_bf16 a[124:127], v[212:215], v[132:135], a[124:127]
    v_exp_f32 v28, v28
    v_mfma_f32_16x16x32_bf16 a[140:143], v[244:247], v[132:135], a[140:143]
    v_mfma_f32_16x16x32_bf16 a[140:143], v[244:247], v[116:119], a[140:143]
    s_waitcnt lgkmcnt(0)
    v_exp_f32 v29, v29
    v_mfma_f32_16x16x32_bf16 v[16:19], v[216:219], v[72:75], v[40:43]
    ds_read_b64_tr_b16 v[200:201], v236 offset:49152
    v_cvt_pk_bf16_f32 v198, v28, v29
    v_mfma_f32_16x16x32_bf16 v[16:19], v[220:223], v[88:91], v[16:19]
    v_exp_f32 v30, v30
    v_mfma_f32_16x16x32_bf16 v[16:19], v[224:227], v[136:139], v[16:19]
    ds_read_b64_tr_b16 v[202:203], v236 offset:53248
    ds_read_b64_tr_b16 v[204:205], v236 offset:57344
    v_mfma_f32_16x16x32_bf16 v[16:19], v[228:231], v[168:171], v[16:19]
    v_exp_f32 v31, v31
    v_mfma_f32_16x16x32_bf16 v[20:23], v[228:231], v[172:175], v[44:47]
    ds_read_b64_tr_b16 v[206:207], v236 offset:61440
    v_cvt_pk_bf16_f32 v199, v30, v31
    v_mfma_f32_16x16x32_bf16 v[20:23], v[224:227], v[140:143], v[20:23]
    v_mfma_f32_16x16x32_bf16 v[20:23], v[220:223], v[92:95], v[20:23]
    ds_read_b64_tr_b16 v[208:209], v237 offset:49152
    ds_read_b64_tr_b16 v[210:211], v237 offset:53248
    v_mfma_f32_16x16x32_bf16 v[20:23], v[216:219], v[76:79], v[20:23]
    v_exp_f32 v16, v16
    v_mfma_f32_16x16x32_bf16 v[24:27], v[216:219], v[80:83], v[48:51]
    ds_read_b64_tr_b16 v[212:213], v237 offset:57344
    ds_read_b64_tr_b16 v[214:215], v237 offset:61440
    v_mfma_f32_16x16x32_bf16 v[24:27], v[220:223], v[96:99], v[24:27]
    v_exp_f32 v17, v17
    v_mfma_f32_16x16x32_bf16 v[24:27], v[224:227], v[144:147], v[24:27]
    v_cvt_pk_bf16_f32 v104, v16, v17
    v_mfma_f32_16x16x32_bf16 v[24:27], v[228:231], v[176:179], v[24:27]
    v_exp_f32 v18, v18
    v_mfma_f32_16x16x32_bf16 v[28:31], v[228:231], v[180:183], v[52:55]
    buffer_load_dword v248, v10, s[4:7], s44 offen sc1
    v_mfma_f32_16x16x32_bf16 v[28:31], v[224:227], v[148:151], v[28:31]
    v_exp_f32 v19, v19
    v_mfma_f32_16x16x32_bf16 v[28:31], v[220:223], v[100:103], v[28:31]
    v_cvt_pk_bf16_f32 v105, v18, v19
    v_mfma_f32_16x16x32_bf16 v[28:31], v[216:219], v[84:87], v[28:31]
    s_waitcnt lgkmcnt(0)
    v_exp_f32 v20, v20
    v_mfma_f32_16x16x32_bf16 a[0:3], v[204:207], v[184:187], a[0:3]
    ds_read_b128 v[216:219], v232 offset:53248
    v_mfma_f32_16x16x32_bf16 a[0:3], v[200:203], v[152:155], a[0:3]
    v_exp_f32 v21, v21
    v_mfma_f32_16x16x32_bf16 a[4:7], v[200:203], v[156:159], a[4:7]
    ds_read_b128 v[220:223], v233 offset:53248
    v_cvt_pk_bf16_f32 v108, v20, v21
    v_mfma_f32_16x16x32_bf16 a[4:7], v[204:207], v[188:191], a[4:7]
    v_exp_f32 v22, v22
    v_mfma_f32_16x16x32_bf16 a[8:11], v[204:207], v[192:195], a[8:11]
    ds_read_b128 v[224:227], v234 offset:53248
    v_mfma_f32_16x16x32_bf16 a[8:11], v[200:203], v[160:163], a[8:11]
    v_exp_f32 v23, v23
    v_mfma_f32_16x16x32_bf16 a[12:15], v[200:203], v[164:167], a[12:15]
    ds_read_b128 v[228:231], v235 offset:53248
    v_cvt_pk_bf16_f32 v109, v22, v23
    v_mfma_f32_16x16x32_bf16 a[12:15], v[204:207], v[196:199], a[12:15]
    v_exp_f32 v24, v24
    v_mfma_f32_16x16x32_bf16 a[28:31], v[212:215], v[196:199], a[28:31]
    v_mfma_f32_16x16x32_bf16 a[28:31], v[208:211], v[164:167], a[28:31]
    v_exp_f32 v25, v25
    v_mfma_f32_16x16x32_bf16 a[24:27], v[208:211], v[160:163], a[24:27]
    v_cvt_pk_bf16_f32 v112, v24, v25
    v_mfma_f32_16x16x32_bf16 a[24:27], v[212:215], v[192:195], a[24:27]
    v_exp_f32 v26, v26
    v_mfma_f32_16x16x32_bf16 a[20:23], v[212:215], v[188:191], a[20:23]
    v_mfma_f32_16x16x32_bf16 a[20:23], v[208:211], v[156:159], a[20:23]
    v_exp_f32 v27, v27
    v_mfma_f32_16x16x32_bf16 a[16:19], v[208:211], v[152:155], a[16:19]
    v_cvt_pk_bf16_f32 v113, v26, v27
    v_mfma_f32_16x16x32_bf16 a[16:19], v[212:215], v[184:187], a[16:19]
    v_exp_f32 v28, v28
    v_mfma_f32_16x16x32_bf16 a[128:131], v[244:247], v[184:187], a[128:131]
    v_mfma_f32_16x16x32_bf16 a[128:131], v[244:247], v[152:155], a[128:131]
    s_waitcnt lgkmcnt(0)
    v_exp_f32 v29, v29
    v_mfma_f32_16x16x32_bf16 v[16:19], v[216:219], v[72:75], v[40:43]
    ds_read_b64_tr_b16 v[200:201], v238 offset:49152
    v_cvt_pk_bf16_f32 v116, v28, v29
    v_mfma_f32_16x16x32_bf16 v[16:19], v[220:223], v[88:91], v[16:19]
    v_exp_f32 v30, v30
    v_mfma_f32_16x16x32_bf16 v[16:19], v[224:227], v[136:139], v[16:19]
    ds_read_b64_tr_b16 v[202:203], v238 offset:53248
    ds_read_b64_tr_b16 v[204:205], v238 offset:57344
    v_mfma_f32_16x16x32_bf16 v[16:19], v[228:231], v[168:171], v[16:19]
    v_exp_f32 v31, v31
    v_mfma_f32_16x16x32_bf16 v[20:23], v[228:231], v[172:175], v[44:47]
    ds_read_b64_tr_b16 v[206:207], v238 offset:61440
    v_cvt_pk_bf16_f32 v117, v30, v31
    v_mfma_f32_16x16x32_bf16 v[20:23], v[224:227], v[140:143], v[20:23]
    v_mfma_f32_16x16x32_bf16 v[20:23], v[220:223], v[92:95], v[20:23]
    ds_read_b64_tr_b16 v[208:209], v239 offset:49152
    ds_read_b64_tr_b16 v[210:211], v239 offset:53248
    v_mfma_f32_16x16x32_bf16 v[20:23], v[216:219], v[76:79], v[20:23]
    v_exp_f32 v16, v16
    v_mfma_f32_16x16x32_bf16 v[24:27], v[216:219], v[80:83], v[48:51]
    ds_read_b64_tr_b16 v[212:213], v239 offset:57344
    ds_read_b64_tr_b16 v[214:215], v239 offset:61440
    v_mfma_f32_16x16x32_bf16 v[24:27], v[220:223], v[96:99], v[24:27]
    v_exp_f32 v17, v17
    v_mfma_f32_16x16x32_bf16 v[24:27], v[224:227], v[144:147], v[24:27]
    v_cvt_pk_bf16_f32 v106, v16, v17
    v_mfma_f32_16x16x32_bf16 v[24:27], v[228:231], v[176:179], v[24:27]
    v_exp_f32 v18, v18
    v_mfma_f32_16x16x32_bf16 v[28:31], v[228:231], v[180:183], v[52:55]
    buffer_load_dword v249, v10, s[4:7], s44 offen sc1
    v_mfma_f32_16x16x32_bf16 v[28:31], v[224:227], v[148:151], v[28:31]
    v_exp_f32 v19, v19
    v_mfma_f32_16x16x32_bf16 v[28:31], v[220:223], v[100:103], v[28:31]
    v_cvt_pk_bf16_f32 v107, v18, v19
    v_mfma_f32_16x16x32_bf16 v[28:31], v[216:219], v[84:87], v[28:31]
    s_waitcnt lgkmcnt(0)
    v_exp_f32 v20, v20
    v_mfma_f32_16x16x32_bf16 a[36:39], v[204:207], v[188:191], a[36:39]
    ds_read_b128 v[216:219], v232 offset:57344
    v_mfma_f32_16x16x32_bf16 a[36:39], v[200:203], v[156:159], a[36:39]
    v_exp_f32 v21, v21
    v_mfma_f32_16x16x32_bf16 a[40:43], v[200:203], v[160:163], a[40:43]
    ds_read_b128 v[220:223], v233 offset:57344
    v_cvt_pk_bf16_f32 v110, v20, v21
    v_mfma_f32_16x16x32_bf16 a[40:43], v[204:207], v[192:195], a[40:43]
    v_exp_f32 v22, v22
    v_mfma_f32_16x16x32_bf16 a[44:47], v[204:207], v[196:199], a[44:47]
    ds_read_b128 v[224:227], v234 offset:57344
    v_mfma_f32_16x16x32_bf16 a[44:47], v[200:203], v[164:167], a[44:47]
    v_exp_f32 v23, v23
    v_mfma_f32_16x16x32_bf16 a[32:35], v[200:203], v[152:155], a[32:35]
    ds_read_b128 v[228:231], v235 offset:57344
    v_cvt_pk_bf16_f32 v111, v22, v23
    v_mfma_f32_16x16x32_bf16 a[32:35], v[204:207], v[184:187], a[32:35]
    v_exp_f32 v24, v24
    v_mfma_f32_16x16x32_bf16 a[48:51], v[212:215], v[184:187], a[48:51]
    v_mfma_f32_16x16x32_bf16 a[48:51], v[208:211], v[152:155], a[48:51]
    v_exp_f32 v25, v25
    v_mfma_f32_16x16x32_bf16 a[60:63], v[208:211], v[164:167], a[60:63]
    v_cvt_pk_bf16_f32 v114, v24, v25
    v_mfma_f32_16x16x32_bf16 a[60:63], v[212:215], v[196:199], a[60:63]
    v_exp_f32 v26, v26
    v_mfma_f32_16x16x32_bf16 a[56:59], v[212:215], v[192:195], a[56:59]
    v_mfma_f32_16x16x32_bf16 a[56:59], v[208:211], v[160:163], a[56:59]
    v_exp_f32 v27, v27
    v_mfma_f32_16x16x32_bf16 a[52:55], v[208:211], v[156:159], a[52:55]
    v_cvt_pk_bf16_f32 v115, v26, v27
    v_mfma_f32_16x16x32_bf16 a[52:55], v[212:215], v[188:191], a[52:55]
    v_exp_f32 v28, v28
    v_mfma_f32_16x16x32_bf16 a[132:135], v[244:247], v[188:191], a[132:135]
    v_mfma_f32_16x16x32_bf16 a[132:135], v[244:247], v[156:159], a[132:135]
    s_waitcnt lgkmcnt(0)
    v_exp_f32 v29, v29
    v_mfma_f32_16x16x32_bf16 v[16:19], v[216:219], v[72:75], v[40:43]
    ds_read_b64_tr_b16 v[200:201], v240 offset:49152
    v_cvt_pk_bf16_f32 v118, v28, v29
    v_mfma_f32_16x16x32_bf16 v[16:19], v[220:223], v[88:91], v[16:19]
    v_exp_f32 v30, v30
    v_mfma_f32_16x16x32_bf16 v[16:19], v[224:227], v[136:139], v[16:19]
    ds_read_b64_tr_b16 v[202:203], v240 offset:53248
    ds_read_b64_tr_b16 v[204:205], v240 offset:57344
    v_mfma_f32_16x16x32_bf16 v[16:19], v[228:231], v[168:171], v[16:19]
    v_exp_f32 v31, v31
    v_mfma_f32_16x16x32_bf16 v[20:23], v[228:231], v[172:175], v[44:47]
    ds_read_b64_tr_b16 v[206:207], v240 offset:61440
    v_cvt_pk_bf16_f32 v119, v30, v31
    v_mfma_f32_16x16x32_bf16 v[20:23], v[224:227], v[140:143], v[20:23]
    v_mfma_f32_16x16x32_bf16 v[20:23], v[220:223], v[92:95], v[20:23]
    ds_read_b64_tr_b16 v[208:209], v241 offset:49152
    ds_read_b64_tr_b16 v[210:211], v241 offset:53248
    v_mfma_f32_16x16x32_bf16 v[20:23], v[216:219], v[76:79], v[20:23]
    v_exp_f32 v16, v16
    v_mfma_f32_16x16x32_bf16 v[24:27], v[216:219], v[80:83], v[48:51]
    ds_read_b64_tr_b16 v[212:213], v241 offset:57344
    ds_read_b64_tr_b16 v[214:215], v241 offset:61440
    v_mfma_f32_16x16x32_bf16 v[24:27], v[220:223], v[96:99], v[24:27]
    v_exp_f32 v17, v17
    v_mfma_f32_16x16x32_bf16 v[24:27], v[224:227], v[144:147], v[24:27]
    v_cvt_pk_bf16_f32 v120, v16, v17
    v_mfma_f32_16x16x32_bf16 v[24:27], v[228:231], v[176:179], v[24:27]
    v_exp_f32 v18, v18
    v_mfma_f32_16x16x32_bf16 v[28:31], v[228:231], v[180:183], v[52:55]
    buffer_load_dword v250, v10, s[4:7], s44 offen sc1
    v_mfma_f32_16x16x32_bf16 v[28:31], v[224:227], v[148:151], v[28:31]
    v_exp_f32 v19, v19
    v_mfma_f32_16x16x32_bf16 v[28:31], v[220:223], v[100:103], v[28:31]
    v_cvt_pk_bf16_f32 v121, v18, v19
    v_mfma_f32_16x16x32_bf16 v[28:31], v[216:219], v[84:87], v[28:31]
    s_waitcnt lgkmcnt(0)
    v_exp_f32 v20, v20
    v_mfma_f32_16x16x32_bf16 a[72:75], v[204:207], v[192:195], a[72:75]
    ds_read_b128 v[216:219], v232 offset:61440
    v_mfma_f32_16x16x32_bf16 a[72:75], v[200:203], v[160:163], a[72:75]
    v_exp_f32 v21, v21
    v_mfma_f32_16x16x32_bf16 a[76:79], v[200:203], v[164:167], a[76:79]
    ds_read_b128 v[220:223], v233 offset:61440
    v_cvt_pk_bf16_f32 v124, v20, v21
    v_mfma_f32_16x16x32_bf16 a[76:79], v[204:207], v[196:199], a[76:79]
    v_exp_f32 v22, v22
    v_mfma_f32_16x16x32_bf16 a[64:67], v[204:207], v[184:187], a[64:67]
    ds_read_b128 v[224:227], v234 offset:61440
    v_mfma_f32_16x16x32_bf16 a[64:67], v[200:203], v[152:155], a[64:67]
    v_exp_f32 v23, v23
    v_mfma_f32_16x16x32_bf16 a[68:71], v[200:203], v[156:159], a[68:71]
    ds_read_b128 v[228:231], v235 offset:61440
    v_cvt_pk_bf16_f32 v125, v22, v23
    v_mfma_f32_16x16x32_bf16 a[68:71], v[204:207], v[188:191], a[68:71]
    v_exp_f32 v24, v24
    v_mfma_f32_16x16x32_bf16 a[84:87], v[212:215], v[188:191], a[84:87]
    v_mfma_f32_16x16x32_bf16 a[84:87], v[208:211], v[156:159], a[84:87]
    v_exp_f32 v25, v25
    v_mfma_f32_16x16x32_bf16 a[80:83], v[208:211], v[152:155], a[80:83]
    v_cvt_pk_bf16_f32 v128, v24, v25
    v_mfma_f32_16x16x32_bf16 a[80:83], v[212:215], v[184:187], a[80:83]
    v_exp_f32 v26, v26
    v_mfma_f32_16x16x32_bf16 a[92:95], v[212:215], v[196:199], a[92:95]
    v_mfma_f32_16x16x32_bf16 a[92:95], v[208:211], v[164:167], a[92:95]
    v_exp_f32 v27, v27
    v_mfma_f32_16x16x32_bf16 a[88:91], v[208:211], v[160:163], a[88:91]
    v_cvt_pk_bf16_f32 v129, v26, v27
    v_mfma_f32_16x16x32_bf16 a[88:91], v[212:215], v[192:195], a[88:91]
    v_exp_f32 v28, v28
    v_mfma_f32_16x16x32_bf16 a[136:139], v[244:247], v[192:195], a[136:139]
    buffer_atomic_add v11, v7, s[4:7], s50 offen sc1
    v_mfma_f32_16x16x32_bf16 a[136:139], v[244:247], v[160:163], a[136:139]
    s_waitcnt lgkmcnt(0)
    v_exp_f32 v29, v29
    v_mfma_f32_16x16x32_bf16 v[16:19], v[216:219], v[72:75], v[40:43]
    ds_read_b64_tr_b16 v[200:201], v242 offset:49152
    v_cvt_pk_bf16_f32 v132, v28, v29
    v_mfma_f32_16x16x32_bf16 v[16:19], v[220:223], v[88:91], v[16:19]
    v_exp_f32 v30, v30
    v_mfma_f32_16x16x32_bf16 v[16:19], v[224:227], v[136:139], v[16:19]
    ds_read_b64_tr_b16 v[202:203], v242 offset:53248
    ds_read_b64_tr_b16 v[204:205], v242 offset:57344
    v_mfma_f32_16x16x32_bf16 v[16:19], v[228:231], v[168:171], v[16:19]
    v_exp_f32 v31, v31
    v_mfma_f32_16x16x32_bf16 v[20:23], v[228:231], v[172:175], v[44:47]
    ds_read_b64_tr_b16 v[206:207], v242 offset:61440
    v_cvt_pk_bf16_f32 v133, v30, v31
    v_mfma_f32_16x16x32_bf16 v[20:23], v[224:227], v[140:143], v[20:23]
    global_load_dword v254, v[252:253], off
    v_mfma_f32_16x16x32_bf16 v[20:23], v[220:223], v[92:95], v[20:23]
    ds_read_b64_tr_b16 v[208:209], v243 offset:49152
    ds_read_b64_tr_b16 v[210:211], v243 offset:53248
    v_mfma_f32_16x16x32_bf16 v[20:23], v[216:219], v[76:79], v[20:23]
    v_exp_f32 v16, v16
    v_mfma_f32_16x16x32_bf16 v[24:27], v[216:219], v[80:83], v[48:51]
    ds_read_b64_tr_b16 v[212:213], v243 offset:57344
    ds_read_b64_tr_b16 v[214:215], v243 offset:61440
    v_mfma_f32_16x16x32_bf16 v[24:27], v[220:223], v[96:99], v[24:27]
    v_exp_f32 v17, v17
    v_mfma_f32_16x16x32_bf16 v[24:27], v[224:227], v[144:147], v[24:27]
    v_cvt_pk_bf16_f32 v122, v16, v17
    v_mfma_f32_16x16x32_bf16 v[24:27], v[228:231], v[176:179], v[24:27]
    v_exp_f32 v18, v18
    v_mfma_f32_16x16x32_bf16 v[28:31], v[228:231], v[180:183], v[52:55]
    buffer_load_dword v251, v10, s[4:7], s44 offen sc1
    v_mfma_f32_16x16x32_bf16 v[28:31], v[224:227], v[148:151], v[28:31]
    v_exp_f32 v19, v19
    v_mfma_f32_16x16x32_bf16 v[28:31], v[220:223], v[100:103], v[28:31]
    v_cvt_pk_bf16_f32 v123, v18, v19
    v_mfma_f32_16x16x32_bf16 v[28:31], v[216:219], v[84:87], v[28:31]
    s_waitcnt vmcnt(6) lgkmcnt(0)
    s_barrier
    v_exp_f32 v20, v20
    v_mfma_f32_16x16x32_bf16 a[108:111], v[204:207], v[196:199], a[108:111]
    ds_read_b128 v[216:219], v232 offset:0
    v_mfma_f32_16x16x32_bf16 a[108:111], v[200:203], v[164:167], a[108:111]
    v_exp_f32 v21, v21
    v_mfma_f32_16x16x32_bf16 a[96:99], v[200:203], v[152:155], a[96:99]
    ds_read_b128 v[220:223], v233 offset:0
    v_cvt_pk_bf16_f32 v126, v20, v21
    v_mfma_f32_16x16x32_bf16 a[96:99], v[204:207], v[184:187], a[96:99]
    v_exp_f32 v22, v22
    v_mfma_f32_16x16x32_bf16 a[100:103], v[204:207], v[188:191], a[100:103]
    ds_read_b128 v[224:227], v234 offset:0
    v_mfma_f32_16x16x32_bf16 a[100:103], v[200:203], v[156:159], a[100:103]
    v_exp_f32 v23, v23
    v_mfma_f32_16x16x32_bf16 a[104:107], v[200:203], v[160:163], a[104:107]
    ds_read_b128 v[228:231], v235 offset:0
    v_cvt_pk_bf16_f32 v127, v22, v23
    v_mfma_f32_16x16x32_bf16 a[104:107], v[204:207], v[192:195], a[104:107]
    v_exp_f32 v24, v24
    v_mfma_f32_16x16x32_bf16 a[120:123], v[212:215], v[192:195], a[120:123]
    s_cmp_eq_u32 s48, 1
    s_cselect_b32 s53, 0, 0x40000000
    v_mfma_f32_16x16x32_bf16 a[120:123], v[208:211], v[160:163], a[120:123]
    s_add_u32 s53, s53, 0x3401000
    v_exp_f32 v25, v25
    v_mfma_f32_16x16x32_bf16 a[116:119], v[208:211], v[156:159], a[116:119]
    v_cvt_pk_bf16_f32 v130, v24, v25
    v_mfma_f32_16x16x32_bf16 a[116:119], v[212:215], v[188:191], a[116:119]
    v_exp_f32 v26, v26
    v_mfma_f32_16x16x32_bf16 a[112:115], v[212:215], v[184:187], a[112:115]
    buffer_load_dwordx4 v[32:35], v1, s[4:7], s53 offen sc1
    v_mfma_f32_16x16x32_bf16 a[112:115], v[208:211], v[152:155], a[112:115]
    v_exp_f32 v27, v27
    v_mfma_f32_16x16x32_bf16 a[124:127], v[208:211], v[164:167], a[124:127]
    v_cvt_pk_bf16_f32 v131, v26, v27
    v_mfma_f32_16x16x32_bf16 a[124:127], v[212:215], v[196:199], a[124:127]
    v_exp_f32 v28, v28
    v_mfma_f32_16x16x32_bf16 a[140:143], v[244:247], v[196:199], a[140:143]
    v_mfma_f32_16x16x32_bf16 a[140:143], v[244:247], v[164:167], a[140:143]
    s_waitcnt lgkmcnt(0)
    v_exp_f32 v29, v29
    v_mfma_f32_16x16x32_bf16 v[16:19], v[216:219], v[72:75], v[40:43]
    ds_read_b64_tr_b16 v[200:201], v236 offset:0
    v_cvt_pk_bf16_f32 v134, v28, v29
    v_mfma_f32_16x16x32_bf16 v[16:19], v[220:223], v[88:91], v[16:19]
    v_exp_f32 v30, v30
    v_mfma_f32_16x16x32_bf16 v[16:19], v[224:227], v[136:139], v[16:19]
    ds_read_b64_tr_b16 v[202:203], v236 offset:4096
    ds_read_b64_tr_b16 v[204:205], v236 offset:8192
    v_mfma_f32_16x16x32_bf16 v[16:19], v[228:231], v[168:171], v[16:19]
    s_add_u32 m0, s35, 0x8000
    v_exp_f32 v31, v31
    v_mfma_f32_16x16x32_bf16 v[20:23], v[228:231], v[172:175], v[44:47]
    s_add_u32 s41, s46, 0
    ds_read_b64_tr_b16 v[206:207], v236 offset:12288
    v_cvt_pk_bf16_f32 v135, v30, v31
    v_mfma_f32_16x16x32_bf16 v[20:23], v[224:227], v[140:143], v[20:23]
    buffer_load_dwordx4 v12, s[20:23], s41 offen nt lds
    v_mfma_f32_16x16x32_bf16 v[20:23], v[220:223], v[92:95], v[20:23]
    ds_read_b64_tr_b16 v[208:209], v237 offset:0
    ds_read_b64_tr_b16 v[210:211], v237 offset:4096
    v_mfma_f32_16x16x32_bf16 v[20:23], v[216:219], v[76:79], v[20:23]
    v_exp_f32 v16, v16
    v_mfma_f32_16x16x32_bf16 v[24:27], v[216:219], v[80:83], v[48:51]
    ds_read_b64_tr_b16 v[212:213], v237 offset:8192
    ds_read_b64_tr_b16 v[214:215], v237 offset:12288
    v_mfma_f32_16x16x32_bf16 v[24:27], v[220:223], v[96:99], v[24:27]
    v_exp_f32 v17, v17
    v_mfma_f32_16x16x32_bf16 v[24:27], v[224:227], v[144:147], v[24:27]
    s_add_u32 m0, s35, 0x9000
    v_cvt_pk_bf16_f32 v152, v16, v17
    v_mfma_f32_16x16x32_bf16 v[24:27], v[228:231], v[176:179], v[24:27]
    s_add_u32 s41, s46, 4096
    v_exp_f32 v18, v18
    v_mfma_f32_16x16x32_bf16 v[28:31], v[228:231], v[180:183], v[52:55]
    buffer_load_dwordx4 v12, s[20:23], s41 offen nt lds
    v_mfma_f32_16x16x32_bf16 v[28:31], v[224:227], v[148:151], v[28:31]
    v_exp_f32 v19, v19
    v_mfma_f32_16x16x32_bf16 v[28:31], v[220:223], v[100:103], v[28:31]
    v_cvt_pk_bf16_f32 v153, v18, v19
    v_mfma_f32_16x16x32_bf16 v[28:31], v[216:219], v[84:87], v[28:31]
    s_waitcnt lgkmcnt(0)
    v_exp_f32 v20, v20
    v_mfma_f32_16x16x32_bf16 a[0:3], v[204:207], v[120:123], a[0:3]
    ds_read_b128 v[216:219], v232 offset:4096
    v_mfma_f32_16x16x32_bf16 a[0:3], v[200:203], v[104:107], a[0:3]
    v_exp_f32 v21, v21
    v_mfma_f32_16x16x32_bf16 a[4:7], v[200:203], v[108:111], a[4:7]
    ds_read_b128 v[220:223], v233 offset:4096
    v_cvt_pk_bf16_f32 v156, v20, v21
    v_mfma_f32_16x16x32_bf16 a[4:7], v[204:207], v[124:127], a[4:7]
    v_exp_f32 v22, v22
    v_mfma_f32_16x16x32_bf16 a[8:11], v[204:207], v[128:131], a[8:11]
    ds_read_b128 v[224:227], v234 offset:4096
    v_mfma_f32_16x16x32_bf16 a[8:11], v[200:203], v[112:115], a[8:11]
    v_exp_f32 v23, v23
    v_mfma_f32_16x16x32_bf16 a[12:15], v[200:203], v[116:119], a[12:15]
    s_add_u32 m0, s35, 0xa000
    ds_read_b128 v[228:231], v235 offset:4096
    v_cvt_pk_bf16_f32 v157, v22, v23
    v_mfma_f32_16x16x32_bf16 a[12:15], v[204:207], v[132:135], a[12:15]
    s_add_u32 s41, s46, 8192
    v_exp_f32 v24, v24
    v_mfma_f32_16x16x32_bf16 a[28:31], v[212:215], v[132:135], a[28:31]
    buffer_load_dwordx4 v12, s[20:23], s41 offen nt lds
    v_mfma_f32_16x16x32_bf16 a[28:31], v[208:211], v[116:119], a[28:31]
    v_exp_f32 v25, v25
    v_mfma_f32_16x16x32_bf16 a[24:27], v[208:211], v[112:115], a[24:27]
    s_add_u32 m0, s35, 0xb000
    v_cvt_pk_bf16_f32 v160, v24, v25
    v_mfma_f32_16x16x32_bf16 a[24:27], v[212:215], v[128:131], a[24:27]
    s_add_u32 s41, s46, 12288
    v_exp_f32 v26, v26
    v_mfma_f32_16x16x32_bf16 a[20:23], v[212:215], v[124:127], a[20:23]
    buffer_load_dwordx4 v12, s[20:23], s41 offen nt lds
    v_mfma_f32_16x16x32_bf16 a[20:23], v[208:211], v[108:111], a[20:23]
    v_exp_f32 v27, v27
    v_mfma_f32_16x16x32_bf16 a[16:19], v[208:211], v[104:107], a[16:19]
    v_cvt_pk_bf16_f32 v161, v26, v27
    v_mfma_f32_16x16x32_bf16 a[16:19], v[212:215], v[120:123], a[16:19]
    v_exp_f32 v28, v28
    v_mfma_f32_16x16x32_bf16 a[128:131], v[244:247], v[120:123], a[128:131]
    v_mfma_f32_16x16x32_bf16 a[128:131], v[244:247], v[104:107], a[128:131]
    s_waitcnt lgkmcnt(0)
    v_exp_f32 v29, v29
    v_mfma_f32_16x16x32_bf16 v[16:19], v[216:219], v[72:75], v[40:43]
    ds_read_b64_tr_b16 v[200:201], v238 offset:0
    v_cvt_pk_bf16_f32 v164, v28, v29
    v_mfma_f32_16x16x32_bf16 v[16:19], v[220:223], v[88:91], v[16:19]
    v_exp_f32 v30, v30
    v_mfma_f32_16x16x32_bf16 v[16:19], v[224:227], v[136:139], v[16:19]
    ds_read_b64_tr_b16 v[202:203], v238 offset:4096
    ds_read_b64_tr_b16 v[204:205], v238 offset:8192
    v_mfma_f32_16x16x32_bf16 v[16:19], v[228:231], v[168:171], v[16:19]
    s_add_u32 m0, s35, 0xc000
    v_exp_f32 v31, v31
    v_mfma_f32_16x16x32_bf16 v[20:23], v[228:231], v[172:175], v[44:47]
    s_add_u32 s41, s46, 16384
    ds_read_b64_tr_b16 v[206:207], v238 offset:12288
    v_cvt_pk_bf16_f32 v165, v30, v31
    v_mfma_f32_16x16x32_bf16 v[20:23], v[224:227], v[140:143], v[20:23]
    buffer_load_dwordx4 v12, s[20:23], s41 offen nt lds
    v_mfma_f32_16x16x32_bf16 v[20:23], v[220:223], v[92:95], v[20:23]
    ds_read_b64_tr_b16 v[208:209], v239 offset:0
    ds_read_b64_tr_b16 v[210:211], v239 offset:4096
    v_mfma_f32_16x16x32_bf16 v[20:23], v[216:219], v[76:79], v[20:23]
    v_exp_f32 v16, v16
    v_mfma_f32_16x16x32_bf16 v[24:27], v[216:219], v[80:83], v[48:51]
    ds_read_b64_tr_b16 v[212:213], v239 offset:8192
    ds_read_b64_tr_b16 v[214:215], v239 offset:12288
    v_mfma_f32_16x16x32_bf16 v[24:27], v[220:223], v[96:99], v[24:27]
    v_exp_f32 v17, v17
    v_mfma_f32_16x16x32_bf16 v[24:27], v[224:227], v[144:147], v[24:27]
    s_add_u32 m0, s35, 0xd000
    v_cvt_pk_bf16_f32 v154, v16, v17
    v_mfma_f32_16x16x32_bf16 v[24:27], v[228:231], v[176:179], v[24:27]
    s_add_u32 s41, s46, 20480
    v_exp_f32 v18, v18
    v_mfma_f32_16x16x32_bf16 v[28:31], v[228:231], v[180:183], v[52:55]
    buffer_load_dwordx4 v12, s[20:23], s41 offen nt lds
    v_mfma_f32_16x16x32_bf16 v[28:31], v[224:227], v[148:151], v[28:31]
    v_exp_f32 v19, v19
    v_mfma_f32_16x16x32_bf16 v[28:31], v[220:223], v[100:103], v[28:31]
    v_cvt_pk_bf16_f32 v155, v18, v19
    v_mfma_f32_16x16x32_bf16 v[28:31], v[216:219], v[84:87], v[28:31]
    s_waitcnt lgkmcnt(0)
    v_exp_f32 v20, v20
    v_mfma_f32_16x16x32_bf16 a[36:39], v[204:207], v[124:127], a[36:39]
    ds_read_b128 v[216:219], v232 offset:8192
    v_mfma_f32_16x16x32_bf16 a[36:39], v[200:203], v[108:111], a[36:39]
    v_exp_f32 v21, v21
    v_mfma_f32_16x16x32_bf16 a[40:43], v[200:203], v[112:115], a[40:43]
    ds_read_b128 v[220:223], v233 offset:8192
    v_cvt_pk_bf16_f32 v158, v20, v21
    v_mfma_f32_16x16x32_bf16 a[40:43], v[204:207], v[128:131], a[40:43]
    v_exp_f32 v22, v22
    v_mfma_f32_16x16x32_bf16 a[44:47], v[204:207], v[132:135], a[44:47]
    ds_read_b128 v[224:227], v234 offset:8192
    v_mfma_f32_16x16x32_bf16 a[44:47], v[200:203], v[116:119], a[44:47]
    v_exp_f32 v23, v23
    v_mfma_f32_16x16x32_bf16 a[32:35], v[200:203], v[104:107], a[32:35]
    s_add_u32 m0, s35, 0xe000
    ds_read_b128 v[228:231], v235 offset:8192
    v_cvt_pk_bf16_f32 v159, v22, v23
    v_mfma_f32_16x16x32_bf16 a[32:35], v[204:207], v[120:123], a[32:35]
    s_add_u32 s41, s46, 24576
    v_exp_f32 v24, v24
    v_mfma_f32_16x16x32_bf16 a[48:51], v[212:215], v[120:123], a[48:51]
    buffer_load_dwordx4 v12, s[20:23], s41 offen nt lds
    v_mfma_f32_16x16x32_bf16 a[48:51], v[208:211], v[104:107], a[48:51]
    v_exp_f32 v25, v25
    v_mfma_f32_16x16x32_bf16 a[60:63], v[208:211], v[116:119], a[60:63]
    s_add_u32 m0, s35, 0xf000
    v_cvt_pk_bf16_f32 v162, v24, v25
    v_mfma_f32_16x16x32_bf16 a[60:63], v[212:215], v[132:135], a[60:63]
    s_add_u32 s41, s46, 28672
    v_exp_f32 v26, v26
    v_mfma_f32_16x16x32_bf16 a[56:59], v[212:215], v[128:131], a[56:59]
    buffer_load_dwordx4 v12, s[20:23], s41 offen nt lds
    v_mfma_f32_16x16x32_bf16 a[56:59], v[208:211], v[112:115], a[56:59]
    v_exp_f32 v27, v27
    v_mfma_f32_16x16x32_bf16 a[52:55], v[208:211], v[108:111], a[52:55]
    v_cvt_pk_bf16_f32 v163, v26, v27
    v_mfma_f32_16x16x32_bf16 a[52:55], v[212:215], v[124:127], a[52:55]
    v_exp_f32 v28, v28
    v_mfma_f32_16x16x32_bf16 a[132:135], v[244:247], v[124:127], a[132:135]
    v_mfma_f32_16x16x32_bf16 a[132:135], v[244:247], v[108:111], a[132:135]
    s_waitcnt lgkmcnt(0)
    v_exp_f32 v29, v29
    v_mfma_f32_16x16x32_bf16 v[16:19], v[216:219], v[72:75], v[40:43]
    ds_read_b64_tr_b16 v[200:201], v240 offset:0
    v_cvt_pk_bf16_f32 v166, v28, v29
    v_mfma_f32_16x16x32_bf16 v[16:19], v[220:223], v[88:91], v[16:19]
    v_exp_f32 v30, v30
    v_mfma_f32_16x16x32_bf16 v[16:19], v[224:227], v[136:139], v[16:19]
    ds_read_b64_tr_b16 v[202:203], v240 offset:4096
    ds_read_b64_tr_b16 v[204:205], v240 offset:8192
    v_mfma_f32_16x16x32_bf16 v[16:19], v[228:231], v[168:171], v[16:19]
    s_add_u32 m0, s35, 0x18000
    v_exp_f32 v31, v31
    v_mfma_f32_16x16x32_bf16 v[20:23], v[228:231], v[172:175], v[44:47]
    s_add_u32 s41, s47, 0
    ds_read_b64_tr_b16 v[206:207], v240 offset:12288
    v_cvt_pk_bf16_f32 v167, v30, v31
    v_mfma_f32_16x16x32_bf16 v[20:23], v[224:227], v[140:143], v[20:23]
    buffer_load_dwordx4 v13, s[24:27], s41 offen nt lds
    v_mfma_f32_16x16x32_bf16 v[20:23], v[220:223], v[92:95], v[20:23]
    ds_read_b64_tr_b16 v[208:209], v241 offset:0
    ds_read_b64_tr_b16 v[210:211], v241 offset:4096
    v_mfma_f32_16x16x32_bf16 v[20:23], v[216:219], v[76:79], v[20:23]
    v_exp_f32 v16, v16
    v_mfma_f32_16x16x32_bf16 v[24:27], v[216:219], v[80:83], v[48:51]
    ds_read_b64_tr_b16 v[212:213], v241 offset:8192
    ds_read_b64_tr_b16 v[214:215], v241 offset:12288
    v_mfma_f32_16x16x32_bf16 v[24:27], v[220:223], v[96:99], v[24:27]
    v_exp_f32 v17, v17
    v_mfma_f32_16x16x32_bf16 v[24:27], v[224:227], v[144:147], v[24:27]
    s_add_u32 m0, s35, 0x19000
    v_cvt_pk_bf16_f32 v184, v16, v17
    v_mfma_f32_16x16x32_bf16 v[24:27], v[228:231], v[176:179], v[24:27]
    s_add_u32 s41, s47, 4096
    v_exp_f32 v18, v18
    v_mfma_f32_16x16x32_bf16 v[28:31], v[228:231], v[180:183], v[52:55]
    buffer_load_dwordx4 v13, s[24:27], s41 offen nt lds
    v_mfma_f32_16x16x32_bf16 v[28:31], v[224:227], v[148:151], v[28:31]
    v_exp_f32 v19, v19
    v_mfma_f32_16x16x32_bf16 v[28:31], v[220:223], v[100:103], v[28:31]
    v_cvt_pk_bf16_f32 v185, v18, v19
    v_mfma_f32_16x16x32_bf16 v[28:31], v[216:219], v[84:87], v[28:31]
    s_waitcnt lgkmcnt(0)
    v_exp_f32 v20, v20
    v_mfma_f32_16x16x32_bf16 a[72:75], v[204:207], v[128:131], a[72:75]
    ds_read_b128 v[216:219], v232 offset:12288
    v_mfma_f32_16x16x32_bf16 a[72:75], v[200:203], v[112:115], a[72:75]
    v_exp_f32 v21, v21
    v_mfma_f32_16x16x32_bf16 a[76:79], v[200:203], v[116:119], a[76:79]
    ds_read_b128 v[220:223], v233 offset:12288
    v_cvt_pk_bf16_f32 v188, v20, v21
    v_mfma_f32_16x16x32_bf16 a[76:79], v[204:207], v[132:135], a[76:79]
L_hop0_14:
    s_cbranch_execz L_hop0_ret
    v_exp_f32 v22, v22
    v_mfma_f32_16x16x32_bf16 a[64:67], v[204:207], v[120:123], a[64:67]
    ds_read_b128 v[224:227], v234 offset:12288
    v_mfma_f32_16x16x32_bf16 a[64:67], v[200:203], v[104:107], a[64:67]
    v_exp_f32 v23, v23
    v_mfma_f32_16x16x32_bf16 a[68:71], v[200:203], v[108:111], a[68:71]
    s_add_u32 m0, s35, 0x1a000
    ds_read_b128 v[228:231], v235 offset:12288
    v_cvt_pk_bf16_f32 v189, v22, v23
    v_mfma_f32_16x16x32_bf16 a[68:71], v[204:207], v[124:127], a[68:71]
    s_add_u32 s41, s47, 8192
    v_exp_f32 v24, v24
    v_mfma_f32_16x16x32_bf16 a[84:87], v[212:215], v[124:127], a[84:87]
    buffer_load_dwordx4 v13, s[24:27], s41 offen nt lds
    v_mfma_f32_16x16x32_bf16 a[84:87], v[208:211], v[108:111], a[84:87]
    v_exp_f32 v25, v25
    v_mfma_f32_16x16x32_bf16 a[80:83], v[208:211], v[104:107], a[80:83]
    s_add_u32 m0, s35, 0x1b000
    v_cvt_pk_bf16_f32 v192, v24, v25
    v_mfma_f32_16x16x32_bf16 a[80:83], v[212:215], v[120:123], a[80:83]
    s_add_u32 s41, s47, 12288
    v_exp_f32 v26, v26
    v_mfma_f32_16x16x32_bf16 a[92:95], v[212:215], v[132:135], a[92:95]
    buffer_load_dwordx4 v13, s[24:27], s41 offen nt lds
    v_mfma_f32_16x16x32_bf16 a[92:95], v[208:211], v[116:119], a[92:95]
    v_exp_f32 v27, v27
    v_mfma_f32_16x16x32_bf16 a[88:91], v[208:211], v[112:115], a[88:91]
    v_cvt_pk_bf16_f32 v193, v26, v27
    v_mfma_f32_16x16x32_bf16 a[88:91], v[212:215], v[128:131], a[88:91]
    v_exp_f32 v28, v28
    v_mfma_f32_16x16x32_bf16 a[136:139], v[244:247], v[128:131], a[136:139]
    buffer_atomic_add v11, v7, s[4:7], s50 offen sc1
    v_mfma_f32_16x16x32_bf16 a[136:139], v[244:247], v[112:115], a[136:139]
    s_waitcnt lgkmcnt(0)
    v_exp_f32 v29, v29
    v_mfma_f32_16x16x32_bf16 v[16:19], v[216:219], v[72:75], v[40:43]
    ds_read_b64_tr_b16 v[200:201], v242 offset:0
    v_cvt_pk_bf16_f32 v196, v28, v29
    v_mfma_f32_16x16x32_bf16 v[16:19], v[220:223], v[88:91], v[16:19]
    v_exp_f32 v30, v30
    v_mfma_f32_16x16x32_bf16 v[16:19], v[224:227], v[136:139], v[16:19]
    ds_read_b64_tr_b16 v[202:203], v242 offset:4096
    ds_read_b64_tr_b16 v[204:205], v242 offset:8192
    v_mfma_f32_16x16x32_bf16 v[16:19], v[228:231], v[168:171], v[16:19]
    s_add_u32 m0, s35, 0x1c000
    v_exp_f32 v31, v31
    v_mfma_f32_16x16x32_bf16 v[20:23], v[228:231], v[172:175], v[44:47]
    s_add_u32 s41, s47, 16384
    ds_read_b64_tr_b16 v[206:207], v242 offset:12288
    v_cvt_pk_bf16_f32 v197, v30, v31
    v_mfma_f32_16x16x32_bf16 v[20:23], v[224:227], v[140:143], v[20:23]
    buffer_load_dwordx4 v13, s[24:27], s41 offen nt lds
    v_mfma_f32_16x16x32_bf16 v[20:23], v[220:223], v[92:95], v[20:23]
    ds_read_b64_tr_b16 v[208:209], v243 offset:0
    ds_read_b64_tr_b16 v[210:211], v243 offset:4096
    v_mfma_f32_16x16x32_bf16 v[20:23], v[216:219], v[76:79], v[20:23]
    v_exp_f32 v16, v16
    v_mfma_f32_16x16x32_bf16 v[24:27], v[216:219], v[80:83], v[48:51]
    ds_read_b64_tr_b16 v[212:213], v243 offset:8192
    ds_read_b64_tr_b16 v[214:215], v243 offset:12288
    v_mfma_f32_16x16x32_bf16 v[24:27], v[220:223], v[96:99], v[24:27]
    v_exp_f32 v17, v17
    v_mfma_f32_16x16x32_bf16 v[24:27], v[224:227], v[144:147], v[24:27]
    s_add_u32 m0, s35, 0x1d000
    v_cvt_pk_bf16_f32 v186, v16, v17
    v_mfma_f32_16x16x32_bf16 v[24:27], v[228:231], v[176:179], v[24:27]
    s_add_u32 s41, s47, 20480
    v_exp_f32 v18, v18
    v_mfma_f32_16x16x32_bf16 v[28:31], v[228:231], v[180:183], v[52:55]
    buffer_load_dwordx4 v13, s[24:27], s41 offen nt lds
    v_mfma_f32_16x16x32_bf16 v[28:31], v[224:227], v[148:151], v[28:31]
    v_exp_f32 v19, v19
    v_mfma_f32_16x16x32_bf16 v[28:31], v[220:223], v[100:103], v[28:31]
    v_cvt_pk_bf16_f32 v187, v18, v19
    v_mfma_f32_16x16x32_bf16 v[28:31], v[216:219], v[84:87], v[28:31]
    s_waitcnt lgkmcnt(0)
    v_exp_f32 v20, v20
    v_mfma_f32_16x16x32_bf16 a[108:111], v[204:207], v[132:135], a[108:111]
    ds_read_b128 v[216:219], v232 offset:16384
    v_mfma_f32_16x16x32_bf16 a[108:111], v[200:203], v[116:119], a[108:111]
    v_exp_f32 v21, v21
    v_mfma_f32_16x16x32_bf16 a[96:99], v[200:203], v[104:107], a[96:99]
    ds_read_b128 v[220:223], v233 offset:16384
    v_cvt_pk_bf16_f32 v190, v20, v21
    v_mfma_f32_16x16x32_bf16 a[96:99], v[204:207], v[120:123], a[96:99]
    v_exp_f32 v22, v22
    v_mfma_f32_16x16x32_bf16 a[100:103], v[204:207], v[124:127], a[100:103]
    ds_read_b128 v[224:227], v234 offset:16384
    v_mfma_f32_16x16x32_bf16 a[100:103], v[200:203], v[108:111], a[100:103]
    v_exp_f32 v23, v23
    v_mfma_f32_16x16x32_bf16 a[104:107], v[200:203], v[112:115], a[104:107]
    s_add_u32 m0, s35, 0x1e000
    ds_read_b128 v[228:231], v235 offset:16384
    v_cvt_pk_bf16_f32 v191, v22, v23
    v_mfma_f32_16x16x32_bf16 a[104:107], v[204:207], v[128:131], a[104:107]
    s_add_u32 s41, s47, 24576
    v_exp_f32 v24, v24
    v_mfma_f32_16x16x32_bf16 a[120:123], v[212:215], v[128:131], a[120:123]
    buffer_load_dwordx4 v13, s[24:27], s41 offen nt lds
    v_mfma_f32_16x16x32_bf16 a[120:123], v[208:211], v[112:115], a[120:123]
    v_exp_f32 v25, v25
    v_mfma_f32_16x16x32_bf16 a[116:119], v[208:211], v[108:111], a[116:119]
    s_add_u32 m0, s35, 0x1f000
    v_cvt_pk_bf16_f32 v194, v24, v25
    v_mfma_f32_16x16x32_bf16 a[116:119], v[212:215], v[124:127], a[116:119]
    s_add_u32 s41, s47, 28672
    v_exp_f32 v26, v26
    v_mfma_f32_16x16x32_bf16 a[112:115], v[212:215], v[120:123], a[112:115]
    buffer_load_dwordx4 v13, s[24:27], s41 offen nt lds
    v_mfma_f32_16x16x32_bf16 a[112:115], v[208:211], v[104:107], a[112:115]
    s_add_u32 s46, s46, 32768
    v_exp_f32 v27, v27
    v_mfma_f32_16x16x32_bf16 a[124:127], v[208:211], v[116:119], a[124:127]
    s_add_u32 s47, s47, 32768
    v_cvt_pk_bf16_f32 v195, v26, v27
    v_mfma_f32_16x16x32_bf16 a[124:127], v[212:215], v[132:135], a[124:127]
    s_sub_u32 s48, s48, 1
    v_exp_f32 v28, v28
    v_mfma_f32_16x16x32_bf16 a[140:143], v[244:247], v[132:135], a[140:143]
    s_cmp_lg_u32 s48, 0
    v_mfma_f32_16x16x32_bf16 a[140:143], v[244:247], v[116:119], a[140:143]
    s_waitcnt lgkmcnt(0)
    v_exp_f32 v29, v29
    s_cbranch_scc1 L_k2_loopb
L_k2_exit:
    s_waitcnt vmcnt(17)
    v_add_u32 v248, v248, v249
    v_add3_u32 v248, v248, v250, v251
    v_and_b32 v32, v32, v33
    v_and_b32 v34, v34, v35
    v_and_b32 v32, v32, v34
    v_cmp_eq_u32 vcc, 0, v32
    v_readlane_b32 s56, v248, 0
    v_readlane_b32 s57, v248, 1
    v_readlane_b32 s58, v248, 2
    v_readlane_b32 s59, v248, 3
    s_cbranch_vccnz L_a_spin
L_a_ret:
    v_mfma_f32_16x16x32_bf16 v[16:19], v[216:219], v[72:75], v[40:43]
    s_add_u32 s54, s56, s57
    ds_read_b64_tr_b16 v[200:201], v236 offset:16384
    v_cvt_pk_bf16_f32 v198, v28, v29
    v_mfma_f32_16x16x32_bf16 v[16:19], v[220:223], v[88:91], v[16:19]
    s_add_u32 s55, s58, s59
    v_exp_f32 v30, v30
    v_mfma_f32_16x16x32_bf16 v[16:19], v[224:227], v[136:139], v[16:19]
    s_add_u32 s54, s54, s55
    ds_read_b64_tr_b16 v[202:203], v236 offset:20480
    ds_read_b64_tr_b16 v[204:205], v236 offset:24576
    v_mfma_f32_16x16x32_bf16 v[16:19], v[228:231], v[168:171], v[16:19]
    s_mul_i32 s54, s54, 30
    v_exp_f32 v31, v31
    v_mfma_f32_16x16x32_bf16 v[20:23], v[228:231], v[172:175], v[44:47]
    s_add_u32 s41, s43, 0x400000
    ds_read_b64_tr_b16 v[206:207], v236 offset:28672
    v_cvt_pk_bf16_f32 v199, v30, v31
    v_mfma_f32_16x16x32_bf16 v[20:23], v[224:227], v[140:143], v[20:23]
    buffer_load_dwordx4 a[144:147], v1, s[4:7], s41 offen offset:0 sc1
    v_mfma_f32_16x16x32_bf16 v[20:23], v[220:223], v[92:95], v[20:23]
    s_sub_u32 s54, 512, s54
    ds_read_b64_tr_b16 v[208:209], v237 offset:16384
    ds_read_b64_tr_b16 v[210:211], v237 offset:20480
    v_mfma_f32_16x16x32_bf16 v[20:23], v[216:219], v[76:79], v[20:23]
    s_mul_i32 s56, s56, 120
    v_exp_f32 v16, v16
    v_mfma_f32_16x16x32_bf16 v[24:27], v[216:219], v[80:83], v[48:51]
    s_add_u32 s56, s56, s54
    ds_read_b64_tr_b16 v[212:213], v237 offset:24576
    ds_read_b64_tr_b16 v[214:215], v237 offset:28672
    v_mfma_f32_16x16x32_bf16 v[24:27], v[220:223], v[96:99], v[24:27]
    s_add_u32 s54, s54, 16
    v_exp_f32 v17, v17
    v_mfma_f32_16x16x32_bf16 v[24:27], v[224:227], v[144:147], v[24:27]
    s_mul_i32 s57, s57, 120
    v_cvt_pk_bf16_f32 v104, v16, v17
    v_mfma_f32_16x16x32_bf16 v[24:27], v[228:231], v[176:179], v[24:27]
    s_add_u32 s41, s43, 0x400000
    v_exp_f32 v18, v18
    v_mfma_f32_16x16x32_bf16 v[28:31], v[228:231], v[180:183], v[52:55]
    buffer_load_dwordx4 a[148:151], v1, s[4:7], s41 offen offset:1024 sc1
    v_mfma_f32_16x16x32_bf16 v[28:31], v[224:227], v[148:151], v[28:31]
    s_add_u32 s57, s57, s54
    v_exp_f32 v19, v19
    v_mfma_f32_16x16x32_bf16 v[28:31], v[220:223], v[100:103], v[28:31]
    s_add_u32 s54, s54, 16
    v_cvt_pk_bf16_f32 v105, v18, v19
    v_mfma_f32_16x16x32_bf16 v[28:31], v[216:219], v[84:87], v[28:31]
    s_waitcnt lgkmcnt(0)
    v_exp_f32 v20, v20
    v_mfma_f32_16x16x32_bf16 a[0:3], v[204:207], v[184:187], a[0:3]
    s_mul_i32 s58, s58, 120
    ds_read_b128 v[216:219], v232 offset:20480
    v_mfma_f32_16x16x32_bf16 a[0:3], v[200:203], v[152:155], a[0:3]
    s_add_u32 s58, s58, s54
    v_exp_f32 v21, v21
    v_mfma_f32_16x16x32_bf16 a[4:7], v[200:203], v[156:159], a[4:7]
    s_add_u32 s54, s54, 16
    ds_read_b128 v[220:223], v233 offset:20480
    v_cvt_pk_bf16_f32 v108, v20, v21
    v_mfma_f32_16x16x32_bf16 a[4:7], v[204:207], v[188:191], a[4:7]
    s_mul_i32 s59, s59, 120
    v_exp_f32 v22, v22
    v_mfma_f32_16x16x32_bf16 a[8:11], v[204:207], v[192:195], a[8:11]
    s_add_u32 s59, s59, s54
    ds_read_b128 v[224:227], v234 offset:20480
    v_mfma_f32_16x16x32_bf16 a[8:11], v[200:203], v[160:163], a[8:11]
    v_exp_f32 v23, v23
    v_mfma_f32_16x16x32_bf16 a[12:15], v[200:203], v[164:167], a[12:15]
    ds_read_b128 v[228:231], v235 offset:20480
    v_cvt_pk_bf16_f32 v109, v22, v23
    v_mfma_f32_16x16x32_bf16 a[12:15], v[204:207], v[196:199], a[12:15]
    s_add_u32 s41, s43, 0x401000
    v_exp_f32 v24, v24
    v_mfma_f32_16x16x32_bf16 a[28:31], v[212:215], v[196:199], a[28:31]
    buffer_load_dwordx4 a[152:155], v1, s[4:7], s41 offen offset:0 sc1
    v_mfma_f32_16x16x32_bf16 a[28:31], v[208:211], v[164:167], a[28:31]
    v_exp_f32 v25, v25
    v_mfma_f32_16x16x32_bf16 a[24:27], v[208:211], v[160:163], a[24:27]
    v_cvt_pk_bf16_f32 v112, v24, v25
    v_lshl_add_u32 v248, v0, 4, s56
    v_mfma_f32_16x16x32_bf16 a[24:27], v[212:215], v[192:195], a[24:27]
    s_add_u32 s41, s43, 0x401000
    v_exp_f32 v26, v26
    v_mfma_f32_16x16x32_bf16 a[20:23], v[212:215], v[188:191], a[20:23]
    buffer_load_dwordx4 a[156:159], v1, s[4:7], s41 offen offset:1024 sc1
    v_mfma_f32_16x16x32_bf16 a[20:23], v[208:211], v[156:159], a[20:23]
    v_exp_f32 v27, v27
    v_mfma_f32_16x16x32_bf16 a[16:19], v[208:211], v[152:155], a[16:19]
    v_cvt_pk_bf16_f32 v113, v26, v27
    v_lshl_add_u32 v249, v0, 4, s57
    v_mfma_f32_16x16x32_bf16 a[16:19], v[212:215], v[184:187], a[16:19]
    s_add_u32 s41, s43, 0x402000
    v_exp_f32 v28, v28
    v_mfma_f32_16x16x32_bf16 a[128:131], v[244:247], v[184:187], a[128:131]
    buffer_load_dwordx4 a[160:163], v1, s[4:7], s41 offen offset:0 sc1
    v_mfma_f32_16x16x32_bf16 a[128:131], v[244:247], v[152:155], a[128:131]
    s_waitcnt lgkmcnt(0)
    v_exp_f32 v29, v29
    v_mfma_f32_16x16x32_bf16 v[16:19], v[216:219], v[72:75], v[40:43]
    ds_read_b64_tr_b16 v[200:201], v238 offset:16384
    v_cvt_pk_bf16_f32 v116, v28, v29
    v_mfma_f32_16x16x32_bf16 v[16:19], v[220:223], v[88:91], v[16:19]
    v_exp_f32 v30, v30
    v_mfma_f32_16x16x32_bf16 v[16:19], v[224:227], v[136:139], v[16:19]
    ds_read_b64_tr_b16 v[202:203], v238 offset:20480
    ds_read_b64_tr_b16 v[204:205], v238 offset:24576
    v_mfma_f32_16x16x32_bf16 v[16:19], v[228:231], v[168:171], v[16:19]
    v_exp_f32 v31, v31
    v_mfma_f32_16x16x32_bf16 v[20:23], v[228:231], v[172:175], v[44:47]
    s_add_u32 s41, s43, 0x402000
    ds_read_b64_tr_b16 v[206:207], v238 offset:28672
    v_cvt_pk_bf16_f32 v117, v30, v31
    v_mfma_f32_16x16x32_bf16 v[20:23], v[224:227], v[140:143], v[20:23]
    buffer_load_dwordx4 a[164:167], v1, s[4:7], s41 offen offset:1024 sc1
    v_mfma_f32_16x16x32_bf16 v[20:23], v[220:223], v[92:95], v[20:23]
    ds_read_b64_tr_b16 v[208:209], v239 offset:16384
    ds_read_b64_tr_b16 v[210:211], v239 offset:20480
    v_mfma_f32_16x16x32_bf16 v[20:23], v[216:219], v[76:79], v[20:23]
    v_exp_f32 v16, v16
    v_mfma_f32_16x16x32_bf16 v[24:27], v[216:219], v[80:83], v[48:51]
    ds_read_b64_tr_b16 v[212:213], v239 offset:24576
    ds_read_b64_tr_b16 v[214:215], v239 offset:28672
    v_mfma_f32_16x16x32_bf16 v[24:27], v[220:223], v[96:99], v[24:27]
    v_exp_f32 v17, v17
    v_mfma_f32_16x16x32_bf16 v[24:27], v[224:227], v[144:147], v[24:27]
    v_cvt_pk_bf16_f32 v106, v16, v17
    v_lshl_add_u32 v250, v0, 4, s58
    v_mfma_f32_16x16x32_bf16 v[24:27], v[228:231], v[176:179], v[24:27]
    s_add_u32 s41, s43, 0x403000
    v_exp_f32 v18, v18
    v_mfma_f32_16x16x32_bf16 v[28:31], v[228:231], v[180:183], v[52:55]
    buffer_load_dwordx4 a[168:171], v1, s[4:7], s41 offen offset:0 sc1
    v_mfma_f32_16x16x32_bf16 v[28:31], v[224:227], v[148:151], v[28:31]
    v_exp_f32 v19, v19
    v_mfma_f32_16x16x32_bf16 v[28:31], v[220:223], v[100:103], v[28:31]
    v_cvt_pk_bf16_f32 v107, v18, v19
    v_lshl_add_u32 v251, v0, 4, s59
    v_mfma_f32_16x16x32_bf16 v[28:31], v[216:219], v[84:87], v[28:31]
    s_waitcnt lgkmcnt(0)
    v_exp_f32 v20, v20
    v_mfma_f32_16x16x32_bf16 a[36:39], v[204:207], v[188:191], a[36:39]
    ds_read_b128 v[216:219], v232 offset:24576
    v_ashrrev_i32 v248, 8, v248
    v_mfma_f32_16x16x32_bf16 a[36:39], v[200:203], v[156:159], a[36:39]
    v_exp_f32 v21, v21
    v_mfma_f32_16x16x32_bf16 a[40:43], v[200:203], v[160:163], a[40:43]
    ds_read_b128 v[220:223], v233 offset:24576
    v_cvt_pk_bf16_f32 v110, v20, v21
    v_mfma_f32_16x16x32_bf16 a[40:43], v[204:207], v[192:195], a[40:43]
    v_exp_f32 v22, v22
    v_mfma_f32_16x16x32_bf16 a[44:47], v[204:207], v[196:199], a[44:47]
    ds_read_b128 v[224:227], v234 offset:24576
    v_ashrrev_i32 v249, 8, v249
    v_mfma_f32_16x16x32_bf16 a[44:47], v[200:203], v[164:167], a[44:47]
    v_exp_f32 v23, v23
    v_mfma_f32_16x16x32_bf16 a[32:35], v[200:203], v[152:155], a[32:35]
    ds_read_b128 v[228:231], v235 offset:24576
    v_cvt_pk_bf16_f32 v111, v22, v23
    v_mfma_f32_16x16x32_bf16 a[32:35], v[204:207], v[184:187], a[32:35]
    s_add_u32 s41, s43, 0x403000
    v_exp_f32 v24, v24
    v_mfma_f32_16x16x32_bf16 a[48:51], v[212:215], v[184:187], a[48:51]
    buffer_load_dwordx4 a[172:175], v1, s[4:7], s41 offen offset:1024 sc1
    v_mfma_f32_16x16x32_bf16 a[48:51], v[208:211], v[152:155], a[48:51]
    v_exp_f32 v25, v25
    v_mfma_f32_16x16x32_bf16 a[60:63], v[208:211], v[164:167], a[60:63]
    v_cvt_pk_bf16_f32 v114, v24, v25
    v_ashrrev_i32 v250, 8, v250
    v_mfma_f32_16x16x32_bf16 a[60:63], v[212:215], v[196:199], a[60:63]
    s_add_u32 s41, s43, 0x404000
    v_exp_f32 v26, v26
    v_mfma_f32_16x16x32_bf16 a[56:59], v[212:215], v[192:195], a[56:59]
    buffer_load_dwordx4 a[176:179], v1, s[4:7], s41 offen offset:0 sc1
    v_mfma_f32_16x16x32_bf16 a[56:59], v[208:211], v[160:163], a[56:59]
    v_exp_f32 v27, v27
    v_mfma_f32_16x16x32_bf16 a[52:55], v[208:211], v[156:159], a[52:55]
    v_cvt_pk_bf16_f32 v115, v26, v27
    v_ashrrev_i32 v251, 8, v251
    v_mfma_f32_16x16x32_bf16 a[52:55], v[212:215], v[188:191], a[52:55]
    s_add_u32 s41, s43, 0x404000
    v_exp_f32 v28, v28
    v_mfma_f32_16x16x32_bf16 a[132:135], v[244:247], v[188:191], a[132:135]
    buffer_load_dwordx4 a[180:183], v1, s[4:7], s41 offen offset:1024 sc1
    v_mfma_f32_16x16x32_bf16 a[132:135], v[244:247], v[156:159], a[132:135]
    s_waitcnt lgkmcnt(0)
    v_exp_f32 v29, v29
    v_mfma_f32_16x16x32_bf16 v[16:19], v[216:219], v[72:75], v[40:43]
    ds_read_b64_tr_b16 v[200:201], v240 offset:16384
    v_cvt_pk_bf16_f32 v118, v28, v29
    v_mfma_f32_16x16x32_bf16 v[16:19], v[220:223], v[88:91], v[16:19]
    v_exp_f32 v30, v30
    v_mfma_f32_16x16x32_bf16 v[16:19], v[224:227], v[136:139], v[16:19]
    ds_read_b64_tr_b16 v[202:203], v240 offset:20480
    ds_read_b64_tr_b16 v[204:205], v240 offset:24576
    v_mfma_f32_16x16x32_bf16 v[16:19], v[228:231], v[168:171], v[16:19]
    v_exp_f32 v31, v31
    v_mfma_f32_16x16x32_bf16 v[20:23], v[228:231], v[172:175], v[44:47]
    s_add_u32 s41, s43, 0x405000
    ds_read_b64_tr_b16 v[206:207], v240 offset:28672
    v_cvt_pk_bf16_f32 v119, v30, v31
    v_mfma_f32_16x16x32_bf16 v[20:23], v[224:227], v[140:143], v[20:23]
    buffer_load_dwordx4 a[184:187], v1, s[4:7], s41 offen offset:0 sc1
    v_mfma_f32_16x16x32_bf16 v[20:23], v[220:223], v[92:95], v[20:23]
    ds_read_b64_tr_b16 v[208:209], v241 offset:16384
    ds_read_b64_tr_b16 v[210:211], v241 offset:20480
    v_mfma_f32_16x16x32_bf16 v[20:23], v[216:219], v[76:79], v[20:23]
    v_exp_f32 v16, v16
    v_mfma_f32_16x16x32_bf16 v[24:27], v[216:219], v[80:83], v[48:51]
    ds_read_b64_tr_b16 v[212:213], v241 offset:24576
    ds_read_b64_tr_b16 v[214:215], v241 offset:28672
    v_mfma_f32_16x16x32_bf16 v[24:27], v[220:223], v[96:99], v[24:27]
    v_exp_f32 v17, v17
    v_mfma_f32_16x16x32_bf16 v[24:27], v[224:227], v[144:147], v[24:27]
    v_cvt_pk_bf16_f32 v120, v16, v17
    v_med3_i32 v248, v248, 1, 20
    v_mfma_f32_16x16x32_bf16 v[24:27], v[228:231], v[176:179], v[24:27]
    s_add_u32 s41, s43, 0x405000
    v_exp_f32 v18, v18
    v_mfma_f32_16x16x32_bf16 v[28:31], v[228:231], v[180:183], v[52:55]
    buffer_load_dwordx4 a[188:191], v1, s[4:7], s41 offen offset:1024 sc1
    v_mfma_f32_16x16x32_bf16 v[28:31], v[224:227], v[148:151], v[28:31]
    v_exp_f32 v19, v19
    v_mfma_f32_16x16x32_bf16 v[28:31], v[220:223], v[100:103], v[28:31]
    v_cvt_pk_bf16_f32 v121, v18, v19
    v_med3_i32 v249, v249, 1, 20
    v_mfma_f32_16x16x32_bf16 v[28:31], v[216:219], v[84:87], v[28:31]
    s_waitcnt lgkmcnt(0)
    v_exp_f32 v20, v20
    v_mfma_f32_16x16x32_bf16 a[72:75], v[204:207], v[192:195], a[72:75]
    ds_read_b128 v[216:219], v232 offset:28672
    v_med3_i32 v250, v250, 1, 20
    v_mfma_f32_16x16x32_bf16 a[72:75], v[200:203], v[160:163], a[72:75]
    v_exp_f32 v21, v21
    v_mfma_f32_16x16x32_bf16 a[76:79], v[200:203], v[164:167], a[76:79]
    ds_read_b128 v[220:223], v233 offset:28672
    v_cvt_pk_bf16_f32 v124, v20, v21
    v_mfma_f32_16x16x32_bf16 a[76:79], v[204:207], v[196:199], a[76:79]
    v_exp_f32 v22, v22
    v_mfma_f32_16x16x32_bf16 a[64:67], v[204:207], v[184:187], a[64:67]
    ds_read_b128 v[224:227], v234 offset:28672
    v_med3_i32 v251, v251, 1, 20
    v_mfma_f32_16x16x32_bf16 a[64:67], v[200:203], v[152:155], a[64:67]
    v_exp_f32 v23, v23
    v_mfma_f32_16x16x32_bf16 a[68:71], v[200:203], v[156:159], a[68:71]
    ds_read_b128 v[228:231], v235 offset:28672
    v_cvt_pk_bf16_f32 v125, v22, v23
    v_mfma_f32_16x16x32_bf16 a[68:71], v[204:207], v[188:191], a[68:71]
    s_add_u32 s41, s43, 0x406000
    v_exp_f32 v24, v24
    v_mfma_f32_16x16x32_bf16 a[84:87], v[212:215], v[188:191], a[84:87]
    buffer_load_dwordx4 a[192:195], v1, s[4:7], s41 offen offset:0 sc1
    v_mfma_f32_16x16x32_bf16 a[84:87], v[208:211], v[156:159], a[84:87]
    v_exp_f32 v25, v25
    v_mfma_f32_16x16x32_bf16 a[80:83], v[208:211], v[152:155], a[80:83]
    v_cvt_pk_bf16_f32 v128, v24, v25
    v_add3_u32 v32, v248, v249, v250
    v_mfma_f32_16x16x32_bf16 a[80:83], v[212:215], v[184:187], a[80:83]
    s_add_u32 s41, s43, 0x406000
    v_exp_f32 v26, v26
    v_mfma_f32_16x16x32_bf16 a[92:95], v[212:215], v[196:199], a[92:95]
    buffer_load_dwordx4 a[196:199], v1, s[4:7], s41 offen offset:1024 sc1
    v_mfma_f32_16x16x32_bf16 a[92:95], v[208:211], v[164:167], a[92:95]
    v_exp_f32 v27, v27
    v_mfma_f32_16x16x32_bf16 a[88:91], v[208:211], v[160:163], a[88:91]
    v_cvt_pk_bf16_f32 v129, v26, v27
    v_add_u32 v32, v32, v251
    v_mfma_f32_16x16x32_bf16 a[88:91], v[212:215], v[192:195], a[88:91]
    s_add_u32 s41, s43, 0x407000
    v_exp_f32 v28, v28
    v_mfma_f32_16x16x32_bf16 a[136:139], v[244:247], v[192:195], a[136:139]
    buffer_load_dwordx4 a[200:203], v1, s[4:7], s41 offen offset:0 sc1
    v_mfma_f32_16x16x32_bf16 a[136:139], v[244:247], v[160:163], a[136:139]
    s_waitcnt lgkmcnt(0)
    v_exp_f32 v29, v29
    v_mfma_f32_16x16x32_bf16 v[16:19], v[216:219], v[72:75], v[40:43]
    ds_read_b64_tr_b16 v[200:201], v242 offset:16384
    v_cvt_pk_bf16_f32 v132, v28, v29
    v_mfma_f32_16x16x32_bf16 v[16:19], v[220:223], v[88:91], v[16:19]
    v_exp_f32 v30, v30
    v_mfma_f32_16x16x32_bf16 v[16:19], v[224:227], v[136:139], v[16:19]
    ds_read_b64_tr_b16 v[202:203], v242 offset:20480
    ds_read_b64_tr_b16 v[204:205], v242 offset:24576
    v_mfma_f32_16x16x32_bf16 v[16:19], v[228:231], v[168:171], v[16:19]
    v_exp_f32 v31, v31
    v_mfma_f32_16x16x32_bf16 v[20:23], v[228:231], v[172:175], v[44:47]
    s_add_u32 s41, s43, 0x407000
    ds_read_b64_tr_b16 v[206:207], v242 offset:28672
    v_cvt_pk_bf16_f32 v133, v30, v31
    v_mfma_f32_16x16x32_bf16 v[20:23], v[224:227], v[140:143], v[20:23]
    buffer_load_dwordx4 a[204:207], v1, s[4:7], s41 offen offset:1024 sc1
    v_mfma_f32_16x16x32_bf16 v[20:23], v[220:223], v[92:95], v[20:23]
    ds_read_b64_tr_b16 v[208:209], v243 offset:16384
    ds_read_b64_tr_b16 v[210:211], v243 offset:20480
    v_mfma_f32_16x16x32_bf16 v[20:23], v[216:219], v[76:79], v[20:23]
    v_exp_f32 v16, v16
    v_mfma_f32_16x16x32_bf16 v[24:27], v[216:219], v[80:83], v[48:51]
    ds_read_b64_tr_b16 v[212:213], v243 offset:24576
    ds_read_b64_tr_b16 v[214:215], v243 offset:28672
    v_mfma_f32_16x16x32_bf16 v[24:27], v[220:223], v[96:99], v[24:27]
    v_exp_f32 v17, v17
    v_mfma_f32_16x16x32_bf16 v[24:27], v[224:227], v[144:147], v[24:27]
    v_cvt_pk_bf16_f32 v122, v16, v17
    v_cmp_le_i32 vcc, 20, v32
    v_mfma_f32_16x16x32_bf16 v[24:27], v[228:231], v[176:179], v[24:27]
    s_add_u32 s41, s43, 0x408000
    v_exp_f32 v18, v18
    v_mfma_f32_16x16x32_bf16 v[28:31], v[228:231], v[180:183], v[52:55]
    buffer_load_dwordx4 a[208:211], v1, s[4:7], s41 offen offset:0 sc1
    v_mfma_f32_16x16x32_bf16 v[28:31], v[224:227], v[148:151], v[28:31]
    s_ff1_i32_b64 s54, vcc
    v_exp_f32 v19, v19
    v_mfma_f32_16x16x32_bf16 v[28:31], v[220:223], v[100:103], v[28:31]
    s_and_b32 s54, s54, 63
    v_cvt_pk_bf16_f32 v123, v18, v19
    v_mfma_f32_16x16x32_bf16 v[28:31], v[216:219], v[84:87], v[28:31]
    s_waitcnt vmcnt(17) lgkmcnt(0)
    s_barrier
    v_exp_f32 v20, v20
    v_mfma_f32_16x16x32_bf16 a[108:111], v[204:207], v[196:199], a[108:111]
    ds_read_b128 v[216:219], v232 offset:32768
    v_readlane_b32 s56, v248, s54
    v_mfma_f32_16x16x32_bf16 a[108:111], v[200:203], v[164:167], a[108:111]
    v_exp_f32 v21, v21
    v_mfma_f32_16x16x32_bf16 a[96:99], v[200:203], v[152:155], a[96:99]
    ds_read_b128 v[220:223], v233 offset:32768
    v_cvt_pk_bf16_f32 v126, v20, v21
    v_mfma_f32_16x16x32_bf16 a[96:99], v[204:207], v[184:187], a[96:99]
    v_exp_f32 v22, v22
    v_mfma_f32_16x16x32_bf16 a[100:103], v[204:207], v[188:191], a[100:103]
    ds_read_b128 v[224:227], v234 offset:32768
    v_readlane_b32 s57, v249, s54
    v_mfma_f32_16x16x32_bf16 a[100:103], v[200:203], v[156:159], a[100:103]
    v_exp_f32 v23, v23
    v_mfma_f32_16x16x32_bf16 a[104:107], v[200:203], v[160:163], a[104:107]
    s_add_u32 m0, s69, 0x0
    ds_read_b128 v[228:231], v235 offset:32768
    v_cvt_pk_bf16_f32 v127, v22, v23
    v_mfma_f32_16x16x32_bf16 a[104:107], v[204:207], v[192:195], a[104:107]
    s_add_u32 s41, s28, 0x0
    v_exp_f32 v24, v24
    v_mfma_f32_16x16x32_bf16 a[120:123], v[212:215], v[192:195], a[120:123]
    buffer_load_dwordx4 v1, s[88:91], s41 offen sc1 lds
    v_mfma_f32_16x16x32_bf16 a[120:123], v[208:211], v[160:163], a[120:123]
    v_exp_f32 v25, v25
    v_mfma_f32_16x16x32_bf16 a[116:119], v[208:211], v[156:159], a[116:119]
    s_add_u32 m0, s69, 0x400
    v_cvt_pk_bf16_f32 v130, v24, v25
    v_readlane_b32 s59, v251, s54
    v_mfma_f32_16x16x32_bf16 a[116:119], v[212:215], v[188:191], a[116:119]
    s_add_u32 s41, s29, 0x0
    v_exp_f32 v26, v26
    v_mfma_f32_16x16x32_bf16 a[112:115], v[212:215], v[184:187], a[112:115]
    buffer_load_dwordx4 v1, s[88:91], s41 offen sc1 lds
    v_mfma_f32_16x16x32_bf16 a[112:115], v[208:211], v[152:155], a[112:115]
    v_exp_f32 v27, v27
    v_mfma_f32_16x16x32_bf16 a[124:127], v[208:211], v[164:167], a[124:127]
    s_add_u32 m0, s69, 0x800
    v_cvt_pk_bf16_f32 v131, v26, v27
    v_mfma_f32_16x16x32_bf16 a[124:127], v[212:215], v[196:199], a[124:127]
    s_add_u32 s41, s30, 0x0
    v_exp_f32 v28, v28
    v_mfma_f32_16x16x32_bf16 a[140:143], v[244:247], v[196:199], a[140:143]
    buffer_load_dwordx4 v1, s[88:91], s41 offen sc1 lds
    v_mfma_f32_16x16x32_bf16 a[140:143], v[244:247], v[164:167], a[140:143]
    s_waitcnt lgkmcnt(0)
    v_exp_f32 v29, v29
    v_mfma_f32_16x16x32_bf16 v[16:19], v[216:219], v[72:75], v[40:43]
    s_add_u32 s57, s57, s56
    ds_read_b64_tr_b16 v[200:201], v236 offset:32768
    v_cvt_pk_bf16_f32 v134, v28, v29
    v_mfma_f32_16x16x32_bf16 v[16:19], v[220:223], v[88:91], v[16:19]
    s_sub_u32 s59, 20, s59
    v_exp_f32 v30, v30
    v_mfma_f32_16x16x32_bf16 v[16:19], v[224:227], v[136:139], v[16:19]
    s_min_u32 s56, s56, 17
    ds_read_b64_tr_b16 v[202:203], v236 offset:36864
    ds_read_b64_tr_b16 v[204:205], v236 offset:40960
    v_mfma_f32_16x16x32_bf16 v[16:19], v[228:231], v[168:171], v[16:19]
    s_add_u32 m0, s69, 0xc00
    v_exp_f32 v31, v31
    v_mfma_f32_16x16x32_bf16 v[20:23], v[228:231], v[172:175], v[44:47]
    s_add_u32 s41, s31, 0x0
    ds_read_b64_tr_b16 v[206:207], v236 offset:45056
    v_cvt_pk_bf16_f32 v135, v30, v31
    v_mfma_f32_16x16x32_bf16 v[20:23], v[224:227], v[140:143], v[20:23]
    buffer_load_dwordx4 v1, s[88:91], s41 offen sc1 lds
    v_mfma_f32_16x16x32_bf16 v[20:23], v[220:223], v[92:95], v[20:23]
    s_min_u32 s57, s57, 18
    ds_read_b64_tr_b16 v[208:209], v237 offset:32768
    ds_read_b64_tr_b16 v[210:211], v237 offset:36864
    v_mfma_f32_16x16x32_bf16 v[20:23], v[216:219], v[76:79], v[20:23]
    s_add_u32 s54, s57, 1
    v_exp_f32 v16, v16
    v_mfma_f32_16x16x32_bf16 v[24:27], v[216:219], v[80:83], v[48:51]
    s_max_i32 s59, s59, s54
    ds_read_b64_tr_b16 v[212:213], v237 offset:40960
    ds_read_b64_tr_b16 v[214:215], v237 offset:45056
    v_mfma_f32_16x16x32_bf16 v[24:27], v[220:223], v[96:99], v[24:27]
    s_lshl_b32 s57, s57, 8
    v_exp_f32 v17, v17
    v_mfma_f32_16x16x32_bf16 v[24:27], v[224:227], v[144:147], v[24:27]
    s_add_u32 m0, s69, 0x1000
    v_cvt_pk_bf16_f32 v152, v16, v17
    v_mfma_f32_16x16x32_bf16 v[24:27], v[228:231], v[176:179], v[24:27]
    s_add_u32 s41, s36, 0x0
    v_exp_f32 v18, v18
    v_mfma_f32_16x16x32_bf16 v[28:31], v[228:231], v[180:183], v[52:55]
    buffer_load_dwordx4 v1, s[88:91], s41 offen sc1 lds
    v_mfma_f32_16x16x32_bf16 v[28:31], v[224:227], v[148:151], v[28:31]
    s_lshl_b32 s59, s59, 16
    v_exp_f32 v19, v19
    v_mfma_f32_16x16x32_bf16 v[28:31], v[220:223], v[100:103], v[28:31]
    s_or_b32 s56, s56, s57
    v_cvt_pk_bf16_f32 v153, v18, v19
    v_mfma_f32_16x16x32_bf16 v[28:31], v[216:219], v[84:87], v[28:31]
    s_waitcnt lgkmcnt(0)
    v_exp_f32 v20, v20
    v_mfma_f32_16x16x32_bf16 a[0:3], v[204:207], v[120:123], a[0:3]
    s_or_b32 s59, s59, 0x14000000
    ds_read_b128 v[216:219], v232 offset:36864
    v_mov_b32 v33, 0
    v_mfma_f32_16x16x32_bf16 a[0:3], v[200:203], v[104:107], a[0:3]
    s_or_b32 s53, s56, s59
    v_exp_f32 v21, v21
    v_mfma_f32_16x16x32_bf16 a[4:7], v[200:203], v[108:111], a[4:7]
    ds_read_b128 v[220:223], v233 offset:36864
    v_cvt_pk_bf16_f32 v156, v20, v21
    v_mfma_f32_16x16x32_bf16 a[4:7], v[204:207], v[124:127], a[4:7]
    v_exp_f32 v22, v22
    v_mfma_f32_16x16x32_bf16 a[8:11], v[204:207], v[128:131], a[8:11]
    ds_read_b128 v[224:227], v234 offset:36864
    v_mov_b32 v32, s53
    v_mfma_f32_16x16x32_bf16 a[8:11], v[200:203], v[112:115], a[8:11]
    v_exp_f32 v23, v23
    v_mfma_f32_16x16x32_bf16 a[12:15], v[200:203], v[116:119], a[12:15]
    ds_read_b128 v[228:231], v235 offset:36864
    v_cvt_pk_bf16_f32 v157, v22, v23
    v_mfma_f32_16x16x32_bf16 a[12:15], v[204:207], v[132:135], a[12:15]
    v_exp_f32 v24, v24
    v_mfma_f32_16x16x32_bf16 a[28:31], v[212:215], v[132:135], a[28:31]
    buffer_atomic_cmpswap v[32:33], v7, s[4:7], s44 offen offset:16 sc0 sc1
    v_mfma_f32_16x16x32_bf16 a[28:31], v[208:211], v[116:119], a[28:31]
    s_mov_b32 s12, s78
    v_exp_f32 v25, v25
    v_mfma_f32_16x16x32_bf16 a[24:27], v[208:211], v[112:115], a[24:27]
    s_add_u32 m0, s69, 0x1400
    v_cvt_pk_bf16_f32 v160, v24, v25
    v_mfma_f32_16x16x32_bf16 a[24:27], v[212:215], v[128:131], a[24:27]
    s_add_u32 s41, s37, 0x0
    v_exp_f32 v26, v26
    v_mfma_f32_16x16x32_bf16 a[20:23], v[212:215], v[124:127], a[20:23]
    buffer_load_dwordx4 v1, s[88:91], s41 offen sc1 lds
    v_mfma_f32_16x16x32_bf16 a[20:23], v[208:211], v[108:111], a[20:23]
    s_and_b32 s13, s79, 0xffff
    v_exp_f32 v27, v27
    v_mfma_f32_16x16x32_bf16 a[16:19], v[208:211], v[104:107], a[16:19]
    s_add_u32 m0, s69, 0x1800
    v_cvt_pk_bf16_f32 v161, v26, v27
    v_mfma_f32_16x16x32_bf16 a[16:19], v[212:215], v[120:123], a[16:19]
L_hop0_15:
    s_cbranch_execz L_hop0_ret
    s_add_u32 s41, s38, 0x0
    v_exp_f32 v28, v28
    v_mfma_f32_16x16x32_bf16 a[128:131], v[244:247], v[120:123], a[128:131]
    buffer_load_dwordx4 v1, s[88:91], s41 offen sc1 lds
    v_mfma_f32_16x16x32_bf16 a[128:131], v[244:247], v[104:107], a[128:131]
    s_waitcnt lgkmcnt(0)
    v_exp_f32 v29, v29
    v_mfma_f32_16x16x32_bf16 v[16:19], v[216:219], v[72:75], v[40:43]
    s_mov_b32 s14, 0x240000
    ds_read_b64_tr_b16 v[200:201], v238 offset:32768
    v_cvt_pk_bf16_f32 v164, v28, v29
    v_mfma_f32_16x16x32_bf16 v[16:19], v[220:223], v[88:91], v[16:19]
    s_mov_b32 s15, 0x20000
    v_exp_f32 v30, v30
    v_mfma_f32_16x16x32_bf16 v[16:19], v[224:227], v[136:139], v[16:19]
    s_lshr_b32 s54, s2, 3
    ds_read_b64_tr_b16 v[202:203], v238 offset:36864
    ds_read_b64_tr_b16 v[204:205], v238 offset:40960
    v_mfma_f32_16x16x32_bf16 v[16:19], v[228:231], v[168:171], v[16:19]
    s_add_u32 m0, s69, 0x1c00
    v_exp_f32 v31, v31
    v_mfma_f32_16x16x32_bf16 v[20:23], v[228:231], v[172:175], v[44:47]
    s_add_u32 s41, s39, 0x0
    ds_read_b64_tr_b16 v[206:207], v238 offset:45056
    v_cvt_pk_bf16_f32 v165, v30, v31
    v_mfma_f32_16x16x32_bf16 v[20:23], v[224:227], v[140:143], v[20:23]
    buffer_load_dwordx4 v1, s[88:91], s41 offen sc1 lds
    v_mfma_f32_16x16x32_bf16 v[20:23], v[220:223], v[92:95], v[20:23]
    s_lshl_b32 s54, s54, 1
    ds_read_b64_tr_b16 v[208:209], v239 offset:32768
    ds_read_b64_tr_b16 v[210:211], v239 offset:36864
    v_mfma_f32_16x16x32_bf16 v[20:23], v[216:219], v[76:79], v[20:23]
    s_add_u32 s54, s54, s3
    v_exp_f32 v16, v16
    v_mfma_f32_16x16x32_bf16 v[24:27], v[216:219], v[80:83], v[48:51]
    s_lshl_b32 s54, s54, 2
    ds_read_b64_tr_b16 v[212:213], v239 offset:40960
    ds_read_b64_tr_b16 v[214:215], v239 offset:45056
    v_mfma_f32_16x16x32_bf16 v[24:27], v[220:223], v[96:99], v[24:27]
    s_add_u32 s54, s54, s32
    v_exp_f32 v17, v17
    v_mfma_f32_16x16x32_bf16 v[24:27], v[224:227], v[144:147], v[24:27]
    s_add_u32 m0, s69, 0x2000
    v_cvt_pk_bf16_f32 v154, v16, v17
    v_mfma_f32_16x16x32_bf16 v[24:27], v[228:231], v[176:179], v[24:27]
    s_add_u32 s41, s40, 0x0
    v_exp_f32 v18, v18
    v_mfma_f32_16x16x32_bf16 v[28:31], v[228:231], v[180:183], v[52:55]
    buffer_load_dwordx4 v1, s[88:91], s41 offen sc1 lds
    v_mfma_f32_16x16x32_bf16 v[28:31], v[224:227], v[148:151], v[28:31]
    s_lshl_b32 s54, s54, 4
    v_exp_f32 v19, v19
    v_mfma_f32_16x16x32_bf16 v[28:31], v[220:223], v[100:103], v[28:31]
    s_add_u32 s50, s54, 0x3402000
    v_cvt_pk_bf16_f32 v155, v18, v19
    v_mfma_f32_16x16x32_bf16 v[28:31], v[216:219], v[84:87], v[28:31]
    s_waitcnt lgkmcnt(0)
    v_exp_f32 v20, v20
    v_mfma_f32_16x16x32_bf16 a[36:39], v[204:207], v[124:127], a[36:39]
    s_bfe_u32 s54, s2, 0x20001
    ds_read_b128 v[216:219], v232 offset:40960
    v_mfma_f32_16x16x32_bf16 a[36:39], v[200:203], v[108:111], a[36:39]
    s_lshl_b32 s54, s54, 2
    v_exp_f32 v21, v21
    v_mfma_f32_16x16x32_bf16 a[40:43], v[200:203], v[112:115], a[40:43]
    s_add_u32 s44, s54, s50
    ds_read_b128 v[220:223], v233 offset:40960
    v_cvt_pk_bf16_f32 v158, v20, v21
    v_mfma_f32_16x16x32_bf16 a[40:43], v[204:207], v[128:131], a[40:43]
    v_exp_f32 v22, v22
    v_mfma_f32_16x16x32_bf16 a[44:47], v[204:207], v[132:135], a[44:47]
    ds_read_b128 v[224:227], v234 offset:40960
    v_mfma_f32_16x16x32_bf16 a[44:47], v[200:203], v[116:119], a[44:47]
    v_exp_f32 v23, v23
    v_mfma_f32_16x16x32_bf16 a[32:35], v[200:203], v[104:107], a[32:35]
    s_add_u32 m0, s72, 0x0
    ds_read_b128 v[228:231], v235 offset:40960
    v_cvt_pk_bf16_f32 v159, v22, v23
    v_mfma_f32_16x16x32_bf16 a[32:35], v[204:207], v[120:123], a[32:35]
    s_add_u32 s41, s28, 0x24000
    v_exp_f32 v24, v24
    v_mfma_f32_16x16x32_bf16 a[48:51], v[212:215], v[120:123], a[48:51]
    buffer_load_dwordx4 v1, s[88:91], s41 offen sc1 lds
    v_mfma_f32_16x16x32_bf16 a[48:51], v[208:211], v[104:107], a[48:51]
    v_exp_f32 v25, v25
    v_mfma_f32_16x16x32_bf16 a[60:63], v[208:211], v[116:119], a[60:63]
    s_add_u32 m0, s72, 0x400
    v_cvt_pk_bf16_f32 v162, v24, v25
    v_mfma_f32_16x16x32_bf16 a[60:63], v[212:215], v[132:135], a[60:63]
    s_add_u32 s41, s29, 0x24000
    v_exp_f32 v26, v26
    v_mfma_f32_16x16x32_bf16 a[56:59], v[212:215], v[128:131], a[56:59]
    buffer_load_dwordx4 v1, s[88:91], s41 offen sc1 lds
    v_mfma_f32_16x16x32_bf16 a[56:59], v[208:211], v[112:115], a[56:59]
    v_exp_f32 v27, v27
    v_mfma_f32_16x16x32_bf16 a[52:55], v[208:211], v[108:111], a[52:55]
    s_add_u32 m0, s72, 0x800
    v_cvt_pk_bf16_f32 v163, v26, v27
    v_mfma_f32_16x16x32_bf16 a[52:55], v[212:215], v[124:127], a[52:55]
    s_add_u32 s41, s30, 0x24000
    v_exp_f32 v28, v28
    v_mfma_f32_16x16x32_bf16 a[132:135], v[244:247], v[124:127], a[132:135]
    buffer_load_dwordx4 v1, s[88:91], s41 offen sc1 lds
    v_mfma_f32_16x16x32_bf16 a[132:135], v[244:247], v[108:111], a[132:135]
    s_waitcnt lgkmcnt(0)
    v_exp_f32 v29, v29
    v_mfma_f32_16x16x32_bf16 v[16:19], v[216:219], v[72:75], v[40:43]
    ds_read_b64_tr_b16 v[200:201], v240 offset:32768
    v_cvt_pk_bf16_f32 v166, v28, v29
    v_mfma_f32_16x16x32_bf16 v[16:19], v[220:223], v[88:91], v[16:19]
    v_exp_f32 v30, v30
    v_mfma_f32_16x16x32_bf16 v[16:19], v[224:227], v[136:139], v[16:19]
    ds_read_b64_tr_b16 v[202:203], v240 offset:36864
    ds_read_b64_tr_b16 v[204:205], v240 offset:40960
    v_mfma_f32_16x16x32_bf16 v[16:19], v[228:231], v[168:171], v[16:19]
    s_add_u32 m0, s72, 0xc00
    v_exp_f32 v31, v31
    v_mfma_f32_16x16x32_bf16 v[20:23], v[228:231], v[172:175], v[44:47]
    s_add_u32 s41, s31, 0x24000
    ds_read_b64_tr_b16 v[206:207], v240 offset:45056
    v_cvt_pk_bf16_f32 v167, v30, v31
    v_mfma_f32_16x16x32_bf16 v[20:23], v[224:227], v[140:143], v[20:23]
    buffer_load_dwordx4 v1, s[88:91], s41 offen sc1 lds
    v_mfma_f32_16x16x32_bf16 v[20:23], v[220:223], v[92:95], v[20:23]
    ds_read_b64_tr_b16 v[208:209], v241 offset:32768
    ds_read_b64_tr_b16 v[210:211], v241 offset:36864
    v_mfma_f32_16x16x32_bf16 v[20:23], v[216:219], v[76:79], v[20:23]
    v_exp_f32 v16, v16
    v_mfma_f32_16x16x32_bf16 v[24:27], v[216:219], v[80:83], v[48:51]
    ds_read_b64_tr_b16 v[212:213], v241 offset:40960
    ds_read_b64_tr_b16 v[214:215], v241 offset:45056
    v_mfma_f32_16x16x32_bf16 v[24:27], v[220:223], v[96:99], v[24:27]
    v_exp_f32 v17, v17
    v_mfma_f32_16x16x32_bf16 v[24:27], v[224:227], v[144:147], v[24:27]
    s_add_u32 m0, s72, 0x1000
    v_cvt_pk_bf16_f32 v184, v16, v17
    v_mfma_f32_16x16x32_bf16 v[24:27], v[228:231], v[176:179], v[24:27]
    s_add_u32 s41, s36, 0x24000
    v_exp_f32 v18, v18
    v_mfma_f32_16x16x32_bf16 v[28:31], v[228:231], v[180:183], v[52:55]
    buffer_load_dwordx4 v1, s[88:91], s41 offen sc1 lds
    v_mfma_f32_16x16x32_bf16 v[28:31], v[224:227], v[148:151], v[28:31]
    s_waitcnt vmcnt(9)
    v_exp_f32 v19, v19
    v_mfma_f32_16x16x32_bf16 v[28:31], v[220:223], v[100:103], v[28:31]
    v_cvt_pk_bf16_f32 v185, v18, v19
    v_readfirstlane_b32 s54, v32
    v_mfma_f32_16x16x32_bf16 v[28:31], v[216:219], v[84:87], v[28:31]
    s_waitcnt lgkmcnt(0)
    v_exp_f32 v20, v20
    v_mfma_f32_16x16x32_bf16 a[72:75], v[204:207], v[128:131], a[72:75]
    s_min_u32 s55, s54, 1
    ds_read_b128 v[216:219], v232 offset:45056
    v_mfma_f32_16x16x32_bf16 a[72:75], v[200:203], v[112:115], a[72:75]
    s_sub_u32 s55, s55, 1
    v_exp_f32 v21, v21
    v_mfma_f32_16x16x32_bf16 a[76:79], v[200:203], v[116:119], a[76:79]
    s_and_b32 s55, s55, s53
    ds_read_b128 v[220:223], v233 offset:45056
    v_cvt_pk_bf16_f32 v188, v20, v21
    v_mfma_f32_16x16x32_bf16 a[76:79], v[204:207], v[132:135], a[76:79]
    s_or_b32 s54, s54, s55
    v_exp_f32 v22, v22
    v_mfma_f32_16x16x32_bf16 a[64:67], v[204:207], v[120:123], a[64:67]
    s_lshl_b32 s55, s32, 2
    ds_read_b128 v[224:227], v234 offset:45056
    v_mfma_f32_16x16x32_bf16 a[64:67], v[200:203], v[104:107], a[64:67]
    s_add_u32 s55, s55, 163792
    v_exp_f32 v23, v23
    v_mfma_f32_16x16x32_bf16 a[68:71], v[200:203], v[108:111], a[68:71]
    s_add_u32 m0, s72, 0x1400
    ds_read_b128 v[228:231], v235 offset:45056
    v_cvt_pk_bf16_f32 v189, v22, v23
    v_mfma_f32_16x16x32_bf16 a[68:71], v[204:207], v[124:127], a[68:71]
    s_add_u32 s41, s37, 0x24000
    v_exp_f32 v24, v24
    v_mfma_f32_16x16x32_bf16 a[84:87], v[212:215], v[124:127], a[84:87]
    buffer_load_dwordx4 v1, s[88:91], s41 offen sc1 lds
    v_mfma_f32_16x16x32_bf16 a[84:87], v[208:211], v[108:111], a[84:87]
    v_exp_f32 v25, v25
    v_mfma_f32_16x16x32_bf16 a[80:83], v[208:211], v[104:107], a[80:83]
    s_add_u32 m0, s72, 0x1800
    v_cvt_pk_bf16_f32 v192, v24, v25
    v_mov_b32 v32, s54
    v_mfma_f32_16x16x32_bf16 a[80:83], v[212:215], v[120:123], a[80:83]
    s_add_u32 s41, s38, 0x24000
    v_exp_f32 v26, v26
    v_mfma_f32_16x16x32_bf16 a[92:95], v[212:215], v[132:135], a[92:95]
    buffer_load_dwordx4 v1, s[88:91], s41 offen sc1 lds
    v_mfma_f32_16x16x32_bf16 a[92:95], v[208:211], v[116:119], a[92:95]
    v_exp_f32 v27, v27
    v_mfma_f32_16x16x32_bf16 a[88:91], v[208:211], v[112:115], a[88:91]
    s_add_u32 m0, s72, 0x1c00
    v_cvt_pk_bf16_f32 v193, v26, v27
    v_mov_b32 v33, s55
    v_mfma_f32_16x16x32_bf16 a[88:91], v[212:215], v[128:131], a[88:91]
    s_add_u32 s41, s39, 0x24000
    v_exp_f32 v28, v28
    v_mfma_f32_16x16x32_bf16 a[136:139], v[244:247], v[128:131], a[136:139]
    buffer_load_dwordx4 v1, s[88:91], s41 offen sc1 lds
    v_mfma_f32_16x16x32_bf16 a[136:139], v[244:247], v[112:115], a[136:139]
    s_waitcnt lgkmcnt(0)
    v_exp_f32 v29, v29
    v_mfma_f32_16x16x32_bf16 v[16:19], v[216:219], v[72:75], v[40:43]
    ds_read_b64_tr_b16 v[200:201], v242 offset:32768
    v_cvt_pk_bf16_f32 v196, v28, v29
    v_mfma_f32_16x16x32_bf16 v[16:19], v[220:223], v[88:91], v[16:19]
    v_exp_f32 v30, v30
    v_mfma_f32_16x16x32_bf16 v[16:19], v[224:227], v[136:139], v[16:19]
    ds_read_b64_tr_b16 v[202:203], v242 offset:36864
    ds_read_b64_tr_b16 v[204:205], v242 offset:40960
    v_mfma_f32_16x16x32_bf16 v[16:19], v[228:231], v[168:171], v[16:19]
    s_add_u32 m0, s72, 0x2000
    v_exp_f32 v31, v31
    v_mfma_f32_16x16x32_bf16 v[20:23], v[228:231], v[172:175], v[44:47]
    s_add_u32 s41, s40, 0x24000
    ds_read_b64_tr_b16 v[206:207], v242 offset:45056
    v_cvt_pk_bf16_f32 v197, v30, v31
    v_mfma_f32_16x16x32_bf16 v[20:23], v[224:227], v[140:143], v[20:23]
    buffer_load_dwordx4 v1, s[88:91], s41 offen sc1 lds
    v_mfma_f32_16x16x32_bf16 v[20:23], v[220:223], v[92:95], v[20:23]
    ds_read_b64_tr_b16 v[208:209], v243 offset:32768
    ds_read_b64_tr_b16 v[210:211], v243 offset:36864
    v_mfma_f32_16x16x32_bf16 v[20:23], v[216:219], v[76:79], v[20:23]
    v_exp_f32 v16, v16
    v_mfma_f32_16x16x32_bf16 v[24:27], v[216:219], v[80:83], v[48:51]
    ds_read_b64_tr_b16 v[212:213], v243 offset:40960
    ds_read_b64_tr_b16 v[214:215], v243 offset:45056
    v_mfma_f32_16x16x32_bf16 v[24:27], v[220:223], v[96:99], v[24:27]
    v_exp_f32 v17, v17
    v_mfma_f32_16x16x32_bf16 v[24:27], v[224:227], v[144:147], v[24:27]
    ds_write_b32 v33, v32
    v_cvt_pk_bf16_f32 v186, v16, v17
    v_mfma_f32_16x16x32_bf16 v[24:27], v[228:231], v[176:179], v[24:27]
    s_add_u32 s41, s43, 0x408000
    v_exp_f32 v18, v18
    v_mfma_f32_16x16x32_bf16 v[28:31], v[228:231], v[180:183], v[52:55]
    buffer_load_dwordx4 a[212:215], v1, s[4:7], s41 offen offset:1024 sc1
    v_mfma_f32_16x16x32_bf16 v[28:31], v[224:227], v[148:151], v[28:31]
    v_exp_f32 v19, v19
    v_mfma_f32_16x16x32_bf16 v[28:31], v[220:223], v[100:103], v[28:31]
    v_cvt_pk_bf16_f32 v187, v18, v19
    v_mov_b32 v33, 163792
    v_mfma_f32_16x16x32_bf16 v[28:31], v[216:219], v[84:87], v[28:31]
    s_waitcnt lgkmcnt(0)
    s_barrier
    v_exp_f32 v20, v20
    v_mfma_f32_16x16x32_bf16 a[108:111], v[204:207], v[132:135], a[108:111]
    ds_read_b64_tr_b16 v[216:217], v236 offset:49152
    ds_read_b64_tr_b16 v[218:219], v236 offset:53248
    v_mfma_f32_16x16x32_bf16 a[108:111], v[200:203], v[116:119], a[108:111]
    v_exp_f32 v21, v21
    v_mfma_f32_16x16x32_bf16 a[96:99], v[200:203], v[104:107], a[96:99]
    ds_read_b64_tr_b16 v[220:221], v236 offset:57344
    v_cvt_pk_bf16_f32 v190, v20, v21
    v_mfma_f32_16x16x32_bf16 a[96:99], v[204:207], v[120:123], a[96:99]
    v_exp_f32 v22, v22
    v_mfma_f32_16x16x32_bf16 a[100:103], v[204:207], v[124:127], a[100:103]
    ds_read_b64_tr_b16 v[222:223], v236 offset:61440
    ds_read_b64_tr_b16 v[224:225], v237 offset:49152
    v_mfma_f32_16x16x32_bf16 a[100:103], v[200:203], v[108:111], a[100:103]
    v_exp_f32 v23, v23
    v_mfma_f32_16x16x32_bf16 a[104:107], v[200:203], v[112:115], a[104:107]
    ds_read_b64_tr_b16 v[226:227], v237 offset:53248
    v_cvt_pk_bf16_f32 v191, v22, v23
    v_mfma_f32_16x16x32_bf16 a[104:107], v[204:207], v[128:131], a[104:107]
    v_exp_f32 v24, v24
    v_mfma_f32_16x16x32_bf16 a[120:123], v[212:215], v[128:131], a[120:123]
    ds_read_b64_tr_b16 v[228:229], v237 offset:57344
    ds_read_b64_tr_b16 v[230:231], v237 offset:61440
    v_mfma_f32_16x16x32_bf16 a[120:123], v[208:211], v[112:115], a[120:123]
    v_exp_f32 v25, v25
    v_mfma_f32_16x16x32_bf16 a[116:119], v[208:211], v[108:111], a[116:119]
    ds_read_b32 v32, v33
    v_cvt_pk_bf16_f32 v194, v24, v25
    v_mfma_f32_16x16x32_bf16 a[116:119], v[212:215], v[124:127], a[116:119]
    s_add_u32 s41, s43, 0x409000
    v_exp_f32 v26, v26
    v_mfma_f32_16x16x32_bf16 a[112:115], v[212:215], v[120:123], a[112:115]
    buffer_load_dwordx4 a[216:219], v1, s[4:7], s41 offen offset:0 sc1
    v_mfma_f32_16x16x32_bf16 a[112:115], v[208:211], v[104:107], a[112:115]
    v_exp_f32 v27, v27
    v_mfma_f32_16x16x32_bf16 a[124:127], v[208:211], v[116:119], a[124:127]
    v_cvt_pk_bf16_f32 v195, v26, v27
    v_mfma_f32_16x16x32_bf16 a[124:127], v[212:215], v[132:135], a[124:127]
    s_add_u32 s41, s43, 0x409000
    v_exp_f32 v28, v28
    v_mfma_f32_16x16x32_bf16 a[140:143], v[244:247], v[132:135], a[140:143]
    buffer_load_dwordx4 a[220:223], v1, s[4:7], s41 offen offset:1024 sc1
    v_mfma_f32_16x16x32_bf16 a[140:143], v[244:247], v[116:119], a[140:143]
    s_waitcnt lgkmcnt(0)
    v_exp_f32 v29, v29
    v_mfma_f32_16x16x32_bf16 a[0:3], v[220:223], v[184:187], a[0:3]
    ds_read_b64_tr_b16 v[200:201], v238 offset:49152
    v_cvt_pk_bf16_f32 v198, v28, v29
    v_mfma_f32_16x16x32_bf16 a[0:3], v[216:219], v[152:155], a[0:3]
    v_exp_f32 v30, v30
    v_mfma_f32_16x16x32_bf16 a[4:7], v[216:219], v[156:159], a[4:7]
    ds_read_b64_tr_b16 v[202:203], v238 offset:53248
    v_readfirstlane_b32 s53, v32
    v_mfma_f32_16x16x32_bf16 a[4:7], v[220:223], v[188:191], a[4:7]
    v_exp_f32 v31, v31
    v_mfma_f32_16x16x32_bf16 a[8:11], v[220:223], v[192:195], a[8:11]
    s_add_u32 s56, s45, 0
    ds_read_b64_tr_b16 v[204:205], v238 offset:57344
    v_cvt_pk_bf16_f32 v199, v30, v31
    v_mfma_f32_16x16x32_bf16 a[8:11], v[216:219], v[160:163], a[8:11]
    s_add_u32 s57, s45, 4096
    ds_read_b64_tr_b16 v[206:207], v238 offset:61440
    v_mfma_f32_16x16x32_bf16 a[12:15], v[216:219], v[164:167], a[12:15]
    s_add_u32 s58, s45, 8192
    ds_read_b64_tr_b16 v[208:209], v239 offset:49152
    v_mfma_f32_16x16x32_bf16 a[12:15], v[220:223], v[196:199], a[12:15]
    s_add_u32 s59, s45, 12288
    ds_read_b64_tr_b16 v[210:211], v239 offset:53248
    v_mfma_f32_16x16x32_bf16 a[28:31], v[228:231], v[196:199], a[28:31]
    ds_read_b64_tr_b16 v[212:213], v239 offset:57344
    v_mfma_f32_16x16x32_bf16 a[28:31], v[224:227], v[164:167], a[28:31]
    ds_read_b64_tr_b16 v[214:215], v239 offset:61440
    v_mfma_f32_16x16x32_bf16 a[24:27], v[224:227], v[160:163], a[24:27]
    s_add_u32 m0, s73, 0x0
    s_add_u32 s41, s28, 0x48000
    buffer_load_dwordx4 v1, s[88:91], s41 offen sc1 lds
    v_mfma_f32_16x16x32_bf16 a[24:27], v[228:231], v[192:195], a[24:27]
    s_add_u32 m0, s73, 0x400
    s_add_u32 s41, s29, 0x48000
    buffer_load_dwordx4 v1, s[88:91], s41 offen sc1 lds
    v_mfma_f32_16x16x32_bf16 a[20:23], v[228:231], v[188:191], a[20:23]
    v_mfma_f32_16x16x32_bf16 a[20:23], v[224:227], v[156:159], a[20:23]
    s_add_u32 m0, s73, 0x800
    s_add_u32 s41, s30, 0x48000
    buffer_load_dwordx4 v1, s[88:91], s41 offen sc1 lds
    v_mfma_f32_16x16x32_bf16 a[16:19], v[224:227], v[152:155], a[16:19]
    s_add_u32 m0, s73, 0xc00
    s_add_u32 s41, s31, 0x48000
    buffer_load_dwordx4 v1, s[88:91], s41 offen sc1 lds
    v_mfma_f32_16x16x32_bf16 a[16:19], v[228:231], v[184:187], a[16:19]
    v_mfma_f32_16x16x32_bf16 a[128:131], v[244:247], v[184:187], a[128:131]
    s_add_u32 m0, s73, 0x1000
    s_add_u32 s41, s36, 0x48000
    buffer_load_dwordx4 v1, s[88:91], s41 offen sc1 lds
    v_mfma_f32_16x16x32_bf16 a[128:131], v[244:247], v[152:155], a[128:131]
    v_mfma_f32_16x16x32_bf16 a[132:135], v[244:247], v[188:191], a[132:135]
    s_add_u32 m0, s73, 0x1400
    s_add_u32 s41, s37, 0x48000
    buffer_load_dwordx4 v1, s[88:91], s41 offen sc1 lds
    v_mfma_f32_16x16x32_bf16 a[132:135], v[244:247], v[156:159], a[132:135]
    s_add_u32 m0, s73, 0x1800
    s_add_u32 s41, s38, 0x48000
    buffer_load_dwordx4 v1, s[88:91], s41 offen sc1 lds
    v_mfma_f32_16x16x32_bf16 a[136:139], v[244:247], v[192:195], a[136:139]
    v_mfma_f32_16x16x32_bf16 a[136:139], v[244:247], v[160:163], a[136:139]
    s_add_u32 m0, s73, 0x1c00
    s_add_u32 s41, s39, 0x48000
    buffer_load_dwordx4 v1, s[88:91], s41 offen sc1 lds
    v_accvgpr_read_b32 v104, a0
    v_accvgpr_read_b32 v105, a1
    v_mfma_f32_16x16x32_bf16 a[140:143], v[244:247], v[196:199], a[140:143]
    s_add_u32 m0, s73, 0x2000
    s_add_u32 s41, s40, 0x48000
    buffer_load_dwordx4 v1, s[88:91], s41 offen sc1 lds
    v_accvgpr_read_b32 v106, a2
    v_accvgpr_read_b32 v107, a3
    v_mfma_f32_16x16x32_bf16 a[140:143], v[244:247], v[164:167], a[140:143]
    s_waitcnt lgkmcnt(0)
    v_accvgpr_read_b32 v108, a16
    v_accvgpr_read_b32 v109, a17
    v_accvgpr_read_b32 v110, a18
    v_accvgpr_read_b32 v111, a19
    v_mfma_f32_16x16x32_bf16 a[36:39], v[204:207], v[188:191], a[36:39]
    ds_read_b64_tr_b16 v[216:217], v240 offset:49152
    v_accvgpr_read_b32 v252, a128
    v_accvgpr_read_b32 v112, a4
    v_accvgpr_read_b32 v113, a5
    v_mfma_f32_16x16x32_bf16 a[36:39], v[200:203], v[156:159], a[36:39]
    ds_read_b64_tr_b16 v[218:219], v240 offset:53248
    v_accvgpr_read_b32 v114, a6
    v_accvgpr_read_b32 v115, a7
    v_accvgpr_read_b32 v116, a20
    v_mfma_f32_16x16x32_bf16 a[40:43], v[200:203], v[160:163], a[40:43]
    ds_read_b64_tr_b16 v[220:221], v240 offset:57344
    v_accvgpr_read_b32 v253, a132
    v_accvgpr_read_b32 v117, a21
    v_accvgpr_read_b32 v118, a22
    v_mfma_f32_16x16x32_bf16 a[40:43], v[204:207], v[192:195], a[40:43]
    ds_read_b64_tr_b16 v[222:223], v240 offset:61440
    v_accvgpr_read_b32 v119, a23
    v_accvgpr_read_b32 v120, a8
    v_accvgpr_read_b32 v121, a9
    v_mfma_f32_16x16x32_bf16 a[44:47], v[204:207], v[196:199], a[44:47]
    ds_read_b64_tr_b16 v[224:225], v241 offset:49152
    v_accvgpr_read_b32 v254, a136
    v_accvgpr_read_b32 v122, a10
    v_accvgpr_read_b32 v123, a11
    v_mfma_f32_16x16x32_bf16 a[44:47], v[200:203], v[164:167], a[44:47]
    ds_read_b64_tr_b16 v[226:227], v241 offset:53248
    v_accvgpr_read_b32 v124, a24
    v_accvgpr_read_b32 v125, a25
    v_accvgpr_read_b32 v126, a26
    v_mfma_f32_16x16x32_bf16 a[32:35], v[200:203], v[152:155], a[32:35]
    ds_read_b64_tr_b16 v[228:229], v241 offset:57344
    v_accvgpr_read_b32 v255, a140
    v_accvgpr_read_b32 v127, a27
    v_accvgpr_read_b32 v128, a12
    v_mfma_f32_16x16x32_bf16 a[32:35], v[204:207], v[184:187], a[32:35]
    ds_read_b64_tr_b16 v[230:231], v241 offset:61440
    v_accvgpr_read_b32 v129, a13
    v_accvgpr_read_b32 v130, a14
    v_accvgpr_read_b32 v131, a15
    v_mfma_f32_16x16x32_bf16 a[48:51], v[212:215], v[184:187], a[48:51]
    v_rcp_f32 v248, v252
    v_accvgpr_read_b32 v132, a28
    v_accvgpr_read_b32 v133, a29
    v_mfma_f32_16x16x32_bf16 a[48:51], v[208:211], v[152:155], a[48:51]
    v_rcp_f32 v249, v253
    v_accvgpr_read_b32 v134, a30
    v_accvgpr_read_b32 v135, a31
    v_mfma_f32_16x16x32_bf16 a[60:63], v[208:211], v[164:167], a[60:63]
    v_rcp_f32 v250, v254
    v_mfma_f32_16x16x32_bf16 a[60:63], v[212:215], v[196:199], a[60:63]
    v_rcp_f32 v251, v255
    v_mfma_f32_16x16x32_bf16 a[56:59], v[212:215], v[192:195], a[56:59]
    s_lshl_b32 s55, s32, 2
    v_add_f32 v33, v252, v253
    v_add_f32 v34, v254, v255
    v_mfma_f32_16x16x32_bf16 a[56:59], v[208:211], v[160:163], a[56:59]
    s_add_u32 s55, s55, 163776
    v_add_f32 v33, v33, v34
    v_mov_b32 v32, 163776
    v_accvgpr_read_b32 v252, a252
    v_accvgpr_read_b32 v253, a253
    v_mfma_f32_16x16x32_bf16 a[52:55], v[208:211], v[156:159], a[52:55]
    v_add_f32 v34, v248, v249
    v_add_f32 v35, v250, v251
    v_accvgpr_read_b32 v254, a254
    v_accvgpr_read_b32 v255, a255
    v_mfma_f32_16x16x32_bf16 a[52:55], v[212:215], v[188:191], a[52:55]
    s_waitcnt lgkmcnt(0)
    v_add_f32 v33, v33, v34
    v_mov_b32 v34, s55
    v_mul_f32 v252, v252, v248
    v_mul_f32 v253, v253, v249
    v_mfma_f32_16x16x32_bf16 a[72:75], v[220:223], v[192:195], a[72:75]
    ds_read_b64_tr_b16 v[200:201], v242 offset:49152
    v_add_f32 v33, v33, v35
    v_mul_f32 v254, v254, v250
    v_mul_f32 v255, v255, v251
    v_mfma_f32_16x16x32_bf16 a[72:75], v[216:219], v[160:163], a[72:75]
    ds_read_b64_tr_b16 v[202:203], v242 offset:53248
    v_cmp_nge_f32 vcc, 0x53800000, v33
    v_fma_f32 v104, v104, v248, -v252
    v_fma_f32 v105, v105, v248, -v252
    v_mfma_f32_16x16x32_bf16 a[76:79], v[216:219], v[164:167], a[76:79]
    ds_read_b64_tr_b16 v[204:205], v242 offset:57344
    v_fma_f32 v106, v106, v248, -v252
    v_fma_f32 v107, v107, v248, -v252
    v_fma_f32 v108, v108, v248, -v252
    v_mfma_f32_16x16x32_bf16 a[76:79], v[220:223], v[196:199], a[76:79]
    s_or_b32 s54, vcc_lo, vcc_hi
    ds_read_b64_tr_b16 v[206:207], v242 offset:61440
    v_fma_f32 v109, v109, v248, -v252
    v_fma_f32 v110, v110, v248, -v252
    v_fma_f32 v111, v111, v248, -v252
    v_mfma_f32_16x16x32_bf16 a[64:67], v[220:223], v[184:187], a[64:67]
    ds_read_b64_tr_b16 v[208:209], v243 offset:49152
    v_mov_b32 v33, s54
    v_cvt_pk_bf16_f32 v104, v104, v105
    v_cvt_pk_bf16_f32 v105, v106, v107
    v_mfma_f32_16x16x32_bf16 a[64:67], v[216:219], v[152:155], a[64:67]
    ds_read_b64_tr_b16 v[210:211], v243 offset:53248
    v_cvt_pk_bf16_f32 v106, v108, v109
    v_cvt_pk_bf16_f32 v107, v110, v111
    v_fma_f32 v112, v112, v249, -v253
    v_mfma_f32_16x16x32_bf16 a[68:71], v[216:219], v[156:159], a[68:71]
    ds_read_b64_tr_b16 v[212:213], v243 offset:57344
    v_fma_f32 v113, v113, v249, -v253
    v_fma_f32 v114, v114, v249, -v253
    v_fma_f32 v115, v115, v249, -v253
    v_mfma_f32_16x16x32_bf16 a[68:71], v[220:223], v[188:191], a[68:71]
    ds_read_b64_tr_b16 v[214:215], v243 offset:61440
    v_fma_f32 v116, v116, v249, -v253
    v_fma_f32 v117, v117, v249, -v253
    v_fma_f32 v118, v118, v249, -v253
    v_mfma_f32_16x16x32_bf16 a[84:87], v[228:231], v[188:191], a[84:87]
    ds_write_b32 v34, v33
    v_fma_f32 v119, v119, v249, -v253
    v_cvt_pk_bf16_f32 v112, v112, v113
    v_cvt_pk_bf16_f32 v113, v114, v115
    v_mfma_f32_16x16x32_bf16 a[84:87], v[224:227], v[156:159], a[84:87]
    buffer_store_dwordx4 v[104:107], v1, s[4:7], s56 offen offset:0 sc1
    v_cvt_pk_bf16_f32 v114, v116, v117
    v_cvt_pk_bf16_f32 v115, v118, v119
    v_mfma_f32_16x16x32_bf16 a[80:83], v[224:227], v[152:155], a[80:83]
    s_add_u32 s41, s43, 0x40a000
    buffer_load_dwordx4 a[224:227], v1, s[4:7], s41 offen offset:0 sc1
    v_fma_f32 v120, v120, v250, -v254
    v_fma_f32 v121, v121, v250, -v254
    v_mfma_f32_16x16x32_bf16 a[80:83], v[228:231], v[184:187], a[80:83]
    buffer_store_dwordx4 v[112:115], v1, s[4:7], s56 offen offset:1024 sc1
    v_fma_f32 v122, v122, v250, -v254
    v_fma_f32 v123, v123, v250, -v254
    v_mfma_f32_16x16x32_bf16 a[92:95], v[228:231], v[196:199], a[92:95]
    s_add_u32 s41, s43, 0x40a000
    buffer_load_dwordx4 a[228:231], v1, s[4:7], s41 offen offset:1024 sc1
    v_fma_f32 v124, v124, v250, -v254
    v_fma_f32 v125, v125, v250, -v254
    v_mfma_f32_16x16x32_bf16 a[92:95], v[224:227], v[164:167], a[92:95]
    s_add_u32 s41, s43, 0x40b000
    buffer_load_dwordx4 a[232:235], v1, s[4:7], s41 offen offset:0 sc1
    v_fma_f32 v126, v126, v250, -v254
    v_fma_f32 v127, v127, v250, -v254
    v_mfma_f32_16x16x32_bf16 a[88:91], v[224:227], v[160:163], a[88:91]
    v_cvt_pk_bf16_f32 v120, v120, v121
    v_cvt_pk_bf16_f32 v121, v122, v123
    v_cvt_pk_bf16_f32 v122, v124, v125
    v_cvt_pk_bf16_f32 v123, v126, v127
    v_mfma_f32_16x16x32_bf16 a[88:91], v[228:231], v[192:195], a[88:91]
    s_waitcnt vmcnt(26) lgkmcnt(0)
    s_barrier
    v_fma_f32 v128, v128, v251, -v255
    v_fma_f32 v129, v129, v251, -v255
    v_fma_f32 v130, v130, v251, -v255
    v_fma_f32 v131, v131, v251, -v255
    v_mfma_f32_16x16x32_bf16 a[108:111], v[204:207], v[196:199], a[108:111]
    ds_read_b128 v[36:39], v32
    v_fma_f32 v132, v132, v251, -v255
    v_fma_f32 v133, v133, v251, -v255
    v_fma_f32 v134, v134, v251, -v255
    v_mfma_f32_16x16x32_bf16 a[108:111], v[200:203], v[164:167], a[108:111]
    ds_read_b128 v[216:219], v1 offset:55296
    v_fma_f32 v135, v135, v251, -v255
    v_cvt_pk_bf16_f32 v128, v128, v129
    v_cvt_pk_bf16_f32 v129, v130, v131
    v_mfma_f32_16x16x32_bf16 a[96:99], v[200:203], v[152:155], a[96:99]
    ds_read_b128 v[220:223], v1 offset:64512
    v_cvt_pk_bf16_f32 v130, v132, v133
    v_cvt_pk_bf16_f32 v131, v134, v135
    v_accvgpr_read_b32 v104, a32
    v_mfma_f32_16x16x32_bf16 a[96:99], v[204:207], v[184:187], a[96:99]
    ds_read_b128 v[224:227], v2 offset:8192
    v_accvgpr_read_b32 v105, a33
    v_accvgpr_read_b32 v106, a34
    v_accvgpr_read_b32 v107, a35
    v_mfma_f32_16x16x32_bf16 a[100:103], v[204:207], v[188:191], a[100:103]
    s_waitcnt lgkmcnt(3)
    ds_read_b128 v[228:231], v2 offset:17408
    v_or3_b32 v36, v36, v37, v38
    v_accvgpr_read_b32 v108, a48
    v_accvgpr_read_b32 v109, a49
    v_mfma_f32_16x16x32_bf16 a[100:103], v[200:203], v[156:159], a[100:103]
    v_or_b32 v36, v36, v39
    v_accvgpr_read_b32 v110, a50
    v_accvgpr_read_b32 v111, a51
    v_fma_f32 v104, v104, v248, -v252
    v_mfma_f32_16x16x32_bf16 a[104:107], v[200:203], v[160:163], a[104:107]
    v_readfirstlane_b32 s54, v36
    v_fma_f32 v105, v105, v248, -v252
    v_fma_f32 v106, v106, v248, -v252
    v_fma_f32 v107, v107, v248, -v252
    v_mfma_f32_16x16x32_bf16 a[104:107], v[204:207], v[192:195], a[104:107]
    s_andn2_b32 s54, s54, s51
    s_cbranch_scc1 L_k2_redo
    v_fma_f32 v108, v108, v248, -v252
    v_fma_f32 v109, v109, v248, -v252
    v_fma_f32 v110, v110, v248, -v252
    v_fma_f32 v111, v111, v248, -v252
    v_mfma_f32_16x16x32_bf16 a[120:123], v[212:215], v[192:195], a[120:123]
L_hop0_16:
    s_cbranch_execz L_hop0_ret
    ds_read_b128 v[168:171], v1 offset:56320
    v_cvt_pk_bf16_f32 v104, v104, v105
    v_cvt_pk_bf16_f32 v105, v106, v107
    v_cvt_pk_bf16_f32 v106, v108, v109
    v_mfma_f32_16x16x32_bf16 a[120:123], v[208:211], v[160:163], a[120:123]
    ds_read_b128 v[172:175], v2 offset:0
    v_cvt_pk_bf16_f32 v107, v110, v111
    v_accvgpr_read_b32 v112, a36
    v_accvgpr_read_b32 v113, a37
    v_mfma_f32_16x16x32_bf16 a[116:119], v[208:211], v[156:159], a[116:119]
    ds_read_b128 v[176:179], v2 offset:9216
    v_accvgpr_read_b32 v114, a38
    v_accvgpr_read_b32 v115, a39
    v_accvgpr_read_b32 v116, a52
    v_mfma_f32_16x16x32_bf16 a[116:119], v[212:215], v[188:191], a[116:119]
    ds_read_b128 v[180:183], v2 offset:18432
    v_accvgpr_read_b32 v117, a53
    v_accvgpr_read_b32 v118, a54
    v_accvgpr_read_b32 v119, a55
    v_mfma_f32_16x16x32_bf16 a[112:115], v[212:215], v[184:187], a[112:115]
    s_add_u32 s41, s43, 0x40b000
    buffer_load_dwordx4 a[236:239], v1, s[4:7], s41 offen offset:1024 sc1
    v_fma_f32 v112, v112, v249, -v253
    v_fma_f32 v113, v113, v249, -v253
    v_mfma_f32_16x16x32_bf16 a[112:115], v[208:211], v[152:155], a[112:115]
    buffer_store_dwordx4 v[120:123], v1, s[4:7], s56 offen offset:2048 sc1
    v_fma_f32 v114, v114, v249, -v253
    v_fma_f32 v115, v115, v249, -v253
    v_mfma_f32_16x16x32_bf16 a[124:127], v[208:211], v[164:167], a[124:127]
    buffer_store_dwordx4 v[128:131], v1, s[4:7], s56 offen offset:3072 sc1
    v_fma_f32 v116, v116, v249, -v253
    v_fma_f32 v117, v117, v249, -v253
    v_mfma_f32_16x16x32_bf16 a[124:127], v[212:215], v[196:199], a[124:127]
    s_waitcnt vmcnt(48) lgkmcnt(4)
    v_fma_f32 v118, v118, v249, -v253
    v_fma_f32 v119, v119, v249, -v253
    v_cvt_pk_bf16_f32 v112, v112, v113
    v_cvt_pk_bf16_f32 v113, v114, v115
    v_mfma_f32_16x16x32_bf16 v[16:19], v[216:219], a[144:147], 0
    s_add_u32 s41, s28, s84
    ds_read_b128 v[200:203], v1 offset:57344
    v_cvt_pk_bf16_f32 v114, v116, v117
    v_cvt_pk_bf16_f32 v115, v118, v119
    v_accvgpr_read_b32 v120, a40
    v_mfma_f32_16x16x32_bf16 v[16:19], v[220:223], a[152:155], v[16:19]
    s_add_u32 m0, s74, 0x0
    ds_read_b128 v[204:207], v2 offset:1024
    v_accvgpr_read_b32 v121, a41
    v_accvgpr_read_b32 v122, a42
    v_accvgpr_read_b32 v123, a43
    v_mfma_f32_16x16x32_bf16 v[16:19], v[224:227], a[160:163], v[16:19]
    s_add_u32 s46, s29, s84
    ds_read_b128 v[208:211], v2 offset:10240
    v_accvgpr_read_b32 v124, a56
    v_accvgpr_read_b32 v125, a57
    v_accvgpr_read_b32 v126, a58
    v_mfma_f32_16x16x32_bf16 v[16:19], v[228:231], a[168:171], v[16:19]
    s_mul_i32 s72, s32, 9216
    ds_read_b128 v[212:215], v2 offset:19456
    v_accvgpr_read_b32 v127, a59
    v_fma_f32 v120, v120, v250, -v254
    v_fma_f32 v121, v121, v250, -v254
    v_mfma_f32_16x16x32_bf16 v[20:23], v[228:231], a[172:175], 0
    buffer_load_dwordx4 v1, s[88:91], s41 offen sc1 lds
    v_fma_f32 v122, v122, v250, -v254
    v_fma_f32 v123, v123, v250, -v254
    v_mfma_f32_16x16x32_bf16 v[20:23], v[224:227], a[164:167], v[20:23]
    s_add_u32 m0, s74, 0x400
    v_fma_f32 v124, v124, v250, -v254
    v_fma_f32 v125, v125, v250, -v254
    v_fma_f32 v126, v126, v250, -v254
    v_fma_f32 v127, v127, v250, -v254
    v_mfma_f32_16x16x32_bf16 v[20:23], v[220:223], a[156:159], v[20:23]
    buffer_load_dwordx4 v1, s[88:91], s46 offen sc1 lds
    v_cvt_pk_bf16_f32 v120, v120, v121
    v_cvt_pk_bf16_f32 v121, v122, v123
    v_mfma_f32_16x16x32_bf16 v[20:23], v[216:219], a[148:151], v[20:23]
    s_waitcnt lgkmcnt(4)
    v_cvt_pk_bf16_f32 v122, v124, v125
    v_cvt_pk_bf16_f32 v123, v126, v127
    v_accvgpr_read_b32 v128, a44
    v_accvgpr_read_b32 v129, a45
    v_mfma_f32_16x16x32_bf16 v[28:31], v[168:171], a[148:151], 0
    s_add_u32 s41, s30, s84
    ds_read_b128 v[216:219], v1 offset:58368
    v_accvgpr_read_b32 v130, a46
    v_accvgpr_read_b32 v131, a47
    v_accvgpr_read_b32 v132, a60
    v_mfma_f32_16x16x32_bf16 v[28:31], v[172:175], a[156:159], v[28:31]
    s_add_u32 m0, s74, 0x800
    ds_read_b128 v[220:223], v2 offset:2048
    v_accvgpr_read_b32 v133, a61
    v_accvgpr_read_b32 v134, a62
    v_accvgpr_read_b32 v135, a63
    v_mfma_f32_16x16x32_bf16 v[28:31], v[176:179], a[164:167], v[28:31]
    s_add_u32 s73, s72, 126912
    ds_read_b128 v[224:227], v2 offset:11264
    v_fma_f32 v128, v128, v251, -v255
    v_fma_f32 v129, v129, v251, -v255
    v_fma_f32 v130, v130, v251, -v255
    v_mfma_f32_16x16x32_bf16 v[28:31], v[180:183], a[172:175], v[28:31]
    s_bfe_u32 s54, s2, 0x20001
    ds_read_b128 v[228:231], v2 offset:20480
    v_fma_f32 v131, v131, v251, -v255
    v_fma_f32 v132, v132, v251, -v255
    v_fma_f32 v133, v133, v251, -v255
    v_mfma_f32_16x16x32_bf16 v[24:27], v[180:183], a[168:171], 0
    buffer_load_dwordx4 v1, s[88:91], s41 offen sc1 lds
    v_fma_f32 v134, v134, v251, -v255
    v_fma_f32 v135, v135, v251, -v255
    v_mfma_f32_16x16x32_bf16 v[24:27], v[176:179], a[160:163], v[24:27]
    buffer_store_dwordx4 v[104:107], v1, s[4:7], s57 offen offset:0 sc1
    v_cvt_pk_bf16_f32 v128, v128, v129
    v_cvt_pk_bf16_f32 v129, v130, v131
    v_mfma_f32_16x16x32_bf16 v[24:27], v[172:175], a[152:155], v[24:27]
    buffer_store_dwordx4 v[112:115], v1, s[4:7], s57 offen offset:1024 sc1
    v_cvt_pk_bf16_f32 v130, v132, v133
    v_cvt_pk_bf16_f32 v131, v134, v135
    v_mfma_f32_16x16x32_bf16 v[24:27], v[168:171], a[144:147], v[24:27]
    s_waitcnt lgkmcnt(4)
    v_accvgpr_read_b32 v104, a64
    v_accvgpr_read_b32 v105, a65
    v_accvgpr_read_b32 v106, a66
    v_accvgpr_read_b32 v107, a67
    v_mfma_f32_16x16x32_bf16 v[32:35], v[200:203], a[144:147], 0
    s_add_u32 s41, s31, s84
    ds_read_b128 v[168:171], v1 offset:59392
    v_accvgpr_read_b32 v108, a80
    v_accvgpr_read_b32 v109, a81
    v_accvgpr_read_b32 v110, a82
    v_mfma_f32_16x16x32_bf16 v[32:35], v[204:207], a[152:155], v[32:35]
    s_add_u32 m0, s74, 0xc00
    ds_read_b128 v[172:175], v2 offset:3072
    v_accvgpr_read_b32 v111, a83
    v_fma_f32 v104, v104, v248, -v252
    v_fma_f32 v105, v105, v248, -v252
    v_mfma_f32_16x16x32_bf16 v[32:35], v[208:211], a[160:163], v[32:35]
    s_add_u32 s46, s36, s84
    ds_read_b128 v[176:179], v2 offset:12288
    v_fma_f32 v106, v106, v248, -v252
    v_fma_f32 v107, v107, v248, -v252
    v_fma_f32 v108, v108, v248, -v252
    v_mfma_f32_16x16x32_bf16 v[32:35], v[212:215], a[168:171], v[32:35]
    s_lshl_b32 s55, s54, 3
    ds_read_b128 v[180:183], v2 offset:21504
    v_fma_f32 v109, v109, v248, -v252
    v_fma_f32 v110, v110, v248, -v252
    v_fma_f32 v111, v111, v248, -v252
    v_mfma_f32_16x16x32_bf16 v[36:39], v[212:215], a[172:175], 0
    buffer_load_dwordx4 v1, s[88:91], s41 offen sc1 lds
    v_cvt_pk_bf16_f32 v104, v104, v105
    v_cvt_pk_bf16_f32 v105, v106, v107
    v_mfma_f32_16x16x32_bf16 v[36:39], v[208:211], a[164:167], v[36:39]
    s_add_u32 m0, s74, 0x1000
    v_cvt_pk_bf16_f32 v106, v108, v109
    v_cvt_pk_bf16_f32 v107, v110, v111
    v_accvgpr_read_b32 v112, a68
    v_accvgpr_read_b32 v113, a69
    v_mfma_f32_16x16x32_bf16 v[36:39], v[204:207], a[156:159], v[36:39]
    buffer_load_dwordx4 v1, s[88:91], s46 offen sc1 lds
    v_accvgpr_read_b32 v114, a70
    v_accvgpr_read_b32 v115, a71
    v_mfma_f32_16x16x32_bf16 v[36:39], v[200:203], a[148:151], v[36:39]
    s_waitcnt lgkmcnt(4)
    v_accvgpr_read_b32 v116, a84
    v_accvgpr_read_b32 v117, a85
    v_accvgpr_read_b32 v118, a86
    v_accvgpr_read_b32 v119, a87
    v_mfma_f32_16x16x32_bf16 v[44:47], v[216:219], a[148:151], 0
    s_lshl_b32 s47, s53, 8
    ds_read_b128 v[200:203], v1 offset:60416
    v_fma_f32 v112, v112, v249, -v253
    v_fma_f32 v113, v113, v249, -v253
    v_fma_f32 v114, v114, v249, -v253
    v_mfma_f32_16x16x32_bf16 v[44:47], v[220:223], a[156:159], v[44:47]
    s_lshr_b32 s47, s47, s55
    ds_read_b128 v[204:207], v2 offset:4096
    v_fma_f32 v115, v115, v249, -v253
    v_fma_f32 v116, v116, v249, -v253
    v_fma_f32 v117, v117, v249, -v253
    v_mfma_f32_16x16x32_bf16 v[44:47], v[224:227], a[164:167], v[44:47]
    s_add_u32 s46, s37, s84
    ds_read_b128 v[208:211], v2 offset:13312
    v_fma_f32 v118, v118, v249, -v253
    v_fma_f32 v119, v119, v249, -v253
    v_cvt_pk_bf16_f32 v112, v112, v113
    v_mfma_f32_16x16x32_bf16 v[44:47], v[228:231], a[172:175], v[44:47]
    s_and_b32 s47, s47, 31
    ds_read_b128 v[212:215], v2 offset:22528
    v_cvt_pk_bf16_f32 v113, v114, v115
    v_cvt_pk_bf16_f32 v114, v116, v117
    v_cvt_pk_bf16_f32 v115, v118, v119
    v_mfma_f32_16x16x32_bf16 v[40:43], v[228:231], a[168:171], 0
    buffer_store_dwordx4 v[120:123], v1, s[4:7], s57 offen offset:2048 sc1
    v_accvgpr_read_b32 v124, a88
    v_accvgpr_read_b32 v125, a89
    v_mfma_f32_16x16x32_bf16 v[40:43], v[224:227], a[160:163], v[40:43]
    s_add_u32 m0, s74, 0x1400
    v_accvgpr_read_b32 v126, a90
    v_accvgpr_read_b32 v127, a91
    v_fma_f32 v124, v124, v250, -v254
    v_fma_f32 v125, v125, v250, -v254
    v_mfma_f32_16x16x32_bf16 v[40:43], v[220:223], a[152:155], v[40:43]
    buffer_load_dwordx4 v1, s[88:91], s46 offen sc1 lds
    v_accvgpr_read_b32 v120, a72
    v_accvgpr_read_b32 v121, a73
    v_mfma_f32_16x16x32_bf16 v[40:43], v[216:219], a[144:147], v[40:43]
    s_waitcnt lgkmcnt(4)
    v_accvgpr_read_b32 v122, a74
    v_accvgpr_read_b32 v123, a75
    v_fma_f32 v120, v120, v250, -v254
    v_fma_f32 v121, v121, v250, -v254
    v_mfma_f32_16x16x32_bf16 v[48:51], v[168:171], a[144:147], 0
    s_add_u32 s41, s38, s84
    ds_read_b128 v[216:219], v1 offset:61440
    v_fma_f32 v122, v122, v250, -v254
    v_fma_f32 v123, v123, v250, -v254
    v_fma_f32 v126, v126, v250, -v254
    v_mfma_f32_16x16x32_bf16 v[48:51], v[172:175], a[152:155], v[48:51]
    s_add_u32 m0, s74, 0x1800
    ds_read_b128 v[220:223], v2 offset:5120
    v_fma_f32 v127, v127, v250, -v254
    v_cvt_pk_bf16_f32 v120, v120, v121
    v_cvt_pk_bf16_f32 v121, v122, v123
    v_mfma_f32_16x16x32_bf16 v[48:51], v[176:179], a[160:163], v[48:51]
    s_lshr_b32 s53, s53, s55
    ds_read_b128 v[224:227], v2 offset:14336
    v_cvt_pk_bf16_f32 v122, v124, v125
    v_cvt_pk_bf16_f32 v123, v126, v127
    v_accvgpr_read_b32 v132, a92
    v_mfma_f32_16x16x32_bf16 v[48:51], v[180:183], a[168:171], v[48:51]
    s_and_b32 s53, s53, 31
    ds_read_b128 v[228:231], v2 offset:23552
    v_accvgpr_read_b32 v133, a93
    v_accvgpr_read_b32 v134, a94
    v_accvgpr_read_b32 v135, a95
    v_mfma_f32_16x16x32_bf16 v[52:55], v[180:183], a[172:175], 0
    buffer_load_dwordx4 v1, s[88:91], s41 offen sc1 lds
    v_fma_f32 v132, v132, v251, -v255
    v_fma_f32 v133, v133, v251, -v255
    v_mfma_f32_16x16x32_bf16 v[52:55], v[176:179], a[164:167], v[52:55]
    buffer_store_dwordx4 v[128:131], v1, s[4:7], s57 offen offset:3072 sc1
    v_fma_f32 v134, v134, v251, -v255
    v_fma_f32 v135, v135, v251, -v255
    v_mfma_f32_16x16x32_bf16 v[52:55], v[172:175], a[156:159], v[52:55]
    buffer_store_dwordx4 v[104:107], v1, s[4:7], s58 offen offset:0 sc1
    v_accvgpr_read_b32 v108, a112
    v_accvgpr_read_b32 v109, a113
    v_mfma_f32_16x16x32_bf16 v[52:55], v[168:171], a[148:151], v[52:55]
    s_waitcnt lgkmcnt(4)
    v_accvgpr_read_b32 v128, a76
    v_accvgpr_read_b32 v129, a77
    v_accvgpr_read_b32 v130, a78
    v_accvgpr_read_b32 v131, a79
    v_mfma_f32_16x16x32_bf16 v[60:63], v[200:203], a[148:151], 0
    s_add_u32 s41, s39, s84
    ds_read_b128 v[168:171], v1 offset:62464
    v_fma_f32 v128, v128, v251, -v255
    v_fma_f32 v129, v129, v251, -v255
    v_fma_f32 v130, v130, v251, -v255
    v_mfma_f32_16x16x32_bf16 v[60:63], v[204:207], a[156:159], v[60:63]
    s_add_u32 m0, s74, 0x1c00
    ds_read_b128 v[172:175], v2 offset:6144
    v_fma_f32 v131, v131, v251, -v255
    v_cvt_pk_bf16_f32 v128, v128, v129
    v_accvgpr_read_b32 v104, a96
    v_mfma_f32_16x16x32_bf16 v[60:63], v[208:211], a[164:167], v[60:63]
    s_add_u32 s46, s40, s84
    ds_read_b128 v[176:179], v2 offset:15360
    v_cvt_pk_bf16_f32 v129, v130, v131
    v_cvt_pk_bf16_f32 v130, v132, v133
    v_cvt_pk_bf16_f32 v131, v134, v135
    v_mfma_f32_16x16x32_bf16 v[60:63], v[212:215], a[172:175], v[60:63]
    s_sub_u32 s53, s53, s47
    ds_read_b128 v[180:183], v2 offset:24576
    v_accvgpr_read_b32 v105, a97
    v_accvgpr_read_b32 v106, a98
    v_accvgpr_read_b32 v107, a99
    v_mfma_f32_16x16x32_bf16 v[56:59], v[212:215], a[168:171], 0
    buffer_load_dwordx4 v1, s[88:91], s41 offen sc1 lds
    v_accvgpr_read_b32 v110, a114
    v_accvgpr_read_b32 v111, a115
    v_mfma_f32_16x16x32_bf16 v[56:59], v[208:211], a[160:163], v[56:59]
    s_add_u32 m0, s74, 0x2000
    v_fma_f32 v104, v104, v248, -v252
    v_fma_f32 v105, v105, v248, -v252
    v_fma_f32 v106, v106, v248, -v252
    v_fma_f32 v107, v107, v248, -v252
    v_mfma_f32_16x16x32_bf16 v[56:59], v[204:207], a[152:155], v[56:59]
    buffer_load_dwordx4 v1, s[88:91], s46 offen sc1 lds
    v_fma_f32 v108, v108, v248, -v252
    v_fma_f32 v109, v109, v248, -v252
    v_mfma_f32_16x16x32_bf16 v[56:59], v[200:203], a[144:147], v[56:59]
    s_waitcnt lgkmcnt(4)
    v_fma_f32 v110, v110, v248, -v252
    v_fma_f32 v111, v111, v248, -v252
    v_cvt_pk_bf16_f32 v104, v104, v105
    v_cvt_pk_bf16_f32 v105, v106, v107
    v_mfma_f32_16x16x32_bf16 v[64:67], v[216:219], a[144:147], 0
    s_add_u32 s41, s82, 0x1400000
    ds_read_b128 v[200:203], v1 offset:63488
    v_cvt_pk_bf16_f32 v106, v108, v109
    v_cvt_pk_bf16_f32 v107, v110, v111
    v_accvgpr_read_b32 v116, a116
    v_mfma_f32_16x16x32_bf16 v[64:67], v[220:223], a[152:155], v[64:67]
    s_mul_i32 s55, s47, 52
    ds_read_b128 v[204:207], v2 offset:7168
    v_accvgpr_read_b32 v117, a117
    v_accvgpr_read_b32 v118, a118
    v_accvgpr_read_b32 v119, a119
    v_mfma_f32_16x16x32_bf16 v[64:67], v[224:227], a[160:163], v[64:67]
    s_lshr_b32 s55, s55, 8
    ds_read_b128 v[208:211], v2 offset:16384
    v_fma_f32 v116, v116, v249, -v253
    v_fma_f32 v117, v117, v249, -v253
    v_fma_f32 v118, v118, v249, -v253
    v_mfma_f32_16x16x32_bf16 v[64:67], v[228:231], a[168:171], v[64:67]
    s_mul_i32 s55, s55, 3
    ds_read_b128 v[212:215], v2 offset:25600
    v_fma_f32 v119, v119, v249, -v253
    v_accvgpr_read_b32 v124, a120
    v_accvgpr_read_b32 v125, a121
    v_mfma_f32_16x16x32_bf16 v[68:71], v[228:231], a[172:175], 0
    buffer_load_dwordx2 a[0:1], v4, s[4:7], s41 offen offset:0 sc1
    v_accvgpr_read_b32 v126, a122
    v_accvgpr_read_b32 v127, a123
    v_mfma_f32_16x16x32_bf16 v[68:71], v[224:227], a[164:167], v[68:71]
    buffer_store_dwordx4 v[112:115], v1, s[4:7], s58 offen offset:1024 sc1
    v_fma_f32 v124, v124, v250, -v254
    v_fma_f32 v125, v125, v250, -v254
    v_mfma_f32_16x16x32_bf16 v[68:71], v[220:223], a[156:159], v[68:71]
    buffer_store_dwordx4 v[120:123], v1, s[4:7], s58 offen offset:2048 sc1
    v_fma_f32 v126, v126, v250, -v254
    v_fma_f32 v127, v127, v250, -v254
    v_mfma_f32_16x16x32_bf16 v[68:71], v[216:219], a[148:151], v[68:71]
    s_waitcnt vmcnt(37) lgkmcnt(4)
    s_barrier
    v_accvgpr_read_b32 v112, a100
    v_accvgpr_read_b32 v113, a101
    v_accvgpr_read_b32 v114, a102
    v_accvgpr_read_b32 v115, a103
    v_mfma_f32_16x16x32_bf16 v[76:79], v[168:171], a[148:151], 0
    s_add_u32 s41, s82, 0x1400000
    ds_read_b128 v[216:219], v1 offset:0
    v_fma_f32 v112, v112, v249, -v253
    v_fma_f32 v113, v113, v249, -v253
    v_fma_f32 v114, v114, v249, -v253
    v_mfma_f32_16x16x32_bf16 v[76:79], v[172:175], a[156:159], v[76:79]
    s_add_u32 s47, s47, s55
    ds_read_b128 v[220:223], v1 offset:9216
    v_fma_f32 v115, v115, v249, -v253
    v_cvt_pk_bf16_f32 v112, v112, v113
    v_accvgpr_read_b32 v120, a104
    v_mfma_f32_16x16x32_bf16 v[76:79], v[176:179], a[164:167], v[76:79]
    s_add_u32 s46, s82, 0x1400000
    ds_read_b128 v[224:227], v1 offset:18432
    v_cvt_pk_bf16_f32 v113, v114, v115
    v_cvt_pk_bf16_f32 v114, v116, v117
    v_cvt_pk_bf16_f32 v115, v118, v119
    v_mfma_f32_16x16x32_bf16 v[76:79], v[180:183], a[172:175], v[76:79]
    s_add_u32 s47, s47, 3
    ds_read_b128 v[228:231], v3 offset:5056
    v_accvgpr_read_b32 v121, a105
    v_accvgpr_read_b32 v122, a106
    v_accvgpr_read_b32 v123, a107
    v_mfma_f32_16x16x32_bf16 v[72:75], v[180:183], a[168:171], 0
    buffer_load_dwordx2 a[4:5], v4, s[4:7], s41 offen offset:512 sc1
    v_fma_f32 v120, v120, v250, -v254
    v_fma_f32 v121, v121, v250, -v254
    v_mfma_f32_16x16x32_bf16 v[72:75], v[176:179], a[160:163], v[72:75]
    buffer_store_dwordx4 v[128:131], v1, s[4:7], s58 offen offset:3072 sc1
    v_fma_f32 v122, v122, v250, -v254
    v_fma_f32 v123, v123, v250, -v254
    v_mfma_f32_16x16x32_bf16 v[72:75], v[172:175], a[152:155], v[72:75]
    buffer_load_dwordx2 a[2:3], v4, s[4:7], s46 offen offset:2048 sc1
    v_cvt_pk_bf16_f32 v120, v120, v121
    v_cvt_pk_bf16_f32 v121, v122, v123
    v_mfma_f32_16x16x32_bf16 v[72:75], v[168:171], a[144:147], v[72:75]
    s_waitcnt lgkmcnt(4)
    v_cvt_pk_bf16_f32 v122, v124, v125
    v_cvt_pk_bf16_f32 v123, v126, v127
    v_accvgpr_read_b32 v128, a108
    v_accvgpr_read_b32 v129, a109
    v_mfma_f32_16x16x32_bf16 v[80:83], v[200:203], a[144:147], 0
    s_lshl_b32 s54, s54, 3
    ds_read_b128 v[168:171], v1 offset:1024
    v_accvgpr_read_b32 v130, a110
    v_accvgpr_read_b32 v131, a111
    v_accvgpr_read_b32 v132, a124
    v_mfma_f32_16x16x32_bf16 v[80:83], v[204:207], a[152:155], v[80:83]
    s_sub_u32 s47, s47, s54
    ds_read_b128 v[172:175], v1 offset:10240
    v_accvgpr_read_b32 v133, a125
    v_accvgpr_read_b32 v134, a126
    v_accvgpr_read_b32 v135, a127
    v_mfma_f32_16x16x32_bf16 v[80:83], v[208:211], a[160:163], v[80:83]
    s_add_u32 s46, s82, 0x1400000
    ds_read_b128 v[176:179], v1 offset:19456
    v_fma_f32 v128, v128, v251, -v255
    v_fma_f32 v129, v129, v251, -v255
    v_fma_f32 v130, v130, v251, -v255
    v_mfma_f32_16x16x32_bf16 v[80:83], v[212:215], a[168:171], v[80:83]
    s_lshl_b32 s47, s47, 2
    ds_read_b128 v[180:183], v3 offset:6080
    v_fma_f32 v131, v131, v251, -v255
    v_fma_f32 v132, v132, v251, -v255
    v_fma_f32 v133, v133, v251, -v255
    v_mfma_f32_16x16x32_bf16 v[84:87], v[212:215], a[172:175], 0
    buffer_store_dwordx4 v[104:107], v1, s[4:7], s59 offen offset:0 sc1
    v_fma_f32 v134, v134, v251, -v255
    v_fma_f32 v135, v135, v251, -v255
    v_mfma_f32_16x16x32_bf16 v[84:87], v[208:211], a[164:167], v[84:87]
    buffer_store_dwordx4 v[112:115], v1, s[4:7], s59 offen offset:1024 sc1
    v_cvt_pk_bf16_f32 v128, v128, v129
    v_cvt_pk_bf16_f32 v129, v130, v131
    v_mfma_f32_16x16x32_bf16 v[84:87], v[204:207], a[156:159], v[84:87]
    buffer_load_dwordx2 a[6:7], v4, s[4:7], s46 offen offset:2560 sc1
    v_cvt_pk_bf16_f32 v130, v132, v133
    v_cvt_pk_bf16_f32 v131, v134, v135
    v_mfma_f32_16x16x32_bf16 v[84:87], v[200:203], a[148:151], v[84:87]
    s_waitcnt vmcnt(63) lgkmcnt(4)
    v_mfma_f32_16x16x32_bf16 v[20:23], v[216:219], a[180:183], v[20:23]
    s_add_u32 s41, s82, 0x1401000
    ds_read_b128 v[200:203], v1 offset:2048
    v_mfma_f32_16x16x32_bf16 v[20:23], v[220:223], a[188:191], v[20:23]
    s_lshl_b32 s54, s47, 12
    ds_read_b128 v[204:207], v1 offset:11264
    v_mfma_f32_16x16x32_bf16 v[20:23], v[224:227], a[196:199], v[20:23]
    s_mul_i32 s48, s47, 36864
    ds_read_b128 v[208:211], v1 offset:20480
    v_mfma_f32_16x16x32_bf16 v[20:23], v[228:231], a[204:207], v[20:23]
    s_add_u32 s42, s43, s54
    ds_read_b128 v[212:215], v3 offset:7104
    v_mfma_f32_16x16x32_bf16 v[16:19], v[228:231], a[200:203], v[16:19]
    buffer_load_dwordx2 a[8:9], v4, s[4:7], s41 offen offset:0 sc1
    v_mfma_f32_16x16x32_bf16 v[16:19], v[224:227], a[192:195], v[16:19]
    buffer_store_dwordx4 v[120:123], v1, s[4:7], s59 offen offset:2048 sc1
    v_mfma_f32_16x16x32_bf16 v[16:19], v[220:223], a[184:187], v[16:19]
    buffer_store_dwordx4 v[128:131], v1, s[4:7], s59 offen offset:3072 sc1
    v_mfma_f32_16x16x32_bf16 v[16:19], v[216:219], a[176:179], v[16:19]
    s_waitcnt lgkmcnt(4)
    v_mfma_f32_16x16x32_bf16 v[24:27], v[168:171], a[176:179], v[24:27]
    s_add_u32 s41, s82, 0x1401000
    ds_read_b128 v[216:219], v1 offset:3072
    v_mfma_f32_16x16x32_bf16 v[24:27], v[172:175], a[184:187], v[24:27]
    ds_read_b128 v[220:223], v1 offset:12288
    v_mfma_f32_16x16x32_bf16 v[24:27], v[176:179], a[192:195], v[24:27]
    s_add_u32 s46, s82, 0x1401000
    ds_read_b128 v[224:227], v1 offset:21504
    v_mfma_f32_16x16x32_bf16 v[24:27], v[180:183], a[200:203], v[24:27]
    ds_read_b128 v[228:231], v3 offset:8128
    v_mfma_f32_16x16x32_bf16 v[28:31], v[180:183], a[204:207], v[28:31]
    buffer_load_dwordx2 a[12:13], v4, s[4:7], s41 offen offset:512 sc1
    v_mfma_f32_16x16x32_bf16 v[28:31], v[176:179], a[196:199], v[28:31]
    v_mfma_f32_16x16x32_bf16 v[28:31], v[172:175], a[188:191], v[28:31]
    buffer_load_dwordx2 a[10:11], v4, s[4:7], s46 offen offset:2048 sc1
    v_mfma_f32_16x16x32_bf16 v[28:31], v[168:171], a[180:183], v[28:31]
    s_waitcnt lgkmcnt(4)
    v_mfma_f32_16x16x32_bf16 v[36:39], v[200:203], a[180:183], v[36:39]
    ds_read_b128 v[168:171], v1 offset:4096
    v_mfma_f32_16x16x32_bf16 v[36:39], v[204:207], a[188:191], v[36:39]
    ds_read_b128 v[172:175], v1 offset:13312
    v_mfma_f32_16x16x32_bf16 v[36:39], v[208:211], a[196:199], v[36:39]
    s_add_u32 s46, s82, 0x1401000
    ds_read_b128 v[176:179], v1 offset:22528
    v_mfma_f32_16x16x32_bf16 v[36:39], v[212:215], a[204:207], v[36:39]
    ds_read_b128 v[180:183], v3 offset:9152
    v_mfma_f32_16x16x32_bf16 v[32:35], v[212:215], a[200:203], v[32:35]
    v_mfma_f32_16x16x32_bf16 v[32:35], v[208:211], a[192:195], v[32:35]
    v_mfma_f32_16x16x32_bf16 v[32:35], v[204:207], a[184:187], v[32:35]
    buffer_load_dwordx2 a[14:15], v4, s[4:7], s46 offen offset:2560 sc1
    v_mfma_f32_16x16x32_bf16 v[32:35], v[200:203], a[176:179], v[32:35]
    s_waitcnt lgkmcnt(4)
    v_mfma_f32_16x16x32_bf16 v[40:43], v[216:219], a[176:179], v[40:43]
    s_add_u32 s41, s82, 0x1402000
    ds_read_b128 v[200:203], v1 offset:5120
    v_mfma_f32_16x16x32_bf16 v[40:43], v[220:223], a[184:187], v[40:43]
    ds_read_b128 v[204:207], v1 offset:14336
    v_mfma_f32_16x16x32_bf16 v[40:43], v[224:227], a[192:195], v[40:43]
    s_add_u32 s46, s82, 0x1402000
    ds_read_b128 v[208:211], v1 offset:23552
    v_mfma_f32_16x16x32_bf16 v[40:43], v[228:231], a[200:203], v[40:43]
    ds_read_b128 v[212:215], v3 offset:10176
    v_mfma_f32_16x16x32_bf16 v[44:47], v[228:231], a[204:207], v[44:47]
    buffer_load_dwordx2 a[16:17], v4, s[4:7], s41 offen offset:0 sc1
    v_mfma_f32_16x16x32_bf16 v[44:47], v[224:227], a[196:199], v[44:47]
    v_mfma_f32_16x16x32_bf16 v[44:47], v[220:223], a[188:191], v[44:47]
    buffer_load_dwordx2 a[20:21], v4, s[4:7], s46 offen offset:512 sc1
    v_mfma_f32_16x16x32_bf16 v[44:47], v[216:219], a[180:183], v[44:47]
    s_waitcnt lgkmcnt(4)
    v_mfma_f32_16x16x32_bf16 v[52:55], v[168:171], a[180:183], v[52:55]
    ds_read_b128 v[216:219], v1 offset:6144
    v_mfma_f32_16x16x32_bf16 v[52:55], v[172:175], a[188:191], v[52:55]
    ds_read_b128 v[220:223], v1 offset:15360
    v_mfma_f32_16x16x32_bf16 v[52:55], v[176:179], a[196:199], v[52:55]
    s_add_u32 s46, s82, 0x1402000
    ds_read_b128 v[224:227], v1 offset:24576
    v_mfma_f32_16x16x32_bf16 v[52:55], v[180:183], a[204:207], v[52:55]
    ds_read_b128 v[228:231], v3 offset:11200
    v_mfma_f32_16x16x32_bf16 v[48:51], v[180:183], a[200:203], v[48:51]
    v_mfma_f32_16x16x32_bf16 v[48:51], v[176:179], a[192:195], v[48:51]
    v_mfma_f32_16x16x32_bf16 v[48:51], v[172:175], a[184:187], v[48:51]
    buffer_load_dwordx2 a[18:19], v4, s[4:7], s46 offen offset:2048 sc1
    v_mfma_f32_16x16x32_bf16 v[48:51], v[168:171], a[176:179], v[48:51]
    s_waitcnt lgkmcnt(4)
    v_mfma_f32_16x16x32_bf16 v[56:59], v[200:203], a[176:179], v[56:59]
    s_add_u32 s41, s82, 0x1402000
    ds_read_b128 v[168:171], v1 offset:7168
    v_mfma_f32_16x16x32_bf16 v[56:59], v[204:207], a[184:187], v[56:59]
    ds_read_b128 v[172:175], v1 offset:16384
    v_mfma_f32_16x16x32_bf16 v[56:59], v[208:211], a[192:195], v[56:59]
    ds_read_b128 v[176:179], v1 offset:25600
    v_mfma_f32_16x16x32_bf16 v[56:59], v[212:215], a[200:203], v[56:59]
    ds_read_b128 v[180:183], v3 offset:12224
    v_mfma_f32_16x16x32_bf16 v[60:63], v[212:215], a[204:207], v[60:63]
    buffer_load_dwordx2 a[22:23], v4, s[4:7], s41 offen offset:2560 sc1
    v_mfma_f32_16x16x32_bf16 v[60:63], v[208:211], a[196:199], v[60:63]
    v_mfma_f32_16x16x32_bf16 v[60:63], v[204:207], a[188:191], v[60:63]
    v_mfma_f32_16x16x32_bf16 v[60:63], v[200:203], a[180:183], v[60:63]
    s_waitcnt lgkmcnt(4)
    v_mfma_f32_16x16x32_bf16 v[68:71], v[216:219], a[180:183], v[68:71]
    s_add_u32 s41, s82, 0x1403000
    ds_read_b128 v[200:203], v1 offset:8192
    v_mfma_f32_16x16x32_bf16 v[68:71], v[220:223], a[188:191], v[68:71]
    ds_read_b128 v[204:207], v1 offset:17408
    v_mfma_f32_16x16x32_bf16 v[68:71], v[224:227], a[196:199], v[68:71]
    s_add_u32 s46, s82, 0x1403000
    ds_read_b128 v[208:211], v1 offset:26624
    v_mfma_f32_16x16x32_bf16 v[68:71], v[228:231], a[204:207], v[68:71]
L_hop0_17:
    s_cbranch_execz L_hop0_ret
    ds_read_b128 v[212:215], v3 offset:13248
    v_mfma_f32_16x16x32_bf16 v[64:67], v[228:231], a[200:203], v[64:67]
    buffer_load_dwordx2 a[24:25], v4, s[4:7], s41 offen offset:0 sc1
    v_mfma_f32_16x16x32_bf16 v[64:67], v[224:227], a[192:195], v[64:67]
    v_mfma_f32_16x16x32_bf16 v[64:67], v[220:223], a[184:187], v[64:67]
    buffer_load_dwordx2 a[28:29], v4, s[4:7], s46 offen offset:512 sc1
    v_mfma_f32_16x16x32_bf16 v[64:67], v[216:219], a[176:179], v[64:67]
    s_waitcnt vmcnt(43) lgkmcnt(4)
    s_barrier
    v_mfma_f32_16x16x32_bf16 v[72:75], v[168:171], a[176:179], v[72:75]
    ds_read_b128 v[216:219], v3 offset:14272
    v_mfma_f32_16x16x32_bf16 v[72:75], v[172:175], a[184:187], v[72:75]
    s_waitcnt vmcnt(9)
    ds_read_b128 v[220:223], v3 offset:23488
    v_mfma_f32_16x16x32_bf16 v[72:75], v[176:179], a[192:195], v[72:75]
    s_add_u32 s46, s82, 0x1403000
    ds_read_b128 v[224:227], v1 offset:27648
    v_mfma_f32_16x16x32_bf16 v[72:75], v[180:183], a[200:203], v[72:75]
    ds_read_b128 v[228:231], v1 offset:36864
    v_mfma_f32_16x16x32_bf16 v[76:79], v[180:183], a[204:207], v[76:79]
    v_mfma_f32_16x16x32_bf16 v[76:79], v[176:179], a[196:199], v[76:79]
    buffer_store_dword v11, v7, s[4:7], s80 offen sc1
    v_mfma_f32_16x16x32_bf16 v[76:79], v[172:175], a[188:191], v[76:79]
    buffer_load_dwordx2 a[26:27], v4, s[4:7], s46 offen offset:2048 sc1
    v_mfma_f32_16x16x32_bf16 v[76:79], v[168:171], a[180:183], v[76:79]
    s_waitcnt lgkmcnt(4)
    v_mfma_f32_16x16x32_bf16 v[84:87], v[200:203], a[180:183], v[84:87]
    s_add_u32 s41, s82, 0x1403000
    ds_read_b128 v[168:171], v3 offset:15296
    v_mfma_f32_16x16x32_bf16 v[84:87], v[204:207], a[188:191], v[84:87]
    ds_read_b128 v[172:175], v3 offset:24512
    v_mfma_f32_16x16x32_bf16 v[84:87], v[208:211], a[196:199], v[84:87]
    ds_read_b128 v[176:179], v1 offset:28672
    v_mfma_f32_16x16x32_bf16 v[84:87], v[212:215], a[204:207], v[84:87]
    ds_read_b128 v[180:183], v1 offset:37888
    v_mfma_f32_16x16x32_bf16 v[80:83], v[212:215], a[200:203], v[80:83]
    buffer_load_dwordx2 a[30:31], v4, s[4:7], s41 offen offset:2560 sc1
    v_mfma_f32_16x16x32_bf16 v[80:83], v[208:211], a[192:195], v[80:83]
    v_mfma_f32_16x16x32_bf16 v[80:83], v[204:207], a[184:187], v[80:83]
    v_mfma_f32_16x16x32_bf16 v[80:83], v[200:203], a[176:179], v[80:83]
    s_waitcnt vmcnt(40) lgkmcnt(4)
    v_mfma_f32_16x16x32_bf16 v[16:19], v[216:219], a[208:211], v[16:19]
    s_add_u32 s41, s28, s48
    ds_read_b128 v[200:203], v3 offset:16320
    v_add_u32 v12, 55296, v1
    v_mfma_f32_16x16x32_bf16 v[16:19], v[220:223], a[216:219], v[16:19]
    s_add_u32 m0, s69, 0x0
    ds_read_b128 v[204:207], v3 offset:25536
    v_add_u32 v13, 0, v1
    v_mfma_f32_16x16x32_bf16 v[16:19], v[224:227], a[224:227], v[16:19]
    s_add_u32 s46, s29, s48
    ds_read_b128 v[208:211], v1 offset:29696
    v_add_u32 v14, 126912, v1
    v_mfma_f32_16x16x32_bf16 v[16:19], v[228:231], a[232:235], v[16:19]
    s_add_u32 s47, s47, 4
    ds_read_b128 v[212:215], v1 offset:38912
    v_mfma_f32_16x16x32_bf16 v[20:23], v[228:231], a[236:239], v[20:23]
    buffer_load_dwordx4 v1, s[88:91], s41 offen sc1 lds
    v_mfma_f32_16x16x32_bf16 v[20:23], v[224:227], a[228:231], v[20:23]
    s_add_u32 m0, s69, 0x400
    v_mfma_f32_16x16x32_bf16 v[20:23], v[220:223], a[220:223], v[20:23]
    buffer_load_dwordx4 v1, s[88:91], s46 offen sc1 lds
    v_mfma_f32_16x16x32_bf16 v[20:23], v[216:219], a[212:215], v[20:23]
    s_waitcnt lgkmcnt(4)
    v_mfma_f32_16x16x32_bf16 v[28:31], v[168:171], a[212:215], v[28:31]
    s_add_u32 s41, s30, s48
    ds_read_b128 v[216:219], v3 offset:17344
    v_mfma_f32_16x16x32_bf16 v[28:31], v[172:175], a[220:223], v[28:31]
    s_add_u32 m0, s69, 0x800
    ds_read_b128 v[220:223], v3 offset:26560
    v_mfma_f32_16x16x32_bf16 v[28:31], v[176:179], a[228:231], v[28:31]
    s_add_u32 s46, s31, s48
    ds_read_b128 v[224:227], v1 offset:30720
    v_mfma_f32_16x16x32_bf16 v[28:31], v[180:183], a[236:239], v[28:31]
    s_and_b32 s54, s47, 31
    ds_read_b128 v[228:231], v1 offset:39936
    v_mfma_f32_16x16x32_bf16 v[24:27], v[180:183], a[232:235], v[24:27]
    buffer_load_dwordx4 v1, s[88:91], s41 offen sc1 lds
    v_mfma_f32_16x16x32_bf16 v[24:27], v[176:179], a[224:227], v[24:27]
    s_add_u32 m0, s69, 0xc00
    v_mfma_f32_16x16x32_bf16 v[24:27], v[172:175], a[216:219], v[24:27]
    buffer_load_dwordx4 v1, s[88:91], s46 offen sc1 lds
    v_mfma_f32_16x16x32_bf16 v[24:27], v[168:171], a[208:211], v[24:27]
    s_waitcnt lgkmcnt(4)
    v_mfma_f32_16x16x32_bf16 v[32:35], v[200:203], a[208:211], v[32:35]
    s_add_u32 s41, s36, s48
    ds_read_b128 v[168:171], v3 offset:18368
    v_mfma_f32_16x16x32_bf16 v[32:35], v[204:207], a[216:219], v[32:35]
    s_add_u32 m0, s69, 0x1000
    ds_read_b128 v[172:175], v3 offset:27584
    v_mfma_f32_16x16x32_bf16 v[32:35], v[208:211], a[224:227], v[32:35]
    s_add_u32 s46, s37, s48
    ds_read_b128 v[176:179], v1 offset:31744
    v_mfma_f32_16x16x32_bf16 v[32:35], v[212:215], a[232:235], v[32:35]
    s_sub_u32 s54, s54, 1
    ds_read_b128 v[180:183], v1 offset:40960
    v_mfma_f32_16x16x32_bf16 v[36:39], v[212:215], a[236:239], v[36:39]
    buffer_load_dwordx4 v1, s[88:91], s41 offen sc1 lds
    v_mfma_f32_16x16x32_bf16 v[36:39], v[208:211], a[228:231], v[36:39]
    s_add_u32 m0, s69, 0x1400
    v_mfma_f32_16x16x32_bf16 v[36:39], v[204:207], a[220:223], v[36:39]
    buffer_load_dwordx4 v1, s[88:91], s46 offen sc1 lds
    v_mfma_f32_16x16x32_bf16 v[36:39], v[200:203], a[212:215], v[36:39]
    s_waitcnt lgkmcnt(4)
    v_mfma_f32_16x16x32_bf16 v[44:47], v[216:219], a[212:215], v[44:47]
    s_add_u32 s41, s38, s48
    ds_read_b128 v[200:203], v3 offset:19392
    v_mfma_f32_16x16x32_bf16 v[44:47], v[220:223], a[220:223], v[44:47]
    s_add_u32 m0, s69, 0x1800
    ds_read_b128 v[204:207], v3 offset:28608
    v_mfma_f32_16x16x32_bf16 v[44:47], v[224:227], a[228:231], v[44:47]
    s_add_u32 s46, s39, s48
    ds_read_b128 v[208:211], v1 offset:32768
    v_mfma_f32_16x16x32_bf16 v[44:47], v[228:231], a[236:239], v[44:47]
    s_lshr_b32 s54, s54, 31
    ds_read_b128 v[212:215], v1 offset:41984
    v_mfma_f32_16x16x32_bf16 v[40:43], v[228:231], a[232:235], v[40:43]
    buffer_load_dwordx4 v1, s[88:91], s41 offen sc1 lds
    v_mfma_f32_16x16x32_bf16 v[40:43], v[224:227], a[224:227], v[40:43]
    s_add_u32 m0, s69, 0x1c00
    v_mfma_f32_16x16x32_bf16 v[40:43], v[220:223], a[216:219], v[40:43]
    buffer_load_dwordx4 v1, s[88:91], s46 offen sc1 lds
    v_mfma_f32_16x16x32_bf16 v[40:43], v[216:219], a[208:211], v[40:43]
    s_waitcnt lgkmcnt(4)
    s_mov_b64 exec, 0
    s_cmp_eq_u32 s32, 1
    s_cbranch_scc1 L_hop1_1
    s_cmp_eq_u32 s32, 2
    s_cbranch_scc1 L_hop1_2
    s_cmp_eq_u32 s32, 3
    s_cbranch_scc1 L_hop1_3
    s_branch L_hop1_0
L_hop1_ret:
    s_mov_b64 exec, -1
    v_mfma_f32_16x16x32_bf16 v[48:51], v[168:171], a[208:211], v[48:51]
    s_add_u32 s41, s42, 0x400000
    ds_read_b128 v[216:219], v3 offset:20416
    v_mfma_f32_16x16x32_bf16 v[48:51], v[172:175], a[216:219], v[48:51]
    ds_read_b128 v[220:223], v3 offset:29632
    v_mfma_f32_16x16x32_bf16 v[48:51], v[176:179], a[224:227], v[48:51]
    s_add_u32 s46, s42, 0x400000
    ds_read_b128 v[224:227], v1 offset:33792
    v_mfma_f32_16x16x32_bf16 v[48:51], v[180:183], a[232:235], v[48:51]
    s_mul_i32 s54, s54, 12
    ds_read_b128 v[228:231], v1 offset:43008
    v_mfma_f32_16x16x32_bf16 v[52:55], v[180:183], a[236:239], v[52:55]
    buffer_load_dwordx4 a[144:147], v1, s[4:7], s41 offen offset:0 sc1
    v_mfma_f32_16x16x32_bf16 v[52:55], v[176:179], a[228:231], v[52:55]
    v_mfma_f32_16x16x32_bf16 v[52:55], v[172:175], a[220:223], v[52:55]
    buffer_load_dwordx4 a[148:151], v1, s[4:7], s46 offen offset:1024 sc1
    v_mfma_f32_16x16x32_bf16 v[52:55], v[168:171], a[212:215], v[52:55]
    s_waitcnt lgkmcnt(4)
    v_mfma_f32_16x16x32_bf16 v[60:63], v[200:203], a[212:215], v[60:63]
    s_add_u32 s41, s42, 0x401000
    ds_read_b128 v[168:171], v3 offset:21440
    v_mfma_f32_16x16x32_bf16 v[60:63], v[204:207], a[220:223], v[60:63]
    ds_read_b128 v[172:175], v3 offset:30656
    v_mfma_f32_16x16x32_bf16 v[60:63], v[208:211], a[228:231], v[60:63]
    s_add_u32 s46, s42, 0x401000
    ds_read_b128 v[176:179], v1 offset:34816
    v_mfma_f32_16x16x32_bf16 v[60:63], v[212:215], a[236:239], v[60:63]
    s_add_u32 s47, s47, s54
    ds_read_b128 v[180:183], v1 offset:44032
    v_mfma_f32_16x16x32_bf16 v[56:59], v[212:215], a[232:235], v[56:59]
    buffer_load_dwordx4 a[152:155], v1, s[4:7], s41 offen offset:0 sc1
    v_mfma_f32_16x16x32_bf16 v[56:59], v[208:211], a[224:227], v[56:59]
    v_mfma_f32_16x16x32_bf16 v[56:59], v[204:207], a[216:219], v[56:59]
    buffer_load_dwordx4 a[156:159], v1, s[4:7], s46 offen offset:1024 sc1
    v_mfma_f32_16x16x32_bf16 v[56:59], v[200:203], a[208:211], v[56:59]
    s_waitcnt lgkmcnt(4)
    v_mfma_f32_16x16x32_bf16 v[64:67], v[216:219], a[208:211], v[64:67]
    s_add_u32 s41, s42, 0x402000
    ds_read_b128 v[200:203], v3 offset:22464
    v_mfma_f32_16x16x32_bf16 v[64:67], v[220:223], a[216:219], v[64:67]
    ds_read_b128 v[204:207], v3 offset:31680
    v_mfma_f32_16x16x32_bf16 v[64:67], v[224:227], a[224:227], v[64:67]
    s_add_u32 s46, s42, 0x402000
    ds_read_b128 v[208:211], v1 offset:35840
    v_mfma_f32_16x16x32_bf16 v[64:67], v[228:231], a[232:235], v[64:67]
    s_lshl_b32 s54, s47, 12
    ds_read_b128 v[212:215], v1 offset:45056
    v_mfma_f32_16x16x32_bf16 v[68:71], v[228:231], a[236:239], v[68:71]
    buffer_load_dwordx4 a[160:163], v1, s[4:7], s41 offen offset:0 sc1
    v_mfma_f32_16x16x32_bf16 v[68:71], v[224:227], a[228:231], v[68:71]
    v_mfma_f32_16x16x32_bf16 v[68:71], v[220:223], a[220:223], v[68:71]
    buffer_load_dwordx4 a[164:167], v1, s[4:7], s46 offen offset:1024 sc1
    v_mfma_f32_16x16x32_bf16 v[68:71], v[216:219], a[212:215], v[68:71]
    s_waitcnt vmcnt(38) lgkmcnt(4)
    s_barrier
    v_mfma_f32_16x16x32_bf16 v[76:79], v[168:171], a[212:215], v[76:79]
    s_add_u32 s41, s40, s48
    ds_read_b128 v[216:219], v1 offset:46080
    v_mfma_f32_16x16x32_bf16 v[76:79], v[172:175], a[220:223], v[76:79]
    s_add_u32 m0, s69, 0x2000
    ds_read_b128 v[220:223], v2 offset:26624
    v_mfma_f32_16x16x32_bf16 v[76:79], v[176:179], a[228:231], v[76:79]
    s_add_u32 s46, s42, 0x403000
    ds_read_b128 v[224:227], v2 offset:35840
    v_mfma_f32_16x16x32_bf16 v[76:79], v[180:183], a[236:239], v[76:79]
    s_mul_i32 s48, s47, 36864
    ds_read_b128 v[228:231], v2 offset:61376
    v_mfma_f32_16x16x32_bf16 v[72:75], v[180:183], a[232:235], v[72:75]
    buffer_load_dwordx4 v1, s[88:91], s41 offen sc1 lds
    v_mfma_f32_16x16x32_bf16 v[72:75], v[176:179], a[224:227], v[72:75]
    v_mfma_f32_16x16x32_bf16 v[72:75], v[172:175], a[216:219], v[72:75]
    buffer_load_dwordx4 a[168:171], v1, s[4:7], s46 offen offset:0 sc1
    v_mfma_f32_16x16x32_bf16 v[72:75], v[168:171], a[208:211], v[72:75]
    s_waitcnt lgkmcnt(4)
    v_mfma_f32_16x16x32_bf16 v[80:83], v[200:203], a[208:211], v[80:83]
    s_add_u32 s41, s42, 0x403000
    ds_read_b128 v[168:171], v1 offset:47104
    v_mfma_f32_16x16x32_bf16 v[80:83], v[204:207], a[216:219], v[80:83]
    ds_read_b128 v[172:175], v2 offset:27648
    v_mfma_f32_16x16x32_bf16 v[80:83], v[208:211], a[224:227], v[80:83]
    ds_read_b128 v[176:179], v2 offset:36864
    v_mfma_f32_16x16x32_bf16 v[80:83], v[212:215], a[232:235], v[80:83]
    s_add_u32 s42, s43, s54
    ds_read_b128 v[180:183], v2 offset:62400
    v_mfma_f32_16x16x32_bf16 v[84:87], v[212:215], a[236:239], v[84:87]
    buffer_load_dwordx4 a[172:175], v1, s[4:7], s41 offen offset:1024 sc1
    v_mfma_f32_16x16x32_bf16 v[84:87], v[208:211], a[228:231], v[84:87]
    v_mfma_f32_16x16x32_bf16 v[84:87], v[204:207], a[220:223], v[84:87]
    buffer_load_dword v8, v10, s[4:7], s81 offen sc1
    v_mfma_f32_16x16x32_bf16 v[84:87], v[200:203], a[212:215], v[84:87]
    s_waitcnt vmcnt(18) lgkmcnt(4)
    s_cmp_le_i32 s53, 1
    s_cbranch_scc1 L_k2_br3
    v_mfma_f32_16x16x32_bf16 v[16:19], v[216:219], a[0:3], v[16:19]
    s_add_u32 s41, s28, s48
    ds_read_b128 v[200:203], v1 offset:48128
    v_mfma_f32_16x16x32_bf16 v[16:19], v[220:223], a[8:11], v[16:19]
    s_add_u32 m0, s72, 0x0
    ds_read_b128 v[204:207], v2 offset:28672
    v_mfma_f32_16x16x32_bf16 v[16:19], v[224:227], a[16:19], v[16:19]
    s_add_u32 s46, s29, s48
    ds_read_b128 v[208:211], v2 offset:37888
    v_mfma_f32_16x16x32_bf16 v[16:19], v[228:231], a[24:27], v[16:19]
    s_add_u32 s47, s47, 4
    ds_read_b128 v[212:215], v2 offset:63424
    v_mfma_f32_16x16x32_bf16 v[20:23], v[228:231], a[28:31], v[20:23]
    buffer_load_dwordx4 v1, s[88:91], s41 offen sc1 lds
    v_mfma_f32_16x16x32_bf16 v[20:23], v[224:227], a[20:23], v[20:23]
    s_add_u32 m0, s72, 0x400
    v_mfma_f32_16x16x32_bf16 v[20:23], v[220:223], a[12:15], v[20:23]
    buffer_load_dwordx4 v1, s[88:91], s46 offen sc1 lds
    v_mfma_f32_16x16x32_bf16 v[20:23], v[216:219], a[4:7], v[20:23]
    s_waitcnt lgkmcnt(4)
    v_mfma_f32_16x16x32_bf16 v[28:31], v[168:171], a[4:7], v[28:31]
    s_add_u32 s41, s30, s48
    ds_read_b128 v[216:219], v1 offset:49152
    v_mfma_f32_16x16x32_bf16 v[28:31], v[172:175], a[12:15], v[28:31]
    s_add_u32 m0, s72, 0x800
    ds_read_b128 v[220:223], v2 offset:29696
    v_mfma_f32_16x16x32_bf16 v[28:31], v[176:179], a[20:23], v[28:31]
    s_add_u32 s46, s31, s48
    ds_read_b128 v[224:227], v2 offset:38912
    v_mfma_f32_16x16x32_bf16 v[28:31], v[180:183], a[28:31], v[28:31]
    s_and_b32 s54, s47, 31
    ds_read_b128 v[228:231], v2 offset:64448
    v_mfma_f32_16x16x32_bf16 v[24:27], v[180:183], a[24:27], v[24:27]
    buffer_load_dwordx4 v1, s[88:91], s41 offen sc1 lds
    v_mfma_f32_16x16x32_bf16 v[24:27], v[176:179], a[16:19], v[24:27]
    s_add_u32 m0, s72, 0xc00
    v_mfma_f32_16x16x32_bf16 v[24:27], v[172:175], a[8:11], v[24:27]
    buffer_load_dwordx4 v1, s[88:91], s46 offen sc1 lds
    v_mfma_f32_16x16x32_bf16 v[24:27], v[168:171], a[0:3], v[24:27]
    s_waitcnt lgkmcnt(4)
    v_mfma_f32_16x16x32_bf16 v[32:35], v[200:203], a[0:3], v[32:35]
    s_add_u32 s41, s36, s48
    ds_read_b128 v[168:171], v1 offset:50176
    v_mfma_f32_16x16x32_bf16 v[32:35], v[204:207], a[8:11], v[32:35]
    s_add_u32 m0, s72, 0x1000
    ds_read_b128 v[172:175], v2 offset:30720
    v_mfma_f32_16x16x32_bf16 v[32:35], v[208:211], a[16:19], v[32:35]
    s_add_u32 s46, s37, s48
    ds_read_b128 v[176:179], v2 offset:39936
    v_mfma_f32_16x16x32_bf16 v[32:35], v[212:215], a[24:27], v[32:35]
    s_sub_u32 s54, s54, 1
    ds_read_b128 v[180:183], v2 offset:65472
    v_mfma_f32_16x16x32_bf16 v[36:39], v[212:215], a[28:31], v[36:39]
    buffer_load_dwordx4 v1, s[88:91], s41 offen sc1 lds
    v_mfma_f32_16x16x32_bf16 v[36:39], v[208:211], a[20:23], v[36:39]
    s_add_u32 m0, s72, 0x1400
    v_mfma_f32_16x16x32_bf16 v[36:39], v[204:207], a[12:15], v[36:39]
    buffer_load_dwordx4 v1, s[88:91], s46 offen sc1 lds
    v_mfma_f32_16x16x32_bf16 v[36:39], v[200:203], a[4:7], v[36:39]
    s_waitcnt lgkmcnt(4)
    v_mfma_f32_16x16x32_bf16 v[44:47], v[216:219], a[4:7], v[44:47]
    s_add_u32 s41, s38, s48
    ds_read_b128 v[200:203], v1 offset:51200
    v_mfma_f32_16x16x32_bf16 v[44:47], v[220:223], a[12:15], v[44:47]
    s_add_u32 m0, s72, 0x1800
    ds_read_b128 v[204:207], v2 offset:31744
    v_mfma_f32_16x16x32_bf16 v[44:47], v[224:227], a[20:23], v[44:47]
    s_add_u32 s46, s39, s48
    ds_read_b128 v[208:211], v2 offset:40960
    v_mfma_f32_16x16x32_bf16 v[44:47], v[228:231], a[28:31], v[44:47]
    s_lshr_b32 s54, s54, 31
    ds_read_b128 v[212:215], v3 offset:960
    v_mfma_f32_16x16x32_bf16 v[40:43], v[228:231], a[24:27], v[40:43]
    buffer_load_dwordx4 v1, s[88:91], s41 offen sc1 lds
    v_mfma_f32_16x16x32_bf16 v[40:43], v[224:227], a[16:19], v[40:43]
    s_add_u32 m0, s72, 0x1c00
    v_mfma_f32_16x16x32_bf16 v[40:43], v[220:223], a[8:11], v[40:43]
    buffer_load_dwordx4 v1, s[88:91], s46 offen sc1 lds
    v_mfma_f32_16x16x32_bf16 v[40:43], v[216:219], a[0:3], v[40:43]
    s_waitcnt lgkmcnt(4)
    v_mfma_f32_16x16x32_bf16 v[48:51], v[168:171], a[0:3], v[48:51]
    s_add_u32 s41, s42, 0x400000
    ds_read_b128 v[216:219], v1 offset:52224
    v_mfma_f32_16x16x32_bf16 v[48:51], v[172:175], a[8:11], v[48:51]
    ds_read_b128 v[220:223], v2 offset:32768
    v_mfma_f32_16x16x32_bf16 v[48:51], v[176:179], a[16:19], v[48:51]
    s_add_u32 s46, s42, 0x400000
    ds_read_b128 v[224:227], v2 offset:41984
    v_mfma_f32_16x16x32_bf16 v[48:51], v[180:183], a[24:27], v[48:51]
    s_mul_i32 s54, s54, 12
    ds_read_b128 v[228:231], v3 offset:1984
    v_mfma_f32_16x16x32_bf16 v[52:55], v[180:183], a[28:31], v[52:55]
    buffer_load_dwordx4 a[176:179], v1, s[4:7], s41 offen offset:0 sc1
    v_mfma_f32_16x16x32_bf16 v[52:55], v[176:179], a[20:23], v[52:55]
    v_mfma_f32_16x16x32_bf16 v[52:55], v[172:175], a[12:15], v[52:55]
    buffer_load_dwordx4 a[180:183], v1, s[4:7], s46 offen offset:1024 sc1
    v_mfma_f32_16x16x32_bf16 v[52:55], v[168:171], a[4:7], v[52:55]
    s_waitcnt lgkmcnt(4)
    v_mfma_f32_16x16x32_bf16 v[60:63], v[200:203], a[4:7], v[60:63]
    s_add_u32 s41, s42, 0x401000
    ds_read_b128 v[168:171], v1 offset:53248
    v_mfma_f32_16x16x32_bf16 v[60:63], v[204:207], a[12:15], v[60:63]
    ds_read_b128 v[172:175], v2 offset:33792
    v_mfma_f32_16x16x32_bf16 v[60:63], v[208:211], a[20:23], v[60:63]
    s_add_u32 s46, s42, 0x401000
    ds_read_b128 v[176:179], v2 offset:43008
    v_mfma_f32_16x16x32_bf16 v[60:63], v[212:215], a[28:31], v[60:63]
    s_add_u32 s47, s47, s54
    ds_read_b128 v[180:183], v3 offset:3008
    v_mfma_f32_16x16x32_bf16 v[56:59], v[212:215], a[24:27], v[56:59]
    buffer_load_dwordx4 a[184:187], v1, s[4:7], s41 offen offset:0 sc1
    v_mfma_f32_16x16x32_bf16 v[56:59], v[208:211], a[16:19], v[56:59]
    v_mfma_f32_16x16x32_bf16 v[56:59], v[204:207], a[8:11], v[56:59]
    buffer_load_dwordx4 a[188:191], v1, s[4:7], s46 offen offset:1024 sc1
    v_mfma_f32_16x16x32_bf16 v[56:59], v[200:203], a[0:3], v[56:59]
    s_waitcnt lgkmcnt(4)
    v_mfma_f32_16x16x32_bf16 v[64:67], v[216:219], a[0:3], v[64:67]
    s_add_u32 s41, s42, 0x402000
    ds_read_b128 v[200:203], v1 offset:54272
    v_mfma_f32_16x16x32_bf16 v[64:67], v[220:223], a[8:11], v[64:67]
    ds_read_b128 v[204:207], v2 offset:34816
    v_mfma_f32_16x16x32_bf16 v[64:67], v[224:227], a[16:19], v[64:67]
    s_add_u32 s46, s42, 0x402000
    ds_read_b128 v[208:211], v2 offset:44032
    v_mfma_f32_16x16x32_bf16 v[64:67], v[228:231], a[24:27], v[64:67]
    s_lshl_b32 s54, s47, 12
    ds_read_b128 v[212:215], v3 offset:4032
    v_mfma_f32_16x16x32_bf16 v[68:71], v[228:231], a[28:31], v[68:71]
    buffer_load_dwordx4 a[192:195], v1, s[4:7], s41 offen offset:0 sc1
    v_mfma_f32_16x16x32_bf16 v[68:71], v[224:227], a[20:23], v[68:71]
    v_mfma_f32_16x16x32_bf16 v[68:71], v[220:223], a[12:15], v[68:71]
    buffer_load_dwordx4 a[196:199], v1, s[4:7], s46 offen offset:1024 sc1
    v_mfma_f32_16x16x32_bf16 v[68:71], v[216:219], a[4:7], v[68:71]
    s_waitcnt vmcnt(17) lgkmcnt(4)
    s_barrier
    v_mfma_f32_16x16x32_bf16 v[76:79], v[168:171], a[4:7], v[76:79]
    s_add_u32 s41, s40, s48
    ds_read_b128 v[216:219], v12 offset:0
    v_mfma_f32_16x16x32_bf16 v[76:79], v[172:175], a[12:15], v[76:79]
    s_add_u32 m0, s72, 0x2000
    ds_read_b128 v[220:223], v12 offset:9216
    v_mfma_f32_16x16x32_bf16 v[76:79], v[176:179], a[20:23], v[76:79]
    s_add_u32 s46, s42, 0x403000
    ds_read_b128 v[224:227], v12 offset:18432
    v_mfma_f32_16x16x32_bf16 v[76:79], v[180:183], a[28:31], v[76:79]
    s_mul_i32 s48, s47, 36864
    ds_read_b128 v[228:231], v12 offset:27648
    v_mfma_f32_16x16x32_bf16 v[72:75], v[180:183], a[24:27], v[72:75]
    buffer_load_dwordx4 v1, s[88:91], s41 offen sc1 lds
    v_mfma_f32_16x16x32_bf16 v[72:75], v[176:179], a[16:19], v[72:75]
    v_mfma_f32_16x16x32_bf16 v[72:75], v[172:175], a[8:11], v[72:75]
    buffer_load_dwordx4 a[200:203], v1, s[4:7], s46 offen offset:0 sc1
    v_mfma_f32_16x16x32_bf16 v[72:75], v[168:171], a[0:3], v[72:75]
    s_waitcnt lgkmcnt(4)
    v_mfma_f32_16x16x32_bf16 v[80:83], v[200:203], a[0:3], v[80:83]
    s_add_u32 s41, s42, 0x403000
    ds_read_b128 v[168:171], v12 offset:1024
    v_mfma_f32_16x16x32_bf16 v[80:83], v[204:207], a[8:11], v[80:83]
    ds_read_b128 v[172:175], v12 offset:10240
    v_mfma_f32_16x16x32_bf16 v[80:83], v[208:211], a[16:19], v[80:83]
    ds_read_b128 v[176:179], v12 offset:19456
    v_mfma_f32_16x16x32_bf16 v[80:83], v[212:215], a[24:27], v[80:83]
    s_add_u32 s42, s43, s54
    ds_read_b128 v[180:183], v12 offset:28672
    v_mfma_f32_16x16x32_bf16 v[84:87], v[212:215], a[28:31], v[84:87]
    buffer_load_dwordx4 a[204:207], v1, s[4:7], s41 offen offset:1024 sc1
    v_mfma_f32_16x16x32_bf16 v[84:87], v[208:211], a[20:23], v[84:87]
    v_mfma_f32_16x16x32_bf16 v[84:87], v[204:207], a[12:15], v[84:87]
    buffer_load_dword v8, v10, s[4:7], s81 offen sc1
    v_mfma_f32_16x16x32_bf16 v[84:87], v[200:203], a[4:7], v[84:87]
    s_waitcnt vmcnt(19) lgkmcnt(4)
    s_cmp_le_i32 s53, 2
    s_cbranch_scc1 L_k2_br0
L_k2_flex:
    v_mfma_f32_16x16x32_bf16 v[16:19], v[216:219], a[144:147], v[16:19]
    s_add_u32 s41, s28, s48
    ds_read_b128 v[200:203], v12 offset:2048
    v_mfma_f32_16x16x32_bf16 v[16:19], v[220:223], a[152:155], v[16:19]
    s_add_u32 m0, s73, 0x0
    ds_read_b128 v[204:207], v12 offset:11264
    v_mfma_f32_16x16x32_bf16 v[16:19], v[224:227], a[160:163], v[16:19]
    s_add_u32 s46, s29, s48
    ds_read_b128 v[208:211], v12 offset:20480
    v_mfma_f32_16x16x32_bf16 v[16:19], v[228:231], a[168:171], v[16:19]
    s_add_u32 s47, s47, 4
    ds_read_b128 v[212:215], v12 offset:29696
    v_mfma_f32_16x16x32_bf16 v[20:23], v[228:231], a[172:175], v[20:23]
    buffer_load_dwordx4 v1, s[88:91], s41 offen sc1 lds
    v_mfma_f32_16x16x32_bf16 v[20:23], v[224:227], a[164:167], v[20:23]
    s_add_u32 m0, s73, 0x400
    v_mfma_f32_16x16x32_bf16 v[20:23], v[220:223], a[156:159], v[20:23]
    buffer_load_dwordx4 v1, s[88:91], s46 offen sc1 lds
    v_mfma_f32_16x16x32_bf16 v[20:23], v[216:219], a[148:151], v[20:23]
    s_waitcnt lgkmcnt(4)
    v_mfma_f32_16x16x32_bf16 v[28:31], v[168:171], a[148:151], v[28:31]
    s_add_u32 s41, s30, s48
    ds_read_b128 v[216:219], v12 offset:3072
    v_mfma_f32_16x16x32_bf16 v[28:31], v[172:175], a[156:159], v[28:31]
    s_add_u32 m0, s73, 0x800
    ds_read_b128 v[220:223], v12 offset:12288
    v_mfma_f32_16x16x32_bf16 v[28:31], v[176:179], a[164:167], v[28:31]
    s_add_u32 s46, s31, s48
    ds_read_b128 v[224:227], v12 offset:21504
    v_mfma_f32_16x16x32_bf16 v[28:31], v[180:183], a[172:175], v[28:31]
    s_and_b32 s54, s47, 31
    ds_read_b128 v[228:231], v12 offset:30720
    v_mfma_f32_16x16x32_bf16 v[24:27], v[180:183], a[168:171], v[24:27]
    buffer_load_dwordx4 v1, s[88:91], s41 offen sc1 lds
    v_mfma_f32_16x16x32_bf16 v[24:27], v[176:179], a[160:163], v[24:27]
    s_add_u32 m0, s73, 0xc00
    v_mfma_f32_16x16x32_bf16 v[24:27], v[172:175], a[152:155], v[24:27]
    buffer_load_dwordx4 v1, s[88:91], s46 offen sc1 lds
    v_mfma_f32_16x16x32_bf16 v[24:27], v[168:171], a[144:147], v[24:27]
    s_waitcnt lgkmcnt(4)
    v_mfma_f32_16x16x32_bf16 v[32:35], v[200:203], a[144:147], v[32:35]
    s_add_u32 s41, s36, s48
    ds_read_b128 v[168:171], v12 offset:4096
    v_mfma_f32_16x16x32_bf16 v[32:35], v[204:207], a[152:155], v[32:35]
    s_add_u32 m0, s73, 0x1000
    ds_read_b128 v[172:175], v12 offset:13312
    v_mfma_f32_16x16x32_bf16 v[32:35], v[208:211], a[160:163], v[32:35]
    s_add_u32 s46, s37, s48
    ds_read_b128 v[176:179], v12 offset:22528
    v_mfma_f32_16x16x32_bf16 v[32:35], v[212:215], a[168:171], v[32:35]
    s_sub_u32 s54, s54, 1
    ds_read_b128 v[180:183], v12 offset:31744
    v_mfma_f32_16x16x32_bf16 v[36:39], v[212:215], a[172:175], v[36:39]
    buffer_load_dwordx4 v1, s[88:91], s41 offen sc1 lds
    v_mfma_f32_16x16x32_bf16 v[36:39], v[208:211], a[164:167], v[36:39]
    s_add_u32 m0, s73, 0x1400
    v_mfma_f32_16x16x32_bf16 v[36:39], v[204:207], a[156:159], v[36:39]
    buffer_load_dwordx4 v1, s[88:91], s46 offen sc1 lds
    v_mfma_f32_16x16x32_bf16 v[36:39], v[200:203], a[148:151], v[36:39]
    s_waitcnt lgkmcnt(4)
    v_mfma_f32_16x16x32_bf16 v[44:47], v[216:219], a[148:151], v[44:47]
    s_add_u32 s41, s38, s48
    ds_read_b128 v[200:203], v12 offset:5120
    v_mfma_f32_16x16x32_bf16 v[44:47], v[220:223], a[156:159], v[44:47]
    s_add_u32 m0, s73, 0x1800
    ds_read_b128 v[204:207], v12 offset:14336
    v_mfma_f32_16x16x32_bf16 v[44:47], v[224:227], a[164:167], v[44:47]
    s_add_u32 s46, s39, s48
    ds_read_b128 v[208:211], v12 offset:23552
    v_mfma_f32_16x16x32_bf16 v[44:47], v[228:231], a[172:175], v[44:47]
    s_lshr_b32 s54, s54, 31
    ds_read_b128 v[212:215], v12 offset:32768
    v_mfma_f32_16x16x32_bf16 v[40:43], v[228:231], a[168:171], v[40:43]
    buffer_load_dwordx4 v1, s[88:91], s41 offen sc1 lds
    v_mfma_f32_16x16x32_bf16 v[40:43], v[224:227], a[160:163], v[40:43]
    s_add_u32 m0, s73, 0x1c00
    v_mfma_f32_16x16x32_bf16 v[40:43], v[220:223], a[152:155], v[40:43]
    buffer_load_dwordx4 v1, s[88:91], s46 offen sc1 lds
    v_mfma_f32_16x16x32_bf16 v[40:43], v[216:219], a[144:147], v[40:43]
    s_waitcnt lgkmcnt(4)
    v_mfma_f32_16x16x32_bf16 v[48:51], v[168:171], a[144:147], v[48:51]
    s_add_u32 s41, s42, 0x400000
    ds_read_b128 v[216:219], v12 offset:6144
    v_mfma_f32_16x16x32_bf16 v[48:51], v[172:175], a[152:155], v[48:51]
    ds_read_b128 v[220:223], v12 offset:15360
    v_mfma_f32_16x16x32_bf16 v[48:51], v[176:179], a[160:163], v[48:51]
    s_add_u32 s46, s42, 0x400000
    ds_read_b128 v[224:227], v12 offset:24576
    v_mfma_f32_16x16x32_bf16 v[48:51], v[180:183], a[168:171], v[48:51]
    s_mul_i32 s54, s54, 12
    ds_read_b128 v[228:231], v12 offset:33792
    v_mfma_f32_16x16x32_bf16 v[52:55], v[180:183], a[172:175], v[52:55]
    buffer_load_dwordx4 a[208:211], v1, s[4:7], s41 offen offset:0 sc1
    v_mfma_f32_16x16x32_bf16 v[52:55], v[176:179], a[164:167], v[52:55]
    v_mfma_f32_16x16x32_bf16 v[52:55], v[172:175], a[156:159], v[52:55]
    buffer_load_dwordx4 a[212:215], v1, s[4:7], s46 offen offset:1024 sc1
    v_mfma_f32_16x16x32_bf16 v[52:55], v[168:171], a[148:151], v[52:55]
    s_waitcnt lgkmcnt(4)
    v_mfma_f32_16x16x32_bf16 v[60:63], v[200:203], a[148:151], v[60:63]
    s_add_u32 s41, s42, 0x401000
    ds_read_b128 v[168:171], v12 offset:7168
    v_mfma_f32_16x16x32_bf16 v[60:63], v[204:207], a[156:159], v[60:63]
    ds_read_b128 v[172:175], v12 offset:16384
    v_mfma_f32_16x16x32_bf16 v[60:63], v[208:211], a[164:167], v[60:63]
    s_add_u32 s46, s42, 0x401000
    ds_read_b128 v[176:179], v12 offset:25600
    v_mfma_f32_16x16x32_bf16 v[60:63], v[212:215], a[172:175], v[60:63]
    s_add_u32 s47, s47, s54
    ds_read_b128 v[180:183], v12 offset:34816
    v_mfma_f32_16x16x32_bf16 v[56:59], v[212:215], a[168:171], v[56:59]
    buffer_load_dwordx4 a[216:219], v1, s[4:7], s41 offen offset:0 sc1
    v_mfma_f32_16x16x32_bf16 v[56:59], v[208:211], a[160:163], v[56:59]
    v_mfma_f32_16x16x32_bf16 v[56:59], v[204:207], a[152:155], v[56:59]
    buffer_load_dwordx4 a[220:223], v1, s[4:7], s46 offen offset:1024 sc1
    v_mfma_f32_16x16x32_bf16 v[56:59], v[200:203], a[144:147], v[56:59]
    s_waitcnt lgkmcnt(4)
    v_mfma_f32_16x16x32_bf16 v[64:67], v[216:219], a[144:147], v[64:67]
    s_add_u32 s41, s42, 0x402000
    ds_read_b128 v[200:203], v12 offset:8192
    v_mfma_f32_16x16x32_bf16 v[64:67], v[220:223], a[152:155], v[64:67]
    ds_read_b128 v[204:207], v12 offset:17408
    v_mfma_f32_16x16x32_bf16 v[64:67], v[224:227], a[160:163], v[64:67]
    s_add_u32 s46, s42, 0x402000
    ds_read_b128 v[208:211], v12 offset:26624
    v_mfma_f32_16x16x32_bf16 v[64:67], v[228:231], a[168:171], v[64:67]
    s_lshl_b32 s54, s47, 12
    ds_read_b128 v[212:215], v12 offset:35840
    v_mfma_f32_16x16x32_bf16 v[68:71], v[228:231], a[172:175], v[68:71]
    buffer_load_dwordx4 a[224:227], v1, s[4:7], s41 offen offset:0 sc1
    v_mfma_f32_16x16x32_bf16 v[68:71], v[224:227], a[164:167], v[68:71]
    v_mfma_f32_16x16x32_bf16 v[68:71], v[220:223], a[156:159], v[68:71]
    buffer_load_dwordx4 a[228:231], v1, s[4:7], s46 offen offset:1024 sc1
    v_mfma_f32_16x16x32_bf16 v[68:71], v[216:219], a[148:151], v[68:71]
    s_waitcnt vmcnt(17) lgkmcnt(4)
    s_barrier
    v_mfma_f32_16x16x32_bf16 v[76:79], v[168:171], a[148:151], v[76:79]
    s_add_u32 s41, s40, s48
    ds_read_b128 v[216:219], v13 offset:0
    v_mfma_f32_16x16x32_bf16 v[76:79], v[172:175], a[156:159], v[76:79]
    s_add_u32 m0, s73, 0x2000
    ds_read_b128 v[220:223], v13 offset:9216
    v_mfma_f32_16x16x32_bf16 v[76:79], v[176:179], a[164:167], v[76:79]
    s_add_u32 s46, s42, 0x403000
    ds_read_b128 v[224:227], v13 offset:18432
    v_mfma_f32_16x16x32_bf16 v[76:79], v[180:183], a[172:175], v[76:79]
    s_mul_i32 s48, s47, 36864
    ds_read_b128 v[228:231], v13 offset:27648
    v_mfma_f32_16x16x32_bf16 v[72:75], v[180:183], a[168:171], v[72:75]
    buffer_load_dwordx4 v1, s[88:91], s41 offen sc1 lds
    v_mfma_f32_16x16x32_bf16 v[72:75], v[176:179], a[160:163], v[72:75]
    v_mfma_f32_16x16x32_bf16 v[72:75], v[172:175], a[152:155], v[72:75]
    buffer_load_dwordx4 a[232:235], v1, s[4:7], s46 offen offset:0 sc1
    v_mfma_f32_16x16x32_bf16 v[72:75], v[168:171], a[144:147], v[72:75]
    s_waitcnt lgkmcnt(4)
    v_mfma_f32_16x16x32_bf16 v[80:83], v[200:203], a[144:147], v[80:83]
    s_add_u32 s41, s42, 0x403000
    ds_read_b128 v[168:171], v13 offset:1024
    v_mfma_f32_16x16x32_bf16 v[80:83], v[204:207], a[152:155], v[80:83]
    ds_read_b128 v[172:175], v13 offset:10240
    v_mfma_f32_16x16x32_bf16 v[80:83], v[208:211], a[160:163], v[80:83]
    ds_read_b128 v[176:179], v13 offset:19456
    v_mfma_f32_16x16x32_bf16 v[80:83], v[212:215], a[168:171], v[80:83]
    s_add_u32 s42, s43, s54
    ds_read_b128 v[180:183], v13 offset:28672
    v_mfma_f32_16x16x32_bf16 v[84:87], v[212:215], a[172:175], v[84:87]
    buffer_load_dwordx4 a[236:239], v1, s[4:7], s41 offen offset:1024 sc1
    v_mfma_f32_16x16x32_bf16 v[84:87], v[208:211], a[164:167], v[84:87]
    s_sub_u32 s53, s53, 1
    v_mfma_f32_16x16x32_bf16 v[84:87], v[204:207], a[156:159], v[84:87]
L_hop1_0:
    s_cbranch_execz L_hop1_4
    buffer_load_dword v8, v10, s[4:7], s81 offen sc1
    v_mfma_f32_16x16x32_bf16 v[84:87], v[200:203], a[148:151], v[84:87]
    s_waitcnt vmcnt(19) lgkmcnt(4)
    s_cmp_le_i32 s53, 2
    s_cbranch_scc1 L_k2_br1
    v_mfma_f32_16x16x32_bf16 v[16:19], v[216:219], a[176:179], v[16:19]
    s_add_u32 s41, s28, s48
    ds_read_b128 v[200:203], v13 offset:2048
    v_mfma_f32_16x16x32_bf16 v[16:19], v[220:223], a[184:187], v[16:19]
    s_add_u32 m0, s69, 0x0
    ds_read_b128 v[204:207], v13 offset:11264
    v_mfma_f32_16x16x32_bf16 v[16:19], v[224:227], a[192:195], v[16:19]
    s_add_u32 s46, s29, s48
    ds_read_b128 v[208:211], v13 offset:20480
    v_mfma_f32_16x16x32_bf16 v[16:19], v[228:231], a[200:203], v[16:19]
    s_add_u32 s47, s47, 4
    ds_read_b128 v[212:215], v13 offset:29696
    v_mfma_f32_16x16x32_bf16 v[20:23], v[228:231], a[204:207], v[20:23]
    buffer_load_dwordx4 v1, s[88:91], s41 offen sc1 lds
    v_mfma_f32_16x16x32_bf16 v[20:23], v[224:227], a[196:199], v[20:23]
    s_add_u32 m0, s69, 0x400
    v_mfma_f32_16x16x32_bf16 v[20:23], v[220:223], a[188:191], v[20:23]
    buffer_load_dwordx4 v1, s[88:91], s46 offen sc1 lds
    v_mfma_f32_16x16x32_bf16 v[20:23], v[216:219], a[180:183], v[20:23]
    s_waitcnt lgkmcnt(4)
    v_mfma_f32_16x16x32_bf16 v[28:31], v[168:171], a[180:183], v[28:31]
    s_add_u32 s41, s30, s48
    ds_read_b128 v[216:219], v13 offset:3072
    v_mfma_f32_16x16x32_bf16 v[28:31], v[172:175], a[188:191], v[28:31]
    s_add_u32 m0, s69, 0x800
    ds_read_b128 v[220:223], v13 offset:12288
    v_mfma_f32_16x16x32_bf16 v[28:31], v[176:179], a[196:199], v[28:31]
    s_add_u32 s46, s31, s48
    ds_read_b128 v[224:227], v13 offset:21504
    v_mfma_f32_16x16x32_bf16 v[28:31], v[180:183], a[204:207], v[28:31]
    s_and_b32 s54, s47, 31
    ds_read_b128 v[228:231], v13 offset:30720
    v_mfma_f32_16x16x32_bf16 v[24:27], v[180:183], a[200:203], v[24:27]
    buffer_load_dwordx4 v1, s[88:91], s41 offen sc1 lds
    v_mfma_f32_16x16x32_bf16 v[24:27], v[176:179], a[192:195], v[24:27]
    s_add_u32 m0, s69, 0xc00
    v_mfma_f32_16x16x32_bf16 v[24:27], v[172:175], a[184:187], v[24:27]
    buffer_load_dwordx4 v1, s[88:91], s46 offen sc1 lds
    v_mfma_f32_16x16x32_bf16 v[24:27], v[168:171], a[176:179], v[24:27]
    s_waitcnt lgkmcnt(4)
    v_mfma_f32_16x16x32_bf16 v[32:35], v[200:203], a[176:179], v[32:35]
    s_add_u32 s41, s36, s48
    ds_read_b128 v[168:171], v13 offset:4096
    v_mfma_f32_16x16x32_bf16 v[32:35], v[204:207], a[184:187], v[32:35]
    s_add_u32 m0, s69, 0x1000
    ds_read_b128 v[172:175], v13 offset:13312
    v_mfma_f32_16x16x32_bf16 v[32:35], v[208:211], a[192:195], v[32:35]
    s_add_u32 s46, s37, s48
    ds_read_b128 v[176:179], v13 offset:22528
    v_mfma_f32_16x16x32_bf16 v[32:35], v[212:215], a[200:203], v[32:35]
    s_sub_u32 s54, s54, 1
    ds_read_b128 v[180:183], v13 offset:31744
    v_mfma_f32_16x16x32_bf16 v[36:39], v[212:215], a[204:207], v[36:39]
    buffer_load_dwordx4 v1, s[88:91], s41 offen sc1 lds
    v_mfma_f32_16x16x32_bf16 v[36:39], v[208:211], a[196:199], v[36:39]
    s_add_u32 m0, s69, 0x1400
    v_mfma_f32_16x16x32_bf16 v[36:39], v[204:207], a[188:191], v[36:39]
    buffer_load_dwordx4 v1, s[88:91], s46 offen sc1 lds
    v_mfma_f32_16x16x32_bf16 v[36:39], v[200:203], a[180:183], v[36:39]
    s_waitcnt lgkmcnt(4)
    v_mfma_f32_16x16x32_bf16 v[44:47], v[216:219], a[180:183], v[44:47]
    s_add_u32 s41, s38, s48
    ds_read_b128 v[200:203], v13 offset:5120
    v_mfma_f32_16x16x32_bf16 v[44:47], v[220:223], a[188:191], v[44:47]
    s_add_u32 m0, s69, 0x1800
    ds_read_b128 v[204:207], v13 offset:14336
    v_mfma_f32_16x16x32_bf16 v[44:47], v[224:227], a[196:199], v[44:47]
    s_add_u32 s46, s39, s48
    ds_read_b128 v[208:211], v13 offset:23552
    v_mfma_f32_16x16x32_bf16 v[44:47], v[228:231], a[204:207], v[44:47]
    s_lshr_b32 s54, s54, 31
    ds_read_b128 v[212:215], v13 offset:32768
    v_mfma_f32_16x16x32_bf16 v[40:43], v[228:231], a[200:203], v[40:43]
    buffer_load_dwordx4 v1, s[88:91], s41 offen sc1 lds
    v_mfma_f32_16x16x32_bf16 v[40:43], v[224:227], a[192:195], v[40:43]
    s_add_u32 m0, s69, 0x1c00
    v_mfma_f32_16x16x32_bf16 v[40:43], v[220:223], a[184:187], v[40:43]
    buffer_load_dwordx4 v1, s[88:91], s46 offen sc1 lds
    v_mfma_f32_16x16x32_bf16 v[40:43], v[216:219], a[176:179], v[40:43]
    s_waitcnt lgkmcnt(4)
    v_mfma_f32_16x16x32_bf16 v[48:51], v[168:171], a[176:179], v[48:51]
    s_add_u32 s41, s42, 0x400000
    ds_read_b128 v[216:219], v13 offset:6144
    v_mfma_f32_16x16x32_bf16 v[48:51], v[172:175], a[184:187], v[48:51]
    ds_read_b128 v[220:223], v13 offset:15360
    v_mfma_f32_16x16x32_bf16 v[48:51], v[176:179], a[192:195], v[48:51]
    s_add_u32 s46, s42, 0x400000
    ds_read_b128 v[224:227], v13 offset:24576
    v_mfma_f32_16x16x32_bf16 v[48:51], v[180:183], a[200:203], v[48:51]
    s_mul_i32 s54, s54, 12
    ds_read_b128 v[228:231], v13 offset:33792
    v_mfma_f32_16x16x32_bf16 v[52:55], v[180:183], a[204:207], v[52:55]
    buffer_load_dwordx4 a[144:147], v1, s[4:7], s41 offen offset:0 sc1
    v_mfma_f32_16x16x32_bf16 v[52:55], v[176:179], a[196:199], v[52:55]
    v_mfma_f32_16x16x32_bf16 v[52:55], v[172:175], a[188:191], v[52:55]
    buffer_load_dwordx4 a[148:151], v1, s[4:7], s46 offen offset:1024 sc1
    v_mfma_f32_16x16x32_bf16 v[52:55], v[168:171], a[180:183], v[52:55]
    s_waitcnt lgkmcnt(4)
    v_mfma_f32_16x16x32_bf16 v[60:63], v[200:203], a[180:183], v[60:63]
    s_add_u32 s41, s42, 0x401000
    ds_read_b128 v[168:171], v13 offset:7168
    v_mfma_f32_16x16x32_bf16 v[60:63], v[204:207], a[188:191], v[60:63]
    ds_read_b128 v[172:175], v13 offset:16384
    v_mfma_f32_16x16x32_bf16 v[60:63], v[208:211], a[196:199], v[60:63]
    s_add_u32 s46, s42, 0x401000
    ds_read_b128 v[176:179], v13 offset:25600
    v_mfma_f32_16x16x32_bf16 v[60:63], v[212:215], a[204:207], v[60:63]
    s_add_u32 s47, s47, s54
    ds_read_b128 v[180:183], v13 offset:34816
    v_mfma_f32_16x16x32_bf16 v[56:59], v[212:215], a[200:203], v[56:59]
    buffer_load_dwordx4 a[152:155], v1, s[4:7], s41 offen offset:0 sc1
    v_mfma_f32_16x16x32_bf16 v[56:59], v[208:211], a[192:195], v[56:59]
    v_mfma_f32_16x16x32_bf16 v[56:59], v[204:207], a[184:187], v[56:59]
    buffer_load_dwordx4 a[156:159], v1, s[4:7], s46 offen offset:1024 sc1
    v_mfma_f32_16x16x32_bf16 v[56:59], v[200:203], a[176:179], v[56:59]
    s_waitcnt lgkmcnt(4)
    v_mfma_f32_16x16x32_bf16 v[64:67], v[216:219], a[176:179], v[64:67]
    s_add_u32 s41, s42, 0x402000
    ds_read_b128 v[200:203], v13 offset:8192
    v_mfma_f32_16x16x32_bf16 v[64:67], v[220:223], a[184:187], v[64:67]
    ds_read_b128 v[204:207], v13 offset:17408
    v_mfma_f32_16x16x32_bf16 v[64:67], v[224:227], a[192:195], v[64:67]
    s_add_u32 s46, s42, 0x402000
    ds_read_b128 v[208:211], v13 offset:26624
    v_mfma_f32_16x16x32_bf16 v[64:67], v[228:231], a[200:203], v[64:67]
    s_lshl_b32 s54, s47, 12
    ds_read_b128 v[212:215], v13 offset:35840
    v_mfma_f32_16x16x32_bf16 v[68:71], v[228:231], a[204:207], v[68:71]
    buffer_load_dwordx4 a[160:163], v1, s[4:7], s41 offen offset:0 sc1
    v_mfma_f32_16x16x32_bf16 v[68:71], v[224:227], a[196:199], v[68:71]
    v_mfma_f32_16x16x32_bf16 v[68:71], v[220:223], a[188:191], v[68:71]
    buffer_load_dwordx4 a[164:167], v1, s[4:7], s46 offen offset:1024 sc1
    v_mfma_f32_16x16x32_bf16 v[68:71], v[216:219], a[180:183], v[68:71]
    s_waitcnt vmcnt(17) lgkmcnt(4)
    s_barrier
    v_mfma_f32_16x16x32_bf16 v[76:79], v[168:171], a[180:183], v[76:79]
    s_add_u32 s41, s40, s48
    ds_read_b128 v[216:219], v14 offset:0
    v_mfma_f32_16x16x32_bf16 v[76:79], v[172:175], a[188:191], v[76:79]
    s_add_u32 m0, s69, 0x2000
    ds_read_b128 v[220:223], v14 offset:9216
    v_mfma_f32_16x16x32_bf16 v[76:79], v[176:179], a[196:199], v[76:79]
    s_add_u32 s46, s42, 0x403000
    ds_read_b128 v[224:227], v14 offset:18432
    v_mfma_f32_16x16x32_bf16 v[76:79], v[180:183], a[204:207], v[76:79]
    s_mul_i32 s48, s47, 36864
    ds_read_b128 v[228:231], v14 offset:27648
    v_mfma_f32_16x16x32_bf16 v[72:75], v[180:183], a[200:203], v[72:75]
    buffer_load_dwordx4 v1, s[88:91], s41 offen sc1 lds
    v_mfma_f32_16x16x32_bf16 v[72:75], v[176:179], a[192:195], v[72:75]
    v_mfma_f32_16x16x32_bf16 v[72:75], v[172:175], a[184:187], v[72:75]
    buffer_load_dwordx4 a[168:171], v1, s[4:7], s46 offen offset:0 sc1
    v_mfma_f32_16x16x32_bf16 v[72:75], v[168:171], a[176:179], v[72:75]
    s_waitcnt lgkmcnt(4)
    v_mfma_f32_16x16x32_bf16 v[80:83], v[200:203], a[176:179], v[80:83]
    s_add_u32 s41, s42, 0x403000
    ds_read_b128 v[168:171], v14 offset:1024
    v_mfma_f32_16x16x32_bf16 v[80:83], v[204:207], a[184:187], v[80:83]
    ds_read_b128 v[172:175], v14 offset:10240
    v_mfma_f32_16x16x32_bf16 v[80:83], v[208:211], a[192:195], v[80:83]
    ds_read_b128 v[176:179], v14 offset:19456
    v_mfma_f32_16x16x32_bf16 v[80:83], v[212:215], a[200:203], v[80:83]
    s_add_u32 s42, s43, s54
    ds_read_b128 v[180:183], v14 offset:28672
    v_mfma_f32_16x16x32_bf16 v[84:87], v[212:215], a[204:207], v[84:87]
    buffer_load_dwordx4 a[172:175], v1, s[4:7], s41 offen offset:1024 sc1
    v_mfma_f32_16x16x32_bf16 v[84:87], v[208:211], a[196:199], v[84:87]
    s_sub_u32 s53, s53, 1
    v_mfma_f32_16x16x32_bf16 v[84:87], v[204:207], a[188:191], v[84:87]
    buffer_load_dword v8, v10, s[4:7], s81 offen sc1
    v_mfma_f32_16x16x32_bf16 v[84:87], v[200:203], a[180:183], v[84:87]
    s_waitcnt vmcnt(19) lgkmcnt(4)
    s_cmp_le_i32 s53, 2
    s_cbranch_scc1 L_k2_br2
    v_mfma_f32_16x16x32_bf16 v[16:19], v[216:219], a[208:211], v[16:19]
    s_add_u32 s41, s28, s48
    ds_read_b128 v[200:203], v14 offset:2048
    v_mfma_f32_16x16x32_bf16 v[16:19], v[220:223], a[216:219], v[16:19]
    s_add_u32 m0, s72, 0x0
    ds_read_b128 v[204:207], v14 offset:11264
    v_mfma_f32_16x16x32_bf16 v[16:19], v[224:227], a[224:227], v[16:19]
    s_add_u32 s46, s29, s48
    ds_read_b128 v[208:211], v14 offset:20480
    v_mfma_f32_16x16x32_bf16 v[16:19], v[228:231], a[232:235], v[16:19]
    s_add_u32 s47, s47, 4
    ds_read_b128 v[212:215], v14 offset:29696
    v_mfma_f32_16x16x32_bf16 v[20:23], v[228:231], a[236:239], v[20:23]
    buffer_load_dwordx4 v1, s[88:91], s41 offen sc1 lds
    v_mfma_f32_16x16x32_bf16 v[20:23], v[224:227], a[228:231], v[20:23]
    s_add_u32 m0, s72, 0x400
    v_mfma_f32_16x16x32_bf16 v[20:23], v[220:223], a[220:223], v[20:23]
    buffer_load_dwordx4 v1, s[88:91], s46 offen sc1 lds
    v_mfma_f32_16x16x32_bf16 v[20:23], v[216:219], a[212:215], v[20:23]
    s_waitcnt lgkmcnt(4)
    v_mfma_f32_16x16x32_bf16 v[28:31], v[168:171], a[212:215], v[28:31]
    s_add_u32 s41, s30, s48
    ds_read_b128 v[216:219], v14 offset:3072
    v_mfma_f32_16x16x32_bf16 v[28:31], v[172:175], a[220:223], v[28:31]
    s_add_u32 m0, s72, 0x800
    ds_read_b128 v[220:223], v14 offset:12288
    v_mfma_f32_16x16x32_bf16 v[28:31], v[176:179], a[228:231], v[28:31]
    s_add_u32 s46, s31, s48
    ds_read_b128 v[224:227], v14 offset:21504
    v_mfma_f32_16x16x32_bf16 v[28:31], v[180:183], a[236:239], v[28:31]
    s_and_b32 s54, s47, 31
    ds_read_b128 v[228:231], v14 offset:30720
    v_mfma_f32_16x16x32_bf16 v[24:27], v[180:183], a[232:235], v[24:27]
    buffer_load_dwordx4 v1, s[88:91], s41 offen sc1 lds
    v_mfma_f32_16x16x32_bf16 v[24:27], v[176:179], a[224:227], v[24:27]
    s_add_u32 m0, s72, 0xc00
    v_mfma_f32_16x16x32_bf16 v[24:27], v[172:175], a[216:219], v[24:27]
    buffer_load_dwordx4 v1, s[88:91], s46 offen sc1 lds
    v_mfma_f32_16x16x32_bf16 v[24:27], v[168:171], a[208:211], v[24:27]
    s_waitcnt lgkmcnt(4)
    v_mfma_f32_16x16x32_bf16 v[32:35], v[200:203], a[208:211], v[32:35]
    s_add_u32 s41, s36, s48
    ds_read_b128 v[168:171], v14 offset:4096
    v_mfma_f32_16x16x32_bf16 v[32:35], v[204:207], a[216:219], v[32:35]
    s_add_u32 m0, s72, 0x1000
    ds_read_b128 v[172:175], v14 offset:13312
    v_mfma_f32_16x16x32_bf16 v[32:35], v[208:211], a[224:227], v[32:35]
    s_add_u32 s46, s37, s48
    ds_read_b128 v[176:179], v14 offset:22528
    v_mfma_f32_16x16x32_bf16 v[32:35], v[212:215], a[232:235], v[32:35]
    s_sub_u32 s54, s54, 1
    ds_read_b128 v[180:183], v14 offset:31744
    v_mfma_f32_16x16x32_bf16 v[36:39], v[212:215], a[236:239], v[36:39]
    buffer_load_dwordx4 v1, s[88:91], s41 offen sc1 lds
    v_mfma_f32_16x16x32_bf16 v[36:39], v[208:211], a[228:231], v[36:39]
    s_add_u32 m0, s72, 0x1400
    v_mfma_f32_16x16x32_bf16 v[36:39], v[204:207], a[220:223], v[36:39]
    buffer_load_dwordx4 v1, s[88:91], s46 offen sc1 lds
    v_mfma_f32_16x16x32_bf16 v[36:39], v[200:203], a[212:215], v[36:39]
    s_waitcnt lgkmcnt(4)
    v_mfma_f32_16x16x32_bf16 v[44:47], v[216:219], a[212:215], v[44:47]
    s_add_u32 s41, s38, s48
    ds_read_b128 v[200:203], v14 offset:5120
    v_mfma_f32_16x16x32_bf16 v[44:47], v[220:223], a[220:223], v[44:47]
    s_add_u32 m0, s72, 0x1800
    ds_read_b128 v[204:207], v14 offset:14336
    v_mfma_f32_16x16x32_bf16 v[44:47], v[224:227], a[228:231], v[44:47]
    s_add_u32 s46, s39, s48
    ds_read_b128 v[208:211], v14 offset:23552
    v_mfma_f32_16x16x32_bf16 v[44:47], v[228:231], a[236:239], v[44:47]
    s_lshr_b32 s54, s54, 31
    ds_read_b128 v[212:215], v14 offset:32768
    v_mfma_f32_16x16x32_bf16 v[40:43], v[228:231], a[232:235], v[40:43]
    buffer_load_dwordx4 v1, s[88:91], s41 offen sc1 lds
    v_mfma_f32_16x16x32_bf16 v[40:43], v[224:227], a[224:227], v[40:43]
    s_add_u32 m0, s72, 0x1c00
    v_mfma_f32_16x16x32_bf16 v[40:43], v[220:223], a[216:219], v[40:43]
    buffer_load_dwordx4 v1, s[88:91], s46 offen sc1 lds
    v_mfma_f32_16x16x32_bf16 v[40:43], v[216:219], a[208:211], v[40:43]
    s_waitcnt lgkmcnt(4)
    v_mfma_f32_16x16x32_bf16 v[48:51], v[168:171], a[208:211], v[48:51]
    s_add_u32 s41, s42, 0x400000
    ds_read_b128 v[216:219], v14 offset:6144
    v_mfma_f32_16x16x32_bf16 v[48:51], v[172:175], a[216:219], v[48:51]
    ds_read_b128 v[220:223], v14 offset:15360
    v_mfma_f32_16x16x32_bf16 v[48:51], v[176:179], a[224:227], v[48:51]
    s_add_u32 s46, s42, 0x400000
    ds_read_b128 v[224:227], v14 offset:24576
    v_mfma_f32_16x16x32_bf16 v[48:51], v[180:183], a[232:235], v[48:51]
    s_mul_i32 s54, s54, 12
    ds_read_b128 v[228:231], v14 offset:33792
    v_mfma_f32_16x16x32_bf16 v[52:55], v[180:183], a[236:239], v[52:55]
    buffer_load_dwordx4 a[176:179], v1, s[4:7], s41 offen offset:0 sc1
    v_mfma_f32_16x16x32_bf16 v[52:55], v[176:179], a[228:231], v[52:55]
    v_mfma_f32_16x16x32_bf16 v[52:55], v[172:175], a[220:223], v[52:55]
    buffer_load_dwordx4 a[180:183], v1, s[4:7], s46 offen offset:1024 sc1
    v_mfma_f32_16x16x32_bf16 v[52:55], v[168:171], a[212:215], v[52:55]
    s_waitcnt lgkmcnt(4)
    v_mfma_f32_16x16x32_bf16 v[60:63], v[200:203], a[212:215], v[60:63]
    s_add_u32 s41, s42, 0x401000
    ds_read_b128 v[168:171], v14 offset:7168
    v_mfma_f32_16x16x32_bf16 v[60:63], v[204:207], a[220:223], v[60:63]
    ds_read_b128 v[172:175], v14 offset:16384
    v_mfma_f32_16x16x32_bf16 v[60:63], v[208:211], a[228:231], v[60:63]
    s_add_u32 s46, s42, 0x401000
    ds_read_b128 v[176:179], v14 offset:25600
    v_mfma_f32_16x16x32_bf16 v[60:63], v[212:215], a[236:239], v[60:63]
    s_add_u32 s47, s47, s54
    ds_read_b128 v[180:183], v14 offset:34816
    v_mfma_f32_16x16x32_bf16 v[56:59], v[212:215], a[232:235], v[56:59]
    buffer_load_dwordx4 a[184:187], v1, s[4:7], s41 offen offset:0 sc1
    v_mfma_f32_16x16x32_bf16 v[56:59], v[208:211], a[224:227], v[56:59]
    v_mfma_f32_16x16x32_bf16 v[56:59], v[204:207], a[216:219], v[56:59]
    buffer_load_dwordx4 a[188:191], v1, s[4:7], s46 offen offset:1024 sc1
    v_mfma_f32_16x16x32_bf16 v[56:59], v[200:203], a[208:211], v[56:59]
    s_waitcnt lgkmcnt(4)
    v_mfma_f32_16x16x32_bf16 v[64:67], v[216:219], a[208:211], v[64:67]
    s_add_u32 s41, s42, 0x402000
    ds_read_b128 v[200:203], v14 offset:8192
    v_mfma_f32_16x16x32_bf16 v[64:67], v[220:223], a[216:219], v[64:67]
    ds_read_b128 v[204:207], v14 offset:17408
    v_mfma_f32_16x16x32_bf16 v[64:67], v[224:227], a[224:227], v[64:67]
    s_add_u32 s46, s42, 0x402000
    ds_read_b128 v[208:211], v14 offset:26624
    v_mfma_f32_16x16x32_bf16 v[64:67], v[228:231], a[232:235], v[64:67]
    s_lshl_b32 s54, s47, 12
    ds_read_b128 v[212:215], v14 offset:35840
    v_mfma_f32_16x16x32_bf16 v[68:71], v[228:231], a[236:239], v[68:71]
    buffer_load_dwordx4 a[192:195], v1, s[4:7], s41 offen offset:0 sc1
    v_mfma_f32_16x16x32_bf16 v[68:71], v[224:227], a[228:231], v[68:71]
    v_mfma_f32_16x16x32_bf16 v[68:71], v[220:223], a[220:223], v[68:71]
    buffer_load_dwordx4 a[196:199], v1, s[4:7], s46 offen offset:1024 sc1
    v_mfma_f32_16x16x32_bf16 v[68:71], v[216:219], a[212:215], v[68:71]
    s_waitcnt vmcnt(17) lgkmcnt(4)
    s_barrier
    v_mfma_f32_16x16x32_bf16 v[76:79], v[168:171], a[212:215], v[76:79]
    s_add_u32 s41, s40, s48
    ds_read_b128 v[216:219], v12 offset:0
    v_mfma_f32_16x16x32_bf16 v[76:79], v[172:175], a[220:223], v[76:79]
    s_add_u32 m0, s72, 0x2000
    ds_read_b128 v[220:223], v12 offset:9216
    v_mfma_f32_16x16x32_bf16 v[76:79], v[176:179], a[228:231], v[76:79]
    s_add_u32 s46, s42, 0x403000
    ds_read_b128 v[224:227], v12 offset:18432
    v_mfma_f32_16x16x32_bf16 v[76:79], v[180:183], a[236:239], v[76:79]
    s_mul_i32 s48, s47, 36864
    ds_read_b128 v[228:231], v12 offset:27648
    v_mfma_f32_16x16x32_bf16 v[72:75], v[180:183], a[232:235], v[72:75]
    buffer_load_dwordx4 v1, s[88:91], s41 offen sc1 lds
    v_mfma_f32_16x16x32_bf16 v[72:75], v[176:179], a[224:227], v[72:75]
    v_mfma_f32_16x16x32_bf16 v[72:75], v[172:175], a[216:219], v[72:75]
    buffer_load_dwordx4 a[200:203], v1, s[4:7], s46 offen offset:0 sc1
    v_mfma_f32_16x16x32_bf16 v[72:75], v[168:171], a[208:211], v[72:75]
    s_waitcnt lgkmcnt(4)
    v_mfma_f32_16x16x32_bf16 v[80:83], v[200:203], a[208:211], v[80:83]
    s_add_u32 s41, s42, 0x403000
    ds_read_b128 v[168:171], v12 offset:1024
    v_mfma_f32_16x16x32_bf16 v[80:83], v[204:207], a[216:219], v[80:83]
    ds_read_b128 v[172:175], v12 offset:10240
    v_mfma_f32_16x16x32_bf16 v[80:83], v[208:211], a[224:227], v[80:83]
    ds_read_b128 v[176:179], v12 offset:19456
    v_mfma_f32_16x16x32_bf16 v[80:83], v[212:215], a[232:235], v[80:83]
    s_add_u32 s42, s43, s54
    ds_read_b128 v[180:183], v12 offset:28672
    v_mfma_f32_16x16x32_bf16 v[84:87], v[212:215], a[236:239], v[84:87]
    buffer_load_dwordx4 a[204:207], v1, s[4:7], s41 offen offset:1024 sc1
    v_mfma_f32_16x16x32_bf16 v[84:87], v[208:211], a[228:231], v[84:87]
    s_sub_u32 s53, s53, 1
    v_mfma_f32_16x16x32_bf16 v[84:87], v[204:207], a[220:223], v[84:87]
    buffer_load_dword v8, v10, s[4:7], s81 offen sc1
    v_mfma_f32_16x16x32_bf16 v[84:87], v[200:203], a[212:215], v[84:87]
    s_waitcnt vmcnt(19) lgkmcnt(4)
    s_cmp_le_i32 s53, 2
    s_cbranch_scc0 L_k2_flex
L_k2_br0:
L_hop1_1:
    s_cbranch_execz L_hop1_5
    v_mfma_f32_16x16x32_bf16 v[16:19], v[216:219], a[144:147], v[16:19]
    s_add_u32 s41, s28, 0x510000
    ds_read_b128 v[200:203], v12 offset:2048
    v_mfma_f32_16x16x32_bf16 v[16:19], v[220:223], a[152:155], v[16:19]
    s_add_u32 m0, s73, 0x0
    ds_read_b128 v[204:207], v12 offset:11264
    v_mfma_f32_16x16x32_bf16 v[16:19], v[224:227], a[160:163], v[16:19]
    s_add_u32 s46, s29, 0x510000
    ds_read_b128 v[208:211], v12 offset:20480
    v_mfma_f32_16x16x32_bf16 v[16:19], v[228:231], a[168:171], v[16:19]
    ds_read_b128 v[212:215], v12 offset:29696
    v_mfma_f32_16x16x32_bf16 v[20:23], v[228:231], a[172:175], v[20:23]
    buffer_load_dwordx4 v1, s[88:91], s41 offen sc1 lds
    v_mfma_f32_16x16x32_bf16 v[20:23], v[224:227], a[164:167], v[20:23]
    s_add_u32 m0, s73, 0x400
    v_mfma_f32_16x16x32_bf16 v[20:23], v[220:223], a[156:159], v[20:23]
    buffer_load_dwordx4 v1, s[88:91], s46 offen sc1 lds
    v_mfma_f32_16x16x32_bf16 v[20:23], v[216:219], a[148:151], v[20:23]
    s_waitcnt lgkmcnt(4)
    v_mfma_f32_16x16x32_bf16 v[28:31], v[168:171], a[148:151], v[28:31]
    s_add_u32 s41, s30, 0x510000
    ds_read_b128 v[216:219], v12 offset:3072
    v_mfma_f32_16x16x32_bf16 v[28:31], v[172:175], a[156:159], v[28:31]
    s_add_u32 m0, s73, 0x800
    ds_read_b128 v[220:223], v12 offset:12288
    v_mfma_f32_16x16x32_bf16 v[28:31], v[176:179], a[164:167], v[28:31]
    s_add_u32 s46, s31, 0x510000
    ds_read_b128 v[224:227], v12 offset:21504
    v_mfma_f32_16x16x32_bf16 v[28:31], v[180:183], a[172:175], v[28:31]
    ds_read_b128 v[228:231], v12 offset:30720
    v_mfma_f32_16x16x32_bf16 v[24:27], v[180:183], a[168:171], v[24:27]
    buffer_load_dwordx4 v1, s[88:91], s41 offen sc1 lds
    v_mfma_f32_16x16x32_bf16 v[24:27], v[176:179], a[160:163], v[24:27]
    s_add_u32 m0, s73, 0xc00
    v_mfma_f32_16x16x32_bf16 v[24:27], v[172:175], a[152:155], v[24:27]
    buffer_load_dwordx4 v1, s[88:91], s46 offen sc1 lds
    v_mfma_f32_16x16x32_bf16 v[24:27], v[168:171], a[144:147], v[24:27]
    s_waitcnt lgkmcnt(4)
    v_mfma_f32_16x16x32_bf16 v[32:35], v[200:203], a[144:147], v[32:35]
    s_add_u32 s41, s36, 0x510000
    ds_read_b128 v[168:171], v12 offset:4096
    v_mfma_f32_16x16x32_bf16 v[32:35], v[204:207], a[152:155], v[32:35]
    s_add_u32 m0, s73, 0x1000
    ds_read_b128 v[172:175], v12 offset:13312
    v_mfma_f32_16x16x32_bf16 v[32:35], v[208:211], a[160:163], v[32:35]
    s_add_u32 s46, s37, 0x510000
    ds_read_b128 v[176:179], v12 offset:22528
    v_mfma_f32_16x16x32_bf16 v[32:35], v[212:215], a[168:171], v[32:35]
    ds_read_b128 v[180:183], v12 offset:31744
    v_mfma_f32_16x16x32_bf16 v[36:39], v[212:215], a[172:175], v[36:39]
    buffer_load_dwordx4 v1, s[88:91], s41 offen sc1 lds
    v_mfma_f32_16x16x32_bf16 v[36:39], v[208:211], a[164:167], v[36:39]
    s_add_u32 m0, s73, 0x1400
    v_mfma_f32_16x16x32_bf16 v[36:39], v[204:207], a[156:159], v[36:39]
    buffer_load_dwordx4 v1, s[88:91], s46 offen sc1 lds
    v_mfma_f32_16x16x32_bf16 v[36:39], v[200:203], a[148:151], v[36:39]
    s_waitcnt lgkmcnt(4)
    v_mfma_f32_16x16x32_bf16 v[44:47], v[216:219], a[148:151], v[44:47]
    s_add_u32 s41, s38, 0x510000
    ds_read_b128 v[200:203], v12 offset:5120
    v_mfma_f32_16x16x32_bf16 v[44:47], v[220:223], a[156:159], v[44:47]
    s_add_u32 m0, s73, 0x1800
    ds_read_b128 v[204:207], v12 offset:14336
    v_mfma_f32_16x16x32_bf16 v[44:47], v[224:227], a[164:167], v[44:47]
    s_add_u32 s46, s39, 0x510000
    ds_read_b128 v[208:211], v12 offset:23552
    v_mfma_f32_16x16x32_bf16 v[44:47], v[228:231], a[172:175], v[44:47]
    s_waitcnt vmcnt(6)
    ds_read_b128 v[212:215], v12 offset:32768
    v_cmp_eq_u32 vcc, 0, v8
    v_mfma_f32_16x16x32_bf16 v[40:43], v[228:231], a[168:171], v[40:43]
    buffer_load_dwordx4 v1, s[88:91], s41 offen sc1 lds
    v_mfma_f32_16x16x32_bf16 v[40:43], v[224:227], a[160:163], v[40:43]
    s_add_u32 m0, s73, 0x1c00
    v_mfma_f32_16x16x32_bf16 v[40:43], v[220:223], a[152:155], v[40:43]
    buffer_load_dwordx4 v1, s[88:91], s46 offen sc1 lds
    v_mfma_f32_16x16x32_bf16 v[40:43], v[216:219], a[144:147], v[40:43]
    s_waitcnt lgkmcnt(4)
    s_cbranch_vccnz L_b0_spin
L_b0_ret:
    v_mfma_f32_16x16x32_bf16 v[48:51], v[168:171], a[144:147], v[48:51]
    s_add_u32 s41, s43, 0x1800000
    ds_read_b128 v[216:219], v12 offset:6144
    v_mfma_f32_16x16x32_bf16 v[48:51], v[172:175], a[152:155], v[48:51]
    ds_read_b128 v[220:223], v12 offset:15360
    v_mfma_f32_16x16x32_bf16 v[48:51], v[176:179], a[160:163], v[48:51]
    s_add_u32 s46, s43, 0x1800000
    ds_read_b128 v[224:227], v12 offset:24576
    v_mfma_f32_16x16x32_bf16 v[48:51], v[180:183], a[168:171], v[48:51]
    ds_read_b128 v[228:231], v12 offset:33792
    v_mfma_f32_16x16x32_bf16 v[52:55], v[180:183], a[172:175], v[52:55]
    buffer_load_dwordx4 a[32:35], v1, s[4:7], s41 offen offset:0 sc1
    v_mfma_f32_16x16x32_bf16 v[52:55], v[176:179], a[164:167], v[52:55]
    v_mfma_f32_16x16x32_bf16 v[52:55], v[172:175], a[156:159], v[52:55]
    buffer_load_dwordx4 a[36:39], v1, s[4:7], s46 offen offset:1024 sc1
    v_mfma_f32_16x16x32_bf16 v[52:55], v[168:171], a[148:151], v[52:55]
    s_waitcnt lgkmcnt(4)
    v_mfma_f32_16x16x32_bf16 v[60:63], v[200:203], a[148:151], v[60:63]
    s_add_u32 s41, s43, 0x1801000
    ds_read_b128 v[168:171], v12 offset:7168
    v_mfma_f32_16x16x32_bf16 v[60:63], v[204:207], a[156:159], v[60:63]
    ds_read_b128 v[172:175], v12 offset:16384
    v_mfma_f32_16x16x32_bf16 v[60:63], v[208:211], a[164:167], v[60:63]
    s_add_u32 s46, s43, 0x1801000
    ds_read_b128 v[176:179], v12 offset:25600
    v_mfma_f32_16x16x32_bf16 v[60:63], v[212:215], a[172:175], v[60:63]
    ds_read_b128 v[180:183], v12 offset:34816
    v_mfma_f32_16x16x32_bf16 v[56:59], v[212:215], a[168:171], v[56:59]
    buffer_load_dwordx4 a[40:43], v1, s[4:7], s41 offen offset:0 sc1
    v_mfma_f32_16x16x32_bf16 v[56:59], v[208:211], a[160:163], v[56:59]
    v_mfma_f32_16x16x32_bf16 v[56:59], v[204:207], a[152:155], v[56:59]
    buffer_load_dwordx4 a[44:47], v1, s[4:7], s46 offen offset:1024 sc1
    v_mfma_f32_16x16x32_bf16 v[56:59], v[200:203], a[144:147], v[56:59]
    s_waitcnt lgkmcnt(4)
    v_mfma_f32_16x16x32_bf16 v[64:67], v[216:219], a[144:147], v[64:67]
    s_add_u32 s41, s43, 0x1802000
    ds_read_b128 v[200:203], v12 offset:8192
    v_mfma_f32_16x16x32_bf16 v[64:67], v[220:223], a[152:155], v[64:67]
    ds_read_b128 v[204:207], v12 offset:17408
    v_mfma_f32_16x16x32_bf16 v[64:67], v[224:227], a[160:163], v[64:67]
    s_add_u32 s46, s43, 0x1802000
    ds_read_b128 v[208:211], v12 offset:26624
    v_mfma_f32_16x16x32_bf16 v[64:67], v[228:231], a[168:171], v[64:67]
    ds_read_b128 v[212:215], v12 offset:35840
    v_mfma_f32_16x16x32_bf16 v[68:71], v[228:231], a[172:175], v[68:71]
    buffer_load_dwordx4 a[48:51], v1, s[4:7], s41 offen offset:0 sc1
    v_mfma_f32_16x16x32_bf16 v[68:71], v[224:227], a[164:167], v[68:71]
    v_mfma_f32_16x16x32_bf16 v[68:71], v[220:223], a[156:159], v[68:71]
    buffer_load_dwordx4 a[52:55], v1, s[4:7], s46 offen offset:1024 sc1
    v_mfma_f32_16x16x32_bf16 v[68:71], v[216:219], a[148:151], v[68:71]
    s_waitcnt vmcnt(17) lgkmcnt(4)
    s_barrier
    v_mfma_f32_16x16x32_bf16 v[76:79], v[168:171], a[148:151], v[76:79]
    s_add_u32 s41, s40, 0x510000
    ds_read_b128 v[216:219], v13 offset:0
    v_mfma_f32_16x16x32_bf16 v[76:79], v[172:175], a[156:159], v[76:79]
    s_add_u32 m0, s73, 0x2000
    ds_read_b128 v[220:223], v13 offset:9216
    v_mfma_f32_16x16x32_bf16 v[76:79], v[176:179], a[164:167], v[76:79]
    s_add_u32 s46, s43, 0x1803000
    ds_read_b128 v[224:227], v13 offset:18432
    v_mfma_f32_16x16x32_bf16 v[76:79], v[180:183], a[172:175], v[76:79]
    ds_read_b128 v[228:231], v13 offset:27648
    v_mfma_f32_16x16x32_bf16 v[72:75], v[180:183], a[168:171], v[72:75]
    buffer_load_dwordx4 v1, s[88:91], s41 offen sc1 lds
    v_mfma_f32_16x16x32_bf16 v[72:75], v[176:179], a[160:163], v[72:75]
    v_mfma_f32_16x16x32_bf16 v[72:75], v[172:175], a[152:155], v[72:75]
    buffer_load_dwordx4 a[56:59], v1, s[4:7], s46 offen offset:0 sc1
    v_mfma_f32_16x16x32_bf16 v[72:75], v[168:171], a[144:147], v[72:75]
    s_waitcnt lgkmcnt(4)
    v_mfma_f32_16x16x32_bf16 v[80:83], v[200:203], a[144:147], v[80:83]
    s_add_u32 s41, s43, 0x1803000
    ds_read_b128 v[168:171], v13 offset:1024
    v_mfma_f32_16x16x32_bf16 v[80:83], v[204:207], a[152:155], v[80:83]
    ds_read_b128 v[172:175], v13 offset:10240
    v_mfma_f32_16x16x32_bf16 v[80:83], v[208:211], a[160:163], v[80:83]
    ds_read_b128 v[176:179], v13 offset:19456
    v_mfma_f32_16x16x32_bf16 v[80:83], v[212:215], a[168:171], v[80:83]
    ds_read_b128 v[180:183], v13 offset:28672
    v_mfma_f32_16x16x32_bf16 v[84:87], v[212:215], a[172:175], v[84:87]
    buffer_load_dwordx4 a[60:63], v1, s[4:7], s41 offen offset:1024 sc1
    v_mfma_f32_16x16x32_bf16 v[84:87], v[208:211], a[164:167], v[84:87]
    v_mfma_f32_16x16x32_bf16 v[84:87], v[204:207], a[156:159], v[84:87]
    v_mfma_f32_16x16x32_bf16 v[84:87], v[200:203], a[148:151], v[84:87]
    s_waitcnt vmcnt(18) lgkmcnt(4)
    v_mfma_f32_16x16x32_bf16 v[20:23], v[216:219], a[180:183], v[20:23]
    s_add_u32 s41, s28, 0x534000
    ds_read_b128 v[200:203], v13 offset:2048
    v_mfma_f32_16x16x32_bf16 v[20:23], v[220:223], a[188:191], v[20:23]
    s_add_u32 m0, s69, 0x0
    ds_read_b128 v[204:207], v13 offset:11264
    v_mfma_f32_16x16x32_bf16 v[20:23], v[224:227], a[196:199], v[20:23]
    s_add_u32 s46, s29, 0x534000
    ds_read_b128 v[208:211], v13 offset:20480
    v_mfma_f32_16x16x32_bf16 v[20:23], v[228:231], a[204:207], v[20:23]
    ds_read_b128 v[212:215], v13 offset:29696
    v_mfma_f32_16x16x32_bf16 v[16:19], v[228:231], a[200:203], v[16:19]
    buffer_load_dwordx4 v1, s[88:91], s41 offen sc1 lds
    v_mfma_f32_16x16x32_bf16 v[16:19], v[224:227], a[192:195], v[16:19]
    s_add_u32 m0, s69, 0x400
    v_mfma_f32_16x16x32_bf16 v[16:19], v[220:223], a[184:187], v[16:19]
    buffer_load_dwordx4 v1, s[88:91], s46 offen sc1 lds
    v_mfma_f32_16x16x32_bf16 v[16:19], v[216:219], a[176:179], v[16:19]
    s_waitcnt lgkmcnt(4)
    v_mfma_f32_16x16x32_bf16 v[24:27], v[168:171], a[176:179], v[24:27]
    s_add_u32 s41, s30, 0x534000
    ds_read_b128 v[216:219], v13 offset:3072
    v_mfma_f32_16x16x32_bf16 v[24:27], v[172:175], a[184:187], v[24:27]
    s_add_u32 m0, s69, 0x800
    ds_read_b128 v[220:223], v13 offset:12288
    v_mfma_f32_16x16x32_bf16 v[24:27], v[176:179], a[192:195], v[24:27]
    s_add_u32 s46, s31, 0x534000
    ds_read_b128 v[224:227], v13 offset:21504
    v_mfma_f32_16x16x32_bf16 v[24:27], v[180:183], a[200:203], v[24:27]
    ds_read_b128 v[228:231], v13 offset:30720
    v_mfma_f32_16x16x32_bf16 v[28:31], v[180:183], a[204:207], v[28:31]
    buffer_load_dwordx4 v1, s[88:91], s41 offen sc1 lds
    v_mfma_f32_16x16x32_bf16 v[28:31], v[176:179], a[196:199], v[28:31]
    s_add_u32 m0, s69, 0xc00
    v_mfma_f32_16x16x32_bf16 v[28:31], v[172:175], a[188:191], v[28:31]
L_hop1_2:
    s_cbranch_execz L_hop1_6
    buffer_load_dwordx4 v1, s[88:91], s46 offen sc1 lds
    v_mfma_f32_16x16x32_bf16 v[28:31], v[168:171], a[180:183], v[28:31]
    s_waitcnt lgkmcnt(4)
    v_mfma_f32_16x16x32_bf16 v[36:39], v[200:203], a[180:183], v[36:39]
    s_add_u32 s41, s36, 0x534000
    ds_read_b128 v[168:171], v13 offset:4096
    v_mfma_f32_16x16x32_bf16 v[36:39], v[204:207], a[188:191], v[36:39]
    s_add_u32 m0, s69, 0x1000
    ds_read_b128 v[172:175], v13 offset:13312
    v_mfma_f32_16x16x32_bf16 v[36:39], v[208:211], a[196:199], v[36:39]
    s_add_u32 s46, s37, 0x534000
    ds_read_b128 v[176:179], v13 offset:22528
    v_mfma_f32_16x16x32_bf16 v[36:39], v[212:215], a[204:207], v[36:39]
    ds_read_b128 v[180:183], v13 offset:31744
    v_mfma_f32_16x16x32_bf16 v[32:35], v[212:215], a[200:203], v[32:35]
    buffer_load_dwordx4 v1, s[88:91], s41 offen sc1 lds
    v_mfma_f32_16x16x32_bf16 v[32:35], v[208:211], a[192:195], v[32:35]
    s_add_u32 m0, s69, 0x1400
    v_mfma_f32_16x16x32_bf16 v[32:35], v[204:207], a[184:187], v[32:35]
    buffer_load_dwordx4 v1, s[88:91], s46 offen sc1 lds
    v_mfma_f32_16x16x32_bf16 v[32:35], v[200:203], a[176:179], v[32:35]
    s_waitcnt lgkmcnt(4)
    v_mfma_f32_16x16x32_bf16 v[40:43], v[216:219], a[176:179], v[40:43]
    s_add_u32 s41, s38, 0x534000
    ds_read_b128 v[200:203], v13 offset:5120
    v_mfma_f32_16x16x32_bf16 v[40:43], v[220:223], a[184:187], v[40:43]
    s_add_u32 m0, s69, 0x1800
    ds_read_b128 v[204:207], v13 offset:14336
    v_mfma_f32_16x16x32_bf16 v[40:43], v[224:227], a[192:195], v[40:43]
    s_add_u32 s46, s39, 0x534000
    ds_read_b128 v[208:211], v13 offset:23552
    v_mfma_f32_16x16x32_bf16 v[40:43], v[228:231], a[200:203], v[40:43]
    ds_read_b128 v[212:215], v13 offset:32768
    v_mfma_f32_16x16x32_bf16 v[44:47], v[228:231], a[204:207], v[44:47]
    buffer_load_dwordx4 v1, s[88:91], s41 offen sc1 lds
    v_mfma_f32_16x16x32_bf16 v[44:47], v[224:227], a[196:199], v[44:47]
    s_add_u32 m0, s69, 0x1c00
    v_mfma_f32_16x16x32_bf16 v[44:47], v[220:223], a[188:191], v[44:47]
    buffer_load_dwordx4 v1, s[88:91], s46 offen sc1 lds
    v_mfma_f32_16x16x32_bf16 v[44:47], v[216:219], a[180:183], v[44:47]
    s_waitcnt lgkmcnt(4)
    v_mfma_f32_16x16x32_bf16 v[52:55], v[168:171], a[180:183], v[52:55]
    s_add_u32 s41, s43, 0x1804000
    ds_read_b128 v[216:219], v13 offset:6144
    v_mfma_f32_16x16x32_bf16 v[52:55], v[172:175], a[188:191], v[52:55]
    ds_read_b128 v[220:223], v13 offset:15360
    v_mfma_f32_16x16x32_bf16 v[52:55], v[176:179], a[196:199], v[52:55]
    s_add_u32 s46, s43, 0x1804000
    ds_read_b128 v[224:227], v13 offset:24576
    v_mfma_f32_16x16x32_bf16 v[52:55], v[180:183], a[204:207], v[52:55]
    ds_read_b128 v[228:231], v13 offset:33792
    v_mfma_f32_16x16x32_bf16 v[48:51], v[180:183], a[200:203], v[48:51]
    buffer_load_dwordx4 a[64:67], v1, s[4:7], s41 offen offset:0 sc1
    v_mfma_f32_16x16x32_bf16 v[48:51], v[176:179], a[192:195], v[48:51]
    v_mfma_f32_16x16x32_bf16 v[48:51], v[172:175], a[184:187], v[48:51]
    buffer_load_dwordx4 a[68:71], v1, s[4:7], s46 offen offset:1024 sc1
    v_mfma_f32_16x16x32_bf16 v[48:51], v[168:171], a[176:179], v[48:51]
    s_waitcnt lgkmcnt(4)
    v_mfma_f32_16x16x32_bf16 v[56:59], v[200:203], a[176:179], v[56:59]
    s_add_u32 s41, s43, 0x1805000
    ds_read_b128 v[168:171], v13 offset:7168
    v_mfma_f32_16x16x32_bf16 v[56:59], v[204:207], a[184:187], v[56:59]
    ds_read_b128 v[172:175], v13 offset:16384
    v_mfma_f32_16x16x32_bf16 v[56:59], v[208:211], a[192:195], v[56:59]
    s_add_u32 s46, s43, 0x1805000
    ds_read_b128 v[176:179], v13 offset:25600
    v_mfma_f32_16x16x32_bf16 v[56:59], v[212:215], a[200:203], v[56:59]
    ds_read_b128 v[180:183], v13 offset:34816
    v_mfma_f32_16x16x32_bf16 v[60:63], v[212:215], a[204:207], v[60:63]
    buffer_load_dwordx4 a[72:75], v1, s[4:7], s41 offen offset:0 sc1
    v_mfma_f32_16x16x32_bf16 v[60:63], v[208:211], a[196:199], v[60:63]
    v_mfma_f32_16x16x32_bf16 v[60:63], v[204:207], a[188:191], v[60:63]
    buffer_load_dwordx4 a[76:79], v1, s[4:7], s46 offen offset:1024 sc1
    v_mfma_f32_16x16x32_bf16 v[60:63], v[200:203], a[180:183], v[60:63]
    s_waitcnt lgkmcnt(4)
    v_mfma_f32_16x16x32_bf16 v[68:71], v[216:219], a[180:183], v[68:71]
    s_add_u32 s41, s43, 0x1806000
    ds_read_b128 v[200:203], v13 offset:8192
    v_mfma_f32_16x16x32_bf16 v[68:71], v[220:223], a[188:191], v[68:71]
    ds_read_b128 v[204:207], v13 offset:17408
    v_mfma_f32_16x16x32_bf16 v[68:71], v[224:227], a[196:199], v[68:71]
    s_add_u32 s46, s43, 0x1806000
    ds_read_b128 v[208:211], v13 offset:26624
    v_mfma_f32_16x16x32_bf16 v[68:71], v[228:231], a[204:207], v[68:71]
    ds_read_b128 v[212:215], v13 offset:35840
    v_mfma_f32_16x16x32_bf16 v[64:67], v[228:231], a[200:203], v[64:67]
    buffer_load_dwordx4 a[80:83], v1, s[4:7], s41 offen offset:0 sc1
    v_mfma_f32_16x16x32_bf16 v[64:67], v[224:227], a[192:195], v[64:67]
    v_mfma_f32_16x16x32_bf16 v[64:67], v[220:223], a[184:187], v[64:67]
    buffer_load_dwordx4 a[84:87], v1, s[4:7], s46 offen offset:1024 sc1
    v_mfma_f32_16x16x32_bf16 v[64:67], v[216:219], a[176:179], v[64:67]
    s_waitcnt vmcnt(16) lgkmcnt(4)
    s_barrier
    v_mfma_f32_16x16x32_bf16 v[72:75], v[168:171], a[176:179], v[72:75]
    s_add_u32 s41, s40, 0x534000
    ds_read_b128 v[216:219], v14 offset:0
    v_mfma_f32_16x16x32_bf16 v[72:75], v[172:175], a[184:187], v[72:75]
    s_add_u32 m0, s69, 0x2000
    ds_read_b128 v[220:223], v14 offset:9216
    v_mfma_f32_16x16x32_bf16 v[72:75], v[176:179], a[192:195], v[72:75]
    s_add_u32 s46, s43, 0x1807000
    ds_read_b128 v[224:227], v14 offset:18432
    v_mfma_f32_16x16x32_bf16 v[72:75], v[180:183], a[200:203], v[72:75]
    ds_read_b128 v[228:231], v14 offset:27648
    v_mfma_f32_16x16x32_bf16 v[76:79], v[180:183], a[204:207], v[76:79]
    buffer_load_dwordx4 v1, s[88:91], s41 offen sc1 lds
    v_mfma_f32_16x16x32_bf16 v[76:79], v[176:179], a[196:199], v[76:79]
    v_mfma_f32_16x16x32_bf16 v[76:79], v[172:175], a[188:191], v[76:79]
    buffer_load_dwordx4 a[88:91], v1, s[4:7], s46 offen offset:0 sc1
    v_mfma_f32_16x16x32_bf16 v[76:79], v[168:171], a[180:183], v[76:79]
    s_waitcnt lgkmcnt(4)
    v_mfma_f32_16x16x32_bf16 v[84:87], v[200:203], a[180:183], v[84:87]
    s_add_u32 s41, s43, 0x1807000
    ds_read_b128 v[168:171], v14 offset:1024
    v_mfma_f32_16x16x32_bf16 v[84:87], v[204:207], a[188:191], v[84:87]
    s_mov_b32 s54, s73
    ds_read_b128 v[172:175], v14 offset:10240
    v_mfma_f32_16x16x32_bf16 v[84:87], v[208:211], a[196:199], v[84:87]
    s_mov_b32 s73, s72
    ds_read_b128 v[176:179], v14 offset:19456
    v_mfma_f32_16x16x32_bf16 v[84:87], v[212:215], a[204:207], v[84:87]
    s_mov_b32 s72, s69
    ds_read_b128 v[180:183], v14 offset:28672
    v_mfma_f32_16x16x32_bf16 v[80:83], v[212:215], a[200:203], v[80:83]
    buffer_load_dwordx4 a[92:95], v1, s[4:7], s41 offen offset:1024 sc1
    v_mfma_f32_16x16x32_bf16 v[80:83], v[208:211], a[192:195], v[80:83]
    s_mov_b32 s69, s54
    v_mov_b32 v15, v14
    v_mov_b32 v14, v13
    v_mfma_f32_16x16x32_bf16 v[80:83], v[204:207], a[184:187], v[80:83]
    v_mov_b32 v13, v12
    v_mov_b32 v12, v15
    v_mfma_f32_16x16x32_bf16 v[80:83], v[200:203], a[176:179], v[80:83]
    s_waitcnt vmcnt(17) lgkmcnt(4)
L_k2_rest:
L_hop1_3:
    s_cbranch_execz L_hop1_7
    v_mfma_f32_16x16x32_bf16 v[88:91], v[216:219], a[32:35], 0
    s_add_u32 s41, s28, 0x558000
    ds_read_b128 v[200:203], v12 offset:2048
    v_mfma_f32_16x16x32_bf16 v[88:91], v[220:223], a[40:43], v[88:91]
    s_add_u32 m0, s73, 0x0
    ds_read_b128 v[204:207], v12 offset:11264
    v_mfma_f32_16x16x32_bf16 v[88:91], v[224:227], a[48:51], v[88:91]
    s_add_u32 s46, s29, 0x558000
    ds_read_b128 v[208:211], v12 offset:20480
    v_mfma_f32_16x16x32_bf16 v[88:91], v[228:231], a[56:59], v[88:91]
    ds_read_b128 v[212:215], v12 offset:29696
    v_and_b32 v10, 12, v10
    v_mfma_f32_16x16x32_bf16 v[92:95], v[228:231], a[60:63], 0
    buffer_load_dwordx4 v1, s[88:91], s41 offen sc1 lds
    v_mfma_f32_16x16x32_bf16 v[92:95], v[224:227], a[52:55], v[92:95]
    s_add_u32 m0, s73, 0x400
    v_mfma_f32_16x16x32_bf16 v[92:95], v[220:223], a[44:47], v[92:95]
    buffer_load_dwordx4 v1, s[88:91], s46 offen sc1 lds
    v_mfma_f32_16x16x32_bf16 v[92:95], v[216:219], a[36:39], v[92:95]
    s_waitcnt lgkmcnt(4)
    v_cvt_pk_bf16_f32 v160, v32, v33
    v_cvt_pk_bf16_f32 v161, v34, v35
    v_mfma_f32_16x16x32_bf16 v[100:103], v[168:171], a[36:39], 0
    s_add_u32 s41, s30, 0x558000
    ds_read_b128 v[216:219], v12 offset:3072
    v_cvt_pk_bf16_f32 v162, v36, v37
    v_mfma_f32_16x16x32_bf16 v[100:103], v[172:175], a[44:47], v[100:103]
    s_add_u32 m0, s73, 0x800
    ds_read_b128 v[220:223], v12 offset:12288
    v_cvt_pk_bf16_f32 v163, v38, v39
    v_mfma_f32_16x16x32_bf16 v[100:103], v[176:179], a[52:55], v[100:103]
    s_add_u32 s46, s31, 0x558000
    ds_read_b128 v[224:227], v12 offset:21504
    v_bfe_u32 v248, v0, 2, 2
    v_mfma_f32_16x16x32_bf16 v[100:103], v[180:183], a[60:63], v[100:103]
    s_and_b32 s54, s32, 1
    ds_read_b128 v[228:231], v12 offset:30720
    v_lshrrev_b32 v249, 4, v0
    v_mfma_f32_16x16x32_bf16 v[96:99], v[180:183], a[56:59], 0
    buffer_load_dwordx4 v1, s[88:91], s41 offen sc1 lds
    v_mfma_f32_16x16x32_bf16 v[96:99], v[176:179], a[48:51], v[96:99]
    s_add_u32 m0, s73, 0xc00
    v_xor_b32 v248, v248, v249
    v_and_b32 v249, 1, v0
    v_mfma_f32_16x16x32_bf16 v[96:99], v[172:175], a[40:43], v[96:99]
    buffer_load_dwordx4 v1, s[88:91], s46 offen sc1 lds
    v_mfma_f32_16x16x32_bf16 v[96:99], v[168:171], a[32:35], v[96:99]
    s_waitcnt lgkmcnt(4)
    v_min_u32 v248, 1, v248
    v_lshlrev_b32 v249, 4, v249
    v_mfma_f32_16x16x32_bf16 v[104:107], v[200:203], a[32:35], 0
    s_add_u32 s41, s36, 0x558000
    ds_read_b128 v[168:171], v12 offset:4096
    v_sub_u32 v248, 1, v248
    v_mfma_f32_16x16x32_bf16 v[104:107], v[204:207], a[40:43], v[104:107]
    s_add_u32 m0, s73, 0x1000
    ds_read_b128 v[172:175], v12 offset:13312
    v_mul_u32_u24 v248, 0x3f80, v248
    v_mfma_f32_16x16x32_bf16 v[104:107], v[208:211], a[48:51], v[104:107]
    s_add_u32 s46, s37, 0x558000
    ds_read_b128 v[176:179], v12 offset:22528
    v_lshlrev_b32 v248, v249, v248
    v_mfma_f32_16x16x32_bf16 v[104:107], v[212:215], a[56:59], v[104:107]
    s_mul_i32 s54, s54, 9216
    ds_read_b128 v[180:183], v12 offset:31744
    v_bfe_i32 v249, v0, 1, 1
    v_mfma_f32_16x16x32_bf16 v[108:111], v[212:215], a[60:63], 0
    buffer_load_dwordx4 v1, s[88:91], s41 offen sc1 lds
    v_mfma_f32_16x16x32_bf16 v[108:111], v[208:211], a[52:55], v[108:111]
    s_add_u32 m0, s73, 0x1400
    v_and_b32 v5, 15, v0
    v_lshrrev_b32 v6, 5, v0
    v_mfma_f32_16x16x32_bf16 v[108:111], v[204:207], a[44:47], v[108:111]
    buffer_load_dwordx4 v1, s[88:91], s46 offen sc1 lds
    v_mfma_f32_16x16x32_bf16 v[108:111], v[200:203], a[36:39], v[108:111]
    s_waitcnt lgkmcnt(4)
    v_mul_u32_u24 v5, 1152, v5
    v_accvgpr_read_b32 v232, a240
    v_mfma_f32_16x16x32_bf16 v[116:119], v[216:219], a[36:39], 0
    s_add_u32 s41, s38, 0x558000
    ds_read_b128 v[200:203], v12 offset:5120
    v_lshl_add_u32 v5, v6, 4, v5
    v_mfma_f32_16x16x32_bf16 v[116:119], v[220:223], a[44:47], v[116:119]
    s_add_u32 m0, s73, 0x1800
    ds_read_b128 v[204:207], v12 offset:14336
    v_bfe_u32 v6, v0, 4, 1
    v_mfma_f32_16x16x32_bf16 v[116:119], v[224:227], a[52:55], v[116:119]
    s_add_u32 s46, s39, 0x558000
    ds_read_b128 v[208:211], v12 offset:23552
    v_mul_u32_u24 v15, 18432, v6
    v_mfma_f32_16x16x32_bf16 v[116:119], v[228:231], a[60:63], v[116:119]
    s_lshr_b32 s55, s32, 1
    ds_read_b128 v[212:215], v12 offset:32768
    v_add_u32 v15, v15, v5
    v_mfma_f32_16x16x32_bf16 v[112:115], v[228:231], a[56:59], 0
    buffer_load_dwordx4 v1, s[88:91], s41 offen sc1 lds
    v_mfma_f32_16x16x32_bf16 v[112:115], v[224:227], a[48:51], v[112:115]
    s_add_u32 m0, s73, 0x1c00
    v_lshl_add_u32 v5, v6, 5, v5
    v_accvgpr_read_b32 v233, a241
    v_mfma_f32_16x16x32_bf16 v[112:115], v[220:223], a[40:43], v[112:115]
    buffer_load_dwordx4 v1, s[88:91], s46 offen sc1 lds
    v_mfma_f32_16x16x32_bf16 v[112:115], v[216:219], a[32:35], v[112:115]
    s_waitcnt lgkmcnt(4)
    v_add_u32 v6, 18432, v5
    v_accvgpr_read_b32 v234, a242
    v_mfma_f32_16x16x32_bf16 v[120:123], v[168:171], a[32:35], 0
    s_add_u32 s41, s43, 0x1808000
    ds_read_b128 v[216:219], v12 offset:6144
    v_accvgpr_read_b32 v235, a243
    v_mfma_f32_16x16x32_bf16 v[120:123], v[172:175], a[40:43], v[120:123]
    ds_read_b128 v[220:223], v12 offset:15360
    v_accvgpr_read_b32 v236, a244
    v_mfma_f32_16x16x32_bf16 v[120:123], v[176:179], a[48:51], v[120:123]
    s_add_u32 s46, s43, 0x1808000
    ds_read_b128 v[224:227], v12 offset:24576
    v_cvt_pk_bf16_f32 v164, v40, v41
    v_mfma_f32_16x16x32_bf16 v[120:123], v[180:183], a[56:59], v[120:123]
    s_mul_i32 s55, s55, 55296
    ds_read_b128 v[228:231], v12 offset:33792
    v_cvt_pk_bf16_f32 v165, v42, v43
    v_mfma_f32_16x16x32_bf16 v[124:127], v[180:183], a[60:63], 0
    buffer_load_dwordx4 a[96:99], v1, s[4:7], s41 offen offset:0 sc1
    v_mfma_f32_16x16x32_bf16 v[124:127], v[176:179], a[52:55], v[124:127]
    buffer_store_dwordx4 v[160:163], v1, s[4:7], s62 offen offset:0 sc1
    v_mfma_f32_16x16x32_bf16 v[124:127], v[172:175], a[44:47], v[124:127]
    buffer_load_dwordx4 a[100:103], v1, s[4:7], s46 offen offset:1024 sc1
    v_mfma_f32_16x16x32_bf16 v[124:127], v[168:171], a[36:39], v[124:127]
    s_waitcnt lgkmcnt(4)
    v_cvt_pk_bf16_f32 v166, v44, v45
    v_cvt_pk_bf16_f32 v167, v46, v47
    v_mfma_f32_16x16x32_bf16 v[132:135], v[200:203], a[36:39], 0
    s_add_u32 s41, s43, 0x1809000
    ds_read_b128 v[168:171], v12 offset:7168
    v_accvgpr_read_b32 v237, a245
    v_mfma_f32_16x16x32_bf16 v[132:135], v[204:207], a[44:47], v[132:135]
    ds_read_b128 v[172:175], v12 offset:16384
    v_accvgpr_read_b32 v238, a246
    v_mfma_f32_16x16x32_bf16 v[132:135], v[208:211], a[52:55], v[132:135]
    s_add_u32 s46, s43, 0x1809000
    ds_read_b128 v[176:179], v12 offset:25600
    v_accvgpr_read_b32 v239, a247
    v_mfma_f32_16x16x32_bf16 v[132:135], v[212:215], a[60:63], v[132:135]
    s_add_u32 s54, s54, s55
    ds_read_b128 v[180:183], v12 offset:34816
    v_accvgpr_read_b32 v240, a248
    v_mfma_f32_16x16x32_bf16 v[128:131], v[212:215], a[56:59], 0
    buffer_load_dwordx4 a[104:107], v1, s[4:7], s41 offen offset:0 sc1
    v_mfma_f32_16x16x32_bf16 v[128:131], v[208:211], a[48:51], v[128:131]
    buffer_store_dwordx4 v[164:167], v1, s[4:7], s63 offen offset:0 sc1
    v_mfma_f32_16x16x32_bf16 v[128:131], v[204:207], a[40:43], v[128:131]
    buffer_load_dwordx4 a[108:111], v1, s[4:7], s46 offen offset:1024 sc1
    v_mfma_f32_16x16x32_bf16 v[128:131], v[200:203], a[32:35], v[128:131]
    s_waitcnt lgkmcnt(4)
    v_accvgpr_read_b32 v241, a249
    v_accvgpr_read_b32 v242, a250
    v_mfma_f32_16x16x32_bf16 v[136:139], v[216:219], a[32:35], 0
    s_add_u32 s41, s43, 0x180a000
    ds_read_b128 v[200:203], v12 offset:8192
    v_accvgpr_read_b32 v243, a251
    v_mfma_f32_16x16x32_bf16 v[136:139], v[220:223], a[40:43], v[136:139]
    ds_read_b128 v[204:207], v12 offset:17408
    v_mfma_f32_16x16x32_bf16 v[136:139], v[224:227], a[48:51], v[136:139]
    s_add_u32 s46, s43, 0x180a000
    ds_read_b128 v[208:211], v12 offset:26624
    v_mfma_f32_16x16x32_bf16 v[136:139], v[228:231], a[56:59], v[136:139]
    s_add_u32 s74, s54, 36864
    ds_read_b128 v[212:215], v12 offset:35840
    v_mfma_f32_16x16x32_bf16 v[140:143], v[228:231], a[60:63], 0
    buffer_load_dwordx4 a[112:115], v1, s[4:7], s41 offen offset:0 sc1
    v_mfma_f32_16x16x32_bf16 v[140:143], v[224:227], a[52:55], v[140:143]
    v_mfma_f32_16x16x32_bf16 v[140:143], v[220:223], a[44:47], v[140:143]
    buffer_load_dwordx4 a[116:119], v1, s[4:7], s46 offen offset:1024 sc1
    v_mfma_f32_16x16x32_bf16 v[140:143], v[216:219], a[36:39], v[140:143]
    s_waitcnt vmcnt(18) lgkmcnt(4)
    s_barrier
    v_mfma_f32_16x16x32_bf16 v[148:151], v[168:171], a[36:39], 0
    s_add_u32 s41, s40, 0x558000
    ds_read_b128 v[216:219], v13 offset:0
    v_mfma_f32_16x16x32_bf16 v[148:151], v[172:175], a[44:47], v[148:151]
    s_add_u32 m0, s73, 0x2000
    ds_read_b128 v[220:223], v13 offset:9216
    v_mfma_f32_16x16x32_bf16 v[148:151], v[176:179], a[52:55], v[148:151]
    s_add_u32 s46, s43, 0x180b000
    ds_read_b128 v[224:227], v13 offset:18432
    v_mfma_f32_16x16x32_bf16 v[148:151], v[180:183], a[60:63], v[148:151]
    ds_read_b128 v[228:231], v13 offset:27648
    v_mfma_f32_16x16x32_bf16 v[144:147], v[180:183], a[56:59], 0
    buffer_load_dwordx4 v1, s[88:91], s41 offen sc1 lds
    v_mfma_f32_16x16x32_bf16 v[144:147], v[176:179], a[48:51], v[144:147]
    v_mfma_f32_16x16x32_bf16 v[144:147], v[172:175], a[40:43], v[144:147]
    buffer_load_dwordx4 a[120:123], v1, s[4:7], s46 offen offset:0 sc1
    v_mfma_f32_16x16x32_bf16 v[144:147], v[168:171], a[32:35], v[144:147]
    s_waitcnt lgkmcnt(4)
    v_cvt_pk_bf16_f32 v184, v48, v49
    v_cvt_pk_bf16_f32 v185, v50, v51
    v_mfma_f32_16x16x32_bf16 v[152:155], v[200:203], a[32:35], 0
    s_add_u32 s41, s43, 0x180b000
    ds_read_b128 v[168:171], v13 offset:1024
    v_cvt_pk_bf16_f32 v186, v52, v53
    v_mfma_f32_16x16x32_bf16 v[152:155], v[204:207], a[40:43], v[152:155]
    ds_read_b128 v[172:175], v13 offset:10240
    v_cvt_pk_bf16_f32 v187, v54, v55
    v_mfma_f32_16x16x32_bf16 v[152:155], v[208:211], a[48:51], v[152:155]
    ds_read_b128 v[176:179], v13 offset:19456
    v_mfma_f32_16x16x32_bf16 v[152:155], v[212:215], a[56:59], v[152:155]
    ds_read_b128 v[180:183], v13 offset:28672
    v_mfma_f32_16x16x32_bf16 v[156:159], v[212:215], a[60:63], 0
    buffer_load_dwordx4 a[124:127], v1, s[4:7], s41 offen offset:1024 sc1
    v_mfma_f32_16x16x32_bf16 v[156:159], v[208:211], a[52:55], v[156:159]
    buffer_store_dwordx4 v[184:187], v1, s[4:7], s64 offen offset:0 sc1
    v_mfma_f32_16x16x32_bf16 v[156:159], v[204:207], a[44:47], v[156:159]
    v_mfma_f32_16x16x32_bf16 v[156:159], v[200:203], a[36:39], v[156:159]
    s_waitcnt vmcnt(20) lgkmcnt(4)
    v_mfma_f32_16x16x32_bf16 v[92:95], v[216:219], a[68:71], v[92:95]
    s_add_u32 s41, s28, 0x57c000
    ds_read_b128 v[200:203], v13 offset:2048
    v_mfma_f32_16x16x32_bf16 v[92:95], v[220:223], a[76:79], v[92:95]
    s_add_u32 m0, s69, 0x0
    ds_read_b128 v[204:207], v13 offset:11264
    v_mfma_f32_16x16x32_bf16 v[92:95], v[224:227], a[84:87], v[92:95]
    s_add_u32 s46, s29, 0x57c000
    ds_read_b128 v[208:211], v13 offset:20480
    v_mfma_f32_16x16x32_bf16 v[92:95], v[228:231], a[92:95], v[92:95]
    s_lshr_b32 s47, s2, 3
    ds_read_b128 v[212:215], v13 offset:29696
    v_mfma_f32_16x16x32_bf16 v[88:91], v[228:231], a[88:91], v[88:91]
    buffer_load_dwordx4 v1, s[88:91], s41 offen sc1 lds
    v_mfma_f32_16x16x32_bf16 v[88:91], v[224:227], a[80:83], v[88:91]
    s_add_u32 m0, s69, 0x400
    v_mfma_f32_16x16x32_bf16 v[88:91], v[220:223], a[72:75], v[88:91]
    buffer_load_dwordx4 v1, s[88:91], s46 offen sc1 lds
    v_mfma_f32_16x16x32_bf16 v[88:91], v[216:219], a[64:67], v[88:91]
    s_waitcnt lgkmcnt(4)
    v_mfma_f32_16x16x32_bf16 v[96:99], v[168:171], a[64:67], v[96:99]
    s_add_u32 s41, s30, 0x57c000
    ds_read_b128 v[216:219], v13 offset:3072
    v_mfma_f32_16x16x32_bf16 v[96:99], v[172:175], a[72:75], v[96:99]
    s_add_u32 m0, s69, 0x800
    ds_read_b128 v[220:223], v13 offset:12288
    v_mfma_f32_16x16x32_bf16 v[96:99], v[176:179], a[80:83], v[96:99]
    s_add_u32 s46, s31, 0x57c000
    ds_read_b128 v[224:227], v13 offset:21504
    v_mfma_f32_16x16x32_bf16 v[96:99], v[180:183], a[88:91], v[96:99]
    s_lshl_b32 s47, s47, 2
    ds_read_b128 v[228:231], v13 offset:30720
    v_mfma_f32_16x16x32_bf16 v[100:103], v[180:183], a[92:95], v[100:103]
    buffer_load_dwordx4 v1, s[88:91], s41 offen sc1 lds
    v_mfma_f32_16x16x32_bf16 v[100:103], v[176:179], a[84:87], v[100:103]
    s_add_u32 m0, s69, 0xc00
    v_mfma_f32_16x16x32_bf16 v[100:103], v[172:175], a[76:79], v[100:103]
    buffer_load_dwordx4 v1, s[88:91], s46 offen sc1 lds
    v_mfma_f32_16x16x32_bf16 v[100:103], v[168:171], a[68:71], v[100:103]
    s_waitcnt lgkmcnt(4)
    v_mfma_f32_16x16x32_bf16 v[108:111], v[200:203], a[68:71], v[108:111]
    s_add_u32 s41, s36, 0x57c000
    ds_read_b128 v[168:171], v13 offset:4096
    v_mfma_f32_16x16x32_bf16 v[108:111], v[204:207], a[76:79], v[108:111]
    s_add_u32 m0, s69, 0x1000
    ds_read_b128 v[172:175], v13 offset:13312
    v_mfma_f32_16x16x32_bf16 v[108:111], v[208:211], a[84:87], v[108:111]
    s_add_u32 s46, s37, 0x57c000
    ds_read_b128 v[176:179], v13 offset:22528
    v_cvt_pk_bf16_f32 v188, v56, v57
    v_mfma_f32_16x16x32_bf16 v[108:111], v[212:215], a[92:95], v[108:111]
    s_add_u32 s47, s47, s32
    ds_read_b128 v[180:183], v13 offset:31744
    v_cvt_pk_bf16_f32 v189, v58, v59
    v_mfma_f32_16x16x32_bf16 v[104:107], v[212:215], a[88:91], v[104:107]
    buffer_load_dwordx4 v1, s[88:91], s41 offen sc1 lds
    v_mfma_f32_16x16x32_bf16 v[104:107], v[208:211], a[80:83], v[104:107]
    s_add_u32 m0, s69, 0x1400
    v_cvt_pk_bf16_f32 v190, v60, v61
    v_cvt_pk_bf16_f32 v191, v62, v63
    v_mfma_f32_16x16x32_bf16 v[104:107], v[204:207], a[72:75], v[104:107]
    buffer_load_dwordx4 v1, s[88:91], s46 offen sc1 lds
    v_mfma_f32_16x16x32_bf16 v[104:107], v[200:203], a[64:67], v[104:107]
    s_waitcnt lgkmcnt(4)
    v_mfma_f32_16x16x32_bf16 v[112:115], v[216:219], a[64:67], v[112:115]
    s_add_u32 s41, s38, 0x57c000
    ds_read_b128 v[200:203], v13 offset:5120
    v_mfma_f32_16x16x32_bf16 v[112:115], v[220:223], a[72:75], v[112:115]
    s_add_u32 m0, s69, 0x1800
    ds_read_b128 v[204:207], v13 offset:14336
    v_mfma_f32_16x16x32_bf16 v[112:115], v[224:227], a[80:83], v[112:115]
    s_add_u32 s46, s39, 0x57c000
    ds_read_b128 v[208:211], v13 offset:23552
    v_mfma_f32_16x16x32_bf16 v[112:115], v[228:231], a[88:91], v[112:115]
    s_lshl_b32 s47, s47, 6
    ds_read_b128 v[212:215], v13 offset:32768
    v_mfma_f32_16x16x32_bf16 v[116:119], v[228:231], a[92:95], v[116:119]
    buffer_load_dwordx4 v1, s[88:91], s41 offen sc1 lds
    v_mfma_f32_16x16x32_bf16 v[116:119], v[224:227], a[84:87], v[116:119]
    s_add_u32 m0, s69, 0x1c00
    v_mfma_f32_16x16x32_bf16 v[116:119], v[220:223], a[76:79], v[116:119]
    buffer_load_dwordx4 v1, s[88:91], s46 offen sc1 lds
    v_mfma_f32_16x16x32_bf16 v[116:119], v[216:219], a[68:71], v[116:119]
    s_waitcnt lgkmcnt(4)
    v_mfma_f32_16x16x32_bf16 v[124:127], v[168:171], a[68:71], v[124:127]
    s_add_u32 s41, s43, 0x180c000
    ds_read_b128 v[216:219], v13 offset:6144
    v_mfma_f32_16x16x32_bf16 v[124:127], v[172:175], a[76:79], v[124:127]
    ds_read_b128 v[220:223], v13 offset:15360
    v_mfma_f32_16x16x32_bf16 v[124:127], v[176:179], a[84:87], v[124:127]
    s_add_u32 s46, s43, 0x180c000
    ds_read_b128 v[224:227], v13 offset:24576
    v_mfma_f32_16x16x32_bf16 v[124:127], v[180:183], a[92:95], v[124:127]
    s_add_u32 s47, s47, 4096
    ds_read_b128 v[228:231], v13 offset:33792
    v_mfma_f32_16x16x32_bf16 v[120:123], v[180:183], a[88:91], v[120:123]
    buffer_load_dwordx4 a[0:3], v1, s[4:7], s41 offen offset:0 sc1
    v_mfma_f32_16x16x32_bf16 v[120:123], v[176:179], a[80:83], v[120:123]
    buffer_store_dwordx4 v[188:191], v1, s[4:7], s65 offen offset:0 sc1
    v_mfma_f32_16x16x32_bf16 v[120:123], v[172:175], a[72:75], v[120:123]
    buffer_load_dwordx4 a[4:7], v1, s[4:7], s46 offen offset:1024 sc1
    v_mfma_f32_16x16x32_bf16 v[120:123], v[168:171], a[64:67], v[120:123]
    s_waitcnt lgkmcnt(4)
    v_mfma_f32_16x16x32_bf16 v[128:131], v[200:203], a[64:67], v[128:131]
    s_add_u32 s41, s43, 0x180d000
    ds_read_b128 v[168:171], v13 offset:7168
    v_mfma_f32_16x16x32_bf16 v[128:131], v[204:207], a[72:75], v[128:131]
    ds_read_b128 v[172:175], v13 offset:16384
    v_mfma_f32_16x16x32_bf16 v[128:131], v[208:211], a[80:83], v[128:131]
    s_add_u32 s46, s43, 0x180d000
    ds_read_b128 v[176:179], v13 offset:25600
    v_mfma_f32_16x16x32_bf16 v[128:131], v[212:215], a[88:91], v[128:131]
    s_min_u32 s47, s47, L_k2_last-L_k2_pc3
    ds_read_b128 v[180:183], v13 offset:34816
    v_mfma_f32_16x16x32_bf16 v[132:135], v[212:215], a[92:95], v[132:135]
    buffer_load_dwordx4 a[8:11], v1, s[4:7], s41 offen offset:0 sc1
    v_mfma_f32_16x16x32_bf16 v[132:135], v[208:211], a[84:87], v[132:135]
    v_mfma_f32_16x16x32_bf16 v[132:135], v[204:207], a[76:79], v[132:135]
    buffer_load_dwordx4 a[12:15], v1, s[4:7], s46 offen offset:1024 sc1
    v_mfma_f32_16x16x32_bf16 v[132:135], v[200:203], a[68:71], v[132:135]
    s_waitcnt lgkmcnt(4)
    v_cvt_pk_bf16_f32 v192, v64, v65
    v_cvt_pk_bf16_f32 v193, v66, v67
    v_mfma_f32_16x16x32_bf16 v[140:143], v[216:219], a[68:71], v[140:143]
    s_add_u32 s41, s43, 0x180e000
    ds_read_b128 v[200:203], v13 offset:8192
    v_cvt_pk_bf16_f32 v194, v68, v69
    v_mfma_f32_16x16x32_bf16 v[140:143], v[220:223], a[76:79], v[140:143]
    ds_read_b128 v[204:207], v13 offset:17408
    v_cvt_pk_bf16_f32 v195, v70, v71
    v_mfma_f32_16x16x32_bf16 v[140:143], v[224:227], a[84:87], v[140:143]
    s_add_u32 s46, s43, 0x180e000
    ds_read_b128 v[208:211], v13 offset:26624
    v_mfma_f32_16x16x32_bf16 v[140:143], v[228:231], a[92:95], v[140:143]
    s_getpc_b64 s[54:55]
L_k2_pc3:
    ds_read_b128 v[212:215], v13 offset:35840
    v_mfma_f32_16x16x32_bf16 v[136:139], v[228:231], a[88:91], v[136:139]
    buffer_load_dwordx4 a[16:19], v1, s[4:7], s41 offen offset:0 sc1
    v_mfma_f32_16x16x32_bf16 v[136:139], v[224:227], a[80:83], v[136:139]
    buffer_store_dwordx4 v[192:195], v1, s[4:7], s66 offen offset:0 sc1
    v_mfma_f32_16x16x32_bf16 v[136:139], v[220:223], a[72:75], v[136:139]
    buffer_load_dwordx4 a[20:23], v1, s[4:7], s46 offen offset:1024 sc1
    v_mfma_f32_16x16x32_bf16 v[136:139], v[216:219], a[64:67], v[136:139]
    s_waitcnt vmcnt(19) lgkmcnt(4)
    s_barrier
    v_mfma_f32_16x16x32_bf16 v[144:147], v[168:171], a[64:67], v[144:147]
    s_add_u32 s41, s40, 0x57c000
    ds_read_b128 v[216:219], v14 offset:0
    v_mfma_f32_16x16x32_bf16 v[144:147], v[172:175], a[72:75], v[144:147]
    s_add_u32 m0, s69, 0x2000
    ds_read_b128 v[220:223], v14 offset:9216
    v_mfma_f32_16x16x32_bf16 v[144:147], v[176:179], a[80:83], v[144:147]
    s_add_u32 s46, s43, 0x180f000
    ds_read_b128 v[224:227], v14 offset:18432
    v_mfma_f32_16x16x32_bf16 v[144:147], v[180:183], a[88:91], v[144:147]
    ds_read_b128 v[228:231], v14 offset:27648
    v_mfma_f32_16x16x32_bf16 v[148:151], v[180:183], a[92:95], v[148:151]
    buffer_load_dwordx4 v1, s[88:91], s41 offen sc1 lds
    v_mfma_f32_16x16x32_bf16 v[148:151], v[176:179], a[84:87], v[148:151]
    v_mfma_f32_16x16x32_bf16 v[148:151], v[172:175], a[76:79], v[148:151]
    buffer_load_dwordx4 a[24:27], v1, s[4:7], s46 offen offset:0 sc1
    v_mfma_f32_16x16x32_bf16 v[148:151], v[168:171], a[68:71], v[148:151]
    s_waitcnt lgkmcnt(4)
    v_mfma_f32_16x16x32_bf16 v[156:159], v[200:203], a[68:71], v[156:159]
    s_add_u32 s41, s43, 0x180f000
    ds_read_b128 v[168:171], v14 offset:1024
    v_mfma_f32_16x16x32_bf16 v[156:159], v[204:207], a[76:79], v[156:159]
    ds_read_b128 v[172:175], v14 offset:10240
    v_mfma_f32_16x16x32_bf16 v[156:159], v[208:211], a[84:87], v[156:159]
    ds_read_b128 v[176:179], v14 offset:19456
    v_mfma_f32_16x16x32_bf16 v[156:159], v[212:215], a[92:95], v[156:159]
    ds_read_b128 v[180:183], v14 offset:28672
    v_mfma_f32_16x16x32_bf16 v[152:155], v[212:215], a[88:91], v[152:155]
    buffer_load_dwordx4 a[28:31], v1, s[4:7], s41 offen offset:1024 sc1
    v_mfma_f32_16x16x32_bf16 v[152:155], v[208:211], a[80:83], v[152:155]
    v_mfma_f32_16x16x32_bf16 v[152:155], v[204:207], a[72:75], v[152:155]
    v_mfma_f32_16x16x32_bf16 v[152:155], v[200:203], a[64:67], v[152:155]
    s_waitcnt vmcnt(20) lgkmcnt(4)
    v_mfma_f32_16x16x32_bf16 v[88:91], v[216:219], a[96:99], v[88:91]
    s_add_u32 s41, s28, 0x5a0000
    ds_read_b128 v[200:203], v14 offset:2048
    v_mfma_f32_16x16x32_bf16 v[88:91], v[220:223], a[104:107], v[88:91]
    s_add_u32 m0, s72, 0x0
    ds_read_b128 v[204:207], v14 offset:11264
    v_mfma_f32_16x16x32_bf16 v[88:91], v[224:227], a[112:115], v[88:91]
    s_add_u32 s46, s29, 0x5a0000
    ds_read_b128 v[208:211], v14 offset:20480
    v_cvt_pk_bf16_f32 v196, v72, v73
    v_mfma_f32_16x16x32_bf16 v[88:91], v[228:231], a[120:123], v[88:91]
    s_and_b32 s48, s2, 6
    ds_read_b128 v[212:215], v14 offset:29696
    v_cvt_pk_bf16_f32 v197, v74, v75
    v_mfma_f32_16x16x32_bf16 v[92:95], v[228:231], a[124:127], v[92:95]
L_hop1_4:
    s_cbranch_execz L_hop1_8
    buffer_load_dwordx4 v1, s[88:91], s41 offen sc1 lds
    v_mfma_f32_16x16x32_bf16 v[92:95], v[224:227], a[116:119], v[92:95]
    s_add_u32 m0, s72, 0x400
    v_cvt_pk_bf16_f32 v198, v76, v77
    v_cvt_pk_bf16_f32 v199, v78, v79
    v_mfma_f32_16x16x32_bf16 v[92:95], v[220:223], a[108:111], v[92:95]
    buffer_load_dwordx4 v1, s[88:91], s46 offen sc1 lds
    v_mfma_f32_16x16x32_bf16 v[92:95], v[216:219], a[100:103], v[92:95]
    s_waitcnt lgkmcnt(4)
    v_mov_b32 v76, 0
    v_mov_b32 v77, 0
    v_mfma_f32_16x16x32_bf16 v[100:103], v[168:171], a[100:103], v[100:103]
    s_add_u32 s41, s30, 0x5a0000
    ds_read_b128 v[216:219], v14 offset:3072
    v_and_b32 v79, v248, v249
    v_mfma_f32_16x16x32_bf16 v[100:103], v[172:175], a[108:111], v[100:103]
    s_add_u32 m0, s72, 0x800
    ds_read_b128 v[220:223], v14 offset:12288
    v_xor_b32 v78, v248, v79
    v_mfma_f32_16x16x32_bf16 v[100:103], v[176:179], a[116:119], v[100:103]
    s_add_u32 s46, s31, 0x5a0000
    ds_read_b128 v[224:227], v14 offset:21504
    v_mfma_f32_16x16x32_bf16 v[100:103], v[180:183], a[124:127], v[100:103]
    s_sub_u32 s48, 8, s48
    ds_read_b128 v[228:231], v14 offset:30720
    v_mfma_f32_16x16x32_bf16 v[96:99], v[180:183], a[120:123], v[96:99]
    buffer_load_dwordx4 v1, s[88:91], s41 offen sc1 lds
    v_mfma_f32_16x16x32_bf16 v[96:99], v[176:179], a[112:115], v[96:99]
    s_add_u32 m0, s72, 0xc00
    v_mfma_f32_16x16x32_bf16 v[96:99], v[172:175], a[104:107], v[96:99]
    buffer_load_dwordx4 v1, s[88:91], s46 offen sc1 lds
    v_mfma_f32_16x16x32_bf16 v[96:99], v[168:171], a[96:99], v[96:99]
    s_waitcnt lgkmcnt(4)
    v_mfma_f32_16x16x32_bf16 v[104:107], v[200:203], a[96:99], v[104:107]
    s_add_u32 s41, s36, 0x5a0000
    ds_read_b128 v[168:171], v14 offset:4096
    v_mfma_f32_16x16x32_bf16 v[104:107], v[204:207], a[104:107], v[104:107]
    s_add_u32 m0, s72, 0x1000
    ds_read_b128 v[172:175], v14 offset:13312
    v_mfma_f32_16x16x32_bf16 v[104:107], v[208:211], a[112:115], v[104:107]
    s_add_u32 s46, s37, 0x5a0000
    ds_read_b128 v[176:179], v14 offset:22528
    v_mfma_f32_16x16x32_bf16 v[104:107], v[212:215], a[120:123], v[104:107]
    s_lshl_b32 s48, s48, 11
    ds_read_b128 v[180:183], v14 offset:31744
    v_mfma_f32_16x16x32_bf16 v[108:111], v[212:215], a[124:127], v[108:111]
    buffer_load_dwordx4 v1, s[88:91], s41 offen sc1 lds
    v_mfma_f32_16x16x32_bf16 v[108:111], v[208:211], a[116:119], v[108:111]
    s_add_u32 m0, s72, 0x1400
    v_mfma_f32_16x16x32_bf16 v[108:111], v[204:207], a[108:111], v[108:111]
    buffer_load_dwordx4 v1, s[88:91], s46 offen sc1 lds
    v_mfma_f32_16x16x32_bf16 v[108:111], v[200:203], a[100:103], v[108:111]
    s_waitcnt lgkmcnt(4)
    v_mfma_f32_16x16x32_bf16 v[116:119], v[216:219], a[100:103], v[116:119]
    s_add_u32 s41, s38, 0x5a0000
    ds_read_b128 v[200:203], v14 offset:5120
    v_mfma_f32_16x16x32_bf16 v[116:119], v[220:223], a[108:111], v[116:119]
    s_add_u32 m0, s72, 0x1800
    ds_read_b128 v[204:207], v14 offset:14336
    v_mfma_f32_16x16x32_bf16 v[116:119], v[224:227], a[116:119], v[116:119]
    s_add_u32 s46, s39, 0x5a0000
    ds_read_b128 v[208:211], v14 offset:23552
    v_mfma_f32_16x16x32_bf16 v[116:119], v[228:231], a[124:127], v[116:119]
    ds_read_b128 v[212:215], v14 offset:32768
    v_add_u32 v9, s48, v1
    v_mfma_f32_16x16x32_bf16 v[112:115], v[228:231], a[120:123], v[112:115]
    buffer_load_dwordx4 v1, s[88:91], s41 offen sc1 lds
    v_mfma_f32_16x16x32_bf16 v[112:115], v[224:227], a[112:115], v[112:115]
    s_add_u32 m0, s72, 0x1c00
    v_mfma_f32_16x16x32_bf16 v[112:115], v[220:223], a[104:107], v[112:115]
    buffer_load_dwordx4 v1, s[88:91], s46 offen sc1 lds
    v_mfma_f32_16x16x32_bf16 v[112:115], v[216:219], a[96:99], v[112:115]
    s_waitcnt lgkmcnt(4)
    v_cvt_pk_bf16_f32 v244, v80, v81
    v_cvt_pk_bf16_f32 v245, v82, v83
    v_mfma_f32_16x16x32_bf16 v[120:123], v[168:171], a[96:99], v[120:123]
    s_add_u32 s41, s43, 0x1810000
    ds_read_b128 v[216:219], v14 offset:6144
    v_cvt_pk_bf16_f32 v246, v84, v85
    v_mfma_f32_16x16x32_bf16 v[120:123], v[172:175], a[104:107], v[120:123]
    ds_read_b128 v[220:223], v14 offset:15360
    v_cvt_pk_bf16_f32 v247, v86, v87
    v_mfma_f32_16x16x32_bf16 v[120:123], v[176:179], a[112:115], v[120:123]
    s_add_u32 s46, s43, 0x1810000
    ds_read_b128 v[224:227], v14 offset:24576
    v_mov_b32 v80, 0
    v_mfma_f32_16x16x32_bf16 v[120:123], v[180:183], a[120:123], v[120:123]
    ds_read_b128 v[228:231], v14 offset:33792
    v_mov_b32 v81, 0
    v_mfma_f32_16x16x32_bf16 v[124:127], v[180:183], a[124:127], v[124:127]
    buffer_load_dwordx4 a[144:147], v1, s[4:7], s41 offen offset:0 sc1
    v_mfma_f32_16x16x32_bf16 v[124:127], v[176:179], a[116:119], v[124:127]
    buffer_store_dwordx4 v[196:199], v1, s[4:7], s67 offen offset:0 sc1
    v_mfma_f32_16x16x32_bf16 v[124:127], v[172:175], a[108:111], v[124:127]
    buffer_load_dwordx4 a[148:151], v1, s[4:7], s46 offen offset:1024 sc1
    v_mfma_f32_16x16x32_bf16 v[124:127], v[168:171], a[100:103], v[124:127]
    s_waitcnt lgkmcnt(4)
    v_mfma_f32_16x16x32_bf16 v[132:135], v[200:203], a[100:103], v[132:135]
    s_add_u32 s41, s43, 0x1811000
    ds_read_b128 v[168:171], v14 offset:7168
    v_mfma_f32_16x16x32_bf16 v[132:135], v[204:207], a[108:111], v[132:135]
    ds_read_b128 v[172:175], v14 offset:16384
    v_mfma_f32_16x16x32_bf16 v[132:135], v[208:211], a[116:119], v[132:135]
    s_add_u32 s46, s43, 0x1811000
    ds_read_b128 v[176:179], v14 offset:25600
    v_mfma_f32_16x16x32_bf16 v[132:135], v[212:215], a[124:127], v[132:135]
    ds_read_b128 v[180:183], v14 offset:34816
    v_mfma_f32_16x16x32_bf16 v[128:131], v[212:215], a[120:123], v[128:131]
    buffer_load_dwordx4 a[152:155], v1, s[4:7], s41 offen offset:0 sc1
    v_mfma_f32_16x16x32_bf16 v[128:131], v[208:211], a[112:115], v[128:131]
    buffer_store_dwordx4 v[244:247], v1, s[4:7], s68 offen offset:0 sc1
    v_mfma_f32_16x16x32_bf16 v[128:131], v[204:207], a[104:107], v[128:131]
    buffer_load_dwordx4 a[156:159], v1, s[4:7], s46 offen offset:1024 sc1
    v_mfma_f32_16x16x32_bf16 v[128:131], v[200:203], a[96:99], v[128:131]
    s_waitcnt lgkmcnt(4)
    v_mfma_f32_16x16x32_bf16 v[136:139], v[216:219], a[96:99], v[136:139]
    s_add_u32 s41, s43, 0x1812000
    ds_read_b128 v[200:203], v14 offset:8192
    v_mfma_f32_16x16x32_bf16 v[136:139], v[220:223], a[104:107], v[136:139]
    ds_read_b128 v[204:207], v14 offset:17408
    v_mfma_f32_16x16x32_bf16 v[136:139], v[224:227], a[112:115], v[136:139]
    s_add_u32 s46, s43, 0x1812000
    ds_read_b128 v[208:211], v14 offset:26624
    v_mfma_f32_16x16x32_bf16 v[136:139], v[228:231], a[120:123], v[136:139]
    ds_read_b128 v[212:215], v14 offset:35840
    v_mfma_f32_16x16x32_bf16 v[140:143], v[228:231], a[124:127], v[140:143]
    buffer_load_dwordx4 a[160:163], v1, s[4:7], s41 offen offset:0 sc1
    v_mfma_f32_16x16x32_bf16 v[140:143], v[224:227], a[116:119], v[140:143]
    v_mfma_f32_16x16x32_bf16 v[140:143], v[220:223], a[108:111], v[140:143]
    buffer_load_dwordx4 a[164:167], v1, s[4:7], s46 offen offset:1024 sc1
    v_mfma_f32_16x16x32_bf16 v[140:143], v[216:219], a[100:103], v[140:143]
    s_waitcnt vmcnt(18) lgkmcnt(4)
    s_barrier
    v_mfma_f32_16x16x32_bf16 v[148:151], v[168:171], a[100:103], v[148:151]
    s_add_u32 s41, s40, 0x5a0000
    ds_read_b128 v[216:219], v12 offset:0
    v_mfma_f32_16x16x32_bf16 v[148:151], v[172:175], a[108:111], v[148:151]
    s_add_u32 m0, s72, 0x2000
    ds_read_b128 v[220:223], v12 offset:9216
    v_mfma_f32_16x16x32_bf16 v[148:151], v[176:179], a[116:119], v[148:151]
    s_add_u32 s46, s43, 0x1813000
    ds_read_b128 v[224:227], v12 offset:18432
    v_mfma_f32_16x16x32_bf16 v[148:151], v[180:183], a[124:127], v[148:151]
    ds_read_b128 v[228:231], v12 offset:27648
    v_mfma_f32_16x16x32_bf16 v[144:147], v[180:183], a[120:123], v[144:147]
    buffer_load_dwordx4 v1, s[88:91], s41 offen sc1 lds
    v_mfma_f32_16x16x32_bf16 v[144:147], v[176:179], a[112:115], v[144:147]
    v_mfma_f32_16x16x32_bf16 v[144:147], v[172:175], a[104:107], v[144:147]
    buffer_load_dwordx4 a[168:171], v1, s[4:7], s46 offen offset:0 sc1
    v_mfma_f32_16x16x32_bf16 v[144:147], v[168:171], a[96:99], v[144:147]
    s_waitcnt lgkmcnt(4)
    v_mfma_f32_16x16x32_bf16 v[152:155], v[200:203], a[96:99], v[152:155]
    s_add_u32 s41, s43, 0x1813000
    ds_read_b128 v[168:171], v12 offset:1024
    v_mfma_f32_16x16x32_bf16 v[152:155], v[204:207], a[104:107], v[152:155]
    ds_read_b128 v[172:175], v12 offset:10240
    v_mfma_f32_16x16x32_bf16 v[152:155], v[208:211], a[112:115], v[152:155]
    ds_read_b128 v[176:179], v12 offset:19456
    v_mfma_f32_16x16x32_bf16 v[152:155], v[212:215], a[120:123], v[152:155]
    ds_read_b128 v[180:183], v12 offset:28672
    v_mfma_f32_16x16x32_bf16 v[156:159], v[212:215], a[124:127], v[156:159]
    buffer_load_dwordx4 a[172:175], v1, s[4:7], s41 offen offset:1024 sc1
    v_mfma_f32_16x16x32_bf16 v[156:159], v[208:211], a[116:119], v[156:159]
    v_mfma_f32_16x16x32_bf16 v[156:159], v[204:207], a[108:111], v[156:159]
    v_mfma_f32_16x16x32_bf16 v[156:159], v[200:203], a[100:103], v[156:159]
    s_waitcnt vmcnt(19) lgkmcnt(4)
    v_mfma_f32_16x16x32_bf16 v[92:95], v[216:219], a[4:7], v[92:95]
    s_add_u32 s41, s30, 0x5c4000
    ds_read_b128 v[200:203], v12 offset:2048
    v_mfma_f32_16x16x32_bf16 v[92:95], v[220:223], a[12:15], v[92:95]
    s_add_u32 m0, s73, 0x800
    ds_read_b128 v[204:207], v12 offset:11264
    v_mfma_f32_16x16x32_bf16 v[92:95], v[224:227], a[20:23], v[92:95]
    s_add_u32 s46, s31, 0x5c4000
    ds_read_b128 v[208:211], v12 offset:20480
    v_mfma_f32_16x16x32_bf16 v[92:95], v[228:231], a[28:31], v[92:95]
    ds_read_b128 v[212:215], v12 offset:29696
    v_mfma_f32_16x16x32_bf16 v[88:91], v[228:231], a[24:27], v[88:91]
    buffer_load_dwordx4 v1, s[88:91], s41 offen sc1 lds
    v_mfma_f32_16x16x32_bf16 v[88:91], v[224:227], a[16:19], v[88:91]
    s_add_u32 m0, s73, 0xc00
    v_mfma_f32_16x16x32_bf16 v[88:91], v[220:223], a[8:11], v[88:91]
    buffer_load_dwordx4 v1, s[88:91], s46 offen sc1 lds
    v_mfma_f32_16x16x32_bf16 v[88:91], v[216:219], a[0:3], v[88:91]
    s_waitcnt lgkmcnt(4)
    v_mfma_f32_16x16x32_bf16 v[96:99], v[168:171], a[0:3], v[96:99]
    s_add_u32 s41, s36, 0x5c4000
    ds_read_b128 v[216:219], v12 offset:3072
    v_mfma_f32_16x16x32_bf16 v[96:99], v[172:175], a[8:11], v[96:99]
    s_add_u32 m0, s73, 0x1000
    ds_read_b128 v[220:223], v12 offset:12288
    v_mfma_f32_16x16x32_bf16 v[96:99], v[176:179], a[16:19], v[96:99]
    s_add_u32 s46, s30, 0x60c000
    ds_read_b128 v[224:227], v12 offset:21504
    v_mfma_f32_16x16x32_bf16 v[96:99], v[180:183], a[24:27], v[96:99]
    ds_read_b128 v[228:231], v12 offset:30720
    v_mfma_f32_16x16x32_bf16 v[100:103], v[180:183], a[28:31], v[100:103]
    buffer_load_dwordx4 v1, s[88:91], s41 offen sc1 lds
    v_mfma_f32_16x16x32_bf16 v[100:103], v[176:179], a[20:23], v[100:103]
    s_add_u32 m0, s74, 0x800
    v_mfma_f32_16x16x32_bf16 v[100:103], v[172:175], a[12:15], v[100:103]
    buffer_load_dwordx4 v1, s[88:91], s46 offen sc1 lds
    v_mfma_f32_16x16x32_bf16 v[100:103], v[168:171], a[4:7], v[100:103]
    s_waitcnt lgkmcnt(4)
    v_mfma_f32_16x16x32_bf16 v[108:111], v[200:203], a[4:7], v[108:111]
    s_add_u32 s41, s31, 0x60c000
    ds_read_b128 v[168:171], v12 offset:4096
    v_mfma_f32_16x16x32_bf16 v[108:111], v[204:207], a[12:15], v[108:111]
    s_add_u32 m0, s74, 0xc00
    ds_read_b128 v[172:175], v12 offset:13312
    v_mfma_f32_16x16x32_bf16 v[108:111], v[208:211], a[20:23], v[108:111]
    s_add_u32 s46, s36, 0x60c000
    ds_read_b128 v[176:179], v12 offset:22528
    v_mfma_f32_16x16x32_bf16 v[108:111], v[212:215], a[28:31], v[108:111]
    ds_read_b128 v[180:183], v12 offset:31744
    v_mfma_f32_16x16x32_bf16 v[104:107], v[212:215], a[24:27], v[104:107]
    buffer_load_dwordx4 v1, s[88:91], s41 offen sc1 lds
    v_mfma_f32_16x16x32_bf16 v[104:107], v[208:211], a[16:19], v[104:107]
    s_add_u32 m0, s74, 0x1000
    v_mfma_f32_16x16x32_bf16 v[104:107], v[204:207], a[8:11], v[104:107]
    buffer_load_dwordx4 v1, s[88:91], s46 offen sc1 lds
    v_mfma_f32_16x16x32_bf16 v[104:107], v[200:203], a[0:3], v[104:107]
    s_waitcnt lgkmcnt(4)
    v_mfma_f32_16x16x32_bf16 v[112:115], v[216:219], a[0:3], v[112:115]
    s_add_u32 s41, s43, 0x1814000
    ds_read_b128 v[200:203], v12 offset:5120
    v_mov_b32 v84, s47
    v_mfma_f32_16x16x32_bf16 v[112:115], v[220:223], a[8:11], v[112:115]
    ds_read_b128 v[204:207], v12 offset:14336
    v_mov_b32 v85, s55
    v_mfma_f32_16x16x32_bf16 v[112:115], v[224:227], a[16:19], v[112:115]
    s_add_u32 s46, s43, 0x1814000
    ds_read_b128 v[208:211], v12 offset:23552
    v_add_co_u32 v84, vcc, s54, v84
    v_mfma_f32_16x16x32_bf16 v[112:115], v[228:231], a[24:27], v[112:115]
    ds_read_b128 v[212:215], v12 offset:32768
    v_mfma_f32_16x16x32_bf16 v[116:119], v[228:231], a[28:31], v[116:119]
    buffer_load_dwordx4 a[176:179], v1, s[4:7], s41 offen offset:0 sc1
    v_mfma_f32_16x16x32_bf16 v[116:119], v[224:227], a[20:23], v[116:119]
    v_mfma_f32_16x16x32_bf16 v[116:119], v[220:223], a[12:15], v[116:119]
    buffer_load_dwordx4 a[180:183], v1, s[4:7], s46 offen offset:1024 sc1
    v_mfma_f32_16x16x32_bf16 v[116:119], v[216:219], a[4:7], v[116:119]
    s_waitcnt lgkmcnt(4)
    v_mfma_f32_16x16x32_bf16 v[124:127], v[168:171], a[4:7], v[124:127]
    s_add_u32 s41, s43, 0x1815000
    ds_read_b128 v[216:219], v12 offset:6144
    v_addc_co_u32 v85, vcc, 0, v85, vcc
    v_mfma_f32_16x16x32_bf16 v[124:127], v[172:175], a[12:15], v[124:127]
    ds_read_b128 v[220:223], v12 offset:15360
    v_mfma_f32_16x16x32_bf16 v[124:127], v[176:179], a[20:23], v[124:127]
    s_add_u32 s46, s43, 0x1815000
    ds_read_b128 v[224:227], v12 offset:24576
    v_mfma_f32_16x16x32_bf16 v[124:127], v[180:183], a[28:31], v[124:127]
    ds_read_b128 v[228:231], v12 offset:33792
    v_mfma_f32_16x16x32_bf16 v[120:123], v[180:183], a[24:27], v[120:123]
    buffer_load_dwordx4 a[184:187], v1, s[4:7], s41 offen offset:0 sc1
    v_mfma_f32_16x16x32_bf16 v[120:123], v[176:179], a[16:19], v[120:123]
    global_load_dword v86, v[84:85], off
    v_mfma_f32_16x16x32_bf16 v[120:123], v[172:175], a[8:11], v[120:123]
    buffer_load_dwordx4 a[188:191], v1, s[4:7], s46 offen offset:1024 sc1
    v_mfma_f32_16x16x32_bf16 v[120:123], v[168:171], a[0:3], v[120:123]
    s_waitcnt lgkmcnt(4)
    v_mfma_f32_16x16x32_bf16 v[128:131], v[200:203], a[0:3], v[128:131]
    s_add_u32 s41, s43, 0x1816000
    ds_read_b128 v[168:171], v12 offset:7168
    v_mfma_f32_16x16x32_bf16 v[128:131], v[204:207], a[8:11], v[128:131]
    s_waitcnt vmcnt(17)
    ds_read_b128 v[172:175], v12 offset:16384
    v_mfma_f32_16x16x32_bf16 v[128:131], v[208:211], a[16:19], v[128:131]
    s_add_u32 s46, s43, 0x1816000
    ds_read_b128 v[176:179], v12 offset:25600
    v_mfma_f32_16x16x32_bf16 v[128:131], v[212:215], a[24:27], v[128:131]
    ds_read_b128 v[180:183], v12 offset:34816
    v_mfma_f32_16x16x32_bf16 v[132:135], v[212:215], a[28:31], v[132:135]
    buffer_load_dwordx4 a[192:195], v1, s[4:7], s41 offen offset:0 sc1
    v_mfma_f32_16x16x32_bf16 v[132:135], v[208:211], a[20:23], v[132:135]
    buffer_store_dword v11, v7, s[4:7], s44 offen sc1
    v_mfma_f32_16x16x32_bf16 v[132:135], v[204:207], a[12:15], v[132:135]
    buffer_load_dwordx4 a[196:199], v1, s[4:7], s46 offen offset:1024 sc1
    v_mfma_f32_16x16x32_bf16 v[132:135], v[200:203], a[4:7], v[132:135]
    s_waitcnt lgkmcnt(4)
    v_mfma_f32_16x16x32_bf16 v[140:143], v[216:219], a[4:7], v[140:143]
    s_add_u32 s41, s43, 0x1817000
    ds_read_b128 v[200:203], v12 offset:8192
    v_mfma_f32_16x16x32_bf16 v[140:143], v[220:223], a[12:15], v[140:143]
    ds_read_b128 v[204:207], v12 offset:17408
    v_mfma_f32_16x16x32_bf16 v[140:143], v[224:227], a[20:23], v[140:143]
    s_add_u32 s46, s43, 0x1817000
    ds_read_b128 v[208:211], v12 offset:26624
    v_mfma_f32_16x16x32_bf16 v[140:143], v[228:231], a[28:31], v[140:143]
    ds_read_b128 v[212:215], v12 offset:35840
    v_mfma_f32_16x16x32_bf16 v[136:139], v[228:231], a[24:27], v[136:139]
    buffer_load_dwordx4 a[200:203], v1, s[4:7], s41 offen offset:0 sc1
    v_mfma_f32_16x16x32_bf16 v[136:139], v[224:227], a[16:19], v[136:139]
    v_mfma_f32_16x16x32_bf16 v[136:139], v[220:223], a[8:11], v[136:139]
    buffer_load_dwordx4 a[204:207], v1, s[4:7], s46 offen offset:1024 sc1
    v_mfma_f32_16x16x32_bf16 v[136:139], v[216:219], a[0:3], v[136:139]
    s_waitcnt vmcnt(18) lgkmcnt(4)
    s_barrier
    v_mfma_f32_16x16x32_bf16 v[144:147], v[168:171], a[0:3], v[144:147]
    s_add_u32 s41, s30, 0x5e8000
    ds_read_b128 v[216:219], v13 offset:0
    v_mfma_f32_16x16x32_bf16 v[144:147], v[172:175], a[8:11], v[144:147]
    s_add_u32 m0, s69, 0x800
    ds_read_b128 v[220:223], v13 offset:9216
    v_mfma_f32_16x16x32_bf16 v[144:147], v[176:179], a[16:19], v[144:147]
    s_add_u32 s46, s31, 0x5e8000
    ds_read_b128 v[224:227], v13 offset:18432
    v_mfma_f32_16x16x32_bf16 v[144:147], v[180:183], a[24:27], v[144:147]
    ds_read_b128 v[228:231], v13 offset:27648
    v_mfma_f32_16x16x32_bf16 v[148:151], v[180:183], a[28:31], v[148:151]
    buffer_load_dwordx4 v1, s[88:91], s41 offen sc1 lds
    v_mfma_f32_16x16x32_bf16 v[148:151], v[176:179], a[20:23], v[148:151]
    s_add_u32 m0, s69, 0xc00
    v_mfma_f32_16x16x32_bf16 v[148:151], v[172:175], a[12:15], v[148:151]
    buffer_load_dwordx4 v1, s[88:91], s46 offen sc1 lds
    v_mfma_f32_16x16x32_bf16 v[148:151], v[168:171], a[4:7], v[148:151]
    s_waitcnt lgkmcnt(4)
    v_mfma_f32_16x16x32_bf16 v[156:159], v[200:203], a[4:7], v[156:159]
    s_add_u32 s41, s36, 0x5e8000
    ds_read_b128 v[168:171], v13 offset:1024
    v_mfma_f32_16x16x32_bf16 v[156:159], v[204:207], a[12:15], v[156:159]
    s_add_u32 m0, s69, 0x1000
    ds_read_b128 v[172:175], v13 offset:10240
    v_mfma_f32_16x16x32_bf16 v[156:159], v[208:211], a[20:23], v[156:159]
    s_add_u32 s46, s43, 0x1818000
    ds_read_b128 v[176:179], v13 offset:19456
    v_mfma_f32_16x16x32_bf16 v[156:159], v[212:215], a[28:31], v[156:159]
    ds_read_b128 v[180:183], v13 offset:28672
    v_mfma_f32_16x16x32_bf16 v[152:155], v[212:215], a[24:27], v[152:155]
    buffer_load_dwordx4 v1, s[88:91], s41 offen sc1 lds
    v_mfma_f32_16x16x32_bf16 v[152:155], v[208:211], a[16:19], v[152:155]
    v_mfma_f32_16x16x32_bf16 v[152:155], v[204:207], a[8:11], v[152:155]
    buffer_load_dwordx4 a[208:211], v1, s[4:7], s46 offen offset:0 sc1
    v_mfma_f32_16x16x32_bf16 v[152:155], v[200:203], a[0:3], v[152:155]
    s_waitcnt vmcnt(20) lgkmcnt(4)
    v_mfma_f32_16x16x32_bf16 v[88:91], v[216:219], a[144:147], v[88:91]
    s_add_u32 s41, s43, 0x1818000
    ds_read_b128 v[200:203], v13 offset:2048
    v_mfma_f32_16x16x32_bf16 v[88:91], v[220:223], a[152:155], v[88:91]
    ds_read_b128 v[204:207], v13 offset:11264
    v_mfma_f32_16x16x32_bf16 v[88:91], v[224:227], a[160:163], v[88:91]
    s_add_u32 s46, s43, 0x1819000
    ds_read_b128 v[208:211], v13 offset:20480
    v_mfma_f32_16x16x32_bf16 v[88:91], v[228:231], a[168:171], v[88:91]
    ds_read_b128 v[212:215], v13 offset:29696
    v_mfma_f32_16x16x32_bf16 v[92:95], v[228:231], a[172:175], v[92:95]
    buffer_load_dwordx4 a[212:215], v1, s[4:7], s41 offen offset:1024 sc1
    v_mfma_f32_16x16x32_bf16 v[92:95], v[224:227], a[164:167], v[92:95]
    v_mfma_f32_16x16x32_bf16 v[92:95], v[220:223], a[156:159], v[92:95]
    buffer_load_dwordx4 a[216:219], v1, s[4:7], s46 offen offset:0 sc1
    v_mfma_f32_16x16x32_bf16 v[92:95], v[216:219], a[148:151], v[92:95]
    s_waitcnt lgkmcnt(4)
    v_mfma_f32_16x16x32_bf16 v[100:103], v[168:171], a[148:151], v[100:103]
    s_add_u32 s41, s43, 0x1819000
    ds_read_b128 v[216:219], v13 offset:3072
    v_mfma_f32_16x16x32_bf16 v[100:103], v[172:175], a[156:159], v[100:103]
    ds_read_b128 v[220:223], v13 offset:12288
    v_mfma_f32_16x16x32_bf16 v[100:103], v[176:179], a[164:167], v[100:103]
    s_add_u32 s46, s43, 0x181a000
    ds_read_b128 v[224:227], v13 offset:21504
    v_mfma_f32_16x16x32_bf16 v[100:103], v[180:183], a[172:175], v[100:103]
    ds_read_b128 v[228:231], v13 offset:30720
    v_mfma_f32_16x16x32_bf16 v[96:99], v[180:183], a[168:171], v[96:99]
    buffer_load_dwordx4 a[220:223], v1, s[4:7], s41 offen offset:1024 sc1
    v_mfma_f32_16x16x32_bf16 v[96:99], v[176:179], a[160:163], v[96:99]
    v_mfma_f32_16x16x32_bf16 v[96:99], v[172:175], a[152:155], v[96:99]
    buffer_load_dwordx4 a[224:227], v1, s[4:7], s46 offen offset:0 sc1
    v_mfma_f32_16x16x32_bf16 v[96:99], v[168:171], a[144:147], v[96:99]
    s_waitcnt lgkmcnt(4)
    v_mfma_f32_16x16x32_bf16 v[104:107], v[200:203], a[144:147], v[104:107]
    s_add_u32 s41, s43, 0x181a000
    ds_read_b128 v[168:171], v13 offset:4096
    v_mfma_f32_16x16x32_bf16 v[104:107], v[204:207], a[152:155], v[104:107]
    ds_read_b128 v[172:175], v13 offset:13312
    v_mfma_f32_16x16x32_bf16 v[104:107], v[208:211], a[160:163], v[104:107]
    s_add_u32 s46, s43, 0x181b000
    ds_read_b128 v[176:179], v13 offset:22528
    v_mfma_f32_16x16x32_bf16 v[104:107], v[212:215], a[168:171], v[104:107]
    ds_read_b128 v[180:183], v13 offset:31744
    v_mfma_f32_16x16x32_bf16 v[108:111], v[212:215], a[172:175], v[108:111]
    buffer_load_dwordx4 a[228:231], v1, s[4:7], s41 offen offset:1024 sc1
    v_mfma_f32_16x16x32_bf16 v[108:111], v[208:211], a[164:167], v[108:111]
    v_mfma_f32_16x16x32_bf16 v[108:111], v[204:207], a[156:159], v[108:111]
    buffer_load_dwordx4 a[232:235], v1, s[4:7], s46 offen offset:0 sc1
    v_mfma_f32_16x16x32_bf16 v[108:111], v[200:203], a[148:151], v[108:111]
    s_waitcnt lgkmcnt(4)
    v_mfma_f32_16x16x32_bf16 v[116:119], v[216:219], a[148:151], v[116:119]
    s_add_u32 s41, s43, 0x181b000
    ds_read_b128 v[200:203], v13 offset:5120
    v_mfma_f32_16x16x32_bf16 v[116:119], v[220:223], a[156:159], v[116:119]
    ds_read_b128 v[204:207], v13 offset:14336
    v_mfma_f32_16x16x32_bf16 v[116:119], v[224:227], a[164:167], v[116:119]
    s_add_u32 s46, s43, 0x181c000
    ds_read_b128 v[208:211], v13 offset:23552
    v_mfma_f32_16x16x32_bf16 v[116:119], v[228:231], a[172:175], v[116:119]
    ds_read_b128 v[212:215], v13 offset:32768
    v_mfma_f32_16x16x32_bf16 v[112:115], v[228:231], a[168:171], v[112:115]
    buffer_load_dwordx4 a[236:239], v1, s[4:7], s41 offen offset:1024 sc1
    v_mfma_f32_16x16x32_bf16 v[112:115], v[224:227], a[160:163], v[112:115]
    v_mfma_f32_16x16x32_bf16 v[112:115], v[220:223], a[152:155], v[112:115]
    buffer_load_dwordx4 a[32:35], v1, s[4:7], s46 offen offset:0 sc1
    v_mfma_f32_16x16x32_bf16 v[112:115], v[216:219], a[144:147], v[112:115]
    s_waitcnt lgkmcnt(4)
    v_mfma_f32_16x16x32_bf16 v[120:123], v[168:171], a[144:147], v[120:123]
    s_add_u32 s41, s43, 0x181c000
    ds_read_b128 v[216:219], v13 offset:6144
    v_mfma_f32_16x16x32_bf16 v[120:123], v[172:175], a[152:155], v[120:123]
    ds_read_b128 v[220:223], v13 offset:15360
    v_mfma_f32_16x16x32_bf16 v[120:123], v[176:179], a[160:163], v[120:123]
    s_add_u32 s46, s43, 0x181d000
    ds_read_b128 v[224:227], v13 offset:24576
    v_mfma_f32_16x16x32_bf16 v[120:123], v[180:183], a[168:171], v[120:123]
    ds_read_b128 v[228:231], v13 offset:33792
    v_mfma_f32_16x16x32_bf16 v[124:127], v[180:183], a[172:175], v[124:127]
    buffer_load_dwordx4 a[36:39], v1, s[4:7], s41 offen offset:1024 sc1
    v_mfma_f32_16x16x32_bf16 v[124:127], v[176:179], a[164:167], v[124:127]
    v_mfma_f32_16x16x32_bf16 v[124:127], v[172:175], a[156:159], v[124:127]
    buffer_load_dwordx4 a[40:43], v1, s[4:7], s46 offen offset:0 sc1
    v_mfma_f32_16x16x32_bf16 v[124:127], v[168:171], a[148:151], v[124:127]
    s_waitcnt lgkmcnt(4)
    v_mfma_f32_16x16x32_bf16 v[132:135], v[200:203], a[148:151], v[132:135]
    s_add_u32 s41, s43, 0x181d000
    ds_read_b128 v[168:171], v13 offset:7168
    v_mfma_f32_16x16x32_bf16 v[132:135], v[204:207], a[156:159], v[132:135]
    ds_read_b128 v[172:175], v13 offset:16384
    v_mfma_f32_16x16x32_bf16 v[132:135], v[208:211], a[164:167], v[132:135]
    s_add_u32 s46, s43, 0x181e000
    ds_read_b128 v[176:179], v13 offset:25600
    v_mfma_f32_16x16x32_bf16 v[132:135], v[212:215], a[172:175], v[132:135]
    ds_read_b128 v[180:183], v13 offset:34816
    v_mfma_f32_16x16x32_bf16 v[128:131], v[212:215], a[168:171], v[128:131]
    buffer_load_dwordx4 a[44:47], v1, s[4:7], s41 offen offset:1024 sc1
    v_mfma_f32_16x16x32_bf16 v[128:131], v[208:211], a[160:163], v[128:131]
    buffer_load_dword v8, v10, s[4:7], s50 offen sc1
    v_mfma_f32_16x16x32_bf16 v[128:131], v[204:207], a[152:155], v[128:131]
    buffer_load_dwordx4 a[48:51], v1, s[4:7], s46 offen offset:0 sc1
    v_mfma_f32_16x16x32_bf16 v[128:131], v[200:203], a[144:147], v[128:131]
    s_waitcnt lgkmcnt(4)
    v_mfma_f32_16x16x32_bf16 v[136:139], v[216:219], a[144:147], v[136:139]
    s_add_u32 s41, s43, 0x181e000
    ds_read_b128 v[200:203], v13 offset:8192
    v_mfma_f32_16x16x32_bf16 v[136:139], v[220:223], a[152:155], v[136:139]
    ds_read_b128 v[204:207], v13 offset:17408
    v_mfma_f32_16x16x32_bf16 v[136:139], v[224:227], a[160:163], v[136:139]
    s_add_u32 s46, s43, 0x181f000
    ds_read_b128 v[208:211], v13 offset:26624
    v_mfma_f32_16x16x32_bf16 v[136:139], v[228:231], a[168:171], v[136:139]
    ds_read_b128 v[212:215], v13 offset:35840
    v_mfma_f32_16x16x32_bf16 v[140:143], v[228:231], a[172:175], v[140:143]
    buffer_load_dwordx4 a[52:55], v1, s[4:7], s41 offen offset:1024 sc1
    v_mfma_f32_16x16x32_bf16 v[140:143], v[224:227], a[164:167], v[140:143]
    v_mfma_f32_16x16x32_bf16 v[140:143], v[220:223], a[156:159], v[140:143]
    buffer_load_dwordx4 a[56:59], v1, s[4:7], s46 offen offset:0 sc1
    v_mfma_f32_16x16x32_bf16 v[140:143], v[216:219], a[148:151], v[140:143]
    s_waitcnt vmcnt(16) lgkmcnt(4)
    s_barrier
    v_mfma_f32_16x16x32_bf16 v[148:151], v[168:171], a[148:151], v[148:151]
    s_add_u32 s41, s43, 0x181f000
    ds_read_b128 v[216:219], v14 offset:2048
    v_mfma_f32_16x16x32_bf16 v[148:151], v[172:175], a[156:159], v[148:151]
    ds_read_b128 v[220:223], v14 offset:11264
    v_mfma_f32_16x16x32_bf16 v[148:151], v[176:179], a[164:167], v[148:151]
    s_add_u32 s46, s37, 0x5c4000
    ds_read_b128 v[224:227], v14 offset:20480
    v_mfma_f32_16x16x32_bf16 v[148:151], v[180:183], a[172:175], v[148:151]
    ds_read_b128 v[228:231], v14 offset:29696
    v_mfma_f32_16x16x32_bf16 v[144:147], v[180:183], a[168:171], v[144:147]
    buffer_load_dwordx4 a[60:63], v1, s[4:7], s41 offen offset:1024 sc1
    v_mfma_f32_16x16x32_bf16 v[144:147], v[176:179], a[160:163], v[144:147]
    s_add_u32 m0, s73, 0x1400
    v_mfma_f32_16x16x32_bf16 v[144:147], v[172:175], a[152:155], v[144:147]
    buffer_load_dwordx4 v1, s[88:91], s46 offen sc1 lds
    v_mfma_f32_16x16x32_bf16 v[144:147], v[168:171], a[144:147], v[144:147]
    s_waitcnt lgkmcnt(4)
    v_mfma_f32_16x16x32_bf16 v[152:155], v[200:203], a[144:147], v[152:155]
    s_add_u32 s41, s38, 0x5c4000
    ds_read_b128 v[168:171], v14 offset:3072
    v_mfma_f32_16x16x32_bf16 v[152:155], v[204:207], a[152:155], v[152:155]
    s_add_u32 m0, s73, 0x1800
    ds_read_b128 v[172:175], v14 offset:12288
    v_mfma_f32_16x16x32_bf16 v[152:155], v[208:211], a[160:163], v[152:155]
    s_add_u32 s46, s37, 0x5e8000
    ds_read_b128 v[176:179], v14 offset:21504
    v_mfma_f32_16x16x32_bf16 v[152:155], v[212:215], a[168:171], v[152:155]
    ds_read_b128 v[180:183], v14 offset:30720
    v_mfma_f32_16x16x32_bf16 v[156:159], v[212:215], a[172:175], v[156:159]
    buffer_load_dwordx4 v1, s[88:91], s41 offen sc1 lds
    v_mfma_f32_16x16x32_bf16 v[156:159], v[208:211], a[164:167], v[156:159]
    s_add_u32 m0, s69, 0x1400
    v_mfma_f32_16x16x32_bf16 v[156:159], v[204:207], a[156:159], v[156:159]
    buffer_load_dwordx4 v1, s[88:91], s46 offen sc1 lds
    v_mfma_f32_16x16x32_bf16 v[156:159], v[200:203], a[148:151], v[156:159]
    s_waitcnt vmcnt(23) lgkmcnt(4)
    v_mfma_f32_16x16x32_bf16 v[108:111], v[216:219], a[180:183], v[108:111]
    s_add_u32 s41, s38, 0x5e8000
    ds_read_b128 v[200:203], v14 offset:4096
    v_mfma_f32_16x16x32_bf16 v[108:111], v[220:223], a[188:191], v[108:111]
    s_add_u32 m0, s69, 0x1800
    ds_read_b128 v[204:207], v14 offset:13312
    v_mfma_f32_16x16x32_bf16 v[108:111], v[224:227], a[196:199], v[108:111]
    s_add_u32 s46, s37, 0x60c000
    ds_read_b128 v[208:211], v14 offset:22528
    v_mfma_f32_16x16x32_bf16 v[108:111], v[228:231], a[204:207], v[108:111]
    ds_read_b128 v[212:215], v14 offset:31744
    v_mfma_f32_16x16x32_bf16 v[104:107], v[228:231], a[200:203], v[104:107]
    buffer_load_dwordx4 v1, s[88:91], s41 offen sc1 lds
    v_mfma_f32_16x16x32_bf16 v[104:107], v[224:227], a[192:195], v[104:107]
    s_add_u32 m0, s74, 0x1400
    v_mfma_f32_16x16x32_bf16 v[104:107], v[220:223], a[184:187], v[104:107]
    buffer_load_dwordx4 v1, s[88:91], s46 offen sc1 lds
    v_mfma_f32_16x16x32_bf16 v[104:107], v[216:219], a[176:179], v[104:107]
    s_waitcnt lgkmcnt(4)
    v_mfma_f32_16x16x32_bf16 v[112:115], v[168:171], a[176:179], v[112:115]
    s_add_u32 s41, s38, 0x60c000
    ds_read_b128 v[216:219], v12 offset:2048
    v_mfma_f32_16x16x32_bf16 v[112:115], v[172:175], a[184:187], v[112:115]
    s_add_u32 m0, s74, 0x1800
    ds_read_b128 v[220:223], v12 offset:11264
    v_mfma_f32_16x16x32_bf16 v[112:115], v[176:179], a[192:195], v[112:115]
    s_add_u32 s46, s39, 0x5c4000
    ds_read_b128 v[224:227], v12 offset:20480
    v_mfma_f32_16x16x32_bf16 v[112:115], v[180:183], a[200:203], v[112:115]
    ds_read_b128 v[228:231], v12 offset:29696
    v_mfma_f32_16x16x32_bf16 v[116:119], v[180:183], a[204:207], v[116:119]
    buffer_load_dwordx4 v1, s[88:91], s41 offen sc1 lds
    v_mfma_f32_16x16x32_bf16 v[116:119], v[176:179], a[196:199], v[116:119]
    s_add_u32 m0, s73, 0x1c00
    v_mfma_f32_16x16x32_bf16 v[116:119], v[172:175], a[188:191], v[116:119]
    buffer_load_dwordx4 v1, s[88:91], s46 offen sc1 lds
    v_mfma_f32_16x16x32_bf16 v[116:119], v[168:171], a[180:183], v[116:119]
    s_waitcnt lgkmcnt(4)
    v_mfma_f32_16x16x32_bf16 v[124:127], v[200:203], a[180:183], v[124:127]
    s_add_u32 s41, s40, 0x5c4000
L_hop1_5:
    s_cbranch_execz L_hop1_9
    ds_read_b128 v[168:171], v12 offset:3072
    v_mfma_f32_16x16x32_bf16 v[124:127], v[204:207], a[188:191], v[124:127]
    s_add_u32 m0, s73, 0x2000
    ds_read_b128 v[172:175], v12 offset:12288
    v_mfma_f32_16x16x32_bf16 v[124:127], v[208:211], a[196:199], v[124:127]
    s_add_u32 s46, s39, 0x5e8000
    ds_read_b128 v[176:179], v12 offset:21504
    v_mfma_f32_16x16x32_bf16 v[124:127], v[212:215], a[204:207], v[124:127]
    ds_read_b128 v[180:183], v12 offset:30720
    v_mfma_f32_16x16x32_bf16 v[120:123], v[212:215], a[200:203], v[120:123]
    buffer_load_dwordx4 v1, s[88:91], s41 offen sc1 lds
    v_mfma_f32_16x16x32_bf16 v[120:123], v[208:211], a[192:195], v[120:123]
    s_add_u32 m0, s69, 0x1c00
    v_mfma_f32_16x16x32_bf16 v[120:123], v[204:207], a[184:187], v[120:123]
    buffer_load_dwordx4 v1, s[88:91], s46 offen sc1 lds
    v_mfma_f32_16x16x32_bf16 v[120:123], v[200:203], a[176:179], v[120:123]
    s_waitcnt vmcnt(18) lgkmcnt(4)
    v_mfma_f32_16x16x32_bf16 v[104:107], v[216:219], a[208:211], v[104:107]
    s_add_u32 s41, s40, 0x5e8000
    ds_read_b128 v[200:203], v12 offset:4096
    v_mfma_f32_16x16x32_bf16 v[104:107], v[220:223], a[216:219], v[104:107]
    s_add_u32 m0, s69, 0x2000
    ds_read_b128 v[204:207], v12 offset:13312
    v_mfma_f32_16x16x32_bf16 v[104:107], v[224:227], a[224:227], v[104:107]
    s_add_u32 s46, s39, 0x60c000
    ds_read_b128 v[208:211], v12 offset:22528
    v_mfma_f32_16x16x32_bf16 v[104:107], v[228:231], a[232:235], v[104:107]
    ds_read_b128 v[212:215], v12 offset:31744
    v_mfma_f32_16x16x32_bf16 v[108:111], v[228:231], a[236:239], v[108:111]
    buffer_load_dwordx4 v1, s[88:91], s41 offen sc1 lds
    v_mfma_f32_16x16x32_bf16 v[108:111], v[224:227], a[228:231], v[108:111]
    s_add_u32 m0, s74, 0x1c00
    v_mfma_f32_16x16x32_bf16 v[108:111], v[220:223], a[220:223], v[108:111]
    buffer_load_dwordx4 v1, s[88:91], s46 offen sc1 lds
    v_mfma_f32_16x16x32_bf16 v[108:111], v[216:219], a[212:215], v[108:111]
    s_waitcnt lgkmcnt(4)
    v_mfma_f32_16x16x32_bf16 v[116:119], v[168:171], a[212:215], v[116:119]
    s_add_u32 s41, s40, 0x60c000
    ds_read_b128 v[216:219], v1 offset:38912
    v_mfma_f32_16x16x32_bf16 v[116:119], v[172:175], a[220:223], v[116:119]
    s_add_u32 m0, s74, 0x2000
    ds_read_b128 v[220:223], v1 offset:48128
    v_mfma_f32_16x16x32_bf16 v[116:119], v[176:179], a[228:231], v[116:119]
    s_add_u32 s46, s28, 0x5c4000
    ds_read_b128 v[224:227], v2 offset:28672
    v_mfma_f32_16x16x32_bf16 v[116:119], v[180:183], a[236:239], v[116:119]
    ds_read_b128 v[228:231], v2 offset:37888
    v_mfma_f32_16x16x32_bf16 v[112:115], v[180:183], a[232:235], v[112:115]
    buffer_load_dwordx4 v1, s[88:91], s41 offen sc1 lds
    v_mfma_f32_16x16x32_bf16 v[112:115], v[176:179], a[224:227], v[112:115]
    s_add_u32 m0, s73, 0x0
    v_mfma_f32_16x16x32_bf16 v[112:115], v[172:175], a[216:219], v[112:115]
    buffer_load_dwordx4 v1, s[88:91], s46 offen sc1 lds
    v_mfma_f32_16x16x32_bf16 v[112:115], v[168:171], a[208:211], v[112:115]
    s_waitcnt lgkmcnt(4)
    v_mfma_f32_16x16x32_bf16 v[120:123], v[200:203], a[208:211], v[120:123]
    s_add_u32 s41, s29, 0x5c4000
    ds_read_b128 v[168:171], v1 offset:39936
    v_mfma_f32_16x16x32_bf16 v[120:123], v[204:207], a[216:219], v[120:123]
    s_add_u32 m0, s73, 0x400
    ds_read_b128 v[172:175], v1 offset:49152
    v_mfma_f32_16x16x32_bf16 v[120:123], v[208:211], a[224:227], v[120:123]
    s_add_u32 s46, s28, 0x5e8000
    ds_read_b128 v[176:179], v2 offset:29696
    v_mfma_f32_16x16x32_bf16 v[120:123], v[212:215], a[232:235], v[120:123]
    ds_read_b128 v[180:183], v2 offset:38912
    v_mfma_f32_16x16x32_bf16 v[124:127], v[212:215], a[236:239], v[124:127]
    buffer_load_dwordx4 v1, s[88:91], s41 offen sc1 lds
    v_mfma_f32_16x16x32_bf16 v[124:127], v[208:211], a[228:231], v[124:127]
    s_add_u32 m0, s69, 0x0
    v_mfma_f32_16x16x32_bf16 v[124:127], v[204:207], a[220:223], v[124:127]
    buffer_load_dwordx4 v1, s[88:91], s46 offen sc1 lds
    v_mfma_f32_16x16x32_bf16 v[124:127], v[200:203], a[212:215], v[124:127]
    s_waitcnt vmcnt(15) lgkmcnt(4)
    v_mfma_f32_16x16x32_bf16 v[108:111], v[216:219], a[36:39], v[108:111]
    s_add_u32 s41, s29, 0x5e8000
    ds_read_b128 v[200:203], v1 offset:40960
    v_mfma_f32_16x16x32_bf16 v[108:111], v[220:223], a[44:47], v[108:111]
    s_add_u32 m0, s69, 0x400
    ds_read_b128 v[204:207], v1 offset:50176
    v_mfma_f32_16x16x32_bf16 v[108:111], v[224:227], a[52:55], v[108:111]
    s_add_u32 s46, s28, 0x60c000
    ds_read_b128 v[208:211], v2 offset:30720
    v_mfma_f32_16x16x32_bf16 v[108:111], v[228:231], a[60:63], v[108:111]
    ds_read_b128 v[212:215], v2 offset:39936
    v_mfma_f32_16x16x32_bf16 v[104:107], v[228:231], a[56:59], v[104:107]
    buffer_load_dwordx4 v1, s[88:91], s41 offen sc1 lds
    v_mfma_f32_16x16x32_bf16 v[104:107], v[224:227], a[48:51], v[104:107]
    s_add_u32 m0, s74, 0x0
    v_mfma_f32_16x16x32_bf16 v[104:107], v[220:223], a[40:43], v[104:107]
    buffer_load_dwordx4 v1, s[88:91], s46 offen sc1 lds
    v_mfma_f32_16x16x32_bf16 v[104:107], v[216:219], a[32:35], v[104:107]
    s_waitcnt vmcnt(11) lgkmcnt(4)
    s_barrier
    v_mfma_f32_16x16x32_bf16 v[112:115], v[168:171], a[32:35], v[112:115]
    s_add_u32 s41, s29, 0x60c000
    ds_read_b128 v[216:219], v14 offset:5120
    v_mfma_f32_16x16x32_bf16 v[112:115], v[172:175], a[40:43], v[112:115]
    s_add_u32 m0, s74, 0x400
    ds_read_b128 v[220:223], v14 offset:14336
    v_mfma_f32_16x16x32_bf16 v[112:115], v[176:179], a[48:51], v[112:115]
    ds_read_b128 v[224:227], v14 offset:23552
    v_mfma_f32_16x16x32_bf16 v[112:115], v[180:183], a[56:59], v[112:115]
    s_waitcnt vmcnt(21)
    ds_read_b128 v[228:231], v14 offset:32768
    v_cmp_eq_u32 vcc, 0, v8
    v_mfma_f32_16x16x32_bf16 v[116:119], v[180:183], a[60:63], v[116:119]
    buffer_load_dwordx4 v1, s[88:91], s41 offen sc1 lds
    v_mfma_f32_16x16x32_bf16 v[116:119], v[176:179], a[52:55], v[116:119]
    v_cvt_pk_bf16_f32 v160, v104, v105
    v_cvt_pk_bf16_f32 v161, v106, v107
    v_mfma_f32_16x16x32_bf16 v[116:119], v[172:175], a[44:47], v[116:119]
    v_cvt_pk_bf16_f32 v162, v108, v109
    v_cvt_pk_bf16_f32 v163, v110, v111
    v_mfma_f32_16x16x32_bf16 v[116:119], v[168:171], a[36:39], v[116:119]
    s_waitcnt lgkmcnt(4)
    v_min_u32 v160, -2, v160
    v_min_u32 v161, -2, v161
    s_cbranch_vccnz L_d_spin
L_d_ret:
    v_mfma_f32_16x16x32_bf16 v[124:127], v[200:203], a[36:39], v[124:127]
    ds_read_b128 v[168:171], v14 offset:6144
    v_min_u32 v162, -2, v162
    v_mfma_f32_16x16x32_bf16 v[124:127], v[204:207], a[44:47], v[124:127]
    ds_read_b128 v[172:175], v14 offset:15360
    v_min_u32 v163, -2, v163
    v_mfma_f32_16x16x32_bf16 v[124:127], v[208:211], a[52:55], v[124:127]
    ds_read_b128 v[176:179], v14 offset:24576
    v_mfma_f32_16x16x32_bf16 v[124:127], v[212:215], a[60:63], v[124:127]
    ds_read_b128 v[180:183], v14 offset:33792
    v_mfma_f32_16x16x32_bf16 v[120:123], v[212:215], a[56:59], v[120:123]
    buffer_load_dwordx4 v[40:43], v1, s[4:7], s87 offen offset:0 sc1
    v_mfma_f32_16x16x32_bf16 v[120:123], v[208:211], a[48:51], v[120:123]
    buffer_load_dwordx4 v[44:47], v1, s[4:7], s87 offen offset:2048 sc1
    v_mfma_f32_16x16x32_bf16 v[120:123], v[204:207], a[40:43], v[120:123]
    buffer_load_dwordx4 v[48:51], v9, s[16:19], s87 offen offset:0 sc1
    v_mfma_f32_16x16x32_bf16 v[120:123], v[200:203], a[32:35], v[120:123]
    s_waitcnt lgkmcnt(4)
    v_cvt_pk_bf16_f32 v164, v112, v113
    v_cvt_pk_bf16_f32 v165, v114, v115
    v_mfma_f32_16x16x32_bf16 v[128:131], v[216:219], a[176:179], v[128:131]
    ds_read_b128 v[200:203], v12 offset:5120
    v_cvt_pk_bf16_f32 v166, v116, v117
    v_mfma_f32_16x16x32_bf16 v[128:131], v[220:223], a[184:187], v[128:131]
    ds_read_b128 v[204:207], v12 offset:14336
    v_cvt_pk_bf16_f32 v167, v118, v119
    v_mfma_f32_16x16x32_bf16 v[128:131], v[224:227], a[192:195], v[128:131]
    ds_read_b128 v[208:211], v12 offset:23552
    v_min_u32 v164, -2, v164
    v_mfma_f32_16x16x32_bf16 v[128:131], v[228:231], a[200:203], v[128:131]
    ds_read_b128 v[212:215], v12 offset:32768
    v_min_u32 v165, -2, v165
    v_mfma_f32_16x16x32_bf16 v[132:135], v[228:231], a[204:207], v[132:135]
    buffer_load_dwordx4 v[52:55], v1, s[4:7], s86 offen offset:0 sc1
    v_mfma_f32_16x16x32_bf16 v[132:135], v[224:227], a[196:199], v[132:135]
    buffer_load_dwordx4 v[56:59], v1, s[4:7], s86 offen offset:2048 sc1
    v_mfma_f32_16x16x32_bf16 v[132:135], v[220:223], a[188:191], v[132:135]
    buffer_load_dwordx4 v[60:63], v9, s[16:19], s86 offen offset:0 sc1
    v_mfma_f32_16x16x32_bf16 v[132:135], v[216:219], a[180:183], v[132:135]
    s_waitcnt lgkmcnt(4)
    v_min_u32 v166, -2, v166
    v_min_u32 v167, -2, v167
    v_mfma_f32_16x16x32_bf16 v[140:143], v[168:171], a[180:183], v[140:143]
    ds_read_b128 v[216:219], v12 offset:6144
    v_cvt_pk_bf16_f32 v184, v120, v121
    v_mfma_f32_16x16x32_bf16 v[140:143], v[172:175], a[188:191], v[140:143]
    ds_read_b128 v[220:223], v12 offset:15360
    v_cvt_pk_bf16_f32 v185, v122, v123
    v_mfma_f32_16x16x32_bf16 v[140:143], v[176:179], a[196:199], v[140:143]
    ds_read_b128 v[224:227], v12 offset:24576
    v_cvt_pk_bf16_f32 v186, v124, v125
    v_mfma_f32_16x16x32_bf16 v[140:143], v[180:183], a[204:207], v[140:143]
    ds_read_b128 v[228:231], v12 offset:33792
    v_cvt_pk_bf16_f32 v187, v126, v127
    v_mfma_f32_16x16x32_bf16 v[136:139], v[180:183], a[200:203], v[136:139]
    buffer_load_dwordx4 v[64:67], v1, s[4:7], s85 offen offset:0 sc1
    v_mfma_f32_16x16x32_bf16 v[136:139], v[176:179], a[192:195], v[136:139]
    buffer_load_dwordx4 v[68:71], v1, s[4:7], s85 offen offset:2048 sc1
    v_mfma_f32_16x16x32_bf16 v[136:139], v[172:175], a[184:187], v[136:139]
    buffer_load_dwordx4 v[72:75], v9, s[16:19], s85 offen offset:0 sc1
    v_mfma_f32_16x16x32_bf16 v[136:139], v[168:171], a[176:179], v[136:139]
    s_waitcnt lgkmcnt(4)
    v_min_u32 v184, -2, v184
    v_min_u32 v185, -2, v185
    v_mfma_f32_16x16x32_bf16 v[128:131], v[200:203], a[208:211], v[128:131]
    ds_read_b128 v[168:171], v1 offset:41984
    v_min_u32 v186, -2, v186
    v_mfma_f32_16x16x32_bf16 v[128:131], v[204:207], a[216:219], v[128:131]
    ds_read_b128 v[172:175], v1 offset:51200
    v_min_u32 v187, -2, v187
    v_mfma_f32_16x16x32_bf16 v[128:131], v[208:211], a[224:227], v[128:131]
    ds_read_b128 v[176:179], v2 offset:31744
    v_mfma_f32_16x16x32_bf16 v[128:131], v[212:215], a[232:235], v[128:131]
    ds_read_b128 v[180:183], v2 offset:40960
    v_mfma_f32_16x16x32_bf16 v[132:135], v[212:215], a[236:239], v[132:135]
    buffer_store_dwordx4 v[160:163], v1, s[4:7], s62 offen offset:1024 sc1
    v_mfma_f32_16x16x32_bf16 v[132:135], v[208:211], a[228:231], v[132:135]
    buffer_store_dwordx4 v[164:167], v1, s[4:7], s63 offen offset:1024 sc1
    v_mfma_f32_16x16x32_bf16 v[132:135], v[204:207], a[220:223], v[132:135]
    buffer_store_dwordx4 v[184:187], v1, s[4:7], s64 offen offset:1024 sc1
    v_mfma_f32_16x16x32_bf16 v[132:135], v[200:203], a[212:215], v[132:135]
    s_waitcnt lgkmcnt(4)
    v_mfma_f32_16x16x32_bf16 v[140:143], v[216:219], a[212:215], v[140:143]
    ds_read_b128 v[200:203], v1 offset:43008
    v_mfma_f32_16x16x32_bf16 v[140:143], v[220:223], a[220:223], v[140:143]
    ds_read_b128 v[204:207], v1 offset:52224
    v_mfma_f32_16x16x32_bf16 v[140:143], v[224:227], a[228:231], v[140:143]
    ds_read_b128 v[208:211], v2 offset:32768
    v_mfma_f32_16x16x32_bf16 v[140:143], v[228:231], a[236:239], v[140:143]
    ds_read_b128 v[212:215], v2 offset:41984
    v_mfma_f32_16x16x32_bf16 v[136:139], v[228:231], a[232:235], v[136:139]
    v_mfma_f32_16x16x32_bf16 v[136:139], v[224:227], a[224:227], v[136:139]
    v_mfma_f32_16x16x32_bf16 v[136:139], v[220:223], a[216:219], v[136:139]
    v_mfma_f32_16x16x32_bf16 v[136:139], v[216:219], a[208:211], v[136:139]
    s_waitcnt vmcnt(18) lgkmcnt(4)
    s_barrier
    v_mfma_f32_16x16x32_bf16 v[128:131], v[168:171], a[32:35], v[128:131]
    ds_read_b128 v[216:219], v14 offset:7168
    v_mfma_f32_16x16x32_bf16 v[128:131], v[172:175], a[40:43], v[128:131]
    ds_read_b128 v[220:223], v14 offset:16384
    v_mfma_f32_16x16x32_bf16 v[128:131], v[176:179], a[48:51], v[128:131]
    ds_read_b128 v[224:227], v14 offset:25600
    v_mfma_f32_16x16x32_bf16 v[128:131], v[180:183], a[56:59], v[128:131]
    ds_read_b128 v[228:231], v14 offset:34816
    v_mfma_f32_16x16x32_bf16 v[132:135], v[180:183], a[60:63], v[132:135]
    v_mfma_f32_16x16x32_bf16 v[132:135], v[176:179], a[52:55], v[132:135]
    v_mfma_f32_16x16x32_bf16 v[132:135], v[172:175], a[44:47], v[132:135]
    v_mfma_f32_16x16x32_bf16 v[132:135], v[168:171], a[36:39], v[132:135]
    s_waitcnt lgkmcnt(4)
    v_mfma_f32_16x16x32_bf16 v[140:143], v[200:203], a[36:39], v[140:143]
    ds_read_b128 v[168:171], v14 offset:8192
    v_mfma_f32_16x16x32_bf16 v[140:143], v[204:207], a[44:47], v[140:143]
    ds_read_b128 v[172:175], v14 offset:17408
    v_mfma_f32_16x16x32_bf16 v[140:143], v[208:211], a[52:55], v[140:143]
    ds_read_b128 v[176:179], v14 offset:26624
    v_mfma_f32_16x16x32_bf16 v[140:143], v[212:215], a[60:63], v[140:143]
    ds_read_b128 v[180:183], v14 offset:35840
    v_mfma_f32_16x16x32_bf16 v[136:139], v[212:215], a[56:59], v[136:139]
    v_mfma_f32_16x16x32_bf16 v[136:139], v[208:211], a[48:51], v[136:139]
    v_cvt_pk_bf16_f32 v188, v128, v129
    v_cvt_pk_bf16_f32 v189, v130, v131
    v_mfma_f32_16x16x32_bf16 v[136:139], v[204:207], a[40:43], v[136:139]
    v_cvt_pk_bf16_f32 v190, v132, v133
    v_cvt_pk_bf16_f32 v191, v134, v135
    v_mfma_f32_16x16x32_bf16 v[136:139], v[200:203], a[32:35], v[136:139]
    s_waitcnt lgkmcnt(4)
    v_min_u32 v188, -2, v188
    v_min_u32 v189, -2, v189
    v_mfma_f32_16x16x32_bf16 v[144:147], v[216:219], a[176:179], v[144:147]
    ds_read_b128 v[200:203], v12 offset:7168
    v_min_u32 v190, -2, v190
    v_mfma_f32_16x16x32_bf16 v[144:147], v[220:223], a[184:187], v[144:147]
    ds_read_b128 v[204:207], v12 offset:16384
    v_min_u32 v191, -2, v191
    v_mfma_f32_16x16x32_bf16 v[144:147], v[224:227], a[192:195], v[144:147]
    ds_read_b128 v[208:211], v12 offset:25600
    v_mfma_f32_16x16x32_bf16 v[144:147], v[228:231], a[200:203], v[144:147]
    ds_read_b128 v[212:215], v12 offset:34816
    v_mfma_f32_16x16x32_bf16 v[148:151], v[228:231], a[204:207], v[148:151]
    buffer_store_dwordx4 v[188:191], v1, s[4:7], s65 offen offset:1024 sc1
    v_mfma_f32_16x16x32_bf16 v[148:151], v[224:227], a[196:199], v[148:151]
    v_cvt_pk_bf16_f32 v192, v136, v137
    v_cvt_pk_bf16_f32 v193, v138, v139
    v_mfma_f32_16x16x32_bf16 v[148:151], v[220:223], a[188:191], v[148:151]
    v_cvt_pk_bf16_f32 v194, v140, v141
    v_cvt_pk_bf16_f32 v195, v142, v143
    v_mfma_f32_16x16x32_bf16 v[148:151], v[216:219], a[180:183], v[148:151]
    s_waitcnt lgkmcnt(4)
    v_min_u32 v192, -2, v192
    v_min_u32 v193, -2, v193
    v_mfma_f32_16x16x32_bf16 v[156:159], v[168:171], a[180:183], v[156:159]
    ds_read_b128 v[216:219], v12 offset:8192
    v_min_u32 v194, -2, v194
    v_mfma_f32_16x16x32_bf16 v[156:159], v[172:175], a[188:191], v[156:159]
    ds_read_b128 v[220:223], v12 offset:17408
    v_min_u32 v195, -2, v195
    v_mfma_f32_16x16x32_bf16 v[156:159], v[176:179], a[196:199], v[156:159]
    ds_read_b128 v[224:227], v12 offset:26624
    v_mfma_f32_16x16x32_bf16 v[156:159], v[180:183], a[204:207], v[156:159]
    ds_read_b128 v[228:231], v12 offset:35840
    v_mfma_f32_16x16x32_bf16 v[152:155], v[180:183], a[200:203], v[152:155]
    buffer_store_dwordx4 v[192:195], v1, s[4:7], s66 offen offset:1024 sc1
    v_mfma_f32_16x16x32_bf16 v[152:155], v[176:179], a[192:195], v[152:155]
    v_mfma_f32_16x16x32_bf16 v[152:155], v[172:175], a[184:187], v[152:155]
    v_mfma_f32_16x16x32_bf16 v[152:155], v[168:171], a[176:179], v[152:155]
    s_waitcnt lgkmcnt(4)
    v_mfma_f32_16x16x32_bf16 v[144:147], v[200:203], a[208:211], v[144:147]
    ds_read_b128 v[168:171], v1 offset:44032
    v_mfma_f32_16x16x32_bf16 v[144:147], v[204:207], a[216:219], v[144:147]
    ds_read_b128 v[172:175], v1 offset:53248
    v_mfma_f32_16x16x32_bf16 v[144:147], v[208:211], a[224:227], v[144:147]
    ds_read_b128 v[176:179], v2 offset:33792
    v_mfma_f32_16x16x32_bf16 v[144:147], v[212:215], a[232:235], v[144:147]
    ds_read_b128 v[180:183], v2 offset:43008
    v_mfma_f32_16x16x32_bf16 v[148:151], v[212:215], a[236:239], v[148:151]
    v_mfma_f32_16x16x32_bf16 v[148:151], v[208:211], a[228:231], v[148:151]
    v_mfma_f32_16x16x32_bf16 v[148:151], v[204:207], a[220:223], v[148:151]
    v_mfma_f32_16x16x32_bf16 v[148:151], v[200:203], a[212:215], v[148:151]
    s_waitcnt lgkmcnt(4)
    v_mfma_f32_16x16x32_bf16 v[156:159], v[216:219], a[212:215], v[156:159]
    ds_read_b128 v[200:203], v1 offset:45056
    v_mfma_f32_16x16x32_bf16 v[156:159], v[220:223], a[220:223], v[156:159]
    ds_read_b128 v[204:207], v1 offset:54272
    v_mfma_f32_16x16x32_bf16 v[156:159], v[224:227], a[228:231], v[156:159]
    ds_read_b128 v[208:211], v2 offset:34816
    v_mfma_f32_16x16x32_bf16 v[156:159], v[228:231], a[236:239], v[156:159]
    ds_read_b128 v[212:215], v2 offset:44032
    v_mfma_f32_16x16x32_bf16 v[152:155], v[228:231], a[232:235], v[152:155]
    v_mfma_f32_16x16x32_bf16 v[152:155], v[224:227], a[224:227], v[152:155]
    v_mfma_f32_16x16x32_bf16 v[152:155], v[220:223], a[216:219], v[152:155]
    v_mfma_f32_16x16x32_bf16 v[152:155], v[216:219], a[208:211], v[152:155]
    s_waitcnt vmcnt(14) lgkmcnt(4)
    s_barrier
    v_mfma_f32_16x16x32_bf16 v[144:147], v[168:171], a[32:35], v[144:147]
    ds_read_b128 v[216:219], v14 offset:0
    v_mfma_f32_16x16x32_bf16 v[144:147], v[172:175], a[40:43], v[144:147]
    ds_read_b128 v[220:223], v14 offset:9216
    v_mfma_f32_16x16x32_bf16 v[144:147], v[176:179], a[48:51], v[144:147]
    ds_read_b128 v[224:227], v14 offset:18432
    v_mfma_f32_16x16x32_bf16 v[144:147], v[180:183], a[56:59], v[144:147]
    ds_read_b128 v[228:231], v14 offset:27648
    v_mfma_f32_16x16x32_bf16 v[148:151], v[180:183], a[60:63], v[148:151]
    v_mfma_f32_16x16x32_bf16 v[148:151], v[176:179], a[52:55], v[148:151]
    v_mfma_f32_16x16x32_bf16 v[148:151], v[172:175], a[44:47], v[148:151]
    v_mfma_f32_16x16x32_bf16 v[148:151], v[168:171], a[36:39], v[148:151]
    s_waitcnt lgkmcnt(4)
    v_mfma_f32_16x16x32_bf16 v[156:159], v[200:203], a[36:39], v[156:159]
    ds_read_b128 v[168:171], v14 offset:1024
    v_mfma_f32_16x16x32_bf16 v[156:159], v[204:207], a[44:47], v[156:159]
    ds_read_b128 v[172:175], v14 offset:10240
    v_mfma_f32_16x16x32_bf16 v[156:159], v[208:211], a[52:55], v[156:159]
    ds_read_b128 v[176:179], v14 offset:19456
    v_mfma_f32_16x16x32_bf16 v[156:159], v[212:215], a[60:63], v[156:159]
    s_waitcnt vmcnt(5)
    ds_read_b128 v[180:183], v14 offset:28672
    v_mfma_f32_16x16x32_bf16 v[152:155], v[212:215], a[56:59], v[152:155]
    v_mfma_f32_16x16x32_bf16 v[152:155], v[208:211], a[48:51], v[152:155]
    v_cvt_pk_bf16_f32 v196, v144, v145
    v_cvt_pk_bf16_f32 v197, v146, v147
    v_mfma_f32_16x16x32_bf16 v[152:155], v[204:207], a[40:43], v[152:155]
    v_cvt_pk_bf16_f32 v198, v148, v149
    v_cvt_pk_bf16_f32 v199, v150, v151
    v_mfma_f32_16x16x32_bf16 v[152:155], v[200:203], a[32:35], v[152:155]
    s_waitcnt lgkmcnt(4)
    v_min_u32 v196, -2, v196
    v_min_u32 v197, -2, v197
    v_mfma_f32_16x16x32_bf16 v[16:19], v[78:81], v[64:67], v[16:19]
    v_mfma_f32_16x16x32_bf16 v[16:19], v[78:81], v[52:55], v[16:19]
    v_mfma_f32_16x16x32_bf16 v[16:19], v[78:81], v[40:43], v[16:19]
    v_mfma_f32_16x16x32_bf16 v[20:23], v[76:79], v[64:67], v[20:23]
    v_mfma_f32_16x16x32_bf16 v[20:23], v[76:79], v[52:55], v[20:23]
    v_mfma_f32_16x16x32_bf16 v[20:23], v[76:79], v[40:43], v[20:23]
    v_mfma_f32_16x16x32_bf16 v[24:27], v[78:81], v[68:71], v[24:27]
    v_mfma_f32_16x16x32_bf16 v[24:27], v[78:81], v[56:59], v[24:27]
    v_mfma_f32_16x16x32_bf16 v[24:27], v[78:81], v[44:47], v[24:27]
    v_mfma_f32_16x16x32_bf16 v[28:31], v[76:79], v[68:71], v[28:31]
    v_mfma_f32_16x16x32_bf16 v[28:31], v[76:79], v[56:59], v[28:31]
    v_mfma_f32_16x16x32_bf16 v[28:31], v[76:79], v[44:47], v[28:31]
    v_mfma_f32_16x16x32_bf16 v[32:35], v[78:81], v[72:75], v[32:35]
    v_mfma_f32_16x16x32_bf16 v[32:35], v[78:81], v[60:63], v[32:35]
    v_mfma_f32_16x16x32_bf16 v[32:35], v[78:81], v[48:51], v[32:35]
    v_mfma_f32_16x16x32_bf16 v[36:39], v[76:79], v[72:75], v[36:39]
    v_mfma_f32_16x16x32_bf16 v[36:39], v[76:79], v[60:63], v[36:39]
    v_mfma_f32_16x16x32_bf16 v[36:39], v[76:79], v[48:51], v[36:39]
    v_mfma_f32_16x16x32_bf16 v[88:91], v[216:219], a[176:179], v[88:91]
    ds_read_b128 v[200:203], v12 offset:0
    v_min_u32 v198, -2, v198
    v_mfma_f32_16x16x32_bf16 v[88:91], v[220:223], a[184:187], v[88:91]
    ds_read_b128 v[204:207], v12 offset:9216
    v_min_u32 v199, -2, v199
    v_mfma_f32_16x16x32_bf16 v[88:91], v[224:227], a[192:195], v[88:91]
    ds_read_b128 v[208:211], v12 offset:18432
    v_mfma_f32_16x16x32_bf16 v[88:91], v[228:231], a[200:203], v[88:91]
    ds_read_b128 v[212:215], v12 offset:27648
    v_mfma_f32_16x16x32_bf16 v[92:95], v[228:231], a[204:207], v[92:95]
    buffer_store_dwordx4 v[196:199], v1, s[4:7], s67 offen offset:1024 sc1
    v_mfma_f32_16x16x32_bf16 v[92:95], v[224:227], a[196:199], v[92:95]
    v_cvt_pk_bf16_f32 v244, v152, v153
    v_cvt_pk_bf16_f32 v245, v154, v155
    v_mfma_f32_16x16x32_bf16 v[92:95], v[220:223], a[188:191], v[92:95]
    v_cvt_pk_bf16_f32 v246, v156, v157
    v_cvt_pk_bf16_f32 v247, v158, v159
    v_mfma_f32_16x16x32_bf16 v[92:95], v[216:219], a[180:183], v[92:95]
    s_waitcnt lgkmcnt(4)
    v_min_u32 v244, -2, v244
    v_min_u32 v245, -2, v245
    v_mfma_f32_16x16x32_bf16 v[100:103], v[168:171], a[180:183], v[100:103]
    ds_read_b128 v[216:219], v12 offset:1024
    v_min_u32 v246, -2, v246
    v_mfma_f32_16x16x32_bf16 v[100:103], v[172:175], a[188:191], v[100:103]
    ds_read_b128 v[220:223], v12 offset:10240
    v_min_u32 v247, -2, v247
    v_mfma_f32_16x16x32_bf16 v[100:103], v[176:179], a[196:199], v[100:103]
    ds_read_b128 v[224:227], v12 offset:19456
    v_mul_f32 v248, s49, v16
    v_mfma_f32_16x16x32_bf16 v[100:103], v[180:183], a[204:207], v[100:103]
    ds_read_b128 v[228:231], v12 offset:28672
    v_mul_f32 v249, s49, v17
    v_mfma_f32_16x16x32_bf16 v[96:99], v[180:183], a[200:203], v[96:99]
    buffer_store_dwordx4 v[244:247], v1, s[4:7], s68 offen offset:1024 sc1
    v_mfma_f32_16x16x32_bf16 v[96:99], v[176:179], a[192:195], v[96:99]
    v_mul_f32 v250, s49, v18
    v_mul_f32 v251, s49, v19
    v_mfma_f32_16x16x32_bf16 v[96:99], v[172:175], a[184:187], v[96:99]
    v_mul_f32 v252, s49, v20
    v_mul_f32 v253, s49, v21
    v_mfma_f32_16x16x32_bf16 v[96:99], v[168:171], a[176:179], v[96:99]
    s_waitcnt lgkmcnt(4)
    v_mul_f32 v254, s49, v22
    v_mul_f32 v255, s49, v23
    v_mfma_f32_16x16x32_bf16 v[88:91], v[200:203], a[208:211], v[88:91]
    ds_read_b128 v[168:171], v1 offset:36864
    v_lshlrev_b32 v40, 16, v232
    v_mfma_f32_16x16x32_bf16 v[88:91], v[204:207], a[216:219], v[88:91]
    ds_read_b128 v[172:175], v1 offset:46080
    v_and_b32 v41, 0xffff0000, v232
    v_mfma_f32_16x16x32_bf16 v[88:91], v[208:211], a[224:227], v[88:91]
    ds_read_b128 v[176:179], v2 offset:26624
    v_lshlrev_b32 v42, 16, v233
    v_mfma_f32_16x16x32_bf16 v[88:91], v[212:215], a[232:235], v[88:91]
    ds_read_b128 v[180:183], v2 offset:35840
    v_and_b32 v43, 0xffff0000, v233
    v_mfma_f32_16x16x32_bf16 v[92:95], v[212:215], a[236:239], v[92:95]
    v_exp_f32 v248, v248
    v_mfma_f32_16x16x32_bf16 v[92:95], v[208:211], a[228:231], v[92:95]
    buffer_load_dwordx4 v[112:115], v1, s[4:7], s87 offen offset:1024 sc1
    v_mfma_f32_16x16x32_bf16 v[92:95], v[204:207], a[220:223], v[92:95]
    buffer_load_dwordx4 v[116:119], v1, s[4:7], s87 offen offset:3072 sc1
    v_mfma_f32_16x16x32_bf16 v[92:95], v[200:203], a[212:215], v[92:95]
    s_waitcnt lgkmcnt(4)
    v_exp_f32 v249, v249
    v_mfma_f32_16x16x32_bf16 v[100:103], v[216:219], a[212:215], v[100:103]
    ds_read_b128 v[200:203], v1 offset:37888
    v_add_f32 v248, 1.0, v248
    v_mfma_f32_16x16x32_bf16 v[100:103], v[220:223], a[220:223], v[100:103]
    ds_read_b128 v[204:207], v1 offset:47104
    v_add_f32 v249, 1.0, v249
    v_mfma_f32_16x16x32_bf16 v[100:103], v[224:227], a[228:231], v[100:103]
    ds_read_b128 v[208:211], v2 offset:27648
    v_lshlrev_b32 v44, 16, v234
    v_mfma_f32_16x16x32_bf16 v[100:103], v[228:231], a[236:239], v[100:103]
    ds_read_b128 v[212:215], v2 offset:36864
    v_and_b32 v45, 0xffff0000, v234
    v_mfma_f32_16x16x32_bf16 v[96:99], v[228:231], a[232:235], v[96:99]
    buffer_load_dwordx4 v[120:123], v9, s[16:19], s87 offen offset:1024 sc1
    v_mfma_f32_16x16x32_bf16 v[96:99], v[224:227], a[224:227], v[96:99]
    v_exp_f32 v250, v250
    v_mfma_f32_16x16x32_bf16 v[96:99], v[220:223], a[216:219], v[96:99]
    v_exp_f32 v251, v251
    v_mfma_f32_16x16x32_bf16 v[96:99], v[216:219], a[208:211], v[96:99]
    s_waitcnt lgkmcnt(4)
    v_exp_f32 v252, v252
    v_mfma_f32_16x16x32_bf16 v[88:91], v[168:171], a[32:35], v[88:91]
    v_exp_f32 v253, v253
    v_mfma_f32_16x16x32_bf16 v[88:91], v[172:175], a[40:43], v[88:91]
    v_exp_f32 v254, v254
    v_mfma_f32_16x16x32_bf16 v[88:91], v[176:179], a[48:51], v[88:91]
    v_exp_f32 v255, v255
    v_mfma_f32_16x16x32_bf16 v[88:91], v[180:183], a[56:59], v[88:91]
    buffer_load_dwordx4 v[124:127], v1, s[4:7], s86 offen offset:1024 sc1
    v_mfma_f32_16x16x32_bf16 v[92:95], v[180:183], a[60:63], v[92:95]
    buffer_load_dwordx4 v[128:131], v1, s[4:7], s86 offen offset:3072 sc1
    v_mfma_f32_16x16x32_bf16 v[92:95], v[176:179], a[52:55], v[92:95]
    buffer_load_dwordx4 v[132:135], v9, s[16:19], s86 offen offset:1024 sc1
    v_mfma_f32_16x16x32_bf16 v[92:95], v[172:175], a[44:47], v[92:95]
    v_add_f32 v250, 1.0, v250
    v_add_f32 v251, 1.0, v251
    v_mfma_f32_16x16x32_bf16 v[92:95], v[168:171], a[36:39], v[92:95]
    s_waitcnt lgkmcnt(0)
    v_add_f32 v252, 1.0, v252
    v_add_f32 v253, 1.0, v253
    v_mfma_f32_16x16x32_bf16 v[100:103], v[200:203], a[36:39], v[100:103]
    v_add_f32 v254, 1.0, v254
    v_add_f32 v255, 1.0, v255
    v_mfma_f32_16x16x32_bf16 v[100:103], v[204:207], a[44:47], v[100:103]
    v_rcp_f32 v248, v248
    v_mfma_f32_16x16x32_bf16 v[100:103], v[208:211], a[52:55], v[100:103]
    v_rcp_f32 v249, v249
    v_mfma_f32_16x16x32_bf16 v[100:103], v[212:215], a[60:63], v[100:103]
    v_rcp_f32 v250, v250
    v_mfma_f32_16x16x32_bf16 v[96:99], v[212:215], a[56:59], v[96:99]
    v_rcp_f32 v251, v251
    v_mfma_f32_16x16x32_bf16 v[96:99], v[208:211], a[48:51], v[96:99]
    v_rcp_f32 v252, v252
    v_mfma_f32_16x16x32_bf16 v[96:99], v[204:207], a[40:43], v[96:99]
    v_rcp_f32 v253, v253
    v_mfma_f32_16x16x32_bf16 v[96:99], v[200:203], a[32:35], v[96:99]
    v_rcp_f32 v254, v254
    buffer_load_dwordx4 v[136:139], v1, s[4:7], s85 offen offset:1024 sc1
    buffer_load_dwordx4 v[140:143], v1, s[4:7], s85 offen offset:3072 sc1
    buffer_load_dwordx4 v[144:147], v9, s[16:19], s85 offen offset:1024 sc1
    v_rcp_f32 v255, v255
    v_mul_f32 v16, v16, v248
    v_mul_f32 v17, v17, v249
    v_mul_f32 v18, v18, v250
    v_mul_f32 v19, v19, v251
    v_mul_f32 v20, v20, v252
    v_mul_f32 v21, v21, v253
    v_mul_f32 v22, v22, v254
    v_mul_f32 v23, v23, v255
    v_lshlrev_b32 v46, 16, v235
    v_and_b32 v47, 0xffff0000, v235
    v_mul_f32 v64, s49, v24
    v_mul_f32 v65, s49, v25
    v_mul_f32 v66, s49, v26
    v_mul_f32 v67, s49, v27
    v_mul_f32 v68, s49, v28
    v_mul_f32 v69, s49, v29
    v_mul_f32 v70, s49, v30
    v_mul_f32 v71, s49, v31
    v_exp_f32 v64, v64
    v_exp_f32 v65, v65
    v_exp_f32 v66, v66
    v_exp_f32 v67, v67
    v_exp_f32 v68, v68
    v_exp_f32 v69, v69
    v_exp_f32 v70, v70
    v_exp_f32 v71, v71
    v_add_f32 v64, 1.0, v64
    v_add_f32 v65, 1.0, v65
    v_add_f32 v66, 1.0, v66
    v_add_f32 v67, 1.0, v67
    v_add_f32 v68, 1.0, v68
    v_add_f32 v69, 1.0, v69
    v_add_f32 v70, 1.0, v70
    v_add_f32 v71, 1.0, v71
    v_rcp_f32 v64, v64
    v_rcp_f32 v65, v65
    v_rcp_f32 v66, v66
    v_rcp_f32 v67, v67
    v_rcp_f32 v68, v68
    v_rcp_f32 v69, v69
    v_rcp_f32 v70, v70
    v_rcp_f32 v71, v71
    v_mul_f32 v24, v24, v64
    v_mul_f32 v25, v25, v65
    v_mul_f32 v26, v26, v66
    v_mul_f32 v27, v27, v67
    v_mul_f32 v28, v28, v68
    v_mul_f32 v29, v29, v69
    v_mul_f32 v30, v30, v70
    v_mul_f32 v31, v31, v71
    v_lshlrev_b32 v48, 16, v236
    v_and_b32 v49, 0xffff0000, v236
    v_lshlrev_b32 v50, 16, v237
    v_and_b32 v51, 0xffff0000, v237
    v_lshlrev_b32 v52, 16, v238
    v_and_b32 v53, 0xffff0000, v238
    v_lshlrev_b32 v54, 16, v239
    v_and_b32 v55, 0xffff0000, v239
    v_mul_f32 v248, s49, v32
    v_mul_f32 v249, s49, v33
    v_mul_f32 v250, s49, v34
    v_mul_f32 v251, s49, v35
    v_mul_f32 v252, s49, v36
    v_mul_f32 v253, s49, v37
    v_mul_f32 v254, s49, v38
    v_mul_f32 v255, s49, v39
    v_exp_f32 v248, v248
    v_exp_f32 v249, v249
    v_exp_f32 v250, v250
    v_exp_f32 v251, v251
    v_exp_f32 v252, v252
    v_exp_f32 v253, v253
    v_exp_f32 v254, v254
    v_exp_f32 v255, v255
    v_add_f32 v248, 1.0, v248
    v_add_f32 v249, 1.0, v249
    v_add_f32 v250, 1.0, v250
    v_add_f32 v251, 1.0, v251
    v_add_f32 v252, 1.0, v252
    v_add_f32 v253, 1.0, v253
    v_add_f32 v254, 1.0, v254
    v_add_f32 v255, 1.0, v255
    v_rcp_f32 v248, v248
    v_rcp_f32 v249, v249
    v_rcp_f32 v250, v250
    v_rcp_f32 v251, v251
    v_rcp_f32 v252, v252
    v_rcp_f32 v253, v253
    v_rcp_f32 v254, v254
    v_rcp_f32 v255, v255
    v_mul_f32 v32, v32, v248
    v_mul_f32 v33, v33, v249
    v_mul_f32 v34, v34, v250
    v_mul_f32 v35, v35, v251
    v_mul_f32 v36, v36, v252
    v_mul_f32 v37, v37, v253
    v_mul_f32 v38, v38, v254
    v_mul_f32 v39, v39, v255
    v_lshlrev_b32 v56, 16, v240
    v_and_b32 v57, 0xffff0000, v240
    v_lshlrev_b32 v58, 16, v241
    v_and_b32 v59, 0xffff0000, v241
    v_lshlrev_b32 v60, 16, v242
    v_and_b32 v61, 0xffff0000, v242
    v_lshlrev_b32 v62, 16, v243
    v_and_b32 v63, 0xffff0000, v243
    s_waitcnt vmcnt(3)
    v_max3_u32 v248, v112, v113, v114
    v_max3_u32 v249, v115, v116, v117
    v_max3_u32 v250, v118, v119, v120
    v_max3_u32 v251, v121, v122, v123
    v_max3_u32 v248, v248, v124, v125
    v_max3_u32 v249, v249, v126, v127
    v_max3_u32 v250, v250, v128, v129
    v_max3_u32 v251, v251, v130, v131
    v_max3_u32 v248, v248, v132, v133
    v_max3_u32 v249, v249, v134, v135
    v_max3_u32 v248, v248, v249, v250
L_hop1_6:
    s_cbranch_execz L_hop1_10
    v_max_u32 v248, v248, v251
    v_cmp_eq_u32 vcc, -1, v248
    s_cbranch_vccnz L_r_spin
L_r_ret:
    v_mfma_f32_16x16x32_bf16 v[88:91], v[78:81], v[112:115], v[88:91]
    v_mfma_f32_16x16x32_bf16 v[88:91], v[78:81], v[124:127], v[88:91]
    v_mfma_f32_16x16x32_bf16 v[92:95], v[76:79], v[112:115], v[92:95]
    v_mfma_f32_16x16x32_bf16 v[92:95], v[76:79], v[124:127], v[92:95]
    v_mfma_f32_16x16x32_bf16 v[96:99], v[78:81], v[116:119], v[96:99]
    v_mfma_f32_16x16x32_bf16 v[96:99], v[78:81], v[128:131], v[96:99]
    v_mfma_f32_16x16x32_bf16 v[100:103], v[76:79], v[116:119], v[100:103]
    v_mfma_f32_16x16x32_bf16 v[100:103], v[76:79], v[128:131], v[100:103]
    v_mfma_f32_16x16x32_bf16 v[104:107], v[78:81], v[120:123], v[104:107]
    v_mfma_f32_16x16x32_bf16 v[104:107], v[78:81], v[132:135], v[104:107]
    v_mfma_f32_16x16x32_bf16 v[108:111], v[76:79], v[120:123], v[108:111]
    v_mfma_f32_16x16x32_bf16 v[108:111], v[76:79], v[132:135], v[108:111]
    s_waitcnt vmcnt(0)
    v_max3_u32 v248, v136, v137, v138
    v_max3_u32 v249, v139, v140, v141
    v_max3_u32 v250, v142, v143, v144
    v_max3_u32 v251, v145, v146, v147
    v_max3_u32 v248, v248, v249, v250
    v_max_u32 v248, v248, v251
    v_cmp_eq_u32 vcc, -1, v248
    s_cbranch_vccnz L_s_spin
L_s_ret:
    v_mfma_f32_16x16x32_bf16 v[88:91], v[78:81], v[136:139], v[88:91]
    v_mfma_f32_16x16x32_bf16 v[96:99], v[78:81], v[140:143], v[96:99]
    v_mfma_f32_16x16x32_bf16 v[92:95], v[76:79], v[136:139], v[92:95]
    v_mfma_f32_16x16x32_bf16 v[100:103], v[76:79], v[140:143], v[100:103]
    v_mfma_f32_16x16x32_bf16 v[104:107], v[78:81], v[144:147], v[104:107]
    v_mfma_f32_16x16x32_bf16 v[108:111], v[76:79], v[144:147], v[108:111]
    s_nop 2
    v_fmac_f32 v40, v88, v16
    v_fmac_f32 v41, v89, v17
    v_fmac_f32 v42, v90, v18
    v_fmac_f32 v43, v91, v19
    v_fmac_f32 v48, v96, v24
    v_fmac_f32 v49, v97, v25
    v_fmac_f32 v50, v98, v26
    v_fmac_f32 v51, v99, v27
    v_cvt_pk_bf16_f32 v232, v40, v41
    v_cvt_pk_bf16_f32 v233, v42, v43
    v_cvt_pk_bf16_f32 v234, v48, v49
    v_cvt_pk_bf16_f32 v235, v50, v51
    s_nop 0
    v_permlane16_swap_b32 v232, v234
    v_permlane16_swap_b32 v233, v235
    buffer_store_dwordx4 v[232:235], v5, s[12:15], s83 offen sc1
    v_fmac_f32 v44, v92, v20
    v_fmac_f32 v45, v93, v21
    v_fmac_f32 v46, v94, v22
    v_fmac_f32 v47, v95, v23
    v_fmac_f32 v52, v100, v28
    v_fmac_f32 v53, v101, v29
    v_fmac_f32 v54, v102, v30
    v_fmac_f32 v55, v103, v31
    v_cvt_pk_bf16_f32 v236, v44, v45
    v_cvt_pk_bf16_f32 v237, v46, v47
    v_cvt_pk_bf16_f32 v238, v52, v53
    v_cvt_pk_bf16_f32 v239, v54, v55
    s_nop 0
    v_permlane16_swap_b32 v236, v238
    v_permlane16_swap_b32 v237, v239
    buffer_store_dwordx4 v[236:239], v6, s[12:15], s83 offen sc1
    s_cmp_lg_u32 s18, 0
    s_cbranch_scc0 L_k2_done
    v_fmac_f32 v56, v104, v32
    v_fmac_f32 v57, v105, v33
    v_fmac_f32 v58, v106, v34
    v_fmac_f32 v59, v107, v35
    v_fmac_f32 v60, v108, v36
    v_fmac_f32 v61, v109, v37
    v_fmac_f32 v62, v110, v38
    v_fmac_f32 v63, v111, v39
    v_cvt_pk_bf16_f32 v240, v56, v57
    v_cvt_pk_bf16_f32 v241, v58, v59
    v_cvt_pk_bf16_f32 v242, v60, v61
    v_cvt_pk_bf16_f32 v243, v62, v63
    s_nop 0
    v_permlane16_swap_b32 v240, v242
    v_permlane16_swap_b32 v241, v243
    buffer_store_dwordx4 v[240:243], v15, s[12:15], s1 offen sc1
L_k2_done:
L_k2_end:
    s_endpgm
L_a_spin:
    s_mov_b32 s55, 0x100000
L_a_loop:
    buffer_load_dwordx4 v[32:35], v1, s[4:7], s53 offen sc1
    s_sub_u32 s55, s55, 1
    s_waitcnt vmcnt(0)
    v_and_b32 v32, v32, v33
    v_and_b32 v34, v34, v35
    v_and_b32 v32, v32, v34
    v_cmp_eq_u32 vcc, 0, v32
    s_cmp_eq_u32 s55, 0
    s_cbranch_scc1 L_a_ret
    s_cbranch_vccnz L_a_loop
    s_branch L_a_ret
L_b0_spin:
    s_mov_b32 s55, 0x100000
L_b0_loop:
    buffer_load_dword v8, v10, s[4:7], s81 offen sc1
    s_sub_u32 s55, s55, 1
    s_waitcnt vmcnt(0)
    v_cmp_eq_u32 vcc, 0, v8
    s_cmp_eq_u32 s55, 0
    s_cbranch_scc1 L_b0_ret
    s_cbranch_vccnz L_b0_loop
    s_branch L_b0_ret
L_b1_spin:
    s_mov_b32 s55, 0x100000
L_b1_loop:
    buffer_load_dword v8, v10, s[4:7], s81 offen sc1
    s_sub_u32 s55, s55, 1
    s_waitcnt vmcnt(0)
    v_cmp_eq_u32 vcc, 0, v8
    s_cmp_eq_u32 s55, 0
    s_cbranch_scc1 L_b1_ret
    s_cbranch_vccnz L_b1_loop
    s_branch L_b1_ret
L_b2_spin:
    s_mov_b32 s55, 0x100000
L_b2_loop:
    buffer_load_dword v8, v10, s[4:7], s81 offen sc1
    s_sub_u32 s55, s55, 1
    s_waitcnt vmcnt(0)
    v_cmp_eq_u32 vcc, 0, v8
    s_cmp_eq_u32 s55, 0
    s_cbranch_scc1 L_b2_ret
    s_cbranch_vccnz L_b2_loop
    s_branch L_b2_ret
L_b3_spin:
    s_mov_b32 s55, 0x100000
L_b3_loop:
    buffer_load_dword v8, v10, s[4:7], s81 offen sc1
    s_sub_u32 s55, s55, 1
    s_waitcnt vmcnt(0)
    v_cmp_eq_u32 vcc, 0, v8
    s_cmp_eq_u32 s55, 0
    s_cbranch_scc1 L_b3_ret
    s_cbranch_vccnz L_b3_loop
    s_branch L_b3_ret
L_d_spin:
    s_mov_b32 s55, 0x100000
L_d_loop:
    buffer_load_dword v8, v10, s[4:7], s50 offen sc1
    s_sub_u32 s55, s55, 1
    s_waitcnt vmcnt(0)
    v_cmp_eq_u32 vcc, 0, v8
    s_cmp_eq_u32 s55, 0
    s_cbranch_scc1 L_d_ret
    s_cbranch_vccnz L_d_loop
    s_branch L_d_ret
L_r_spin:
L_hop1_7:
    s_cbranch_execz L_hop1_11
    s_mov_b32 s55, 0x100000
L_r_loop:
    buffer_load_dwordx4 v[112:115], v1, s[4:7], s87 offen offset:1024 sc1
    buffer_load_dwordx4 v[116:119], v1, s[4:7], s87 offen offset:3072 sc1
    buffer_load_dwordx4 v[120:123], v9, s[16:19], s87 offen offset:1024 sc1
    buffer_load_dwordx4 v[124:127], v1, s[4:7], s86 offen offset:1024 sc1
    buffer_load_dwordx4 v[128:131], v1, s[4:7], s86 offen offset:3072 sc1
    buffer_load_dwordx4 v[132:135], v9, s[16:19], s86 offen offset:1024 sc1
    s_sub_u32 s55, s55, 1
    s_waitcnt vmcnt(0)
    v_max3_u32 v248, v112, v113, v114
    v_max3_u32 v249, v115, v116, v117
    v_max3_u32 v250, v118, v119, v120
    v_max3_u32 v251, v121, v122, v123
    v_max3_u32 v248, v248, v124, v125
    v_max3_u32 v249, v249, v126, v127
    v_max3_u32 v250, v250, v128, v129
    v_max3_u32 v251, v251, v130, v131
    v_max3_u32 v248, v248, v132, v133
    v_max3_u32 v249, v249, v134, v135
    v_max3_u32 v248, v248, v249, v250
    v_max_u32 v248, v248, v251
    v_cmp_eq_u32 vcc, -1, v248
    s_cmp_eq_u32 s55, 0
    s_cbranch_scc1 L_r_ret
    s_cbranch_vccnz L_r_loop
    s_branch L_r_ret
L_s_spin:
    s_mov_b32 s55, 0x100000
L_s_loop:
    buffer_load_dwordx4 v[136:139], v1, s[4:7], s85 offen offset:1024 sc1
    buffer_load_dwordx4 v[140:143], v1, s[4:7], s85 offen offset:3072 sc1
    buffer_load_dwordx4 v[144:147], v9, s[16:19], s85 offen offset:1024 sc1
    s_sub_u32 s55, s55, 1
    s_waitcnt vmcnt(0)
    v_max3_u32 v248, v136, v137, v138
    v_max3_u32 v249, v139, v140, v141
    v_max3_u32 v250, v142, v143, v144
    v_max3_u32 v251, v145, v146, v147
    v_max3_u32 v248, v248, v249, v250
    v_max_u32 v248, v248, v251
    v_cmp_eq_u32 vcc, -1, v248
    s_cmp_eq_u32 s55, 0
    s_cbranch_scc1 L_s_ret
    s_cbranch_vccnz L_s_loop
    s_branch L_s_ret
L_k2_br1:
L_hop1_8:
    s_cbranch_execz L_hop1_12
    v_mfma_f32_16x16x32_bf16 v[16:19], v[216:219], a[176:179], v[16:19]
    s_add_u32 s41, s28, 0x510000
    ds_read_b128 v[200:203], v13 offset:2048
    v_mfma_f32_16x16x32_bf16 v[16:19], v[220:223], a[184:187], v[16:19]
    s_add_u32 m0, s69, 0x0
    ds_read_b128 v[204:207], v13 offset:11264
    v_mfma_f32_16x16x32_bf16 v[16:19], v[224:227], a[192:195], v[16:19]
    s_add_u32 s46, s29, 0x510000
    ds_read_b128 v[208:211], v13 offset:20480
    v_mfma_f32_16x16x32_bf16 v[16:19], v[228:231], a[200:203], v[16:19]
    ds_read_b128 v[212:215], v13 offset:29696
    v_mfma_f32_16x16x32_bf16 v[20:23], v[228:231], a[204:207], v[20:23]
    buffer_load_dwordx4 v1, s[88:91], s41 offen sc1 lds
    v_mfma_f32_16x16x32_bf16 v[20:23], v[224:227], a[196:199], v[20:23]
    s_add_u32 m0, s69, 0x400
    v_mfma_f32_16x16x32_bf16 v[20:23], v[220:223], a[188:191], v[20:23]
    buffer_load_dwordx4 v1, s[88:91], s46 offen sc1 lds
    v_mfma_f32_16x16x32_bf16 v[20:23], v[216:219], a[180:183], v[20:23]
    s_waitcnt lgkmcnt(4)
    v_mfma_f32_16x16x32_bf16 v[28:31], v[168:171], a[180:183], v[28:31]
    s_add_u32 s41, s30, 0x510000
    ds_read_b128 v[216:219], v13 offset:3072
    v_mfma_f32_16x16x32_bf16 v[28:31], v[172:175], a[188:191], v[28:31]
    s_add_u32 m0, s69, 0x800
    ds_read_b128 v[220:223], v13 offset:12288
    v_mfma_f32_16x16x32_bf16 v[28:31], v[176:179], a[196:199], v[28:31]
    s_add_u32 s46, s31, 0x510000
    ds_read_b128 v[224:227], v13 offset:21504
    v_mfma_f32_16x16x32_bf16 v[28:31], v[180:183], a[204:207], v[28:31]
    ds_read_b128 v[228:231], v13 offset:30720
    v_mfma_f32_16x16x32_bf16 v[24:27], v[180:183], a[200:203], v[24:27]
    buffer_load_dwordx4 v1, s[88:91], s41 offen sc1 lds
    v_mfma_f32_16x16x32_bf16 v[24:27], v[176:179], a[192:195], v[24:27]
    s_add_u32 m0, s69, 0xc00
    v_mfma_f32_16x16x32_bf16 v[24:27], v[172:175], a[184:187], v[24:27]
    buffer_load_dwordx4 v1, s[88:91], s46 offen sc1 lds
    v_mfma_f32_16x16x32_bf16 v[24:27], v[168:171], a[176:179], v[24:27]
    s_waitcnt lgkmcnt(4)
    v_mfma_f32_16x16x32_bf16 v[32:35], v[200:203], a[176:179], v[32:35]
    s_add_u32 s41, s36, 0x510000
    ds_read_b128 v[168:171], v13 offset:4096
    v_mfma_f32_16x16x32_bf16 v[32:35], v[204:207], a[184:187], v[32:35]
    s_add_u32 m0, s69, 0x1000
    ds_read_b128 v[172:175], v13 offset:13312
    v_mfma_f32_16x16x32_bf16 v[32:35], v[208:211], a[192:195], v[32:35]
    s_add_u32 s46, s37, 0x510000
    ds_read_b128 v[176:179], v13 offset:22528
    v_mfma_f32_16x16x32_bf16 v[32:35], v[212:215], a[200:203], v[32:35]
    ds_read_b128 v[180:183], v13 offset:31744
    v_mfma_f32_16x16x32_bf16 v[36:39], v[212:215], a[204:207], v[36:39]
    buffer_load_dwordx4 v1, s[88:91], s41 offen sc1 lds
    v_mfma_f32_16x16x32_bf16 v[36:39], v[208:211], a[196:199], v[36:39]
    s_add_u32 m0, s69, 0x1400
    v_mfma_f32_16x16x32_bf16 v[36:39], v[204:207], a[188:191], v[36:39]
    buffer_load_dwordx4 v1, s[88:91], s46 offen sc1 lds
    v_mfma_f32_16x16x32_bf16 v[36:39], v[200:203], a[180:183], v[36:39]
    s_waitcnt lgkmcnt(4)
    v_mfma_f32_16x16x32_bf16 v[44:47], v[216:219], a[180:183], v[44:47]
    s_add_u32 s41, s38, 0x510000
    ds_read_b128 v[200:203], v13 offset:5120
    v_mfma_f32_16x16x32_bf16 v[44:47], v[220:223], a[188:191], v[44:47]
    s_add_u32 m0, s69, 0x1800
    ds_read_b128 v[204:207], v13 offset:14336
    v_mfma_f32_16x16x32_bf16 v[44:47], v[224:227], a[196:199], v[44:47]
    s_add_u32 s46, s39, 0x510000
    ds_read_b128 v[208:211], v13 offset:23552
    v_mfma_f32_16x16x32_bf16 v[44:47], v[228:231], a[204:207], v[44:47]
    s_waitcnt vmcnt(6)
    ds_read_b128 v[212:215], v13 offset:32768
    v_cmp_eq_u32 vcc, 0, v8
    v_mfma_f32_16x16x32_bf16 v[40:43], v[228:231], a[200:203], v[40:43]
    buffer_load_dwordx4 v1, s[88:91], s41 offen sc1 lds
    v_mfma_f32_16x16x32_bf16 v[40:43], v[224:227], a[192:195], v[40:43]
    s_add_u32 m0, s69, 0x1c00
    v_mfma_f32_16x16x32_bf16 v[40:43], v[220:223], a[184:187], v[40:43]
    buffer_load_dwordx4 v1, s[88:91], s46 offen sc1 lds
    v_mfma_f32_16x16x32_bf16 v[40:43], v[216:219], a[176:179], v[40:43]
    s_waitcnt lgkmcnt(4)
    s_cbranch_vccnz L_b1_spin
L_b1_ret:
    v_mfma_f32_16x16x32_bf16 v[48:51], v[168:171], a[176:179], v[48:51]
    s_add_u32 s41, s43, 0x1800000
    ds_read_b128 v[216:219], v13 offset:6144
    v_mfma_f32_16x16x32_bf16 v[48:51], v[172:175], a[184:187], v[48:51]
    ds_read_b128 v[220:223], v13 offset:15360
    v_mfma_f32_16x16x32_bf16 v[48:51], v[176:179], a[192:195], v[48:51]
    s_add_u32 s46, s43, 0x1800000
    ds_read_b128 v[224:227], v13 offset:24576
    v_mfma_f32_16x16x32_bf16 v[48:51], v[180:183], a[200:203], v[48:51]
    ds_read_b128 v[228:231], v13 offset:33792
    v_mfma_f32_16x16x32_bf16 v[52:55], v[180:183], a[204:207], v[52:55]
    buffer_load_dwordx4 a[32:35], v1, s[4:7], s41 offen offset:0 sc1
    v_mfma_f32_16x16x32_bf16 v[52:55], v[176:179], a[196:199], v[52:55]
    v_mfma_f32_16x16x32_bf16 v[52:55], v[172:175], a[188:191], v[52:55]
    buffer_load_dwordx4 a[36:39], v1, s[4:7], s46 offen offset:1024 sc1
    v_mfma_f32_16x16x32_bf16 v[52:55], v[168:171], a[180:183], v[52:55]
    s_waitcnt lgkmcnt(4)
    v_mfma_f32_16x16x32_bf16 v[60:63], v[200:203], a[180:183], v[60:63]
    s_add_u32 s41, s43, 0x1801000
    ds_read_b128 v[168:171], v13 offset:7168
    v_mfma_f32_16x16x32_bf16 v[60:63], v[204:207], a[188:191], v[60:63]
    ds_read_b128 v[172:175], v13 offset:16384
    v_mfma_f32_16x16x32_bf16 v[60:63], v[208:211], a[196:199], v[60:63]
    s_add_u32 s46, s43, 0x1801000
    ds_read_b128 v[176:179], v13 offset:25600
    v_mfma_f32_16x16x32_bf16 v[60:63], v[212:215], a[204:207], v[60:63]
    ds_read_b128 v[180:183], v13 offset:34816
    v_mfma_f32_16x16x32_bf16 v[56:59], v[212:215], a[200:203], v[56:59]
    buffer_load_dwordx4 a[40:43], v1, s[4:7], s41 offen offset:0 sc1
    v_mfma_f32_16x16x32_bf16 v[56:59], v[208:211], a[192:195], v[56:59]
    v_mfma_f32_16x16x32_bf16 v[56:59], v[204:207], a[184:187], v[56:59]
    buffer_load_dwordx4 a[44:47], v1, s[4:7], s46 offen offset:1024 sc1
    v_mfma_f32_16x16x32_bf16 v[56:59], v[200:203], a[176:179], v[56:59]
    s_waitcnt lgkmcnt(4)
    v_mfma_f32_16x16x32_bf16 v[64:67], v[216:219], a[176:179], v[64:67]
    s_add_u32 s41, s43, 0x1802000
    ds_read_b128 v[200:203], v13 offset:8192
    v_mfma_f32_16x16x32_bf16 v[64:67], v[220:223], a[184:187], v[64:67]
    ds_read_b128 v[204:207], v13 offset:17408
    v_mfma_f32_16x16x32_bf16 v[64:67], v[224:227], a[192:195], v[64:67]
    s_add_u32 s46, s43, 0x1802000
    ds_read_b128 v[208:211], v13 offset:26624
    v_mfma_f32_16x16x32_bf16 v[64:67], v[228:231], a[200:203], v[64:67]
    ds_read_b128 v[212:215], v13 offset:35840
    v_mfma_f32_16x16x32_bf16 v[68:71], v[228:231], a[204:207], v[68:71]
    buffer_load_dwordx4 a[48:51], v1, s[4:7], s41 offen offset:0 sc1
    v_mfma_f32_16x16x32_bf16 v[68:71], v[224:227], a[196:199], v[68:71]
    v_mfma_f32_16x16x32_bf16 v[68:71], v[220:223], a[188:191], v[68:71]
    buffer_load_dwordx4 a[52:55], v1, s[4:7], s46 offen offset:1024 sc1
    v_mfma_f32_16x16x32_bf16 v[68:71], v[216:219], a[180:183], v[68:71]
    s_waitcnt vmcnt(17) lgkmcnt(4)
    s_barrier
    v_mfma_f32_16x16x32_bf16 v[76:79], v[168:171], a[180:183], v[76:79]
    s_add_u32 s41, s40, 0x510000
    ds_read_b128 v[216:219], v14 offset:0
    v_mfma_f32_16x16x32_bf16 v[76:79], v[172:175], a[188:191], v[76:79]
    s_add_u32 m0, s69, 0x2000
    ds_read_b128 v[220:223], v14 offset:9216
    v_mfma_f32_16x16x32_bf16 v[76:79], v[176:179], a[196:199], v[76:79]
    s_add_u32 s46, s43, 0x1803000
    ds_read_b128 v[224:227], v14 offset:18432
    v_mfma_f32_16x16x32_bf16 v[76:79], v[180:183], a[204:207], v[76:79]
    ds_read_b128 v[228:231], v14 offset:27648
    v_mfma_f32_16x16x32_bf16 v[72:75], v[180:183], a[200:203], v[72:75]
    buffer_load_dwordx4 v1, s[88:91], s41 offen sc1 lds
    v_mfma_f32_16x16x32_bf16 v[72:75], v[176:179], a[192:195], v[72:75]
    v_mfma_f32_16x16x32_bf16 v[72:75], v[172:175], a[184:187], v[72:75]
    buffer_load_dwordx4 a[56:59], v1, s[4:7], s46 offen offset:0 sc1
    v_mfma_f32_16x16x32_bf16 v[72:75], v[168:171], a[176:179], v[72:75]
    s_waitcnt lgkmcnt(4)
    v_mfma_f32_16x16x32_bf16 v[80:83], v[200:203], a[176:179], v[80:83]
    s_add_u32 s41, s43, 0x1803000
    ds_read_b128 v[168:171], v14 offset:1024
    v_mfma_f32_16x16x32_bf16 v[80:83], v[204:207], a[184:187], v[80:83]
    ds_read_b128 v[172:175], v14 offset:10240
    v_mfma_f32_16x16x32_bf16 v[80:83], v[208:211], a[192:195], v[80:83]
    ds_read_b128 v[176:179], v14 offset:19456
    v_mfma_f32_16x16x32_bf16 v[80:83], v[212:215], a[200:203], v[80:83]
    ds_read_b128 v[180:183], v14 offset:28672
    v_mfma_f32_16x16x32_bf16 v[84:87], v[212:215], a[204:207], v[84:87]
    buffer_load_dwordx4 a[60:63], v1, s[4:7], s41 offen offset:1024 sc1
    v_mfma_f32_16x16x32_bf16 v[84:87], v[208:211], a[196:199], v[84:87]
    v_mfma_f32_16x16x32_bf16 v[84:87], v[204:207], a[188:191], v[84:87]
    v_mfma_f32_16x16x32_bf16 v[84:87], v[200:203], a[180:183], v[84:87]
    s_waitcnt vmcnt(18) lgkmcnt(4)
    v_mfma_f32_16x16x32_bf16 v[20:23], v[216:219], a[212:215], v[20:23]
    s_add_u32 s41, s28, 0x534000
    ds_read_b128 v[200:203], v14 offset:2048
    v_mfma_f32_16x16x32_bf16 v[20:23], v[220:223], a[220:223], v[20:23]
    s_add_u32 m0, s72, 0x0
    ds_read_b128 v[204:207], v14 offset:11264
    v_mfma_f32_16x16x32_bf16 v[20:23], v[224:227], a[228:231], v[20:23]
    s_add_u32 s46, s29, 0x534000
    ds_read_b128 v[208:211], v14 offset:20480
    v_mfma_f32_16x16x32_bf16 v[20:23], v[228:231], a[236:239], v[20:23]
    ds_read_b128 v[212:215], v14 offset:29696
    v_mfma_f32_16x16x32_bf16 v[16:19], v[228:231], a[232:235], v[16:19]
    buffer_load_dwordx4 v1, s[88:91], s41 offen sc1 lds
    v_mfma_f32_16x16x32_bf16 v[16:19], v[224:227], a[224:227], v[16:19]
    s_add_u32 m0, s72, 0x400
    v_mfma_f32_16x16x32_bf16 v[16:19], v[220:223], a[216:219], v[16:19]
    buffer_load_dwordx4 v1, s[88:91], s46 offen sc1 lds
    v_mfma_f32_16x16x32_bf16 v[16:19], v[216:219], a[208:211], v[16:19]
    s_waitcnt lgkmcnt(4)
    v_mfma_f32_16x16x32_bf16 v[24:27], v[168:171], a[208:211], v[24:27]
    s_add_u32 s41, s30, 0x534000
    ds_read_b128 v[216:219], v14 offset:3072
    v_mfma_f32_16x16x32_bf16 v[24:27], v[172:175], a[216:219], v[24:27]
    s_add_u32 m0, s72, 0x800
    ds_read_b128 v[220:223], v14 offset:12288
    v_mfma_f32_16x16x32_bf16 v[24:27], v[176:179], a[224:227], v[24:27]
    s_add_u32 s46, s31, 0x534000
    ds_read_b128 v[224:227], v14 offset:21504
    v_mfma_f32_16x16x32_bf16 v[24:27], v[180:183], a[232:235], v[24:27]
    ds_read_b128 v[228:231], v14 offset:30720
    v_mfma_f32_16x16x32_bf16 v[28:31], v[180:183], a[236:239], v[28:31]
    buffer_load_dwordx4 v1, s[88:91], s41 offen sc1 lds
    v_mfma_f32_16x16x32_bf16 v[28:31], v[176:179], a[228:231], v[28:31]
    s_add_u32 m0, s72, 0xc00
    v_mfma_f32_16x16x32_bf16 v[28:31], v[172:175], a[220:223], v[28:31]
    buffer_load_dwordx4 v1, s[88:91], s46 offen sc1 lds
    v_mfma_f32_16x16x32_bf16 v[28:31], v[168:171], a[212:215], v[28:31]
    s_waitcnt lgkmcnt(4)
    v_mfma_f32_16x16x32_bf16 v[36:39], v[200:203], a[212:215], v[36:39]
    s_add_u32 s41, s36, 0x534000
    ds_read_b128 v[168:171], v14 offset:4096
    v_mfma_f32_16x16x32_bf16 v[36:39], v[204:207], a[220:223], v[36:39]
    s_add_u32 m0, s72, 0x1000
    ds_read_b128 v[172:175], v14 offset:13312
    v_mfma_f32_16x16x32_bf16 v[36:39], v[208:211], a[228:231], v[36:39]
    s_add_u32 s46, s37, 0x534000
    ds_read_b128 v[176:179], v14 offset:22528
    v_mfma_f32_16x16x32_bf16 v[36:39], v[212:215], a[236:239], v[36:39]
    ds_read_b128 v[180:183], v14 offset:31744
    v_mfma_f32_16x16x32_bf16 v[32:35], v[212:215], a[232:235], v[32:35]
    buffer_load_dwordx4 v1, s[88:91], s41 offen sc1 lds
    v_mfma_f32_16x16x32_bf16 v[32:35], v[208:211], a[224:227], v[32:35]
    s_add_u32 m0, s72, 0x1400
    v_mfma_f32_16x16x32_bf16 v[32:35], v[204:207], a[216:219], v[32:35]
    buffer_load_dwordx4 v1, s[88:91], s46 offen sc1 lds
    v_mfma_f32_16x16x32_bf16 v[32:35], v[200:203], a[208:211], v[32:35]
    s_waitcnt lgkmcnt(4)
    v_mfma_f32_16x16x32_bf16 v[40:43], v[216:219], a[208:211], v[40:43]
    s_add_u32 s41, s38, 0x534000
    ds_read_b128 v[200:203], v14 offset:5120
    v_mfma_f32_16x16x32_bf16 v[40:43], v[220:223], a[216:219], v[40:43]
    s_add_u32 m0, s72, 0x1800
    ds_read_b128 v[204:207], v14 offset:14336
    v_mfma_f32_16x16x32_bf16 v[40:43], v[224:227], a[224:227], v[40:43]
    s_add_u32 s46, s39, 0x534000
    ds_read_b128 v[208:211], v14 offset:23552
    v_mfma_f32_16x16x32_bf16 v[40:43], v[228:231], a[232:235], v[40:43]
    ds_read_b128 v[212:215], v14 offset:32768
    v_mfma_f32_16x16x32_bf16 v[44:47], v[228:231], a[236:239], v[44:47]
    buffer_load_dwordx4 v1, s[88:91], s41 offen sc1 lds
    v_mfma_f32_16x16x32_bf16 v[44:47], v[224:227], a[228:231], v[44:47]
    s_add_u32 m0, s72, 0x1c00
    v_mfma_f32_16x16x32_bf16 v[44:47], v[220:223], a[220:223], v[44:47]
    buffer_load_dwordx4 v1, s[88:91], s46 offen sc1 lds
    v_mfma_f32_16x16x32_bf16 v[44:47], v[216:219], a[212:215], v[44:47]
    s_waitcnt lgkmcnt(4)
    v_mfma_f32_16x16x32_bf16 v[52:55], v[168:171], a[212:215], v[52:55]
    s_add_u32 s41, s43, 0x1804000
    ds_read_b128 v[216:219], v14 offset:6144
    v_mfma_f32_16x16x32_bf16 v[52:55], v[172:175], a[220:223], v[52:55]
    ds_read_b128 v[220:223], v14 offset:15360
    v_mfma_f32_16x16x32_bf16 v[52:55], v[176:179], a[228:231], v[52:55]
    s_add_u32 s46, s43, 0x1804000
    ds_read_b128 v[224:227], v14 offset:24576
    v_mfma_f32_16x16x32_bf16 v[52:55], v[180:183], a[236:239], v[52:55]
    ds_read_b128 v[228:231], v14 offset:33792
    v_mfma_f32_16x16x32_bf16 v[48:51], v[180:183], a[232:235], v[48:51]
    buffer_load_dwordx4 a[64:67], v1, s[4:7], s41 offen offset:0 sc1
    v_mfma_f32_16x16x32_bf16 v[48:51], v[176:179], a[224:227], v[48:51]
    v_mfma_f32_16x16x32_bf16 v[48:51], v[172:175], a[216:219], v[48:51]
    buffer_load_dwordx4 a[68:71], v1, s[4:7], s46 offen offset:1024 sc1
    v_mfma_f32_16x16x32_bf16 v[48:51], v[168:171], a[208:211], v[48:51]
    s_waitcnt lgkmcnt(4)
    v_mfma_f32_16x16x32_bf16 v[56:59], v[200:203], a[208:211], v[56:59]
    s_add_u32 s41, s43, 0x1805000
    ds_read_b128 v[168:171], v14 offset:7168
    v_mfma_f32_16x16x32_bf16 v[56:59], v[204:207], a[216:219], v[56:59]
    ds_read_b128 v[172:175], v14 offset:16384
    v_mfma_f32_16x16x32_bf16 v[56:59], v[208:211], a[224:227], v[56:59]
    s_add_u32 s46, s43, 0x1805000
    ds_read_b128 v[176:179], v14 offset:25600
    v_mfma_f32_16x16x32_bf16 v[56:59], v[212:215], a[232:235], v[56:59]
    ds_read_b128 v[180:183], v14 offset:34816
    v_mfma_f32_16x16x32_bf16 v[60:63], v[212:215], a[236:239], v[60:63]
    buffer_load_dwordx4 a[72:75], v1, s[4:7], s41 offen offset:0 sc1
    v_mfma_f32_16x16x32_bf16 v[60:63], v[208:211], a[228:231], v[60:63]
    v_mfma_f32_16x16x32_bf16 v[60:63], v[204:207], a[220:223], v[60:63]
    buffer_load_dwordx4 a[76:79], v1, s[4:7], s46 offen offset:1024 sc1
    v_mfma_f32_16x16x32_bf16 v[60:63], v[200:203], a[212:215], v[60:63]
    s_waitcnt lgkmcnt(4)
    v_mfma_f32_16x16x32_bf16 v[68:71], v[216:219], a[212:215], v[68:71]
    s_add_u32 s41, s43, 0x1806000
    ds_read_b128 v[200:203], v14 offset:8192
    v_mfma_f32_16x16x32_bf16 v[68:71], v[220:223], a[220:223], v[68:71]
    ds_read_b128 v[204:207], v14 offset:17408
    v_mfma_f32_16x16x32_bf16 v[68:71], v[224:227], a[228:231], v[68:71]
    s_add_u32 s46, s43, 0x1806000
    ds_read_b128 v[208:211], v14 offset:26624
    v_mfma_f32_16x16x32_bf16 v[68:71], v[228:231], a[236:239], v[68:71]
    ds_read_b128 v[212:215], v14 offset:35840
    v_mfma_f32_16x16x32_bf16 v[64:67], v[228:231], a[232:235], v[64:67]
    buffer_load_dwordx4 a[80:83], v1, s[4:7], s41 offen offset:0 sc1
    v_mfma_f32_16x16x32_bf16 v[64:67], v[224:227], a[224:227], v[64:67]
    v_mfma_f32_16x16x32_bf16 v[64:67], v[220:223], a[216:219], v[64:67]
    buffer_load_dwordx4 a[84:87], v1, s[4:7], s46 offen offset:1024 sc1
    v_mfma_f32_16x16x32_bf16 v[64:67], v[216:219], a[208:211], v[64:67]
    s_waitcnt vmcnt(16) lgkmcnt(4)
    s_barrier
    v_mfma_f32_16x16x32_bf16 v[72:75], v[168:171], a[208:211], v[72:75]
    s_add_u32 s41, s40, 0x534000
    ds_read_b128 v[216:219], v12 offset:0
    v_mfma_f32_16x16x32_bf16 v[72:75], v[172:175], a[216:219], v[72:75]
    s_add_u32 m0, s72, 0x2000
    ds_read_b128 v[220:223], v12 offset:9216
    v_mfma_f32_16x16x32_bf16 v[72:75], v[176:179], a[224:227], v[72:75]
    s_add_u32 s46, s43, 0x1807000
    ds_read_b128 v[224:227], v12 offset:18432
    v_mfma_f32_16x16x32_bf16 v[72:75], v[180:183], a[232:235], v[72:75]
    ds_read_b128 v[228:231], v12 offset:27648
    v_mfma_f32_16x16x32_bf16 v[76:79], v[180:183], a[236:239], v[76:79]
    buffer_load_dwordx4 v1, s[88:91], s41 offen sc1 lds
    v_mfma_f32_16x16x32_bf16 v[76:79], v[176:179], a[228:231], v[76:79]
    v_mfma_f32_16x16x32_bf16 v[76:79], v[172:175], a[220:223], v[76:79]
    buffer_load_dwordx4 a[88:91], v1, s[4:7], s46 offen offset:0 sc1
    v_mfma_f32_16x16x32_bf16 v[76:79], v[168:171], a[212:215], v[76:79]
    s_waitcnt lgkmcnt(4)
    v_mfma_f32_16x16x32_bf16 v[84:87], v[200:203], a[212:215], v[84:87]
    s_add_u32 s41, s43, 0x1807000
    ds_read_b128 v[168:171], v12 offset:1024
    v_mfma_f32_16x16x32_bf16 v[84:87], v[204:207], a[220:223], v[84:87]
    ds_read_b128 v[172:175], v12 offset:10240
    v_mfma_f32_16x16x32_bf16 v[84:87], v[208:211], a[228:231], v[84:87]
    ds_read_b128 v[176:179], v12 offset:19456
    v_mfma_f32_16x16x32_bf16 v[84:87], v[212:215], a[236:239], v[84:87]
    ds_read_b128 v[180:183], v12 offset:28672
    v_mfma_f32_16x16x32_bf16 v[80:83], v[212:215], a[232:235], v[80:83]
    buffer_load_dwordx4 a[92:95], v1, s[4:7], s41 offen offset:1024 sc1
    v_mfma_f32_16x16x32_bf16 v[80:83], v[208:211], a[224:227], v[80:83]
    v_mfma_f32_16x16x32_bf16 v[80:83], v[204:207], a[216:219], v[80:83]
    v_mfma_f32_16x16x32_bf16 v[80:83], v[200:203], a[208:211], v[80:83]
    s_waitcnt vmcnt(17) lgkmcnt(4)
    s_branch L_k2_rest
L_k2_br2:
L_hop1_9:
    s_cbranch_execz L_hop1_ret
    v_mfma_f32_16x16x32_bf16 v[16:19], v[216:219], a[208:211], v[16:19]
    s_add_u32 s41, s28, 0x510000
    ds_read_b128 v[200:203], v14 offset:2048
    v_mfma_f32_16x16x32_bf16 v[16:19], v[220:223], a[216:219], v[16:19]
    s_add_u32 m0, s72, 0x0
    ds_read_b128 v[204:207], v14 offset:11264
    v_mfma_f32_16x16x32_bf16 v[16:19], v[224:227], a[224:227], v[16:19]
    s_add_u32 s46, s29, 0x510000
    ds_read_b128 v[208:211], v14 offset:20480
    v_mfma_f32_16x16x32_bf16 v[16:19], v[228:231], a[232:235], v[16:19]
    ds_read_b128 v[212:215], v14 offset:29696
    v_mfma_f32_16x16x32_bf16 v[20:23], v[228:231], a[236:239], v[20:23]
    buffer_load_dwordx4 v1, s[88:91], s41 offen sc1 lds
    v_mfma_f32_16x16x32_bf16 v[20:23], v[224:227], a[228:231], v[20:23]
    s_add_u32 m0, s72, 0x400
    v_mfma_f32_16x16x32_bf16 v[20:23], v[220:223], a[220:223], v[20:23]
    buffer_load_dwordx4 v1, s[88:91], s46 offen sc1 lds
    v_mfma_f32_16x16x32_bf16 v[20:23], v[216:219], a[212:215], v[20:23]
    s_waitcnt lgkmcnt(4)
    v_mfma_f32_16x16x32_bf16 v[28:31], v[168:171], a[212:215], v[28:31]
    s_add_u32 s41, s30, 0x510000
    ds_read_b128 v[216:219], v14 offset:3072
    v_mfma_f32_16x16x32_bf16 v[28:31], v[172:175], a[220:223], v[28:31]
    s_add_u32 m0, s72, 0x800
    ds_read_b128 v[220:223], v14 offset:12288
    v_mfma_f32_16x16x32_bf16 v[28:31], v[176:179], a[228:231], v[28:31]
    s_add_u32 s46, s31, 0x510000
    ds_read_b128 v[224:227], v14 offset:21504
    v_mfma_f32_16x16x32_bf16 v[28:31], v[180:183], a[236:239], v[28:31]
    ds_read_b128 v[228:231], v14 offset:30720
    v_mfma_f32_16x16x32_bf16 v[24:27], v[180:183], a[232:235], v[24:27]
    buffer_load_dwordx4 v1, s[88:91], s41 offen sc1 lds
    v_mfma_f32_16x16x32_bf16 v[24:27], v[176:179], a[224:227], v[24:27]
    s_add_u32 m0, s72, 0xc00
    v_mfma_f32_16x16x32_bf16 v[24:27], v[172:175], a[216:219], v[24:27]
    buffer_load_dwordx4 v1, s[88:91], s46 offen sc1 lds
    v_mfma_f32_16x16x32_bf16 v[24:27], v[168:171], a[208:211], v[24:27]
    s_waitcnt lgkmcnt(4)
    v_mfma_f32_16x16x32_bf16 v[32:35], v[200:203], a[208:211], v[32:35]
    s_add_u32 s41, s36, 0x510000
    ds_read_b128 v[168:171], v14 offset:4096
    v_mfma_f32_16x16x32_bf16 v[32:35], v[204:207], a[216:219], v[32:35]
    s_add_u32 m0, s72, 0x1000
    ds_read_b128 v[172:175], v14 offset:13312
    v_mfma_f32_16x16x32_bf16 v[32:35], v[208:211], a[224:227], v[32:35]
    s_add_u32 s46, s37, 0x510000
    ds_read_b128 v[176:179], v14 offset:22528
    v_mfma_f32_16x16x32_bf16 v[32:35], v[212:215], a[232:235], v[32:35]
    ds_read_b128 v[180:183], v14 offset:31744
    v_mfma_f32_16x16x32_bf16 v[36:39], v[212:215], a[236:239], v[36:39]
    buffer_load_dwordx4 v1, s[88:91], s41 offen sc1 lds
    v_mfma_f32_16x16x32_bf16 v[36:39], v[208:211], a[228:231], v[36:39]
    s_add_u32 m0, s72, 0x1400
    v_mfma_f32_16x16x32_bf16 v[36:39], v[204:207], a[220:223], v[36:39]
    buffer_load_dwordx4 v1, s[88:91], s46 offen sc1 lds
    v_mfma_f32_16x16x32_bf16 v[36:39], v[200:203], a[212:215], v[36:39]
    s_waitcnt lgkmcnt(4)
    v_mfma_f32_16x16x32_bf16 v[44:47], v[216:219], a[212:215], v[44:47]
    s_add_u32 s41, s38, 0x510000
    ds_read_b128 v[200:203], v14 offset:5120
    v_mfma_f32_16x16x32_bf16 v[44:47], v[220:223], a[220:223], v[44:47]
    s_add_u32 m0, s72, 0x1800
    ds_read_b128 v[204:207], v14 offset:14336
    v_mfma_f32_16x16x32_bf16 v[44:47], v[224:227], a[228:231], v[44:47]
    s_add_u32 s46, s39, 0x510000
    ds_read_b128 v[208:211], v14 offset:23552
    v_mfma_f32_16x16x32_bf16 v[44:47], v[228:231], a[236:239], v[44:47]
    s_waitcnt vmcnt(6)
    ds_read_b128 v[212:215], v14 offset:32768
    v_cmp_eq_u32 vcc, 0, v8
    v_mfma_f32_16x16x32_bf16 v[40:43], v[228:231], a[232:235], v[40:43]
L_hop1_10:
    s_cbranch_execz L_hop1_ret
    buffer_load_dwordx4 v1, s[88:91], s41 offen sc1 lds
    v_mfma_f32_16x16x32_bf16 v[40:43], v[224:227], a[224:227], v[40:43]
    s_add_u32 m0, s72, 0x1c00
    v_mfma_f32_16x16x32_bf16 v[40:43], v[220:223], a[216:219], v[40:43]
    buffer_load_dwordx4 v1, s[88:91], s46 offen sc1 lds
    v_mfma_f32_16x16x32_bf16 v[40:43], v[216:219], a[208:211], v[40:43]
    s_waitcnt lgkmcnt(4)
    s_cbranch_vccnz L_b2_spin
L_b2_ret:
    v_mfma_f32_16x16x32_bf16 v[48:51], v[168:171], a[208:211], v[48:51]
    s_add_u32 s41, s43, 0x1800000
    ds_read_b128 v[216:219], v14 offset:6144
    v_mfma_f32_16x16x32_bf16 v[48:51], v[172:175], a[216:219], v[48:51]
    ds_read_b128 v[220:223], v14 offset:15360
    v_mfma_f32_16x16x32_bf16 v[48:51], v[176:179], a[224:227], v[48:51]
    s_add_u32 s46, s43, 0x1800000
    ds_read_b128 v[224:227], v14 offset:24576
    v_mfma_f32_16x16x32_bf16 v[48:51], v[180:183], a[232:235], v[48:51]
    ds_read_b128 v[228:231], v14 offset:33792
    v_mfma_f32_16x16x32_bf16 v[52:55], v[180:183], a[236:239], v[52:55]
    buffer_load_dwordx4 a[32:35], v1, s[4:7], s41 offen offset:0 sc1
    v_mfma_f32_16x16x32_bf16 v[52:55], v[176:179], a[228:231], v[52:55]
    v_mfma_f32_16x16x32_bf16 v[52:55], v[172:175], a[220:223], v[52:55]
    buffer_load_dwordx4 a[36:39], v1, s[4:7], s46 offen offset:1024 sc1
    v_mfma_f32_16x16x32_bf16 v[52:55], v[168:171], a[212:215], v[52:55]
    s_waitcnt lgkmcnt(4)
    v_mfma_f32_16x16x32_bf16 v[60:63], v[200:203], a[212:215], v[60:63]
    s_add_u32 s41, s43, 0x1801000
    ds_read_b128 v[168:171], v14 offset:7168
    v_mfma_f32_16x16x32_bf16 v[60:63], v[204:207], a[220:223], v[60:63]
    ds_read_b128 v[172:175], v14 offset:16384
    v_mfma_f32_16x16x32_bf16 v[60:63], v[208:211], a[228:231], v[60:63]
    s_add_u32 s46, s43, 0x1801000
    ds_read_b128 v[176:179], v14 offset:25600
    v_mfma_f32_16x16x32_bf16 v[60:63], v[212:215], a[236:239], v[60:63]
    ds_read_b128 v[180:183], v14 offset:34816
    v_mfma_f32_16x16x32_bf16 v[56:59], v[212:215], a[232:235], v[56:59]
    buffer_load_dwordx4 a[40:43], v1, s[4:7], s41 offen offset:0 sc1
    v_mfma_f32_16x16x32_bf16 v[56:59], v[208:211], a[224:227], v[56:59]
    v_mfma_f32_16x16x32_bf16 v[56:59], v[204:207], a[216:219], v[56:59]
    buffer_load_dwordx4 a[44:47], v1, s[4:7], s46 offen offset:1024 sc1
    v_mfma_f32_16x16x32_bf16 v[56:59], v[200:203], a[208:211], v[56:59]
    s_waitcnt lgkmcnt(4)
    v_mfma_f32_16x16x32_bf16 v[64:67], v[216:219], a[208:211], v[64:67]
    s_add_u32 s41, s43, 0x1802000
    ds_read_b128 v[200:203], v14 offset:8192
    v_mfma_f32_16x16x32_bf16 v[64:67], v[220:223], a[216:219], v[64:67]
    ds_read_b128 v[204:207], v14 offset:17408
    v_mfma_f32_16x16x32_bf16 v[64:67], v[224:227], a[224:227], v[64:67]
    s_add_u32 s46, s43, 0x1802000
    ds_read_b128 v[208:211], v14 offset:26624
    v_mfma_f32_16x16x32_bf16 v[64:67], v[228:231], a[232:235], v[64:67]
    ds_read_b128 v[212:215], v14 offset:35840
    v_mfma_f32_16x16x32_bf16 v[68:71], v[228:231], a[236:239], v[68:71]
    buffer_load_dwordx4 a[48:51], v1, s[4:7], s41 offen offset:0 sc1
    v_mfma_f32_16x16x32_bf16 v[68:71], v[224:227], a[228:231], v[68:71]
    v_mfma_f32_16x16x32_bf16 v[68:71], v[220:223], a[220:223], v[68:71]
    buffer_load_dwordx4 a[52:55], v1, s[4:7], s46 offen offset:1024 sc1
    v_mfma_f32_16x16x32_bf16 v[68:71], v[216:219], a[212:215], v[68:71]
    s_waitcnt vmcnt(17) lgkmcnt(4)
    s_barrier
    v_mfma_f32_16x16x32_bf16 v[76:79], v[168:171], a[212:215], v[76:79]
    s_add_u32 s41, s40, 0x510000
    ds_read_b128 v[216:219], v12 offset:0
    v_mfma_f32_16x16x32_bf16 v[76:79], v[172:175], a[220:223], v[76:79]
    s_add_u32 m0, s72, 0x2000
    ds_read_b128 v[220:223], v12 offset:9216
    v_mfma_f32_16x16x32_bf16 v[76:79], v[176:179], a[228:231], v[76:79]
    s_add_u32 s46, s43, 0x1803000
    ds_read_b128 v[224:227], v12 offset:18432
    v_mfma_f32_16x16x32_bf16 v[76:79], v[180:183], a[236:239], v[76:79]
    ds_read_b128 v[228:231], v12 offset:27648
    v_mfma_f32_16x16x32_bf16 v[72:75], v[180:183], a[232:235], v[72:75]
    buffer_load_dwordx4 v1, s[88:91], s41 offen sc1 lds
    v_mfma_f32_16x16x32_bf16 v[72:75], v[176:179], a[224:227], v[72:75]
    v_mfma_f32_16x16x32_bf16 v[72:75], v[172:175], a[216:219], v[72:75]
    buffer_load_dwordx4 a[56:59], v1, s[4:7], s46 offen offset:0 sc1
    v_mfma_f32_16x16x32_bf16 v[72:75], v[168:171], a[208:211], v[72:75]
    s_waitcnt lgkmcnt(4)
    v_mfma_f32_16x16x32_bf16 v[80:83], v[200:203], a[208:211], v[80:83]
    s_add_u32 s41, s43, 0x1803000
    ds_read_b128 v[168:171], v12 offset:1024
    v_mfma_f32_16x16x32_bf16 v[80:83], v[204:207], a[216:219], v[80:83]
    ds_read_b128 v[172:175], v12 offset:10240
    v_mfma_f32_16x16x32_bf16 v[80:83], v[208:211], a[224:227], v[80:83]
    ds_read_b128 v[176:179], v12 offset:19456
    v_mfma_f32_16x16x32_bf16 v[80:83], v[212:215], a[232:235], v[80:83]
    ds_read_b128 v[180:183], v12 offset:28672
    v_mfma_f32_16x16x32_bf16 v[84:87], v[212:215], a[236:239], v[84:87]
    buffer_load_dwordx4 a[60:63], v1, s[4:7], s41 offen offset:1024 sc1
    v_mfma_f32_16x16x32_bf16 v[84:87], v[208:211], a[228:231], v[84:87]
    v_mfma_f32_16x16x32_bf16 v[84:87], v[204:207], a[220:223], v[84:87]
    v_mfma_f32_16x16x32_bf16 v[84:87], v[200:203], a[212:215], v[84:87]
    s_waitcnt vmcnt(18) lgkmcnt(4)
    v_mfma_f32_16x16x32_bf16 v[20:23], v[216:219], a[148:151], v[20:23]
    s_add_u32 s41, s28, 0x534000
    ds_read_b128 v[200:203], v12 offset:2048
    v_mfma_f32_16x16x32_bf16 v[20:23], v[220:223], a[156:159], v[20:23]
    s_add_u32 m0, s73, 0x0
    ds_read_b128 v[204:207], v12 offset:11264
    v_mfma_f32_16x16x32_bf16 v[20:23], v[224:227], a[164:167], v[20:23]
    s_add_u32 s46, s29, 0x534000
    ds_read_b128 v[208:211], v12 offset:20480
    v_mfma_f32_16x16x32_bf16 v[20:23], v[228:231], a[172:175], v[20:23]
    ds_read_b128 v[212:215], v12 offset:29696
    v_mfma_f32_16x16x32_bf16 v[16:19], v[228:231], a[168:171], v[16:19]
    buffer_load_dwordx4 v1, s[88:91], s41 offen sc1 lds
    v_mfma_f32_16x16x32_bf16 v[16:19], v[224:227], a[160:163], v[16:19]
    s_add_u32 m0, s73, 0x400
    v_mfma_f32_16x16x32_bf16 v[16:19], v[220:223], a[152:155], v[16:19]
    buffer_load_dwordx4 v1, s[88:91], s46 offen sc1 lds
    v_mfma_f32_16x16x32_bf16 v[16:19], v[216:219], a[144:147], v[16:19]
    s_waitcnt lgkmcnt(4)
    v_mfma_f32_16x16x32_bf16 v[24:27], v[168:171], a[144:147], v[24:27]
    s_add_u32 s41, s30, 0x534000
    ds_read_b128 v[216:219], v12 offset:3072
    v_mfma_f32_16x16x32_bf16 v[24:27], v[172:175], a[152:155], v[24:27]
    s_add_u32 m0, s73, 0x800
    ds_read_b128 v[220:223], v12 offset:12288
    v_mfma_f32_16x16x32_bf16 v[24:27], v[176:179], a[160:163], v[24:27]
    s_add_u32 s46, s31, 0x534000
    ds_read_b128 v[224:227], v12 offset:21504
    v_mfma_f32_16x16x32_bf16 v[24:27], v[180:183], a[168:171], v[24:27]
    ds_read_b128 v[228:231], v12 offset:30720
    v_mfma_f32_16x16x32_bf16 v[28:31], v[180:183], a[172:175], v[28:31]
    buffer_load_dwordx4 v1, s[88:91], s41 offen sc1 lds
    v_mfma_f32_16x16x32_bf16 v[28:31], v[176:179], a[164:167], v[28:31]
    s_add_u32 m0, s73, 0xc00
    v_mfma_f32_16x16x32_bf16 v[28:31], v[172:175], a[156:159], v[28:31]
    buffer_load_dwordx4 v1, s[88:91], s46 offen sc1 lds
    v_mfma_f32_16x16x32_bf16 v[28:31], v[168:171], a[148:151], v[28:31]
    s_waitcnt lgkmcnt(4)
    v_mfma_f32_16x16x32_bf16 v[36:39], v[200:203], a[148:151], v[36:39]
    s_add_u32 s41, s36, 0x534000
    ds_read_b128 v[168:171], v12 offset:4096
    v_mfma_f32_16x16x32_bf16 v[36:39], v[204:207], a[156:159], v[36:39]
    s_add_u32 m0, s73, 0x1000
    ds_read_b128 v[172:175], v12 offset:13312
    v_mfma_f32_16x16x32_bf16 v[36:39], v[208:211], a[164:167], v[36:39]
    s_add_u32 s46, s37, 0x534000
    ds_read_b128 v[176:179], v12 offset:22528
    v_mfma_f32_16x16x32_bf16 v[36:39], v[212:215], a[172:175], v[36:39]
    ds_read_b128 v[180:183], v12 offset:31744
    v_mfma_f32_16x16x32_bf16 v[32:35], v[212:215], a[168:171], v[32:35]
    buffer_load_dwordx4 v1, s[88:91], s41 offen sc1 lds
    v_mfma_f32_16x16x32_bf16 v[32:35], v[208:211], a[160:163], v[32:35]
    s_add_u32 m0, s73, 0x1400
    v_mfma_f32_16x16x32_bf16 v[32:35], v[204:207], a[152:155], v[32:35]
    buffer_load_dwordx4 v1, s[88:91], s46 offen sc1 lds
    v_mfma_f32_16x16x32_bf16 v[32:35], v[200:203], a[144:147], v[32:35]
    s_waitcnt lgkmcnt(4)
    v_mfma_f32_16x16x32_bf16 v[40:43], v[216:219], a[144:147], v[40:43]
    s_add_u32 s41, s38, 0x534000
    ds_read_b128 v[200:203], v12 offset:5120
    v_mfma_f32_16x16x32_bf16 v[40:43], v[220:223], a[152:155], v[40:43]
    s_add_u32 m0, s73, 0x1800
    ds_read_b128 v[204:207], v12 offset:14336
    v_mfma_f32_16x16x32_bf16 v[40:43], v[224:227], a[160:163], v[40:43]
    s_add_u32 s46, s39, 0x534000
    ds_read_b128 v[208:211], v12 offset:23552
    v_mfma_f32_16x16x32_bf16 v[40:43], v[228:231], a[168:171], v[40:43]
    ds_read_b128 v[212:215], v12 offset:32768
    v_mfma_f32_16x16x32_bf16 v[44:47], v[228:231], a[172:175], v[44:47]
    buffer_load_dwordx4 v1, s[88:91], s41 offen sc1 lds
    v_mfma_f32_16x16x32_bf16 v[44:47], v[224:227], a[164:167], v[44:47]
    s_add_u32 m0, s73, 0x1c00
    v_mfma_f32_16x16x32_bf16 v[44:47], v[220:223], a[156:159], v[44:47]
    buffer_load_dwordx4 v1, s[88:91], s46 offen sc1 lds
    v_mfma_f32_16x16x32_bf16 v[44:47], v[216:219], a[148:151], v[44:47]
    s_waitcnt lgkmcnt(4)
    v_mfma_f32_16x16x32_bf16 v[52:55], v[168:171], a[148:151], v[52:55]
    s_add_u32 s41, s43, 0x1804000
    ds_read_b128 v[216:219], v12 offset:6144
    v_mfma_f32_16x16x32_bf16 v[52:55], v[172:175], a[156:159], v[52:55]
    ds_read_b128 v[220:223], v12 offset:15360
    v_mfma_f32_16x16x32_bf16 v[52:55], v[176:179], a[164:167], v[52:55]
    s_add_u32 s46, s43, 0x1804000
    ds_read_b128 v[224:227], v12 offset:24576
    v_mfma_f32_16x16x32_bf16 v[52:55], v[180:183], a[172:175], v[52:55]
    ds_read_b128 v[228:231], v12 offset:33792
    v_mfma_f32_16x16x32_bf16 v[48:51], v[180:183], a[168:171], v[48:51]
    buffer_load_dwordx4 a[64:67], v1, s[4:7], s41 offen offset:0 sc1
    v_mfma_f32_16x16x32_bf16 v[48:51], v[176:179], a[160:163], v[48:51]
    v_mfma_f32_16x16x32_bf16 v[48:51], v[172:175], a[152:155], v[48:51]
    buffer_load_dwordx4 a[68:71], v1, s[4:7], s46 offen offset:1024 sc1
    v_mfma_f32_16x16x32_bf16 v[48:51], v[168:171], a[144:147], v[48:51]
    s_waitcnt lgkmcnt(4)
    v_mfma_f32_16x16x32_bf16 v[56:59], v[200:203], a[144:147], v[56:59]
    s_add_u32 s41, s43, 0x1805000
    ds_read_b128 v[168:171], v12 offset:7168
    v_mfma_f32_16x16x32_bf16 v[56:59], v[204:207], a[152:155], v[56:59]
    ds_read_b128 v[172:175], v12 offset:16384
    v_mfma_f32_16x16x32_bf16 v[56:59], v[208:211], a[160:163], v[56:59]
    s_add_u32 s46, s43, 0x1805000
    ds_read_b128 v[176:179], v12 offset:25600
    v_mfma_f32_16x16x32_bf16 v[56:59], v[212:215], a[168:171], v[56:59]
    ds_read_b128 v[180:183], v12 offset:34816
    v_mfma_f32_16x16x32_bf16 v[60:63], v[212:215], a[172:175], v[60:63]
    buffer_load_dwordx4 a[72:75], v1, s[4:7], s41 offen offset:0 sc1
    v_mfma_f32_16x16x32_bf16 v[60:63], v[208:211], a[164:167], v[60:63]
    v_mfma_f32_16x16x32_bf16 v[60:63], v[204:207], a[156:159], v[60:63]
    buffer_load_dwordx4 a[76:79], v1, s[4:7], s46 offen offset:1024 sc1
    v_mfma_f32_16x16x32_bf16 v[60:63], v[200:203], a[148:151], v[60:63]
    s_waitcnt lgkmcnt(4)
    v_mfma_f32_16x16x32_bf16 v[68:71], v[216:219], a[148:151], v[68:71]
    s_add_u32 s41, s43, 0x1806000
    ds_read_b128 v[200:203], v12 offset:8192
    v_mfma_f32_16x16x32_bf16 v[68:71], v[220:223], a[156:159], v[68:71]
    ds_read_b128 v[204:207], v12 offset:17408
    v_mfma_f32_16x16x32_bf16 v[68:71], v[224:227], a[164:167], v[68:71]
    s_add_u32 s46, s43, 0x1806000
    ds_read_b128 v[208:211], v12 offset:26624
    v_mfma_f32_16x16x32_bf16 v[68:71], v[228:231], a[172:175], v[68:71]
    ds_read_b128 v[212:215], v12 offset:35840
    v_mfma_f32_16x16x32_bf16 v[64:67], v[228:231], a[168:171], v[64:67]
    buffer_load_dwordx4 a[80:83], v1, s[4:7], s41 offen offset:0 sc1
    v_mfma_f32_16x16x32_bf16 v[64:67], v[224:227], a[160:163], v[64:67]
    v_mfma_f32_16x16x32_bf16 v[64:67], v[220:223], a[152:155], v[64:67]
    buffer_load_dwordx4 a[84:87], v1, s[4:7], s46 offen offset:1024 sc1
    v_mfma_f32_16x16x32_bf16 v[64:67], v[216:219], a[144:147], v[64:67]
    s_waitcnt vmcnt(16) lgkmcnt(4)
    s_barrier
    v_mfma_f32_16x16x32_bf16 v[72:75], v[168:171], a[144:147], v[72:75]
    s_add_u32 s41, s40, 0x534000
    ds_read_b128 v[216:219], v13 offset:0
    v_mfma_f32_16x16x32_bf16 v[72:75], v[172:175], a[152:155], v[72:75]
    s_add_u32 m0, s73, 0x2000
    ds_read_b128 v[220:223], v13 offset:9216
    v_mfma_f32_16x16x32_bf16 v[72:75], v[176:179], a[160:163], v[72:75]
    s_add_u32 s46, s43, 0x1807000
    ds_read_b128 v[224:227], v13 offset:18432
    v_mfma_f32_16x16x32_bf16 v[72:75], v[180:183], a[168:171], v[72:75]
    ds_read_b128 v[228:231], v13 offset:27648
    v_mfma_f32_16x16x32_bf16 v[76:79], v[180:183], a[172:175], v[76:79]
    buffer_load_dwordx4 v1, s[88:91], s41 offen sc1 lds
    v_mfma_f32_16x16x32_bf16 v[76:79], v[176:179], a[164:167], v[76:79]
    v_mfma_f32_16x16x32_bf16 v[76:79], v[172:175], a[156:159], v[76:79]
    buffer_load_dwordx4 a[88:91], v1, s[4:7], s46 offen offset:0 sc1
    v_mfma_f32_16x16x32_bf16 v[76:79], v[168:171], a[148:151], v[76:79]
    s_waitcnt lgkmcnt(4)
    v_mfma_f32_16x16x32_bf16 v[84:87], v[200:203], a[148:151], v[84:87]
    s_add_u32 s41, s43, 0x1807000
    ds_read_b128 v[168:171], v13 offset:1024
    v_mfma_f32_16x16x32_bf16 v[84:87], v[204:207], a[156:159], v[84:87]
    s_mov_b32 s54, s69
    ds_read_b128 v[172:175], v13 offset:10240
    v_mfma_f32_16x16x32_bf16 v[84:87], v[208:211], a[164:167], v[84:87]
    s_mov_b32 s69, s72
    ds_read_b128 v[176:179], v13 offset:19456
    v_mfma_f32_16x16x32_bf16 v[84:87], v[212:215], a[172:175], v[84:87]
    s_mov_b32 s72, s73
    ds_read_b128 v[180:183], v13 offset:28672
    v_mfma_f32_16x16x32_bf16 v[80:83], v[212:215], a[168:171], v[80:83]
    buffer_load_dwordx4 a[92:95], v1, s[4:7], s41 offen offset:1024 sc1
    v_mfma_f32_16x16x32_bf16 v[80:83], v[208:211], a[160:163], v[80:83]
    s_mov_b32 s73, s54
    v_mov_b32 v15, v12
    v_mov_b32 v12, v13
    v_mfma_f32_16x16x32_bf16 v[80:83], v[204:207], a[152:155], v[80:83]
    v_mov_b32 v13, v14
    v_mov_b32 v14, v15
    v_mfma_f32_16x16x32_bf16 v[80:83], v[200:203], a[144:147], v[80:83]
    s_waitcnt vmcnt(17) lgkmcnt(4)
    s_branch L_k2_rest
L_k2_br3:
L_hop1_11:
    s_cbranch_execz L_hop1_ret
    v_mfma_f32_16x16x32_bf16 v[16:19], v[216:219], a[0:3], v[16:19]
    s_add_u32 s41, s28, 0x510000
    ds_read_b128 v[200:203], v1 offset:48128
    v_mfma_f32_16x16x32_bf16 v[16:19], v[220:223], a[8:11], v[16:19]
    s_add_u32 m0, s72, 0x0
    ds_read_b128 v[204:207], v2 offset:28672
    v_mfma_f32_16x16x32_bf16 v[16:19], v[224:227], a[16:19], v[16:19]
    s_add_u32 s46, s29, 0x510000
    ds_read_b128 v[208:211], v2 offset:37888
    v_mfma_f32_16x16x32_bf16 v[16:19], v[228:231], a[24:27], v[16:19]
    ds_read_b128 v[212:215], v2 offset:63424
    v_mfma_f32_16x16x32_bf16 v[20:23], v[228:231], a[28:31], v[20:23]
    buffer_load_dwordx4 v1, s[88:91], s41 offen sc1 lds
    v_mfma_f32_16x16x32_bf16 v[20:23], v[224:227], a[20:23], v[20:23]
    s_add_u32 m0, s72, 0x400
    v_mfma_f32_16x16x32_bf16 v[20:23], v[220:223], a[12:15], v[20:23]
    buffer_load_dwordx4 v1, s[88:91], s46 offen sc1 lds
    v_mfma_f32_16x16x32_bf16 v[20:23], v[216:219], a[4:7], v[20:23]
    s_waitcnt lgkmcnt(4)
    v_mfma_f32_16x16x32_bf16 v[28:31], v[168:171], a[4:7], v[28:31]
    s_add_u32 s41, s30, 0x510000
    ds_read_b128 v[216:219], v1 offset:49152
    v_mfma_f32_16x16x32_bf16 v[28:31], v[172:175], a[12:15], v[28:31]
    s_add_u32 m0, s72, 0x800
    ds_read_b128 v[220:223], v2 offset:29696
    v_mfma_f32_16x16x32_bf16 v[28:31], v[176:179], a[20:23], v[28:31]
    s_add_u32 s46, s31, 0x510000
    ds_read_b128 v[224:227], v2 offset:38912
    v_mfma_f32_16x16x32_bf16 v[28:31], v[180:183], a[28:31], v[28:31]
    ds_read_b128 v[228:231], v2 offset:64448
    v_mfma_f32_16x16x32_bf16 v[24:27], v[180:183], a[24:27], v[24:27]
    buffer_load_dwordx4 v1, s[88:91], s41 offen sc1 lds
    v_mfma_f32_16x16x32_bf16 v[24:27], v[176:179], a[16:19], v[24:27]
    s_add_u32 m0, s72, 0xc00
    v_mfma_f32_16x16x32_bf16 v[24:27], v[172:175], a[8:11], v[24:27]
    buffer_load_dwordx4 v1, s[88:91], s46 offen sc1 lds
    v_mfma_f32_16x16x32_bf16 v[24:27], v[168:171], a[0:3], v[24:27]
    s_waitcnt lgkmcnt(4)
    v_mfma_f32_16x16x32_bf16 v[32:35], v[200:203], a[0:3], v[32:35]
    s_add_u32 s41, s36, 0x510000
    ds_read_b128 v[168:171], v1 offset:50176
    v_mfma_f32_16x16x32_bf16 v[32:35], v[204:207], a[8:11], v[32:35]
    s_add_u32 m0, s72, 0x1000
    ds_read_b128 v[172:175], v2 offset:30720
    v_mfma_f32_16x16x32_bf16 v[32:35], v[208:211], a[16:19], v[32:35]
    s_add_u32 s46, s37, 0x510000
    ds_read_b128 v[176:179], v2 offset:39936
    v_mfma_f32_16x16x32_bf16 v[32:35], v[212:215], a[24:27], v[32:35]
    ds_read_b128 v[180:183], v2 offset:65472
    v_mfma_f32_16x16x32_bf16 v[36:39], v[212:215], a[28:31], v[36:39]
    buffer_load_dwordx4 v1, s[88:91], s41 offen sc1 lds
    v_mfma_f32_16x16x32_bf16 v[36:39], v[208:211], a[20:23], v[36:39]
    s_add_u32 m0, s72, 0x1400
    v_mfma_f32_16x16x32_bf16 v[36:39], v[204:207], a[12:15], v[36:39]
    buffer_load_dwordx4 v1, s[88:91], s46 offen sc1 lds
    v_mfma_f32_16x16x32_bf16 v[36:39], v[200:203], a[4:7], v[36:39]
    s_waitcnt lgkmcnt(4)
    v_mfma_f32_16x16x32_bf16 v[44:47], v[216:219], a[4:7], v[44:47]
    s_add_u32 s41, s38, 0x510000
    ds_read_b128 v[200:203], v1 offset:51200
    v_mfma_f32_16x16x32_bf16 v[44:47], v[220:223], a[12:15], v[44:47]
    s_add_u32 m0, s72, 0x1800
    ds_read_b128 v[204:207], v2 offset:31744
    v_mfma_f32_16x16x32_bf16 v[44:47], v[224:227], a[20:23], v[44:47]
    s_add_u32 s46, s39, 0x510000
    ds_read_b128 v[208:211], v2 offset:40960
    v_mfma_f32_16x16x32_bf16 v[44:47], v[228:231], a[28:31], v[44:47]
    s_waitcnt vmcnt(6)
    ds_read_b128 v[212:215], v3 offset:960
    v_cmp_eq_u32 vcc, 0, v8
    v_mfma_f32_16x16x32_bf16 v[40:43], v[228:231], a[24:27], v[40:43]
    buffer_load_dwordx4 v1, s[88:91], s41 offen sc1 lds
    v_mfma_f32_16x16x32_bf16 v[40:43], v[224:227], a[16:19], v[40:43]
    s_add_u32 m0, s72, 0x1c00
    v_mfma_f32_16x16x32_bf16 v[40:43], v[220:223], a[8:11], v[40:43]
    buffer_load_dwordx4 v1, s[88:91], s46 offen sc1 lds
    v_mfma_f32_16x16x32_bf16 v[40:43], v[216:219], a[0:3], v[40:43]
    s_waitcnt lgkmcnt(4)
    s_cbranch_vccnz L_b3_spin
L_b3_ret:
    v_mfma_f32_16x16x32_bf16 v[48:51], v[168:171], a[0:3], v[48:51]
    s_add_u32 s41, s43, 0x1800000
    ds_read_b128 v[216:219], v1 offset:52224
    v_mfma_f32_16x16x32_bf16 v[48:51], v[172:175], a[8:11], v[48:51]
    ds_read_b128 v[220:223], v2 offset:32768
    v_mfma_f32_16x16x32_bf16 v[48:51], v[176:179], a[16:19], v[48:51]
    s_add_u32 s46, s43, 0x1800000
    ds_read_b128 v[224:227], v2 offset:41984
    v_mfma_f32_16x16x32_bf16 v[48:51], v[180:183], a[24:27], v[48:51]
    ds_read_b128 v[228:231], v3 offset:1984
    v_mfma_f32_16x16x32_bf16 v[52:55], v[180:183], a[28:31], v[52:55]
    buffer_load_dwordx4 a[32:35], v1, s[4:7], s41 offen offset:0 sc1
    v_mfma_f32_16x16x32_bf16 v[52:55], v[176:179], a[20:23], v[52:55]
    v_mfma_f32_16x16x32_bf16 v[52:55], v[172:175], a[12:15], v[52:55]
    buffer_load_dwordx4 a[36:39], v1, s[4:7], s46 offen offset:1024 sc1
    v_mfma_f32_16x16x32_bf16 v[52:55], v[168:171], a[4:7], v[52:55]
    s_waitcnt lgkmcnt(4)
    v_mfma_f32_16x16x32_bf16 v[60:63], v[200:203], a[4:7], v[60:63]
    s_add_u32 s41, s43, 0x1801000
    ds_read_b128 v[168:171], v1 offset:53248
    v_mfma_f32_16x16x32_bf16 v[60:63], v[204:207], a[12:15], v[60:63]
    ds_read_b128 v[172:175], v2 offset:33792
    v_mfma_f32_16x16x32_bf16 v[60:63], v[208:211], a[20:23], v[60:63]
    s_add_u32 s46, s43, 0x1801000
    ds_read_b128 v[176:179], v2 offset:43008
    v_mfma_f32_16x16x32_bf16 v[60:63], v[212:215], a[28:31], v[60:63]
    ds_read_b128 v[180:183], v3 offset:3008
    v_mfma_f32_16x16x32_bf16 v[56:59], v[212:215], a[24:27], v[56:59]
    buffer_load_dwordx4 a[40:43], v1, s[4:7], s41 offen offset:0 sc1
    v_mfma_f32_16x16x32_bf16 v[56:59], v[208:211], a[16:19], v[56:59]
    v_mfma_f32_16x16x32_bf16 v[56:59], v[204:207], a[8:11], v[56:59]
    buffer_load_dwordx4 a[44:47], v1, s[4:7], s46 offen offset:1024 sc1
    v_mfma_f32_16x16x32_bf16 v[56:59], v[200:203], a[0:3], v[56:59]
    s_waitcnt lgkmcnt(4)
    v_mfma_f32_16x16x32_bf16 v[64:67], v[216:219], a[0:3], v[64:67]
    s_add_u32 s41, s43, 0x1802000
    ds_read_b128 v[200:203], v1 offset:54272
    v_mfma_f32_16x16x32_bf16 v[64:67], v[220:223], a[8:11], v[64:67]
    ds_read_b128 v[204:207], v2 offset:34816
    v_mfma_f32_16x16x32_bf16 v[64:67], v[224:227], a[16:19], v[64:67]
    s_add_u32 s46, s43, 0x1802000
    ds_read_b128 v[208:211], v2 offset:44032
    v_mfma_f32_16x16x32_bf16 v[64:67], v[228:231], a[24:27], v[64:67]
    ds_read_b128 v[212:215], v3 offset:4032
    v_mfma_f32_16x16x32_bf16 v[68:71], v[228:231], a[28:31], v[68:71]
    buffer_load_dwordx4 a[48:51], v1, s[4:7], s41 offen offset:0 sc1
    v_mfma_f32_16x16x32_bf16 v[68:71], v[224:227], a[20:23], v[68:71]
    v_mfma_f32_16x16x32_bf16 v[68:71], v[220:223], a[12:15], v[68:71]
    buffer_load_dwordx4 a[52:55], v1, s[4:7], s46 offen offset:1024 sc1
    v_mfma_f32_16x16x32_bf16 v[68:71], v[216:219], a[4:7], v[68:71]
    s_waitcnt vmcnt(17) lgkmcnt(4)
    s_barrier
    v_mfma_f32_16x16x32_bf16 v[76:79], v[168:171], a[4:7], v[76:79]
    s_add_u32 s41, s40, 0x510000
    ds_read_b128 v[216:219], v12 offset:0
    v_mfma_f32_16x16x32_bf16 v[76:79], v[172:175], a[12:15], v[76:79]
    s_add_u32 m0, s72, 0x2000
    ds_read_b128 v[220:223], v12 offset:9216
    v_mfma_f32_16x16x32_bf16 v[76:79], v[176:179], a[20:23], v[76:79]
    s_add_u32 s46, s43, 0x1803000
    ds_read_b128 v[224:227], v12 offset:18432
    v_mfma_f32_16x16x32_bf16 v[76:79], v[180:183], a[28:31], v[76:79]
    ds_read_b128 v[228:231], v12 offset:27648
    v_mfma_f32_16x16x32_bf16 v[72:75], v[180:183], a[24:27], v[72:75]
    buffer_load_dwordx4 v1, s[88:91], s41 offen sc1 lds
    v_mfma_f32_16x16x32_bf16 v[72:75], v[176:179], a[16:19], v[72:75]
    v_mfma_f32_16x16x32_bf16 v[72:75], v[172:175], a[8:11], v[72:75]
    buffer_load_dwordx4 a[56:59], v1, s[4:7], s46 offen offset:0 sc1
    v_mfma_f32_16x16x32_bf16 v[72:75], v[168:171], a[0:3], v[72:75]
    s_waitcnt lgkmcnt(4)
    v_mfma_f32_16x16x32_bf16 v[80:83], v[200:203], a[0:3], v[80:83]
    s_add_u32 s41, s43, 0x1803000
    ds_read_b128 v[168:171], v12 offset:1024
    v_mfma_f32_16x16x32_bf16 v[80:83], v[204:207], a[8:11], v[80:83]
    ds_read_b128 v[172:175], v12 offset:10240
    v_mfma_f32_16x16x32_bf16 v[80:83], v[208:211], a[16:19], v[80:83]
    ds_read_b128 v[176:179], v12 offset:19456
    v_mfma_f32_16x16x32_bf16 v[80:83], v[212:215], a[24:27], v[80:83]
    ds_read_b128 v[180:183], v12 offset:28672
    v_mfma_f32_16x16x32_bf16 v[84:87], v[212:215], a[28:31], v[84:87]
    buffer_load_dwordx4 a[60:63], v1, s[4:7], s41 offen offset:1024 sc1
    v_mfma_f32_16x16x32_bf16 v[84:87], v[208:211], a[20:23], v[84:87]
    v_mfma_f32_16x16x32_bf16 v[84:87], v[204:207], a[12:15], v[84:87]
    v_mfma_f32_16x16x32_bf16 v[84:87], v[200:203], a[4:7], v[84:87]
    s_waitcnt vmcnt(18) lgkmcnt(4)
    v_mfma_f32_16x16x32_bf16 v[20:23], v[216:219], a[148:151], v[20:23]
    s_add_u32 s41, s28, 0x534000
    ds_read_b128 v[200:203], v12 offset:2048
    v_mfma_f32_16x16x32_bf16 v[20:23], v[220:223], a[156:159], v[20:23]
    s_add_u32 m0, s73, 0x0
    ds_read_b128 v[204:207], v12 offset:11264
    v_mfma_f32_16x16x32_bf16 v[20:23], v[224:227], a[164:167], v[20:23]
    s_add_u32 s46, s29, 0x534000
    ds_read_b128 v[208:211], v12 offset:20480
    v_mfma_f32_16x16x32_bf16 v[20:23], v[228:231], a[172:175], v[20:23]
    ds_read_b128 v[212:215], v12 offset:29696
    v_mfma_f32_16x16x32_bf16 v[16:19], v[228:231], a[168:171], v[16:19]
    buffer_load_dwordx4 v1, s[88:91], s41 offen sc1 lds
    v_mfma_f32_16x16x32_bf16 v[16:19], v[224:227], a[160:163], v[16:19]
    s_add_u32 m0, s73, 0x400
    v_mfma_f32_16x16x32_bf16 v[16:19], v[220:223], a[152:155], v[16:19]
    buffer_load_dwordx4 v1, s[88:91], s46 offen sc1 lds
    v_mfma_f32_16x16x32_bf16 v[16:19], v[216:219], a[144:147], v[16:19]
    s_waitcnt lgkmcnt(4)
    v_mfma_f32_16x16x32_bf16 v[24:27], v[168:171], a[144:147], v[24:27]
    s_add_u32 s41, s30, 0x534000
    ds_read_b128 v[216:219], v12 offset:3072
    v_mfma_f32_16x16x32_bf16 v[24:27], v[172:175], a[152:155], v[24:27]
    s_add_u32 m0, s73, 0x800
    ds_read_b128 v[220:223], v12 offset:12288
    v_mfma_f32_16x16x32_bf16 v[24:27], v[176:179], a[160:163], v[24:27]
    s_add_u32 s46, s31, 0x534000
    ds_read_b128 v[224:227], v12 offset:21504
    v_mfma_f32_16x16x32_bf16 v[24:27], v[180:183], a[168:171], v[24:27]
    ds_read_b128 v[228:231], v12 offset:30720
    v_mfma_f32_16x16x32_bf16 v[28:31], v[180:183], a[172:175], v[28:31]
    buffer_load_dwordx4 v1, s[88:91], s41 offen sc1 lds
    v_mfma_f32_16x16x32_bf16 v[28:31], v[176:179], a[164:167], v[28:31]
    s_add_u32 m0, s73, 0xc00
    v_mfma_f32_16x16x32_bf16 v[28:31], v[172:175], a[156:159], v[28:31]
    buffer_load_dwordx4 v1, s[88:91], s46 offen sc1 lds
    v_mfma_f32_16x16x32_bf16 v[28:31], v[168:171], a[148:151], v[28:31]
    s_waitcnt lgkmcnt(4)
    v_mfma_f32_16x16x32_bf16 v[36:39], v[200:203], a[148:151], v[36:39]
    s_add_u32 s41, s36, 0x534000
    ds_read_b128 v[168:171], v12 offset:4096
    v_mfma_f32_16x16x32_bf16 v[36:39], v[204:207], a[156:159], v[36:39]
    s_add_u32 m0, s73, 0x1000
    ds_read_b128 v[172:175], v12 offset:13312
    v_mfma_f32_16x16x32_bf16 v[36:39], v[208:211], a[164:167], v[36:39]
    s_add_u32 s46, s37, 0x534000
    ds_read_b128 v[176:179], v12 offset:22528
    v_mfma_f32_16x16x32_bf16 v[36:39], v[212:215], a[172:175], v[36:39]
    ds_read_b128 v[180:183], v12 offset:31744
    v_mfma_f32_16x16x32_bf16 v[32:35], v[212:215], a[168:171], v[32:35]
    buffer_load_dwordx4 v1, s[88:91], s41 offen sc1 lds
    v_mfma_f32_16x16x32_bf16 v[32:35], v[208:211], a[160:163], v[32:35]
    s_add_u32 m0, s73, 0x1400
    v_mfma_f32_16x16x32_bf16 v[32:35], v[204:207], a[152:155], v[32:35]
    buffer_load_dwordx4 v1, s[88:91], s46 offen sc1 lds
    v_mfma_f32_16x16x32_bf16 v[32:35], v[200:203], a[144:147], v[32:35]
    s_waitcnt lgkmcnt(4)
    v_mfma_f32_16x16x32_bf16 v[40:43], v[216:219], a[144:147], v[40:43]
    s_add_u32 s41, s38, 0x534000
    ds_read_b128 v[200:203], v12 offset:5120
    v_mfma_f32_16x16x32_bf16 v[40:43], v[220:223], a[152:155], v[40:43]
    s_add_u32 m0, s73, 0x1800
    ds_read_b128 v[204:207], v12 offset:14336
    v_mfma_f32_16x16x32_bf16 v[40:43], v[224:227], a[160:163], v[40:43]
    s_add_u32 s46, s39, 0x534000
    ds_read_b128 v[208:211], v12 offset:23552
    v_mfma_f32_16x16x32_bf16 v[40:43], v[228:231], a[168:171], v[40:43]
    ds_read_b128 v[212:215], v12 offset:32768
    v_mfma_f32_16x16x32_bf16 v[44:47], v[228:231], a[172:175], v[44:47]
    buffer_load_dwordx4 v1, s[88:91], s41 offen sc1 lds
    v_mfma_f32_16x16x32_bf16 v[44:47], v[224:227], a[164:167], v[44:47]
    s_add_u32 m0, s73, 0x1c00
    v_mfma_f32_16x16x32_bf16 v[44:47], v[220:223], a[156:159], v[44:47]
    buffer_load_dwordx4 v1, s[88:91], s46 offen sc1 lds
    v_mfma_f32_16x16x32_bf16 v[44:47], v[216:219], a[148:151], v[44:47]
    s_waitcnt lgkmcnt(4)
    v_mfma_f32_16x16x32_bf16 v[52:55], v[168:171], a[148:151], v[52:55]
    s_add_u32 s41, s43, 0x1804000
    ds_read_b128 v[216:219], v12 offset:6144
    v_mfma_f32_16x16x32_bf16 v[52:55], v[172:175], a[156:159], v[52:55]
    ds_read_b128 v[220:223], v12 offset:15360
    v_mfma_f32_16x16x32_bf16 v[52:55], v[176:179], a[164:167], v[52:55]
    s_add_u32 s46, s43, 0x1804000
    ds_read_b128 v[224:227], v12 offset:24576
    v_mfma_f32_16x16x32_bf16 v[52:55], v[180:183], a[172:175], v[52:55]
    ds_read_b128 v[228:231], v12 offset:33792
    v_mfma_f32_16x16x32_bf16 v[48:51], v[180:183], a[168:171], v[48:51]
    buffer_load_dwordx4 a[64:67], v1, s[4:7], s41 offen offset:0 sc1
    v_mfma_f32_16x16x32_bf16 v[48:51], v[176:179], a[160:163], v[48:51]
    v_mfma_f32_16x16x32_bf16 v[48:51], v[172:175], a[152:155], v[48:51]
    buffer_load_dwordx4 a[68:71], v1, s[4:7], s46 offen offset:1024 sc1
    v_mfma_f32_16x16x32_bf16 v[48:51], v[168:171], a[144:147], v[48:51]
    s_waitcnt lgkmcnt(4)
    v_mfma_f32_16x16x32_bf16 v[56:59], v[200:203], a[144:147], v[56:59]
    s_add_u32 s41, s43, 0x1805000
    ds_read_b128 v[168:171], v12 offset:7168
    v_mfma_f32_16x16x32_bf16 v[56:59], v[204:207], a[152:155], v[56:59]
    ds_read_b128 v[172:175], v12 offset:16384
    v_mfma_f32_16x16x32_bf16 v[56:59], v[208:211], a[160:163], v[56:59]
    s_add_u32 s46, s43, 0x1805000
    ds_read_b128 v[176:179], v12 offset:25600
    v_mfma_f32_16x16x32_bf16 v[56:59], v[212:215], a[168:171], v[56:59]
    ds_read_b128 v[180:183], v12 offset:34816
    v_mfma_f32_16x16x32_bf16 v[60:63], v[212:215], a[172:175], v[60:63]
    buffer_load_dwordx4 a[72:75], v1, s[4:7], s41 offen offset:0 sc1
    v_mfma_f32_16x16x32_bf16 v[60:63], v[208:211], a[164:167], v[60:63]
L_hop1_12:
    s_cbranch_execz L_hop1_ret
    v_mfma_f32_16x16x32_bf16 v[60:63], v[204:207], a[156:159], v[60:63]
    buffer_load_dwordx4 a[76:79], v1, s[4:7], s46 offen offset:1024 sc1
    v_mfma_f32_16x16x32_bf16 v[60:63], v[200:203], a[148:151], v[60:63]
    s_waitcnt lgkmcnt(4)
    v_mfma_f32_16x16x32_bf16 v[68:71], v[216:219], a[148:151], v[68:71]
    s_add_u32 s41, s43, 0x1806000
    ds_read_b128 v[200:203], v12 offset:8192
    v_mfma_f32_16x16x32_bf16 v[68:71], v[220:223], a[156:159], v[68:71]
    ds_read_b128 v[204:207], v12 offset:17408
    v_mfma_f32_16x16x32_bf16 v[68:71], v[224:227], a[164:167], v[68:71]
    s_add_u32 s46, s43, 0x1806000
    ds_read_b128 v[208:211], v12 offset:26624
    v_mfma_f32_16x16x32_bf16 v[68:71], v[228:231], a[172:175], v[68:71]
    ds_read_b128 v[212:215], v12 offset:35840
    v_mfma_f32_16x16x32_bf16 v[64:67], v[228:231], a[168:171], v[64:67]
    buffer_load_dwordx4 a[80:83], v1, s[4:7], s41 offen offset:0 sc1
    v_mfma_f32_16x16x32_bf16 v[64:67], v[224:227], a[160:163], v[64:67]
    v_mfma_f32_16x16x32_bf16 v[64:67], v[220:223], a[152:155], v[64:67]
    buffer_load_dwordx4 a[84:87], v1, s[4:7], s46 offen offset:1024 sc1
    v_mfma_f32_16x16x32_bf16 v[64:67], v[216:219], a[144:147], v[64:67]
    s_waitcnt vmcnt(16) lgkmcnt(4)
    s_barrier
    v_mfma_f32_16x16x32_bf16 v[72:75], v[168:171], a[144:147], v[72:75]
    s_add_u32 s41, s40, 0x534000
    ds_read_b128 v[216:219], v13 offset:0
    v_mfma_f32_16x16x32_bf16 v[72:75], v[172:175], a[152:155], v[72:75]
    s_add_u32 m0, s73, 0x2000
    ds_read_b128 v[220:223], v13 offset:9216
    v_mfma_f32_16x16x32_bf16 v[72:75], v[176:179], a[160:163], v[72:75]
    s_add_u32 s46, s43, 0x1807000
    ds_read_b128 v[224:227], v13 offset:18432
    v_mfma_f32_16x16x32_bf16 v[72:75], v[180:183], a[168:171], v[72:75]
    ds_read_b128 v[228:231], v13 offset:27648
    v_mfma_f32_16x16x32_bf16 v[76:79], v[180:183], a[172:175], v[76:79]
    buffer_load_dwordx4 v1, s[88:91], s41 offen sc1 lds
    v_mfma_f32_16x16x32_bf16 v[76:79], v[176:179], a[164:167], v[76:79]
    v_mfma_f32_16x16x32_bf16 v[76:79], v[172:175], a[156:159], v[76:79]
    buffer_load_dwordx4 a[88:91], v1, s[4:7], s46 offen offset:0 sc1
    v_mfma_f32_16x16x32_bf16 v[76:79], v[168:171], a[148:151], v[76:79]
    s_waitcnt lgkmcnt(4)
    v_mfma_f32_16x16x32_bf16 v[84:87], v[200:203], a[148:151], v[84:87]
    s_add_u32 s41, s43, 0x1807000
    ds_read_b128 v[168:171], v13 offset:1024
    v_mfma_f32_16x16x32_bf16 v[84:87], v[204:207], a[156:159], v[84:87]
    s_mov_b32 s54, s69
    ds_read_b128 v[172:175], v13 offset:10240
    v_mfma_f32_16x16x32_bf16 v[84:87], v[208:211], a[164:167], v[84:87]
    s_mov_b32 s69, s72
    ds_read_b128 v[176:179], v13 offset:19456
    v_mfma_f32_16x16x32_bf16 v[84:87], v[212:215], a[172:175], v[84:87]
    s_mov_b32 s72, s73
    ds_read_b128 v[180:183], v13 offset:28672
    v_mfma_f32_16x16x32_bf16 v[80:83], v[212:215], a[168:171], v[80:83]
    buffer_load_dwordx4 a[92:95], v1, s[4:7], s41 offen offset:1024 sc1
    v_mfma_f32_16x16x32_bf16 v[80:83], v[208:211], a[160:163], v[80:83]
    s_mov_b32 s73, s54
    v_mov_b32 v15, v12
    v_mov_b32 v12, v13
    v_mfma_f32_16x16x32_bf16 v[80:83], v[204:207], a[152:155], v[80:83]
    v_mov_b32 v13, v14
    v_mov_b32 v14, v15
    v_mfma_f32_16x16x32_bf16 v[80:83], v[200:203], a[144:147], v[80:83]
    s_waitcnt vmcnt(17) lgkmcnt(4)
    s_branch L_k2_rest
L_k2_redo:
    s_mov_b32 s51, -1
    s_waitcnt vmcnt(0) lgkmcnt(0)
    s_barrier
    s_add_u32 m0, s35, 0xc000
    s_add_u32 s41, s52, 0x0
    buffer_load_dwordx4 v12, s[20:23], s41 offen nt lds
    s_add_u32 m0, s35, 0xd000
    s_add_u32 s41, s52, 0x1000
    buffer_load_dwordx4 v12, s[20:23], s41 offen nt lds
    s_add_u32 m0, s35, 0xe000
    s_add_u32 s41, s52, 0x2000
    buffer_load_dwordx4 v12, s[20:23], s41 offen nt lds
    s_add_u32 m0, s35, 0xf000
    s_add_u32 s41, s52, 0x3000
    buffer_load_dwordx4 v12, s[20:23], s41 offen nt lds
    s_add_u32 m0, s35, 0x0
    s_add_u32 s41, s52, 0x4000
    buffer_load_dwordx4 v12, s[20:23], s41 offen nt lds
    s_add_u32 m0, s35, 0x1000
    s_add_u32 s41, s52, 0x5000
    buffer_load_dwordx4 v12, s[20:23], s41 offen nt lds
    s_add_u32 m0, s35, 0x2000
    s_add_u32 s41, s52, 0x6000
    buffer_load_dwordx4 v12, s[20:23], s41 offen nt lds
    s_add_u32 m0, s35, 0x3000
    s_add_u32 s41, s52, 0x7000
    buffer_load_dwordx4 v12, s[20:23], s41 offen nt lds
    s_add_u32 m0, s35, 0x4000
    s_add_u32 s41, s52, 0x8000
    buffer_load_dwordx4 v12, s[20:23], s41 offen nt lds
    s_add_u32 m0, s35, 0x5000
    s_add_u32 s41, s52, 0x9000
    buffer_load_dwordx4 v12, s[20:23], s41 offen nt lds
    s_add_u32 m0, s35, 0x6000
    s_add_u32 s41, s52, 0xa000
    buffer_load_dwordx4 v12, s[20:23], s41 offen nt lds
    s_add_u32 m0, s35, 0x7000
    s_add_u32 s41, s52, 0xb000
    buffer_load_dwordx4 v12, s[20:23], s41 offen nt lds
    s_add_u32 m0, s35, 0x10000
    s_add_u32 s41, s52, 0x0
    buffer_load_dwordx4 v13, s[24:27], s41 offen nt lds
    s_add_u32 m0, s35, 0x11000
    s_add_u32 s41, s52, 0x1000
    buffer_load_dwordx4 v13, s[24:27], s41 offen nt lds
    s_add_u32 m0, s35, 0x12000
    s_add_u32 s41, s52, 0x2000
    buffer_load_dwordx4 v13, s[24:27], s41 offen nt lds
    s_add_u32 m0, s35, 0x13000
    s_add_u32 s41, s52, 0x3000
    buffer_load_dwordx4 v13, s[24:27], s41 offen nt lds
    s_add_u32 m0, s35, 0x14000
    s_add_u32 s41, s52, 0x4000
    buffer_load_dwordx4 v13, s[24:27], s41 offen nt lds
    s_add_u32 m0, s35, 0x15000
    s_add_u32 s41, s52, 0x5000
    buffer_load_dwordx4 v13, s[24:27], s41 offen nt lds
    s_add_u32 m0, s35, 0x16000
    s_add_u32 s41, s52, 0x6000
    buffer_load_dwordx4 v13, s[24:27], s41 offen nt lds
    s_add_u32 m0, s35, 0x17000
    s_add_u32 s41, s52, 0x7000
    buffer_load_dwordx4 v13, s[24:27], s41 offen nt lds
    v_and_b32 v32, 15, v0
    v_lshlrev_b32 v32, 8, v32
    v_lshrrev_b32 v248, 4, v0
    v_lshl_add_u32 v32, v248, 4, v32
    s_lshl_b32 s54, s33, 19
    s_mov_b32 s55, 128
    v_mov_b32 v56, 0xff800000
    v_mov_b32 v57, 0xff800000
    v_mov_b32 v58, 0xff800000
    v_mov_b32 v59, 0xff800000
    v_mov_b32 v60, 0xff800000
    v_mov_b32 v61, 0xff800000
    v_mov_b32 v62, 0xff800000
    v_mov_b32 v63, 0xff800000
    v_mov_b32 v64, 0xff800000
    v_mov_b32 v65, 0xff800000
    v_mov_b32 v66, 0xff800000
    v_mov_b32 v67, 0xff800000
    v_mov_b32 v68, 0xff800000
    v_mov_b32 v69, 0xff800000
    v_mov_b32 v70, 0xff800000
    v_mov_b32 v71, 0xff800000
L_k2_maxloop:
    buffer_load_dwordx4 v[216:219], v32, s[20:23], s54 offen offset:0
    buffer_load_dwordx4 v[220:223], v32, s[20:23], s54 offen offset:64
    buffer_load_dwordx4 v[224:227], v32, s[20:23], s54 offen offset:128
    buffer_load_dwordx4 v[228:231], v32, s[20:23], s54 offen offset:192
    s_waitcnt vmcnt(0)
    v_mfma_f32_16x16x32_bf16 v[16:19], v[216:219], v[72:75], 0
    v_mfma_f32_16x16x32_bf16 v[16:19], v[220:223], v[88:91], v[16:19]
    v_mfma_f32_16x16x32_bf16 v[16:19], v[224:227], v[136:139], v[16:19]
    v_mfma_f32_16x16x32_bf16 v[16:19], v[228:231], v[168:171], v[16:19]
    v_mfma_f32_16x16x32_bf16 v[20:23], v[228:231], v[172:175], 0
    v_mfma_f32_16x16x32_bf16 v[20:23], v[224:227], v[140:143], v[20:23]
    v_mfma_f32_16x16x32_bf16 v[20:23], v[220:223], v[92:95], v[20:23]
    v_mfma_f32_16x16x32_bf16 v[20:23], v[216:219], v[76:79], v[20:23]
    v_mfma_f32_16x16x32_bf16 v[24:27], v[216:219], v[80:83], 0
    v_mfma_f32_16x16x32_bf16 v[24:27], v[220:223], v[96:99], v[24:27]
    v_mfma_f32_16x16x32_bf16 v[24:27], v[224:227], v[144:147], v[24:27]
    v_mfma_f32_16x16x32_bf16 v[24:27], v[228:231], v[176:179], v[24:27]
    v_mfma_f32_16x16x32_bf16 v[28:31], v[228:231], v[180:183], 0
    v_mfma_f32_16x16x32_bf16 v[28:31], v[224:227], v[148:151], v[28:31]
    v_mfma_f32_16x16x32_bf16 v[28:31], v[220:223], v[100:103], v[28:31]
    v_mfma_f32_16x16x32_bf16 v[28:31], v[216:219], v[84:87], v[28:31]
    s_nop 7
    v_max_f32 v56, v56, v16
    v_max_f32 v57, v57, v17
    v_max_f32 v58, v58, v18
    v_max_f32 v59, v59, v19
    v_max_f32 v60, v60, v20
    v_max_f32 v61, v61, v21
    v_max_f32 v62, v62, v22
    v_max_f32 v63, v63, v23
    v_max_f32 v64, v64, v24
    v_max_f32 v65, v65, v25
    v_max_f32 v66, v66, v26
    v_max_f32 v67, v67, v27
    v_max_f32 v68, v68, v28
    v_max_f32 v69, v69, v29
    v_max_f32 v70, v70, v30
    v_max_f32 v71, v71, v31
    s_add_u32 s54, s54, 4096
    s_sub_u32 s55, s55, 1
    s_cmp_lg_u32 s55, 0
    s_cbranch_scc1 L_k2_maxloop
    v_max3_f32 v248, v56, v57, v58
    v_max3_f32 v249, v60, v61, v62
    v_max3_f32 v250, v64, v65, v66
    v_max3_f32 v251, v68, v69, v70
    v_max_f32 v248, v248, v59
    v_max_f32 v249, v249, v63
    v_max_f32 v250, v250, v67
    v_max_f32 v251, v251, v71
    v_mov_b32 v32, v248
    v_mov_b32 v33, v249
    v_mov_b32 v34, v250
    v_mov_b32 v35, v251
    s_nop 1
    v_permlane32_swap_b32 v248, v32
    v_permlane32_swap_b32 v249, v33
    v_permlane32_swap_b32 v250, v34
    v_permlane32_swap_b32 v251, v35
    v_max_f32 v248, v248, v32
    v_max_f32 v249, v249, v33
    v_max_f32 v250, v250, v34
    v_max_f32 v251, v251, v35
    v_mov_b32 v32, v248
    v_mov_b32 v33, v249
    v_mov_b32 v34, v250
    v_mov_b32 v35, v251
    s_nop 1
    v_permlane16_swap_b32 v248, v32
    v_permlane16_swap_b32 v249, v33
    v_permlane16_swap_b32 v250, v34
    v_permlane16_swap_b32 v251, v35
    v_max_f32 v248, v248, v32
    v_max_f32 v249, v249, v33
    v_max_f32 v250, v250, v34
    v_max_f32 v251, v251, v35
    v_sub_f32 v40, 0, v248
    v_sub_f32 v41, 0, v248
    v_sub_f32 v42, 0, v248
    v_sub_f32 v43, 0, v248
    v_sub_f32 v44, 0, v249
    v_sub_f32 v45, 0, v249
    v_sub_f32 v46, 0, v249
    v_sub_f32 v47, 0, v249
    v_sub_f32 v48, 0, v250
    v_sub_f32 v49, 0, v250
    v_sub_f32 v50, 0, v250
    v_sub_f32 v51, 0, v250
    v_sub_f32 v52, 0, v251
    v_sub_f32 v53, 0, v251
    v_sub_f32 v54, 0, v251
    v_sub_f32 v55, 0, v251
    s_getpc_b64 s[54:55]
    v_mov_b32 v252, s54
    v_mov_b32 v253, s55
    s_barrier
    ds_read_b128 v[216:219], v232 offset:49152
    ds_read_b128 v[220:223], v233 offset:49152
    ds_read_b128 v[224:227], v234 offset:49152
    ds_read_b128 v[228:231], v235 offset:49152
    s_waitcnt lgkmcnt(0)
L_k2_last:
    s_branch L_k2_attn
.section .rodata,"a"
.p2align 6
.amdhsa_kernel ln_kernel
  .amdhsa_next_free_vgpr 56
  .amdhsa_next_free_sgpr 40
  .amdhsa_accum_offset 56
  .amdhsa_group_segment_fixed_size 0
  .amdhsa_kernarg_size 96
  .amdhsa_user_sgpr_count 2
  .amdhsa_user_sgpr_kernarg_segment_ptr 1
  .amdhsa_system_sgpr_workgroup_id_x 1
.end_amdhsa_kernel
.p2align 6
.amdhsa_kernel attn_kernel
  .amdhsa_next_free_vgpr 512
  .amdhsa_next_free_sgpr 102
  .amdhsa_accum_offset 256
  .amdhsa_group_segment_fixed_size 0
  .amdhsa_kernarg_size 96
  .amdhsa_user_sgpr_count 2
  .amdhsa_user_sgpr_kernarg_segment_ptr 1
  .amdhsa_system_sgpr_workgroup_id_x 1
.end_amdhsa_kernel
```
